```python
import torch

def _softmax(x, axis=-1):
    return torch.softmax(x, dim=axis)
def _gelu(x):
    return torch.nn.functional.gelu(x, approximate="tanh")
def _silu(x):
    return torch.nn.functional.silu(x)
def _sigmoid(x):
    return torch.sigmoid(x)
def _layernorm(x, axis=-1, eps=1e-5):
    m = x.mean(dim=axis, keepdim=True)
    v = x.var(dim=axis, keepdim=True, unbiased=False)
    return (x - m) / torch.sqrt(v + eps)
def _scatter_add(tgt, idx, src, axis=0):
    return tgt.clone().index_add_(axis, idx, src)
def _segment_sum(src, seg, n):
    out = torch.zeros((n,) + src.shape[1:], dtype=src.dtype)
    return out.index_add_(0, seg, src)
def _pad(x, pw):
    flat = tuple(v for pair in reversed(pw) for v in pair)
    return torch.nn.functional.pad(x, flat)

kernel_name = 'gated_mix__sliding_block__dense_activation_relu__prompt'

def setup_inputs():

    _w = (lambda a: (lambda t: t.to(torch.bfloat16) if t.is_floating_point() else t)(torch.as_tensor(a)))
    def _A_setup():
        B, S, D = 1, 2048, 1024
        return {
            "x": _w((lambda *s: torch.randn(*s, dtype=torch.bfloat16) * 0.05)(B, S, D)),
            "wqkv": _w((lambda *s: torch.randn(*s, dtype=torch.bfloat16) * 0.8)(D, 3 * D)),
            "wo": _w((lambda *s: torch.randn(*s, dtype=torch.bfloat16) * 0.05)(D, D)),
        }
    _A_in = _A_setup()

    def _B_setup():
        B, S, D, Dff = 1, 2048, 1024, 3584
        return {
            "x": _w((lambda *s: torch.randn(*s, dtype=torch.bfloat16) * 0.05)(B, S, D)),
            "w1": _w((lambda *s: torch.randn(*s, dtype=torch.bfloat16) * 0.05)(D, Dff)),
            "w2": _w((lambda *s: torch.randn(*s, dtype=torch.bfloat16) * 0.05)(Dff, D)),
        }
    _B_in = _B_setup()

    return {
        "A_x": _A_in["x"],
        "A_wqkv": _A_in["wqkv"],
        "A_wo": _A_in["wo"],
        "B_x": _B_in["x"],
        "B_w1": _B_in["w1"],
        "B_w2": _B_in["w2"],
        "gate_w": _w((lambda *s: torch.randn(*s, dtype=torch.bfloat16) * 0.05)(1024) * 16.0),
    }

def reference(A_x, A_wqkv, A_wo, B_x, B_w1, B_w2, gate_w):
    def _A_ref(x, wqkv, wo):
        B, S, D = x.shape
        H = 32; Dh = D // H; W = 256
        qkv = (lambda x, *d: x.permute(*d))((x @ wqkv).reshape(B, S, 3, H, Dh), 2, 0, 3, 1, 4)
        q, k, v = qkv[0], qkv[1], qkv[2]
        scores = torch.einsum("bhqd,bhkd->bhqk", q, k) * (Dh ** -0.5)
        idx = torch.arange(S)
        mask = (idx[:, None] - idx[None, :] >= 0) & (idx[:, None] - idx[None, :] < W)
        scores = torch.where(mask[None, None], scores, -1e9)
        p = _softmax(scores, axis=-1)
        o = torch.einsum("bhqk,bhkd->bhqd", p, v)
        return (lambda x, *d: x.permute(*d))(o, 0, 2, 1, 3).reshape(B, S, D) @ wo

    def _B_ref(x, w1, w2):
        h = torch.einsum("bsd,df->bsf", x, w1)
        zero = torch.zeros_like(h)
        h = torch.maximum(h, zero)
        return torch.einsum("bsf,fd->bsd", h, w2)

    x = A_x
    g = _sigmoid((x * gate_w).sum(-1, keepdims=True))
    a = _A_ref(x, A_wqkv, A_wo)
    b = _B_ref(x, B_w1, B_w2)
    return g * a + (1 - g) * b
```

```asm
; @launch kernel=fused_kernel grid=(256,1,1) block=(512,1,1) lds=163840
.amdgcn_target "amdgcn-amd-amdhsa--gfx950"
.text
.globl fused_kernel
.p2align 12
.type fused_kernel,@function
fused_kernel:
    s_cmp_ge_u32 s2, 256
    s_cbranch_scc1 fused_kernel_end
    s_load_dwordx16 s[64:79], s[0:1], 0
    s_load_dwordx4 s[80:83], s[0:1], 64
    s_getpc_b64 s[16:17]
fused_kernel_pc:
    v_lshrrev_b32 v1, 4, v0
    v_and_b32 v2, 15, v0
    s_lshl_b32 s40, s2, 4
    v_lshlrev_b32 v1, 12, v1
    s_and_b32 s40, s40, 0xf80
    v_lshl_add_u32 v1, v2, 24, v1
    s_and_b32 s17, s17, 0xffff
    s_mov_b32 s18, fused_kernel_last-fused_kernel_pc
    s_mov_b32 s19, 0x20000
    buffer_load_dword v2, v1, s[16:19], s40 offen
    v_lshrrev_b32 v1, 6, v0
    v_and_b32 v120, 63, v0
    s_and_b32 s40, s2, 7
    v_readfirstlane_b32 s21, v1
    s_lshr_b32 s41, s2, 3
    s_and_b32 s28, s40, 1
    s_lshl_b32 s46, s41, 1
    s_add_u32 s46, s46, s28
    s_lshl_b32 s28, s28, 2
    s_and_b32 s42, s41, 3
    s_add_u32 s28, s28, s42
    s_lshr_b32 s43, s40, 1
    s_lshl_b32 s29, s43, 3
    s_lshr_b32 s42, s41, 2
    s_add_u32 s29, s29, s42
    s_and_b32 s20, s21, 3
    s_lshl_b32 s55, s20, 13
    v_lshrrev_b32 v122, 3, v120
    v_and_b32 v123, 7, v120
    v_xor_b32 v123, v123, v122
    v_lshlrev_b32 v122, 11, v122
    v_lshl_add_u32 v122, v123, 4, v122
    s_lshl_b32 s44, s28, 19
    v_add_u32 v112, s44, v122
    v_add_u32 v113, 15360, v112
    v_add_u32 v114, 30720, v112
    v_add_u32 v115, 46080, v112
    s_mov_b32 s7, 0x20000
    s_mov_b32 s11, 0x20000
    s_mov_b32 s6, 4194304
    s_mov_b32 s24, 0
    s_lshl_b32 s23, s20, 16
    s_lshl_b32 s47, s46, 2
    s_add_u32 s47, s47, s20
    v_lshlrev_b32 v158, 4, v120
    s_cmp_ge_u32 s21, 4
    s_cbranch_scc1 fused_kernel_A
    s_mov_b32 s10, 6291456
    s_mov_b32 s19, 0x20000
    s_cmp_ge_u32 s20, 2
    s_cbranch_scc1 fused_kernel_pa2
    s_cmp_eq_u32 s20, 1
    s_cbranch_scc1 fused_kernel_pa1
    v_and_b32 v122, 15, v120
    v_lshrrev_b32 v123, 4, v120
    v_mov_b32 v127, 1073741824
    v_lshrrev_b32 v124, 2, v122
    v_and_b32 v125, 3, v122
    v_lshlrev_b32 v124, 11, v124
    v_lshl_add_u32 v124, v125, 7, v124
    s_lshl_b32 s42, s43, 9
    v_cmp_gt_u32 vcc, 12, v122
    v_add_u32 v124, s42, v124
    v_lshl_add_u32 v125, v123, 5, s41
    s_add_u32 s42, s46, 4294967232
    v_cndmask_b32 v124, v127, v124, vcc
    v_cmp_gt_u32 vcc, 2, v123
    v_lshl_add_u32 v126, v123, 6, s42
    s_nop 0
    v_cndmask_b32 v125, v126, v125, vcc
    v_cmp_gt_u32 vcc, 4, v123
    v_mul_u32_u24 v125, 6144, v125
    v_add_u32 v125, v125, v124
    v_cndmask_b32 v121, v127, v125, vcc
    s_mov_b32 s18, s10
    s_waitcnt lgkmcnt(0)
    s_mov_b32 s16, s66
    s_and_b32 s17, s67, 0xffff
    s_branch fused_kernel_pb
fused_kernel_pa1:
    v_and_b32 v122, 31, v120
    v_lshlrev_b32 v122, 11, v122
    v_lshrrev_b32 v123, 5, v120
    v_lshl_add_u32 v122, v123, 7, v122
    s_and_b32 s44, s2, 1
    s_lshl_b32 s44, s44, 21
    s_lshl_b32 s42, s41, 16
    s_add_u32 s44, s44, s42
    v_add_u32 v121, s44, v122
    s_branch fused_kernel_pax
fused_kernel_pa2:
    s_cmp_eq_u32 s20, 3
    s_cbranch_scc1 fused_kernel_pa3
    v_and_b32 v122, 7, v120
    v_lshlrev_b32 v122, 11, v122
    v_lshrrev_b32 v123, 3, v120
    v_lshl_add_u32 v122, v123, 7, v122
    s_lshl_b32 s44, s28, 19
    s_lshl_b32 s42, s29, 14
    s_add_u32 s44, s44, s42
    s_add_u32 s44, s44, 256
    v_cmp_gt_u32 vcc, 2, v123
    v_add_u32 v122, s44, v122
    v_mov_b32 v123, 1073741824
    v_cndmask_b32 v121, v123, v122, vcc
fused_kernel_pax:
    s_mov_b32 s18, s6
    s_waitcnt lgkmcnt(0)
    s_mov_b32 s16, s64
    s_and_b32 s17, s65, 0xffff
    s_branch fused_kernel_pb
fused_kernel_pa3:
    v_and_b32 v122, 15, v120
    v_lshrrev_b32 v123, 4, v120
    v_mov_b32 v127, 1073741824
    v_lshlrev_b32 v124, 7, v122
    s_mul_i32 s42, s43, 1792
    v_cmp_gt_u32 vcc, 14, v122
    v_add_u32 v124, s42, v124
    v_lshl_add_u32 v125, v123, 5, s41
    s_add_u32 s42, s46, 4294967232
    v_cndmask_b32 v124, v127, v124, vcc
    v_cmp_gt_u32 vcc, 2, v123
    v_lshl_add_u32 v126, v123, 6, s42
    s_nop 0
    v_cndmask_b32 v125, v126, v125, vcc
    v_cmp_gt_u32 vcc, 4, v123
    v_mul_u32_u24 v125, 7168, v125
    v_add_u32 v125, v125, v124
    v_cndmask_b32 v121, v127, v125, vcc
    s_mov_b32 s18, 7340032
    s_waitcnt lgkmcnt(0)
    s_mov_b32 s16, s72
    s_and_b32 s17, s73, 0xffff
fused_kernel_pb:
    buffer_load_dword v150, v121, s[16:19], 0 offen
    s_mov_b32 s4, s64
    s_and_b32 s5, s65, 0xffff
    s_mov_b32 s8, s66
    s_and_b32 s9, s67, 0xffff
    s_add_u32 m0, s55, 4096
    s_nop 0
    buffer_load_dwordx4 v112, s[4:7], s23 offen offset:0 lds
    buffer_load_dwordx4 v113, s[4:7], s23 offen offset:1024 lds
    buffer_load_dwordx4 v114, s[4:7], s23 offen offset:2048 lds
    buffer_load_dwordx4 v115, s[4:7], s23 offen offset:3072 lds
    s_add_u32 s23, s23, 128
    v_lshrrev_b32 v122, 2, v120
    v_and_b32 v123, 3, v120
    v_and_b32 v125, 3, v122
    v_bfe_u32 v126, v122, 2, 1
    v_lshl_add_u32 v125, v126, 3, v125
    v_bfe_u32 v127, v122, 3, 1
    v_lshl_add_u32 v125, v127, 2, v125
    v_mul_u32_u24 v125, 6144, v125
    v_lshlrev_b32 v126, 1, v126
    v_xor_b32 v124, v123, v126
    v_lshl_add_u32 v125, v124, 4, v125
    s_lshl_b32 s42, s29, 6
    s_mul_i32 s44, s20, 98304
    s_add_u32 s42, s42, s44
    v_add_u32 v116, s42, v125
    v_add_u32 v117, 1024, v116
    v_add_u32 v118, 2048, v116
    s_mul_i32 s32, s20, 3072
    s_add_u32 s32, s32, 126976
    s_add_u32 m0, s32, 0
    s_nop 0
    buffer_load_dwordx4 v116, s[8:11], s24 offen offset:0 lds
    buffer_load_dwordx4 v117, s[8:11], s24 offen offset:1024 lds
    buffer_load_dwordx4 v118, s[8:11], s24 offen offset:2048 lds
    s_add_u32 s24, s24, 393216
    s_lshl_b32 s40, s47, 7
    s_lshl_b32 s22, s43, 19
    s_add_u32 s22, s22, s40
    s_mul_i32 s25, s43, 1835008
    s_add_u32 s25, s25, s40
    s_min_u32 s47, s47, 251
    s_mul_i32 s48, s47, 171
    s_lshr_b32 s48, s48, 11
    s_mul_i32 s49, s48, 12
    s_sub_u32 s49, s47, s49
    s_mul_i32 s48, s48, 6144
    s_lshr_b32 s50, s49, 2
    s_lshl_b32 s50, s50, 11
    s_add_u32 s48, s48, s50
    s_and_b32 s49, s49, 3
    s_lshl_b32 s50, s43, 2
    s_add_u32 s49, s49, s50
    s_lshl_b32 s49, s49, 7
    s_add_u32 s48, s48, s49
    s_add_u32 s48, s48, 60
    s_add_u32 s94, s66, s48
    s_addc_u32 s95, s67, 0
    s_add_u32 s94, s94, 1179648
    s_addc_u32 s95, s95, 0
    s_load_dwordx2 s[100:101], s[94:95], 0
    s_load_dwordx2 s[100:101], s[94:95], 129024
    s_load_dwordx2 s[100:101], s[94:95], 258048
    v_and_b32 v122, 15, v120
    v_lshlrev_b32 v123, 7, v122
    v_lshrrev_b32 v124, 4, v120
    v_and_b32 v125, 7, v120
    v_xor_b32 v125, v125, v124
    v_lshl_add_u32 v123, v125, 4, v123
    v_add_u32 v152, s55, v123
    v_xor_b32 v153, 64, v152
    v_add_u32 v154, 0x10000, v152
    v_add_u32 v155, 0x10000, v153
    v_bfe_u32 v125, v120, 2, 2
    v_bfe_u32 v126, v120, 4, 1
    v_lshl_add_u32 v125, v126, 2, v125
    v_lshrrev_b32 v127, 5, v120
    v_and_b32 v128, 3, v120
    v_lshlrev_b32 v128, 3, v128
    s_lshl_b32 s42, s28, 5
    s_add_u32 s42, s42, s29
    s_lshl_b32 s57, s28, 2
    s_add_u32 s57, s57, s20
    s_lshl_b32 s57, s57, 4
    s_add_u32 s57, s57, s43
    s_lshl_b32 s57, s57, 5
    s_and_b32 s41, s29, 7
    s_add_u32 s57, s57, s41
    s_lshl_b32 s57, s57, 2
    s_add_u32 s57, s57, 35667968
    s_lshl_b32 s62, s42, 2
    s_add_u32 s62, s62, s20
    s_lshl_b32 s62, s62, 11
    s_add_u32 s62, s62, 50331648
    s_lshl_b32 s3, s28, 3
    s_add_u32 s3, s3, s43
    s_lshl_b32 s3, s3, 2
    s_mov_b32 s12, s82
    s_and_b32 s13, s83, 0xffff
    s_mov_b32 s14, 67108864
    s_mov_b32 s15, 0x20000
    v_lshl_add_u32 v129, v127, 4, v125
    v_mul_u32_u24 v129, 224, v129
    v_add_u32 v129, v129, v128
    s_and_b32 s40, s29, 1
    s_lshl_b32 s41, s40, 5
    s_add_u32 s41, s41, 98304
    v_add_u32 v156, s41, v129
    s_mul_i32 s41, s40, 192
    s_sub_u32 s41, 98496, s41
    v_add_u32 v157, s41, v129
    s_mov_b32 s16, s74
    s_and_b32 s17, s75, 0xffff
    s_mov_b32 s18, 7340032
    s_mov_b32 s84, s68
    s_and_b32 s85, s69, 0xffff
    s_mov_b32 s86, 2097152
    s_mov_b32 s87, 0x20000
    s_mov_b32 s36, s80
    s_and_b32 s37, s81, 0xffff
    s_mov_b32 s38, 256
    s_mov_b32 s39, 0x20000
    s_mov_b64 exec, 0
    s_cmp_eq_u32 s20, 0
    s_cbranch_scc1 fused_kernel_pg1
    s_cmp_eq_u32 s20, 1
    s_cbranch_scc1 fused_kernel_pg2
    s_cmp_eq_u32 s20, 2
    s_cbranch_scc1 fused_kernel_pg3
    s_branch fused_kernel_pg4
fused_kernel_pgrB:
    s_mov_b64 exec, -1
    s_waitcnt vmcnt(4)
    s_add_u32 m0, s55, 69632
    s_nop 0
    buffer_load_dwordx4 v112, s[4:7], s23 offen offset:0 lds
    buffer_load_dwordx4 v113, s[4:7], s23 offen offset:1024 lds
    buffer_load_dwordx4 v114, s[4:7], s23 offen offset:2048 lds
    buffer_load_dwordx4 v115, s[4:7], s23 offen offset:3072 lds
    s_add_u32 s23, s23, 128
    s_add_u32 m0, s32, 12288
    s_nop 0
    buffer_load_dwordx4 v116, s[8:11], s24 offen offset:0 lds
    buffer_load_dwordx4 v117, s[8:11], s24 offen offset:1024 lds
    buffer_load_dwordx4 v118, s[8:11], s24 offen offset:2048 lds
    s_add_u32 s24, s24, 393216
    s_waitcnt vmcnt(10)
    s_barrier
fused_kernel_sb0:
    ds_read_b128 a[0:3], v152 offset:0
    ds_read_b128 a[16:19], v153 offset:0
    ds_read_b64_tr_b16 a[32:33], v156 offset:0
    ds_read_b64_tr_b16 a[34:35], v156 offset:1792
    ds_read_b64_tr_b16 a[36:37], v156 offset:7168
    ds_read_b64_tr_b16 a[38:39], v156 offset:8960
    ds_read_b128 a[4:7], v152 offset:2048
    ds_read_b128 a[20:23], v153 offset:2048
    ds_read_b128 a[8:11], v152 offset:4096
    ds_read_b128 a[24:27], v153 offset:4096
    ds_read_b128 a[12:15], v152 offset:6144
    ds_read_b128 a[28:31], v153 offset:6144
    ds_read_b64_tr_b16 a[40:41], v156 offset:32
    ds_read_b64_tr_b16 a[42:43], v156 offset:1824
    ds_read_b64_tr_b16 a[44:45], v156 offset:7200
    ds_read_b64_tr_b16 a[46:47], v156 offset:8992
    ds_read_b64_tr_b16 a[48:49], v156 offset:64
    ds_read_b64_tr_b16 a[50:51], v156 offset:1856
    ds_read_b64_tr_b16 a[52:53], v156 offset:7232
    ds_read_b64_tr_b16 a[54:55], v156 offset:9024
    ds_read_b64_tr_b16 a[56:57], v156 offset:96
    ds_read_b64_tr_b16 a[58:59], v156 offset:1888
    ds_read_b64_tr_b16 a[60:61], v156 offset:7264
    ds_read_b64_tr_b16 a[62:63], v156 offset:9056
    ds_read_b64_tr_b16 a[64:65], v156 offset:128
    ds_read_b64_tr_b16 a[66:67], v156 offset:1920
    ds_read_b64_tr_b16 a[68:69], v156 offset:7296
    ds_read_b64_tr_b16 a[70:71], v156 offset:9088
    ds_read_b64_tr_b16 a[72:73], v156 offset:160
    ds_read_b64_tr_b16 a[74:75], v156 offset:1952
    ds_read_b64_tr_b16 a[76:77], v156 offset:7328
    ds_read_b64_tr_b16 a[78:79], v156 offset:9120
    ds_read_b64_tr_b16 a[80:81], v157 offset:0
    ds_read_b64_tr_b16 a[82:83], v157 offset:1792
    ds_read_b64_tr_b16 a[84:85], v157 offset:7168
    ds_read_b64_tr_b16 a[86:87], v157 offset:8960
    s_waitcnt lgkmcnt(15)
    v_mfma_f32_16x16x32_bf16 v[0:3], a[32:35], a[0:3], 0
    ds_read_b32 v121, v152
    v_mfma_f32_16x16x32_bf16 v[0:3], a[36:39], a[16:19], v[0:3]
    ds_read_b32 v121, v152
    v_mfma_f32_16x16x32_bf16 v[4:7], a[36:39], a[20:23], 0
    s_add_u32 m0, s55, 36864
    s_nop 0
    buffer_load_dwordx4 v112, s[4:7], s23 offen offset:0 lds
    ds_read_b32 v121, v152
    v_mfma_f32_16x16x32_bf16 v[4:7], a[32:35], a[4:7], v[4:7]
    ds_read_b32 v121, v152
    v_mfma_f32_16x16x32_bf16 v[8:11], a[32:35], a[8:11], 0
    ds_read_b32 v121, v152
    v_mfma_f32_16x16x32_bf16 v[8:11], a[36:39], a[24:27], v[8:11]
    buffer_load_dwordx4 v113, s[4:7], s23 offen offset:1024 lds
    ds_read_b32 v121, v152
    v_mfma_f32_16x16x32_bf16 v[12:15], a[36:39], a[28:31], 0
    v_mfma_f32_16x16x32_bf16 v[12:15], a[32:35], a[12:15], v[12:15]
    v_mfma_f32_16x16x32_bf16 v[28:31], a[40:43], a[12:15], 0
    buffer_load_dwordx4 v114, s[4:7], s23 offen offset:2048 lds
    v_mfma_f32_16x16x32_bf16 v[28:31], a[44:47], a[28:31], v[28:31]
    v_mfma_f32_16x16x32_bf16 v[24:27], a[44:47], a[24:27], 0
    v_mfma_f32_16x16x32_bf16 v[24:27], a[40:43], a[8:11], v[24:27]
    buffer_load_dwordx4 v115, s[4:7], s23 offen offset:3072 lds
    s_add_u32 s23, s23, 128
    v_mfma_f32_16x16x32_bf16 v[20:23], a[40:43], a[4:7], 0
    v_mfma_f32_16x16x32_bf16 v[20:23], a[44:47], a[20:23], v[20:23]
    v_mfma_f32_16x16x32_bf16 v[16:19], a[44:47], a[16:19], 0
    v_mfma_f32_16x16x32_bf16 v[16:19], a[40:43], a[0:3], v[16:19]
    v_mfma_f32_16x16x32_bf16 v[32:35], a[48:51], a[0:3], 0
    s_waitcnt vmcnt(11) lgkmcnt(6)
    s_barrier
    v_mfma_f32_16x16x32_bf16 v[32:35], a[52:55], a[16:19], v[32:35]
    v_mfma_f32_16x16x32_bf16 v[36:39], a[52:55], a[20:23], 0
    v_mfma_f32_16x16x32_bf16 v[36:39], a[48:51], a[4:7], v[36:39]
    s_load_dwordx2 s[100:101], s[94:95], 387072
    v_mfma_f32_16x16x32_bf16 v[40:43], a[48:51], a[8:11], 0
    v_mfma_f32_16x16x32_bf16 v[40:43], a[52:55], a[24:27], v[40:43]
    s_load_dwordx2 s[100:101], s[94:95], 516096
    v_mfma_f32_16x16x32_bf16 v[44:47], a[52:55], a[28:31], 0
    v_mfma_f32_16x16x32_bf16 v[44:47], a[48:51], a[12:15], v[44:47]
    s_load_dwordx2 s[100:101], s[94:95], 645120
    v_mfma_f32_16x16x32_bf16 v[60:63], a[56:59], a[12:15], 0
    v_mfma_f32_16x16x32_bf16 v[60:63], a[60:63], a[28:31], v[60:63]
    s_load_dwordx2 s[100:101], s[94:95], 774144
    v_mfma_f32_16x16x32_bf16 v[56:59], a[60:63], a[24:27], 0
    v_mfma_f32_16x16x32_bf16 v[56:59], a[56:59], a[8:11], v[56:59]
    v_mfma_f32_16x16x32_bf16 v[52:55], a[56:59], a[4:7], 0
    v_mfma_f32_16x16x32_bf16 v[52:55], a[60:63], a[20:23], v[52:55]
    v_mfma_f32_16x16x32_bf16 v[48:51], a[60:63], a[16:19], 0
    v_mfma_f32_16x16x32_bf16 v[48:51], a[56:59], a[0:3], v[48:51]
    v_mfma_f32_16x16x32_bf16 v[64:67], a[64:67], a[0:3], 0
    v_mfma_f32_16x16x32_bf16 v[64:67], a[68:71], a[16:19], v[64:67]
    v_mfma_f32_16x16x32_bf16 v[68:71], a[68:71], a[20:23], 0
    v_mfma_f32_16x16x32_bf16 v[68:71], a[64:67], a[4:7], v[68:71]
    v_mfma_f32_16x16x32_bf16 v[72:75], a[64:67], a[8:11], 0
    v_mfma_f32_16x16x32_bf16 v[72:75], a[68:71], a[24:27], v[72:75]
    v_mfma_f32_16x16x32_bf16 v[76:79], a[68:71], a[28:31], 0
    v_mfma_f32_16x16x32_bf16 v[76:79], a[64:67], a[12:15], v[76:79]
    v_mfma_f32_16x16x32_bf16 v[92:95], a[72:75], a[12:15], 0
    v_mfma_f32_16x16x32_bf16 v[92:95], a[76:79], a[28:31], v[92:95]
    v_mfma_f32_16x16x32_bf16 v[88:91], a[76:79], a[24:27], 0
    v_mfma_f32_16x16x32_bf16 v[88:91], a[72:75], a[8:11], v[88:91]
    v_mfma_f32_16x16x32_bf16 v[84:87], a[72:75], a[4:7], 0
    v_mfma_f32_16x16x32_bf16 v[84:87], a[76:79], a[20:23], v[84:87]
    v_mfma_f32_16x16x32_bf16 v[80:83], a[76:79], a[16:19], 0
    v_mfma_f32_16x16x32_bf16 v[80:83], a[72:75], a[0:3], v[80:83]
    v_mfma_f32_16x16x32_bf16 v[96:99], a[80:83], a[0:3], 0
    v_mfma_f32_16x16x32_bf16 v[96:99], a[84:87], a[16:19], v[96:99]
    v_mfma_f32_16x16x32_bf16 v[100:103], a[84:87], a[20:23], 0
    v_mfma_f32_16x16x32_bf16 v[100:103], a[80:83], a[4:7], v[100:103]
    s_setprio 2
    s_waitcnt vmcnt(7)
    s_barrier
    v_mfma_f32_16x16x32_bf16 v[104:107], a[80:83], a[8:11], 0
    v_mfma_f32_16x16x32_bf16 v[104:107], a[84:87], a[24:27], v[104:107]
    v_mfma_f32_16x16x32_bf16 v[108:111], a[84:87], a[28:31], 0
    v_mfma_f32_16x16x32_bf16 v[108:111], a[80:83], a[12:15], v[108:111]
    s_setprio 0
fused_kernel_sb1:
    ds_read_b128 a[0:3], v154 offset:0
    ds_read_b128 a[16:19], v155 offset:0
    s_add_u32 m0, s55, 4096
    s_nop 0
    buffer_load_dwordx4 v112, s[4:7], s23 offen offset:0 lds
    ds_read_b128 a[4:7], v154 offset:2048
    ds_read_b128 a[20:23], v155 offset:2048
    ds_read_b128 a[8:11], v154 offset:4096
    ds_read_b128 a[24:27], v155 offset:4096
    buffer_load_dwordx4 v113, s[4:7], s23 offen offset:1024 lds
    ds_read_b128 a[12:15], v154 offset:6144
    ds_read_b128 a[28:31], v155 offset:6144
    ds_read_b64_tr_b16 a[32:33], v156 offset:14336
    ds_read_b64_tr_b16 a[34:35], v156 offset:16128
    ds_read_b64_tr_b16 a[36:37], v156 offset:21504
    buffer_load_dwordx4 v114, s[4:7], s23 offen offset:2048 lds
    ds_read_b64_tr_b16 a[38:39], v156 offset:23296
    ds_read_b64_tr_b16 a[40:41], v156 offset:14368
    ds_read_b64_tr_b16 a[42:43], v156 offset:16160
    ds_read_b64_tr_b16 a[44:45], v156 offset:21536
    buffer_load_dwordx4 v115, s[4:7], s23 offen offset:3072 lds
    s_add_u32 s23, s23, 128
    ds_read_b64_tr_b16 a[46:47], v156 offset:23328
    ds_read_b64_tr_b16 a[48:49], v156 offset:14400
    ds_read_b64_tr_b16 a[50:51], v156 offset:16192
    ds_read_b64_tr_b16 a[52:53], v156 offset:21568
    ds_read_b64_tr_b16 a[54:55], v156 offset:23360
    s_add_u32 m0, s32, 0
    s_nop 0
    buffer_load_dwordx4 v116, s[8:11], s24 offen offset:0 lds
    ds_read_b64_tr_b16 a[56:57], v156 offset:14432
    ds_read_b64_tr_b16 a[58:59], v156 offset:16224
    ds_read_b64_tr_b16 a[60:61], v156 offset:21600
    ds_read_b64_tr_b16 a[62:63], v156 offset:23392
    buffer_load_dwordx4 v117, s[8:11], s24 offen offset:1024 lds
    ds_read_b64_tr_b16 a[64:65], v156 offset:14464
    ds_read_b64_tr_b16 a[66:67], v156 offset:16256
    ds_read_b64_tr_b16 a[68:69], v156 offset:21632
    ds_read_b64_tr_b16 a[70:71], v156 offset:23424
    ds_read_b64_tr_b16 a[72:73], v156 offset:14496
    buffer_load_dwordx4 v118, s[8:11], s24 offen offset:2048 lds
    s_add_u32 s24, s24, 393216
    ds_read_b64_tr_b16 a[74:75], v156 offset:16288
    ds_read_b64_tr_b16 a[76:77], v156 offset:21664
    ds_read_b64_tr_b16 a[78:79], v156 offset:23456
    ds_read_b64_tr_b16 a[80:81], v157 offset:14336
    ds_read_b64_tr_b16 a[82:83], v157 offset:16128
    ds_read_b64_tr_b16 a[84:85], v157 offset:21504
    ds_read_b64_tr_b16 a[86:87], v157 offset:23296
    ds_read_b32 v121, v152
    ds_read_b32 v121, v152
    ds_read_b32 v121, v152
    ds_read_b32 v121, v152
    ds_read_b32 v121, v152
    ds_read_b32 v121, v152
    ds_read_b32 v121, v152
    ds_read_b32 v121, v152
    s_waitcnt vmcnt(11) lgkmcnt(8)
    s_barrier
    v_mfma_f32_16x16x32_bf16 v[0:3], a[32:35], a[0:3], v[0:3]
    v_mfma_f32_16x16x32_bf16 v[0:3], a[36:39], a[16:19], v[0:3]
    v_mfma_f32_16x16x32_bf16 v[4:7], a[36:39], a[20:23], v[4:7]
    s_load_dwordx2 s[100:101], s[94:95], 903168
    v_mfma_f32_16x16x32_bf16 v[4:7], a[32:35], a[4:7], v[4:7]
    v_mfma_f32_16x16x32_bf16 v[8:11], a[32:35], a[8:11], v[8:11]
    s_load_dwordx2 s[100:101], s[94:95], 1032192
    v_mfma_f32_16x16x32_bf16 v[8:11], a[36:39], a[24:27], v[8:11]
    v_mfma_f32_16x16x32_bf16 v[12:15], a[36:39], a[28:31], v[12:15]
    s_add_u32 s94, s94, 1161216
    s_addc_u32 s95, s95, 0
    s_load_dwordx2 s[100:101], s[94:95], 0
    v_mfma_f32_16x16x32_bf16 v[12:15], a[32:35], a[12:15], v[12:15]
    v_mfma_f32_16x16x32_bf16 v[28:31], a[40:43], a[12:15], v[28:31]
    s_load_dwordx2 s[100:101], s[94:95], 129024
    v_mfma_f32_16x16x32_bf16 v[28:31], a[44:47], a[28:31], v[28:31]
    v_mfma_f32_16x16x32_bf16 v[24:27], a[44:47], a[24:27], v[24:27]
    v_mfma_f32_16x16x32_bf16 v[24:27], a[40:43], a[8:11], v[24:27]
    v_mfma_f32_16x16x32_bf16 v[20:23], a[40:43], a[4:7], v[20:23]
    v_mfma_f32_16x16x32_bf16 v[20:23], a[44:47], a[20:23], v[20:23]
    v_mfma_f32_16x16x32_bf16 v[16:19], a[44:47], a[16:19], v[16:19]
    v_mfma_f32_16x16x32_bf16 v[16:19], a[40:43], a[0:3], v[16:19]
    v_mfma_f32_16x16x32_bf16 v[32:35], a[48:51], a[0:3], v[32:35]
    v_mfma_f32_16x16x32_bf16 v[32:35], a[52:55], a[16:19], v[32:35]
    v_mfma_f32_16x16x32_bf16 v[36:39], a[52:55], a[20:23], v[36:39]
    v_mfma_f32_16x16x32_bf16 v[36:39], a[48:51], a[4:7], v[36:39]
    v_mfma_f32_16x16x32_bf16 v[40:43], a[48:51], a[8:11], v[40:43]
    v_mfma_f32_16x16x32_bf16 v[40:43], a[52:55], a[24:27], v[40:43]
    v_mfma_f32_16x16x32_bf16 v[44:47], a[52:55], a[28:31], v[44:47]
    v_mfma_f32_16x16x32_bf16 v[44:47], a[48:51], a[12:15], v[44:47]
    v_mfma_f32_16x16x32_bf16 v[60:63], a[56:59], a[12:15], v[60:63]
    v_mfma_f32_16x16x32_bf16 v[60:63], a[60:63], a[28:31], v[60:63]
    v_mfma_f32_16x16x32_bf16 v[56:59], a[60:63], a[24:27], v[56:59]
    v_mfma_f32_16x16x32_bf16 v[56:59], a[56:59], a[8:11], v[56:59]
    v_mfma_f32_16x16x32_bf16 v[52:55], a[56:59], a[4:7], v[52:55]
    v_mfma_f32_16x16x32_bf16 v[52:55], a[60:63], a[20:23], v[52:55]
    v_mfma_f32_16x16x32_bf16 v[48:51], a[60:63], a[16:19], v[48:51]
    v_mfma_f32_16x16x32_bf16 v[48:51], a[56:59], a[0:3], v[48:51]
    v_mfma_f32_16x16x32_bf16 v[64:67], a[64:67], a[0:3], v[64:67]
    v_mfma_f32_16x16x32_bf16 v[64:67], a[68:71], a[16:19], v[64:67]
    v_mfma_f32_16x16x32_bf16 v[68:71], a[68:71], a[20:23], v[68:71]
    v_mfma_f32_16x16x32_bf16 v[68:71], a[64:67], a[4:7], v[68:71]
    v_mfma_f32_16x16x32_bf16 v[72:75], a[64:67], a[8:11], v[72:75]
    v_mfma_f32_16x16x32_bf16 v[72:75], a[68:71], a[24:27], v[72:75]
    v_mfma_f32_16x16x32_bf16 v[76:79], a[68:71], a[28:31], v[76:79]
    v_mfma_f32_16x16x32_bf16 v[76:79], a[64:67], a[12:15], v[76:79]
    v_mfma_f32_16x16x32_bf16 v[92:95], a[72:75], a[12:15], v[92:95]
    v_mfma_f32_16x16x32_bf16 v[92:95], a[76:79], a[28:31], v[92:95]
    v_mfma_f32_16x16x32_bf16 v[88:91], a[76:79], a[24:27], v[88:91]
    v_mfma_f32_16x16x32_bf16 v[88:91], a[72:75], a[8:11], v[88:91]
    v_mfma_f32_16x16x32_bf16 v[84:87], a[72:75], a[4:7], v[84:87]
    v_mfma_f32_16x16x32_bf16 v[84:87], a[76:79], a[20:23], v[84:87]
    v_mfma_f32_16x16x32_bf16 v[80:83], a[76:79], a[16:19], v[80:83]
    v_mfma_f32_16x16x32_bf16 v[80:83], a[72:75], a[0:3], v[80:83]
    v_mfma_f32_16x16x32_bf16 v[96:99], a[80:83], a[0:3], v[96:99]
    v_mfma_f32_16x16x32_bf16 v[96:99], a[84:87], a[16:19], v[96:99]
    v_mfma_f32_16x16x32_bf16 v[100:103], a[84:87], a[20:23], v[100:103]
    v_mfma_f32_16x16x32_bf16 v[100:103], a[80:83], a[4:7], v[100:103]
    s_setprio 2
    s_waitcnt vmcnt(7)
    s_barrier
    v_mfma_f32_16x16x32_bf16 v[104:107], a[80:83], a[8:11], v[104:107]
    v_mfma_f32_16x16x32_bf16 v[104:107], a[84:87], a[24:27], v[104:107]
    v_mfma_f32_16x16x32_bf16 v[108:111], a[84:87], a[28:31], v[108:111]
    v_mfma_f32_16x16x32_bf16 v[108:111], a[80:83], a[12:15], v[108:111]
    s_setprio 0
fused_kernel_sb2:
    ds_read_b128 a[0:3], v152 offset:32768
    ds_read_b128 a[16:19], v153 offset:32768
    s_add_u32 m0, s55, 69632
    s_nop 0
    buffer_load_dwordx4 v112, s[4:7], s23 offen offset:0 lds
    ds_read_b128 a[4:7], v152 offset:34816
    ds_read_b128 a[20:23], v153 offset:34816
    ds_read_b128 a[8:11], v152 offset:36864
    ds_read_b128 a[24:27], v153 offset:36864
    buffer_load_dwordx4 v113, s[4:7], s23 offen offset:1024 lds
    ds_read_b128 a[12:15], v152 offset:38912
    ds_read_b128 a[28:31], v153 offset:38912
    ds_read_b64_tr_b16 a[32:33], v156 offset:0
    ds_read_b64_tr_b16 a[34:35], v156 offset:1792
    ds_read_b64_tr_b16 a[36:37], v156 offset:7168
    buffer_load_dwordx4 v114, s[4:7], s23 offen offset:2048 lds
    ds_read_b64_tr_b16 a[38:39], v156 offset:8960
    ds_read_b64_tr_b16 a[40:41], v156 offset:32
    ds_read_b64_tr_b16 a[42:43], v156 offset:1824
    ds_read_b64_tr_b16 a[44:45], v156 offset:7200
    buffer_load_dwordx4 v115, s[4:7], s23 offen offset:3072 lds
    s_add_u32 s23, s23, 128
    ds_read_b64_tr_b16 a[46:47], v156 offset:8992
    ds_read_b64_tr_b16 a[48:49], v156 offset:64
    ds_read_b64_tr_b16 a[50:51], v156 offset:1856
    ds_read_b64_tr_b16 a[52:53], v156 offset:7232
    ds_read_b64_tr_b16 a[54:55], v156 offset:9024
    s_add_u32 m0, s32, 12288
    s_nop 0
    buffer_load_dwordx4 v116, s[8:11], s24 offen offset:0 lds
    ds_read_b64_tr_b16 a[56:57], v156 offset:96
    ds_read_b64_tr_b16 a[58:59], v156 offset:1888
    ds_read_b64_tr_b16 a[60:61], v156 offset:7264
    ds_read_b64_tr_b16 a[62:63], v156 offset:9056
    buffer_load_dwordx4 v117, s[8:11], s24 offen offset:1024 lds
    ds_read_b64_tr_b16 a[64:65], v156 offset:128
    ds_read_b64_tr_b16 a[66:67], v156 offset:1920
    ds_read_b64_tr_b16 a[68:69], v156 offset:7296
    ds_read_b64_tr_b16 a[70:71], v156 offset:9088
    ds_read_b64_tr_b16 a[72:73], v156 offset:160
    buffer_load_dwordx4 v118, s[8:11], s24 offen offset:2048 lds
    s_add_u32 s24, s24, 393216
    ds_read_b64_tr_b16 a[74:75], v156 offset:1952
    ds_read_b64_tr_b16 a[76:77], v156 offset:7328
    ds_read_b64_tr_b16 a[78:79], v156 offset:9120
    ds_read_b64_tr_b16 a[80:81], v157 offset:0
    ds_read_b64_tr_b16 a[82:83], v157 offset:1792
    ds_read_b64_tr_b16 a[84:85], v157 offset:7168
    ds_read_b64_tr_b16 a[86:87], v157 offset:8960
    ds_read_b32 v121, v152
    ds_read_b32 v121, v152
    ds_read_b32 v121, v152
    ds_read_b32 v121, v152
    ds_read_b32 v121, v152
    ds_read_b32 v121, v152
    ds_read_b32 v121, v152
    ds_read_b32 v121, v152
    s_waitcnt vmcnt(7) lgkmcnt(8)
    s_barrier
    v_mfma_f32_16x16x32_bf16 v[0:3], a[32:35], a[0:3], v[0:3]
    v_mfma_f32_16x16x32_bf16 v[0:3], a[36:39], a[16:19], v[0:3]
    v_mfma_f32_16x16x32_bf16 v[4:7], a[36:39], a[20:23], v[4:7]
    s_load_dwordx2 s[100:101], s[94:95], 258048
    v_mfma_f32_16x16x32_bf16 v[4:7], a[32:35], a[4:7], v[4:7]
    v_mfma_f32_16x16x32_bf16 v[8:11], a[32:35], a[8:11], v[8:11]
    s_load_dwordx2 s[100:101], s[94:95], 387072
    v_mfma_f32_16x16x32_bf16 v[8:11], a[36:39], a[24:27], v[8:11]
    v_mfma_f32_16x16x32_bf16 v[12:15], a[36:39], a[28:31], v[12:15]
    s_load_dwordx2 s[100:101], s[94:95], 516096
    v_mfma_f32_16x16x32_bf16 v[12:15], a[32:35], a[12:15], v[12:15]
    v_mfma_f32_16x16x32_bf16 v[28:31], a[40:43], a[12:15], v[28:31]
    s_load_dwordx2 s[100:101], s[94:95], 645120
    v_mfma_f32_16x16x32_bf16 v[28:31], a[44:47], a[28:31], v[28:31]
    v_mfma_f32_16x16x32_bf16 v[24:27], a[44:47], a[24:27], v[24:27]
    v_mfma_f32_16x16x32_bf16 v[24:27], a[40:43], a[8:11], v[24:27]
    v_mfma_f32_16x16x32_bf16 v[20:23], a[40:43], a[4:7], v[20:23]
    v_mfma_f32_16x16x32_bf16 v[20:23], a[44:47], a[20:23], v[20:23]
    v_mfma_f32_16x16x32_bf16 v[16:19], a[44:47], a[16:19], v[16:19]
    v_mfma_f32_16x16x32_bf16 v[16:19], a[40:43], a[0:3], v[16:19]
    v_mfma_f32_16x16x32_bf16 v[32:35], a[48:51], a[0:3], v[32:35]
    v_mfma_f32_16x16x32_bf16 v[32:35], a[52:55], a[16:19], v[32:35]
    v_mfma_f32_16x16x32_bf16 v[36:39], a[52:55], a[20:23], v[36:39]
    v_mfma_f32_16x16x32_bf16 v[36:39], a[48:51], a[4:7], v[36:39]
    v_mfma_f32_16x16x32_bf16 v[40:43], a[48:51], a[8:11], v[40:43]
    v_mfma_f32_16x16x32_bf16 v[40:43], a[52:55], a[24:27], v[40:43]
    v_mfma_f32_16x16x32_bf16 v[44:47], a[52:55], a[28:31], v[44:47]
    v_mfma_f32_16x16x32_bf16 v[44:47], a[48:51], a[12:15], v[44:47]
    v_mfma_f32_16x16x32_bf16 v[60:63], a[56:59], a[12:15], v[60:63]
    v_mfma_f32_16x16x32_bf16 v[60:63], a[60:63], a[28:31], v[60:63]
    v_mfma_f32_16x16x32_bf16 v[56:59], a[60:63], a[24:27], v[56:59]
fused_kernel_pg1:
    s_cbranch_execz fused_kernel_pg9
    v_mfma_f32_16x16x32_bf16 v[56:59], a[56:59], a[8:11], v[56:59]
    v_mfma_f32_16x16x32_bf16 v[52:55], a[56:59], a[4:7], v[52:55]
    v_mfma_f32_16x16x32_bf16 v[52:55], a[60:63], a[20:23], v[52:55]
    v_mfma_f32_16x16x32_bf16 v[48:51], a[60:63], a[16:19], v[48:51]
    v_mfma_f32_16x16x32_bf16 v[48:51], a[56:59], a[0:3], v[48:51]
    v_mfma_f32_16x16x32_bf16 v[64:67], a[64:67], a[0:3], v[64:67]
    v_mfma_f32_16x16x32_bf16 v[64:67], a[68:71], a[16:19], v[64:67]
    v_mfma_f32_16x16x32_bf16 v[68:71], a[68:71], a[20:23], v[68:71]
    v_mfma_f32_16x16x32_bf16 v[68:71], a[64:67], a[4:7], v[68:71]
    v_mfma_f32_16x16x32_bf16 v[72:75], a[64:67], a[8:11], v[72:75]
    v_mfma_f32_16x16x32_bf16 v[72:75], a[68:71], a[24:27], v[72:75]
    v_mfma_f32_16x16x32_bf16 v[76:79], a[68:71], a[28:31], v[76:79]
    v_mfma_f32_16x16x32_bf16 v[76:79], a[64:67], a[12:15], v[76:79]
    v_mfma_f32_16x16x32_bf16 v[92:95], a[72:75], a[12:15], v[92:95]
    v_mfma_f32_16x16x32_bf16 v[92:95], a[76:79], a[28:31], v[92:95]
    v_mfma_f32_16x16x32_bf16 v[88:91], a[76:79], a[24:27], v[88:91]
    v_mfma_f32_16x16x32_bf16 v[88:91], a[72:75], a[8:11], v[88:91]
    v_mfma_f32_16x16x32_bf16 v[84:87], a[72:75], a[4:7], v[84:87]
    v_mfma_f32_16x16x32_bf16 v[84:87], a[76:79], a[20:23], v[84:87]
    v_mfma_f32_16x16x32_bf16 v[80:83], a[76:79], a[16:19], v[80:83]
    v_mfma_f32_16x16x32_bf16 v[80:83], a[72:75], a[0:3], v[80:83]
    v_mfma_f32_16x16x32_bf16 v[96:99], a[80:83], a[0:3], v[96:99]
    v_mfma_f32_16x16x32_bf16 v[96:99], a[84:87], a[16:19], v[96:99]
    v_mfma_f32_16x16x32_bf16 v[100:103], a[84:87], a[20:23], v[100:103]
    v_mfma_f32_16x16x32_bf16 v[100:103], a[80:83], a[4:7], v[100:103]
    s_setprio 2
    s_barrier
    v_mfma_f32_16x16x32_bf16 v[104:107], a[80:83], a[8:11], v[104:107]
    v_mfma_f32_16x16x32_bf16 v[104:107], a[84:87], a[24:27], v[104:107]
    v_mfma_f32_16x16x32_bf16 v[108:111], a[84:87], a[28:31], v[108:111]
    v_mfma_f32_16x16x32_bf16 v[108:111], a[80:83], a[12:15], v[108:111]
    s_setprio 0
fused_kernel_sb3:
    ds_read_b128 a[0:3], v152 offset:0
    ds_read_b128 a[16:19], v153 offset:0
    s_add_u32 m0, s55, 36864
    s_nop 0
    buffer_load_dwordx4 v112, s[4:7], s23 offen offset:0 lds
    ds_read_b128 a[4:7], v152 offset:2048
    ds_read_b128 a[20:23], v153 offset:2048
    ds_read_b128 a[8:11], v152 offset:4096
    ds_read_b128 a[24:27], v153 offset:4096
    buffer_load_dwordx4 v113, s[4:7], s23 offen offset:1024 lds
    ds_read_b128 a[12:15], v152 offset:6144
    ds_read_b128 a[28:31], v153 offset:6144
    ds_read_b64_tr_b16 a[32:33], v156 offset:14336
    ds_read_b64_tr_b16 a[34:35], v156 offset:16128
    ds_read_b64_tr_b16 a[36:37], v156 offset:21504
    buffer_load_dwordx4 v114, s[4:7], s23 offen offset:2048 lds
    ds_read_b64_tr_b16 a[38:39], v156 offset:23296
    ds_read_b64_tr_b16 a[40:41], v156 offset:14368
    ds_read_b64_tr_b16 a[42:43], v156 offset:16160
    ds_read_b64_tr_b16 a[44:45], v156 offset:21536
    buffer_load_dwordx4 v115, s[4:7], s23 offen offset:3072 lds
    s_add_u32 s23, s23, 128
    ds_read_b64_tr_b16 a[46:47], v156 offset:23328
    ds_read_b64_tr_b16 a[48:49], v156 offset:14400
    ds_read_b64_tr_b16 a[50:51], v156 offset:16192
    ds_read_b64_tr_b16 a[52:53], v156 offset:21568
    ds_read_b64_tr_b16 a[54:55], v156 offset:23360
    s_add_u32 m0, s32, 0
    s_nop 0
    buffer_load_dwordx4 v116, s[8:11], s24 offen offset:0 lds
    ds_read_b64_tr_b16 a[56:57], v156 offset:14432
    ds_read_b64_tr_b16 a[58:59], v156 offset:16224
    ds_read_b64_tr_b16 a[60:61], v156 offset:21600
    ds_read_b64_tr_b16 a[62:63], v156 offset:23392
    buffer_load_dwordx4 v117, s[8:11], s24 offen offset:1024 lds
    ds_read_b64_tr_b16 a[64:65], v156 offset:14464
    ds_read_b64_tr_b16 a[66:67], v156 offset:16256
    ds_read_b64_tr_b16 a[68:69], v156 offset:21632
    ds_read_b64_tr_b16 a[70:71], v156 offset:23424
    ds_read_b64_tr_b16 a[72:73], v156 offset:14496
    buffer_load_dwordx4 v118, s[8:11], s24 offen offset:2048 lds
    s_add_u32 s24, s24, 393216
    ds_read_b64_tr_b16 a[74:75], v156 offset:16288
    ds_read_b64_tr_b16 a[76:77], v156 offset:21664
    ds_read_b64_tr_b16 a[78:79], v156 offset:23456
    ds_read_b64_tr_b16 a[80:81], v157 offset:14336
    ds_read_b64_tr_b16 a[82:83], v157 offset:16128
    ds_read_b64_tr_b16 a[84:85], v157 offset:21504
    ds_read_b64_tr_b16 a[86:87], v157 offset:23296
    ds_read_b32 v121, v152
    ds_read_b32 v121, v152
    ds_read_b32 v121, v152
    ds_read_b32 v121, v152
    ds_read_b32 v121, v152
    ds_read_b32 v121, v152
    ds_read_b32 v121, v152
    ds_read_b32 v121, v152
    s_waitcnt vmcnt(7) lgkmcnt(8)
    s_barrier
    v_mfma_f32_16x16x32_bf16 v[0:3], a[32:35], a[0:3], v[0:3]
    v_mfma_f32_16x16x32_bf16 v[0:3], a[36:39], a[16:19], v[0:3]
    v_mfma_f32_16x16x32_bf16 v[4:7], a[36:39], a[20:23], v[4:7]
    s_load_dwordx2 s[100:101], s[94:95], 774144
    v_mfma_f32_16x16x32_bf16 v[4:7], a[32:35], a[4:7], v[4:7]
    v_mfma_f32_16x16x32_bf16 v[8:11], a[32:35], a[8:11], v[8:11]
    s_load_dwordx2 s[100:101], s[94:95], 903168
    v_mfma_f32_16x16x32_bf16 v[8:11], a[36:39], a[24:27], v[8:11]
    v_mfma_f32_16x16x32_bf16 v[12:15], a[36:39], a[28:31], v[12:15]
    s_load_dwordx2 s[100:101], s[94:95], 1032192
    v_mfma_f32_16x16x32_bf16 v[12:15], a[32:35], a[12:15], v[12:15]
    v_mfma_f32_16x16x32_bf16 v[28:31], a[40:43], a[12:15], v[28:31]
    s_add_u32 s94, s94, 1161216
    s_addc_u32 s95, s95, 0
    s_load_dwordx2 s[100:101], s[94:95], 0
    v_mfma_f32_16x16x32_bf16 v[28:31], a[44:47], a[28:31], v[28:31]
    v_mfma_f32_16x16x32_bf16 v[24:27], a[44:47], a[24:27], v[24:27]
    v_mfma_f32_16x16x32_bf16 v[24:27], a[40:43], a[8:11], v[24:27]
    v_mfma_f32_16x16x32_bf16 v[20:23], a[40:43], a[4:7], v[20:23]
    v_mfma_f32_16x16x32_bf16 v[20:23], a[44:47], a[20:23], v[20:23]
    v_mfma_f32_16x16x32_bf16 v[16:19], a[44:47], a[16:19], v[16:19]
    v_mfma_f32_16x16x32_bf16 v[16:19], a[40:43], a[0:3], v[16:19]
    v_mfma_f32_16x16x32_bf16 v[32:35], a[48:51], a[0:3], v[32:35]
    v_mfma_f32_16x16x32_bf16 v[32:35], a[52:55], a[16:19], v[32:35]
    v_mfma_f32_16x16x32_bf16 v[36:39], a[52:55], a[20:23], v[36:39]
    v_mfma_f32_16x16x32_bf16 v[36:39], a[48:51], a[4:7], v[36:39]
    v_mfma_f32_16x16x32_bf16 v[40:43], a[48:51], a[8:11], v[40:43]
    v_mfma_f32_16x16x32_bf16 v[40:43], a[52:55], a[24:27], v[40:43]
    v_mfma_f32_16x16x32_bf16 v[44:47], a[52:55], a[28:31], v[44:47]
    v_mfma_f32_16x16x32_bf16 v[44:47], a[48:51], a[12:15], v[44:47]
    v_mfma_f32_16x16x32_bf16 v[60:63], a[56:59], a[12:15], v[60:63]
    v_mfma_f32_16x16x32_bf16 v[60:63], a[60:63], a[28:31], v[60:63]
    v_mfma_f32_16x16x32_bf16 v[56:59], a[60:63], a[24:27], v[56:59]
    v_mfma_f32_16x16x32_bf16 v[56:59], a[56:59], a[8:11], v[56:59]
    v_mfma_f32_16x16x32_bf16 v[52:55], a[56:59], a[4:7], v[52:55]
    v_mfma_f32_16x16x32_bf16 v[52:55], a[60:63], a[20:23], v[52:55]
    v_mfma_f32_16x16x32_bf16 v[48:51], a[60:63], a[16:19], v[48:51]
    v_mfma_f32_16x16x32_bf16 v[48:51], a[56:59], a[0:3], v[48:51]
    v_mfma_f32_16x16x32_bf16 v[64:67], a[64:67], a[0:3], v[64:67]
    v_mfma_f32_16x16x32_bf16 v[64:67], a[68:71], a[16:19], v[64:67]
    v_mfma_f32_16x16x32_bf16 v[68:71], a[68:71], a[20:23], v[68:71]
    v_mfma_f32_16x16x32_bf16 v[68:71], a[64:67], a[4:7], v[68:71]
    v_mfma_f32_16x16x32_bf16 v[72:75], a[64:67], a[8:11], v[72:75]
    v_mfma_f32_16x16x32_bf16 v[72:75], a[68:71], a[24:27], v[72:75]
    v_mfma_f32_16x16x32_bf16 v[76:79], a[68:71], a[28:31], v[76:79]
    v_mfma_f32_16x16x32_bf16 v[76:79], a[64:67], a[12:15], v[76:79]
    v_mfma_f32_16x16x32_bf16 v[92:95], a[72:75], a[12:15], v[92:95]
    v_mfma_f32_16x16x32_bf16 v[92:95], a[76:79], a[28:31], v[92:95]
    v_mfma_f32_16x16x32_bf16 v[88:91], a[76:79], a[24:27], v[88:91]
    v_mfma_f32_16x16x32_bf16 v[88:91], a[72:75], a[8:11], v[88:91]
    v_mfma_f32_16x16x32_bf16 v[84:87], a[72:75], a[4:7], v[84:87]
    v_mfma_f32_16x16x32_bf16 v[84:87], a[76:79], a[20:23], v[84:87]
    v_mfma_f32_16x16x32_bf16 v[80:83], a[76:79], a[16:19], v[80:83]
    v_mfma_f32_16x16x32_bf16 v[80:83], a[72:75], a[0:3], v[80:83]
    v_mfma_f32_16x16x32_bf16 v[96:99], a[80:83], a[0:3], v[96:99]
    v_mfma_f32_16x16x32_bf16 v[96:99], a[84:87], a[16:19], v[96:99]
    v_mfma_f32_16x16x32_bf16 v[100:103], a[84:87], a[20:23], v[100:103]
    v_mfma_f32_16x16x32_bf16 v[100:103], a[80:83], a[4:7], v[100:103]
    s_setprio 2
    s_barrier
    v_mfma_f32_16x16x32_bf16 v[104:107], a[80:83], a[8:11], v[104:107]
    v_mfma_f32_16x16x32_bf16 v[104:107], a[84:87], a[24:27], v[104:107]
    v_mfma_f32_16x16x32_bf16 v[108:111], a[84:87], a[28:31], v[108:111]
    v_mfma_f32_16x16x32_bf16 v[108:111], a[80:83], a[12:15], v[108:111]
    s_setprio 0
fused_kernel_sb4:
    ds_read_b128 a[0:3], v154 offset:0
    ds_read_b128 a[16:19], v155 offset:0
    s_add_u32 m0, s55, 4096
    s_nop 0
    buffer_load_dwordx4 v112, s[4:7], s23 offen offset:0 lds
    ds_read_b128 a[4:7], v154 offset:2048
    ds_read_b128 a[20:23], v155 offset:2048
    ds_read_b128 a[8:11], v154 offset:4096
    ds_read_b128 a[24:27], v155 offset:4096
    buffer_load_dwordx4 v113, s[4:7], s23 offen offset:1024 lds
    ds_read_b128 a[12:15], v154 offset:6144
    ds_read_b128 a[28:31], v155 offset:6144
    ds_read_b64_tr_b16 a[32:33], v156 offset:0
    ds_read_b64_tr_b16 a[34:35], v156 offset:1792
    ds_read_b64_tr_b16 a[36:37], v156 offset:7168
    buffer_load_dwordx4 v114, s[4:7], s23 offen offset:2048 lds
    ds_read_b64_tr_b16 a[38:39], v156 offset:8960
    ds_read_b64_tr_b16 a[40:41], v156 offset:32
    ds_read_b64_tr_b16 a[42:43], v156 offset:1824
    ds_read_b64_tr_b16 a[44:45], v156 offset:7200
    buffer_load_dwordx4 v115, s[4:7], s23 offen offset:3072 lds
    s_add_u32 s23, s23, 128
    ds_read_b64_tr_b16 a[46:47], v156 offset:8992
    ds_read_b64_tr_b16 a[48:49], v156 offset:64
    ds_read_b64_tr_b16 a[50:51], v156 offset:1856
    ds_read_b64_tr_b16 a[52:53], v156 offset:7232
    ds_read_b64_tr_b16 a[54:55], v156 offset:9024
    s_add_u32 m0, s32, 12288
    s_nop 0
    buffer_load_dwordx4 v116, s[8:11], s24 offen offset:0 lds
    ds_read_b64_tr_b16 a[56:57], v156 offset:96
    ds_read_b64_tr_b16 a[58:59], v156 offset:1888
    ds_read_b64_tr_b16 a[60:61], v156 offset:7264
    ds_read_b64_tr_b16 a[62:63], v156 offset:9056
    buffer_load_dwordx4 v117, s[8:11], s24 offen offset:1024 lds
    ds_read_b64_tr_b16 a[64:65], v156 offset:128
    ds_read_b64_tr_b16 a[66:67], v156 offset:1920
    ds_read_b64_tr_b16 a[68:69], v156 offset:7296
    ds_read_b64_tr_b16 a[70:71], v156 offset:9088
    ds_read_b64_tr_b16 a[72:73], v156 offset:160
    buffer_load_dwordx4 v118, s[8:11], s24 offen offset:2048 lds
    s_add_u32 s24, s24, 393216
    ds_read_b64_tr_b16 a[74:75], v156 offset:1952
    ds_read_b64_tr_b16 a[76:77], v156 offset:7328
    ds_read_b64_tr_b16 a[78:79], v156 offset:9120
    ds_read_b64_tr_b16 a[80:81], v157 offset:0
    ds_read_b64_tr_b16 a[82:83], v157 offset:1792
    ds_read_b64_tr_b16 a[84:85], v157 offset:7168
    ds_read_b64_tr_b16 a[86:87], v157 offset:8960
    ds_read_b32 v121, v152
    ds_read_b32 v121, v152
    ds_read_b32 v121, v152
    ds_read_b32 v121, v152
    ds_read_b32 v121, v152
    ds_read_b32 v121, v152
    ds_read_b32 v121, v152
    ds_read_b32 v121, v152
    s_waitcnt vmcnt(7) lgkmcnt(8)
    s_barrier
    v_mfma_f32_16x16x32_bf16 v[0:3], a[32:35], a[0:3], v[0:3]
    v_mfma_f32_16x16x32_bf16 v[0:3], a[36:39], a[16:19], v[0:3]
    v_mfma_f32_16x16x32_bf16 v[4:7], a[36:39], a[20:23], v[4:7]
    s_load_dwordx2 s[100:101], s[94:95], 129024
    v_mfma_f32_16x16x32_bf16 v[4:7], a[32:35], a[4:7], v[4:7]
    v_mfma_f32_16x16x32_bf16 v[8:11], a[32:35], a[8:11], v[8:11]
    s_load_dwordx2 s[100:101], s[94:95], 258048
    v_mfma_f32_16x16x32_bf16 v[8:11], a[36:39], a[24:27], v[8:11]
    v_mfma_f32_16x16x32_bf16 v[12:15], a[36:39], a[28:31], v[12:15]
    s_load_dwordx2 s[100:101], s[94:95], 387072
    v_mfma_f32_16x16x32_bf16 v[12:15], a[32:35], a[12:15], v[12:15]
    v_mfma_f32_16x16x32_bf16 v[28:31], a[40:43], a[12:15], v[28:31]
    s_load_dwordx2 s[100:101], s[94:95], 516096
    v_mfma_f32_16x16x32_bf16 v[28:31], a[44:47], a[28:31], v[28:31]
    v_mfma_f32_16x16x32_bf16 v[24:27], a[44:47], a[24:27], v[24:27]
    v_mfma_f32_16x16x32_bf16 v[24:27], a[40:43], a[8:11], v[24:27]
    v_mfma_f32_16x16x32_bf16 v[20:23], a[40:43], a[4:7], v[20:23]
    v_mfma_f32_16x16x32_bf16 v[20:23], a[44:47], a[20:23], v[20:23]
    v_mfma_f32_16x16x32_bf16 v[16:19], a[44:47], a[16:19], v[16:19]
    v_mfma_f32_16x16x32_bf16 v[16:19], a[40:43], a[0:3], v[16:19]
    v_mfma_f32_16x16x32_bf16 v[32:35], a[48:51], a[0:3], v[32:35]
    v_mfma_f32_16x16x32_bf16 v[32:35], a[52:55], a[16:19], v[32:35]
    v_mfma_f32_16x16x32_bf16 v[36:39], a[52:55], a[20:23], v[36:39]
    v_mfma_f32_16x16x32_bf16 v[36:39], a[48:51], a[4:7], v[36:39]
    v_mfma_f32_16x16x32_bf16 v[40:43], a[48:51], a[8:11], v[40:43]
    v_mfma_f32_16x16x32_bf16 v[40:43], a[52:55], a[24:27], v[40:43]
    v_mfma_f32_16x16x32_bf16 v[44:47], a[52:55], a[28:31], v[44:47]
    v_mfma_f32_16x16x32_bf16 v[44:47], a[48:51], a[12:15], v[44:47]
    v_mfma_f32_16x16x32_bf16 v[60:63], a[56:59], a[12:15], v[60:63]
    v_mfma_f32_16x16x32_bf16 v[60:63], a[60:63], a[28:31], v[60:63]
    v_mfma_f32_16x16x32_bf16 v[56:59], a[60:63], a[24:27], v[56:59]
    v_mfma_f32_16x16x32_bf16 v[56:59], a[56:59], a[8:11], v[56:59]
    v_mfma_f32_16x16x32_bf16 v[52:55], a[56:59], a[4:7], v[52:55]
    v_mfma_f32_16x16x32_bf16 v[52:55], a[60:63], a[20:23], v[52:55]
    v_mfma_f32_16x16x32_bf16 v[48:51], a[60:63], a[16:19], v[48:51]
    v_mfma_f32_16x16x32_bf16 v[48:51], a[56:59], a[0:3], v[48:51]
    v_mfma_f32_16x16x32_bf16 v[64:67], a[64:67], a[0:3], v[64:67]
    v_mfma_f32_16x16x32_bf16 v[64:67], a[68:71], a[16:19], v[64:67]
    v_mfma_f32_16x16x32_bf16 v[68:71], a[68:71], a[20:23], v[68:71]
    v_mfma_f32_16x16x32_bf16 v[68:71], a[64:67], a[4:7], v[68:71]
    v_mfma_f32_16x16x32_bf16 v[72:75], a[64:67], a[8:11], v[72:75]
    v_mfma_f32_16x16x32_bf16 v[72:75], a[68:71], a[24:27], v[72:75]
    v_mfma_f32_16x16x32_bf16 v[76:79], a[68:71], a[28:31], v[76:79]
    v_mfma_f32_16x16x32_bf16 v[76:79], a[64:67], a[12:15], v[76:79]
    v_mfma_f32_16x16x32_bf16 v[92:95], a[72:75], a[12:15], v[92:95]
    v_mfma_f32_16x16x32_bf16 v[92:95], a[76:79], a[28:31], v[92:95]
    v_mfma_f32_16x16x32_bf16 v[88:91], a[76:79], a[24:27], v[88:91]
    v_mfma_f32_16x16x32_bf16 v[88:91], a[72:75], a[8:11], v[88:91]
    v_mfma_f32_16x16x32_bf16 v[84:87], a[72:75], a[4:7], v[84:87]
    v_mfma_f32_16x16x32_bf16 v[84:87], a[76:79], a[20:23], v[84:87]
    v_mfma_f32_16x16x32_bf16 v[80:83], a[76:79], a[16:19], v[80:83]
    v_mfma_f32_16x16x32_bf16 v[80:83], a[72:75], a[0:3], v[80:83]
    v_mfma_f32_16x16x32_bf16 v[96:99], a[80:83], a[0:3], v[96:99]
    v_mfma_f32_16x16x32_bf16 v[96:99], a[84:87], a[16:19], v[96:99]
    v_mfma_f32_16x16x32_bf16 v[100:103], a[84:87], a[20:23], v[100:103]
    v_mfma_f32_16x16x32_bf16 v[100:103], a[80:83], a[4:7], v[100:103]
    s_setprio 2
    s_barrier
    v_mfma_f32_16x16x32_bf16 v[104:107], a[80:83], a[8:11], v[104:107]
    v_mfma_f32_16x16x32_bf16 v[104:107], a[84:87], a[24:27], v[104:107]
    v_mfma_f32_16x16x32_bf16 v[108:111], a[84:87], a[28:31], v[108:111]
    v_mfma_f32_16x16x32_bf16 v[108:111], a[80:83], a[12:15], v[108:111]
    s_setprio 0
fused_kernel_sb5:
    ds_read_b128 a[0:3], v152 offset:32768
    ds_read_b128 a[16:19], v153 offset:32768
    s_add_u32 m0, s55, 69632
    s_nop 0
    buffer_load_dwordx4 v112, s[4:7], s23 offen offset:0 lds
    ds_read_b128 a[4:7], v152 offset:34816
    ds_read_b128 a[20:23], v153 offset:34816
    ds_read_b128 a[8:11], v152 offset:36864
    ds_read_b128 a[24:27], v153 offset:36864
    buffer_load_dwordx4 v113, s[4:7], s23 offen offset:1024 lds
    ds_read_b128 a[12:15], v152 offset:38912
    ds_read_b128 a[28:31], v153 offset:38912
    ds_read_b64_tr_b16 a[32:33], v156 offset:14336
    ds_read_b64_tr_b16 a[34:35], v156 offset:16128
    ds_read_b64_tr_b16 a[36:37], v156 offset:21504
    buffer_load_dwordx4 v114, s[4:7], s23 offen offset:2048 lds
    ds_read_b64_tr_b16 a[38:39], v156 offset:23296
    ds_read_b64_tr_b16 a[40:41], v156 offset:14368
    ds_read_b64_tr_b16 a[42:43], v156 offset:16160
    ds_read_b64_tr_b16 a[44:45], v156 offset:21536
    buffer_load_dwordx4 v115, s[4:7], s23 offen offset:3072 lds
    s_add_u32 s23, s23, 128
    ds_read_b64_tr_b16 a[46:47], v156 offset:23328
    ds_read_b64_tr_b16 a[48:49], v156 offset:14400
    ds_read_b64_tr_b16 a[50:51], v156 offset:16192
    ds_read_b64_tr_b16 a[52:53], v156 offset:21568
    ds_read_b64_tr_b16 a[54:55], v156 offset:23360
    s_add_u32 m0, s32, 0
    s_nop 0
    buffer_load_dwordx4 v116, s[8:11], s24 offen offset:0 lds
    ds_read_b64_tr_b16 a[56:57], v156 offset:14432
    ds_read_b64_tr_b16 a[58:59], v156 offset:16224
    ds_read_b64_tr_b16 a[60:61], v156 offset:21600
    ds_read_b64_tr_b16 a[62:63], v156 offset:23392
    buffer_load_dwordx4 v117, s[8:11], s24 offen offset:1024 lds
    ds_read_b64_tr_b16 a[64:65], v156 offset:14464
    ds_read_b64_tr_b16 a[66:67], v156 offset:16256
    ds_read_b64_tr_b16 a[68:69], v156 offset:21632
    ds_read_b64_tr_b16 a[70:71], v156 offset:23424
    ds_read_b64_tr_b16 a[72:73], v156 offset:14496
    buffer_load_dwordx4 v118, s[8:11], s24 offen offset:2048 lds
    s_add_u32 s24, s24, 393216
    ds_read_b64_tr_b16 a[74:75], v156 offset:16288
    ds_read_b64_tr_b16 a[76:77], v156 offset:21664
    ds_read_b64_tr_b16 a[78:79], v156 offset:23456
    ds_read_b64_tr_b16 a[80:81], v157 offset:14336
    ds_read_b64_tr_b16 a[82:83], v157 offset:16128
    ds_read_b64_tr_b16 a[84:85], v157 offset:21504
    ds_read_b64_tr_b16 a[86:87], v157 offset:23296
    ds_read_b32 v121, v152
    ds_read_b32 v121, v152
    ds_read_b32 v121, v152
    ds_read_b32 v121, v152
    ds_read_b32 v121, v152
    ds_read_b32 v121, v152
    ds_read_b32 v121, v152
    ds_read_b32 v121, v152
    s_waitcnt vmcnt(7) lgkmcnt(8)
    s_barrier
    v_mfma_f32_16x16x32_bf16 v[0:3], a[32:35], a[0:3], v[0:3]
    v_mfma_f32_16x16x32_bf16 v[0:3], a[36:39], a[16:19], v[0:3]
    v_mfma_f32_16x16x32_bf16 v[4:7], a[36:39], a[20:23], v[4:7]
    s_load_dwordx2 s[100:101], s[94:95], 645120
    v_mfma_f32_16x16x32_bf16 v[4:7], a[32:35], a[4:7], v[4:7]
    v_mfma_f32_16x16x32_bf16 v[8:11], a[32:35], a[8:11], v[8:11]
    s_load_dwordx2 s[100:101], s[94:95], 774144
    v_mfma_f32_16x16x32_bf16 v[8:11], a[36:39], a[24:27], v[8:11]
    v_mfma_f32_16x16x32_bf16 v[12:15], a[36:39], a[28:31], v[12:15]
    s_load_dwordx2 s[100:101], s[94:95], 903168
    v_mfma_f32_16x16x32_bf16 v[12:15], a[32:35], a[12:15], v[12:15]
    v_mfma_f32_16x16x32_bf16 v[28:31], a[40:43], a[12:15], v[28:31]
    s_load_dwordx2 s[100:101], s[94:95], 1032192
    v_mfma_f32_16x16x32_bf16 v[28:31], a[44:47], a[28:31], v[28:31]
    v_mfma_f32_16x16x32_bf16 v[24:27], a[44:47], a[24:27], v[24:27]
    v_mfma_f32_16x16x32_bf16 v[24:27], a[40:43], a[8:11], v[24:27]
    v_mfma_f32_16x16x32_bf16 v[20:23], a[40:43], a[4:7], v[20:23]
    v_mfma_f32_16x16x32_bf16 v[20:23], a[44:47], a[20:23], v[20:23]
    v_mfma_f32_16x16x32_bf16 v[16:19], a[44:47], a[16:19], v[16:19]
    v_mfma_f32_16x16x32_bf16 v[16:19], a[40:43], a[0:3], v[16:19]
    v_mfma_f32_16x16x32_bf16 v[32:35], a[48:51], a[0:3], v[32:35]
    v_mfma_f32_16x16x32_bf16 v[32:35], a[52:55], a[16:19], v[32:35]
    v_mfma_f32_16x16x32_bf16 v[36:39], a[52:55], a[20:23], v[36:39]
    v_mfma_f32_16x16x32_bf16 v[36:39], a[48:51], a[4:7], v[36:39]
    v_mfma_f32_16x16x32_bf16 v[40:43], a[48:51], a[8:11], v[40:43]
    v_mfma_f32_16x16x32_bf16 v[40:43], a[52:55], a[24:27], v[40:43]
    v_mfma_f32_16x16x32_bf16 v[44:47], a[52:55], a[28:31], v[44:47]
    v_mfma_f32_16x16x32_bf16 v[44:47], a[48:51], a[12:15], v[44:47]
    v_mfma_f32_16x16x32_bf16 v[60:63], a[56:59], a[12:15], v[60:63]
    v_mfma_f32_16x16x32_bf16 v[60:63], a[60:63], a[28:31], v[60:63]
    v_mfma_f32_16x16x32_bf16 v[56:59], a[60:63], a[24:27], v[56:59]
    v_mfma_f32_16x16x32_bf16 v[56:59], a[56:59], a[8:11], v[56:59]
    v_mfma_f32_16x16x32_bf16 v[52:55], a[56:59], a[4:7], v[52:55]
    v_mfma_f32_16x16x32_bf16 v[52:55], a[60:63], a[20:23], v[52:55]
    v_mfma_f32_16x16x32_bf16 v[48:51], a[60:63], a[16:19], v[48:51]
    v_mfma_f32_16x16x32_bf16 v[48:51], a[56:59], a[0:3], v[48:51]
    v_mfma_f32_16x16x32_bf16 v[64:67], a[64:67], a[0:3], v[64:67]
    v_mfma_f32_16x16x32_bf16 v[64:67], a[68:71], a[16:19], v[64:67]
    v_mfma_f32_16x16x32_bf16 v[68:71], a[68:71], a[20:23], v[68:71]
    v_mfma_f32_16x16x32_bf16 v[68:71], a[64:67], a[4:7], v[68:71]
    v_mfma_f32_16x16x32_bf16 v[72:75], a[64:67], a[8:11], v[72:75]
    v_mfma_f32_16x16x32_bf16 v[72:75], a[68:71], a[24:27], v[72:75]
    v_mfma_f32_16x16x32_bf16 v[76:79], a[68:71], a[28:31], v[76:79]
    v_mfma_f32_16x16x32_bf16 v[76:79], a[64:67], a[12:15], v[76:79]
    v_mfma_f32_16x16x32_bf16 v[92:95], a[72:75], a[12:15], v[92:95]
    v_mfma_f32_16x16x32_bf16 v[92:95], a[76:79], a[28:31], v[92:95]
    v_mfma_f32_16x16x32_bf16 v[88:91], a[76:79], a[24:27], v[88:91]
    v_mfma_f32_16x16x32_bf16 v[88:91], a[72:75], a[8:11], v[88:91]
    v_mfma_f32_16x16x32_bf16 v[84:87], a[72:75], a[4:7], v[84:87]
    v_mfma_f32_16x16x32_bf16 v[84:87], a[76:79], a[20:23], v[84:87]
    v_mfma_f32_16x16x32_bf16 v[80:83], a[76:79], a[16:19], v[80:83]
    v_mfma_f32_16x16x32_bf16 v[80:83], a[72:75], a[0:3], v[80:83]
    v_mfma_f32_16x16x32_bf16 v[96:99], a[80:83], a[0:3], v[96:99]
    v_mfma_f32_16x16x32_bf16 v[96:99], a[84:87], a[16:19], v[96:99]
    v_mfma_f32_16x16x32_bf16 v[100:103], a[84:87], a[20:23], v[100:103]
    v_mfma_f32_16x16x32_bf16 v[100:103], a[80:83], a[4:7], v[100:103]
    s_setprio 2
    s_barrier
    v_mfma_f32_16x16x32_bf16 v[104:107], a[80:83], a[8:11], v[104:107]
    v_mfma_f32_16x16x32_bf16 v[104:107], a[84:87], a[24:27], v[104:107]
    v_mfma_f32_16x16x32_bf16 v[108:111], a[84:87], a[28:31], v[108:111]
    v_mfma_f32_16x16x32_bf16 v[108:111], a[80:83], a[12:15], v[108:111]
    s_setprio 0
fused_kernel_sb6:
    ds_read_b128 a[0:3], v152 offset:0
    ds_read_b128 a[16:19], v153 offset:0
    s_add_u32 m0, s55, 36864
    s_nop 0
    buffer_load_dwordx4 v112, s[4:7], s23 offen offset:0 lds
    ds_read_b128 a[4:7], v152 offset:2048
    ds_read_b128 a[20:23], v153 offset:2048
    ds_read_b128 a[8:11], v152 offset:4096
    ds_read_b128 a[24:27], v153 offset:4096
    buffer_load_dwordx4 v113, s[4:7], s23 offen offset:1024 lds
    ds_read_b128 a[12:15], v152 offset:6144
    ds_read_b128 a[28:31], v153 offset:6144
    ds_read_b64_tr_b16 a[32:33], v156 offset:0
    ds_read_b64_tr_b16 a[34:35], v156 offset:1792
    ds_read_b64_tr_b16 a[36:37], v156 offset:7168
    buffer_load_dwordx4 v114, s[4:7], s23 offen offset:2048 lds
    ds_read_b64_tr_b16 a[38:39], v156 offset:8960
    ds_read_b64_tr_b16 a[40:41], v156 offset:32
    ds_read_b64_tr_b16 a[42:43], v156 offset:1824
    ds_read_b64_tr_b16 a[44:45], v156 offset:7200
    buffer_load_dwordx4 v115, s[4:7], s23 offen offset:3072 lds
    s_add_u32 s23, s23, 128
    ds_read_b64_tr_b16 a[46:47], v156 offset:8992
    ds_read_b64_tr_b16 a[48:49], v156 offset:64
    ds_read_b64_tr_b16 a[50:51], v156 offset:1856
    ds_read_b64_tr_b16 a[52:53], v156 offset:7232
    ds_read_b64_tr_b16 a[54:55], v156 offset:9024
    s_add_u32 m0, s32, 12288
    s_nop 0
    buffer_load_dwordx4 v116, s[8:11], s24 offen offset:0 lds
    ds_read_b64_tr_b16 a[56:57], v156 offset:96
    ds_read_b64_tr_b16 a[58:59], v156 offset:1888
    ds_read_b64_tr_b16 a[60:61], v156 offset:7264
    ds_read_b64_tr_b16 a[62:63], v156 offset:9056
    buffer_load_dwordx4 v117, s[8:11], s24 offen offset:1024 lds
    ds_read_b64_tr_b16 a[64:65], v156 offset:128
    ds_read_b64_tr_b16 a[66:67], v156 offset:1920
    ds_read_b64_tr_b16 a[68:69], v156 offset:7296
    ds_read_b64_tr_b16 a[70:71], v156 offset:9088
    ds_read_b64_tr_b16 a[72:73], v156 offset:160
    buffer_load_dwordx4 v118, s[8:11], s24 offen offset:2048 lds
    s_add_u32 s24, s24, 393216
    ds_read_b64_tr_b16 a[74:75], v156 offset:1952
    ds_read_b64_tr_b16 a[76:77], v156 offset:7328
    ds_read_b64_tr_b16 a[78:79], v156 offset:9120
    ds_read_b64_tr_b16 a[80:81], v157 offset:0
    ds_read_b64_tr_b16 a[82:83], v157 offset:1792
    ds_read_b64_tr_b16 a[84:85], v157 offset:7168
    ds_read_b64_tr_b16 a[86:87], v157 offset:8960
    ds_read_b32 v121, v152
    ds_read_b32 v121, v152
    ds_read_b32 v121, v152
    ds_read_b32 v121, v152
    ds_read_b32 v121, v152
    ds_read_b32 v121, v152
    ds_read_b32 v121, v152
    ds_read_b32 v121, v152
    s_waitcnt vmcnt(7) lgkmcnt(8)
    s_barrier
    v_mfma_f32_16x16x32_bf16 v[0:3], a[32:35], a[0:3], v[0:3]
    v_mfma_f32_16x16x32_bf16 v[0:3], a[36:39], a[16:19], v[0:3]
    v_mfma_f32_16x16x32_bf16 v[4:7], a[36:39], a[20:23], v[4:7]
    s_add_u32 s94, s94, 1161216
    s_addc_u32 s95, s95, 0
    s_load_dwordx2 s[100:101], s[94:95], 0
    v_mfma_f32_16x16x32_bf16 v[4:7], a[32:35], a[4:7], v[4:7]
    v_mfma_f32_16x16x32_bf16 v[8:11], a[32:35], a[8:11], v[8:11]
    s_load_dwordx2 s[100:101], s[94:95], 129024
    v_mfma_f32_16x16x32_bf16 v[8:11], a[36:39], a[24:27], v[8:11]
    v_mfma_f32_16x16x32_bf16 v[12:15], a[36:39], a[28:31], v[12:15]
    s_load_dwordx2 s[100:101], s[94:95], 258048
    v_mfma_f32_16x16x32_bf16 v[12:15], a[32:35], a[12:15], v[12:15]
    v_mfma_f32_16x16x32_bf16 v[28:31], a[40:43], a[12:15], v[28:31]
    s_load_dwordx2 s[100:101], s[94:95], 387072
    v_mfma_f32_16x16x32_bf16 v[28:31], a[44:47], a[28:31], v[28:31]
    v_mfma_f32_16x16x32_bf16 v[24:27], a[44:47], a[24:27], v[24:27]
    v_mfma_f32_16x16x32_bf16 v[24:27], a[40:43], a[8:11], v[24:27]
    v_mfma_f32_16x16x32_bf16 v[20:23], a[40:43], a[4:7], v[20:23]
    v_mfma_f32_16x16x32_bf16 v[20:23], a[44:47], a[20:23], v[20:23]
    v_mfma_f32_16x16x32_bf16 v[16:19], a[44:47], a[16:19], v[16:19]
    v_mfma_f32_16x16x32_bf16 v[16:19], a[40:43], a[0:3], v[16:19]
    v_mfma_f32_16x16x32_bf16 v[32:35], a[48:51], a[0:3], v[32:35]
    v_mfma_f32_16x16x32_bf16 v[32:35], a[52:55], a[16:19], v[32:35]
    v_mfma_f32_16x16x32_bf16 v[36:39], a[52:55], a[20:23], v[36:39]
    v_mfma_f32_16x16x32_bf16 v[36:39], a[48:51], a[4:7], v[36:39]
    v_mfma_f32_16x16x32_bf16 v[40:43], a[48:51], a[8:11], v[40:43]
    v_mfma_f32_16x16x32_bf16 v[40:43], a[52:55], a[24:27], v[40:43]
    v_mfma_f32_16x16x32_bf16 v[44:47], a[52:55], a[28:31], v[44:47]
    v_mfma_f32_16x16x32_bf16 v[44:47], a[48:51], a[12:15], v[44:47]
    v_mfma_f32_16x16x32_bf16 v[60:63], a[56:59], a[12:15], v[60:63]
    v_mfma_f32_16x16x32_bf16 v[60:63], a[60:63], a[28:31], v[60:63]
    v_mfma_f32_16x16x32_bf16 v[56:59], a[60:63], a[24:27], v[56:59]
    v_mfma_f32_16x16x32_bf16 v[56:59], a[56:59], a[8:11], v[56:59]
    v_mfma_f32_16x16x32_bf16 v[52:55], a[56:59], a[4:7], v[52:55]
    v_mfma_f32_16x16x32_bf16 v[52:55], a[60:63], a[20:23], v[52:55]
    v_mfma_f32_16x16x32_bf16 v[48:51], a[60:63], a[16:19], v[48:51]
    v_mfma_f32_16x16x32_bf16 v[48:51], a[56:59], a[0:3], v[48:51]
    v_mfma_f32_16x16x32_bf16 v[64:67], a[64:67], a[0:3], v[64:67]
    v_mfma_f32_16x16x32_bf16 v[64:67], a[68:71], a[16:19], v[64:67]
    v_mfma_f32_16x16x32_bf16 v[68:71], a[68:71], a[20:23], v[68:71]
    v_mfma_f32_16x16x32_bf16 v[68:71], a[64:67], a[4:7], v[68:71]
    v_mfma_f32_16x16x32_bf16 v[72:75], a[64:67], a[8:11], v[72:75]
    v_mfma_f32_16x16x32_bf16 v[72:75], a[68:71], a[24:27], v[72:75]
    v_mfma_f32_16x16x32_bf16 v[76:79], a[68:71], a[28:31], v[76:79]
    v_mfma_f32_16x16x32_bf16 v[76:79], a[64:67], a[12:15], v[76:79]
    v_mfma_f32_16x16x32_bf16 v[92:95], a[72:75], a[12:15], v[92:95]
    v_mfma_f32_16x16x32_bf16 v[92:95], a[76:79], a[28:31], v[92:95]
    v_mfma_f32_16x16x32_bf16 v[88:91], a[76:79], a[24:27], v[88:91]
    v_mfma_f32_16x16x32_bf16 v[88:91], a[72:75], a[8:11], v[88:91]
    v_mfma_f32_16x16x32_bf16 v[84:87], a[72:75], a[4:7], v[84:87]
    v_mfma_f32_16x16x32_bf16 v[84:87], a[76:79], a[20:23], v[84:87]
    v_mfma_f32_16x16x32_bf16 v[80:83], a[76:79], a[16:19], v[80:83]
    v_mfma_f32_16x16x32_bf16 v[80:83], a[72:75], a[0:3], v[80:83]
    v_mfma_f32_16x16x32_bf16 v[96:99], a[80:83], a[0:3], v[96:99]
    v_mfma_f32_16x16x32_bf16 v[96:99], a[84:87], a[16:19], v[96:99]
    v_mfma_f32_16x16x32_bf16 v[100:103], a[84:87], a[20:23], v[100:103]
    v_mfma_f32_16x16x32_bf16 v[100:103], a[80:83], a[4:7], v[100:103]
    s_setprio 2
    s_barrier
    v_mfma_f32_16x16x32_bf16 v[104:107], a[80:83], a[8:11], v[104:107]
    v_mfma_f32_16x16x32_bf16 v[104:107], a[84:87], a[24:27], v[104:107]
    v_mfma_f32_16x16x32_bf16 v[108:111], a[84:87], a[28:31], v[108:111]
    v_mfma_f32_16x16x32_bf16 v[108:111], a[80:83], a[12:15], v[108:111]
    s_setprio 0
fused_kernel_sb7:
    ds_read_b128 a[0:3], v154 offset:0
    ds_read_b128 a[16:19], v155 offset:0
    s_add_u32 m0, s55, 4096
    s_nop 0
    buffer_load_dwordx4 v112, s[4:7], s23 offen offset:0 lds
fused_kernel_pg2:
    s_cbranch_execz fused_kernel_pg10
    ds_read_b128 a[4:7], v154 offset:2048
    ds_read_b128 a[20:23], v155 offset:2048
    ds_read_b128 a[8:11], v154 offset:4096
    ds_read_b128 a[24:27], v155 offset:4096
    buffer_load_dwordx4 v113, s[4:7], s23 offen offset:1024 lds
    ds_read_b128 a[12:15], v154 offset:6144
    ds_read_b128 a[28:31], v155 offset:6144
    ds_read_b64_tr_b16 a[32:33], v156 offset:14336
    ds_read_b64_tr_b16 a[34:35], v156 offset:16128
    ds_read_b64_tr_b16 a[36:37], v156 offset:21504
    buffer_load_dwordx4 v114, s[4:7], s23 offen offset:2048 lds
    ds_read_b64_tr_b16 a[38:39], v156 offset:23296
    ds_read_b64_tr_b16 a[40:41], v156 offset:14368
    ds_read_b64_tr_b16 a[42:43], v156 offset:16160
    ds_read_b64_tr_b16 a[44:45], v156 offset:21536
    buffer_load_dwordx4 v115, s[4:7], s23 offen offset:3072 lds
    s_add_u32 s23, s23, 128
    ds_read_b64_tr_b16 a[46:47], v156 offset:23328
    ds_read_b64_tr_b16 a[48:49], v156 offset:14400
    ds_read_b64_tr_b16 a[50:51], v156 offset:16192
    ds_read_b64_tr_b16 a[52:53], v156 offset:21568
    ds_read_b64_tr_b16 a[54:55], v156 offset:23360
    s_add_u32 m0, s32, 0
    s_nop 0
    buffer_load_dwordx4 v116, s[8:11], s24 offen offset:0 lds
    ds_read_b64_tr_b16 a[56:57], v156 offset:14432
    ds_read_b64_tr_b16 a[58:59], v156 offset:16224
    ds_read_b64_tr_b16 a[60:61], v156 offset:21600
    ds_read_b64_tr_b16 a[62:63], v156 offset:23392
    buffer_load_dwordx4 v117, s[8:11], s24 offen offset:1024 lds
    ds_read_b64_tr_b16 a[64:65], v156 offset:14464
    ds_read_b64_tr_b16 a[66:67], v156 offset:16256
    ds_read_b64_tr_b16 a[68:69], v156 offset:21632
    ds_read_b64_tr_b16 a[70:71], v156 offset:23424
    ds_read_b64_tr_b16 a[72:73], v156 offset:14496
    buffer_load_dwordx4 v118, s[8:11], s24 offen offset:2048 lds
    s_add_u32 s24, s24, 393216
    ds_read_b64_tr_b16 a[74:75], v156 offset:16288
    ds_read_b64_tr_b16 a[76:77], v156 offset:21664
    ds_read_b64_tr_b16 a[78:79], v156 offset:23456
    ds_read_b64_tr_b16 a[80:81], v157 offset:14336
    ds_read_b64_tr_b16 a[82:83], v157 offset:16128
    ds_read_b64_tr_b16 a[84:85], v157 offset:21504
    ds_read_b64_tr_b16 a[86:87], v157 offset:23296
    ds_read_b32 v121, v152
    ds_read_b32 v121, v152
    ds_read_b32 v121, v152
    ds_read_b32 v121, v152
    ds_read_b32 v121, v152
    ds_read_b32 v121, v152
    ds_read_b32 v121, v152
    ds_read_b32 v121, v152
    s_waitcnt vmcnt(7) lgkmcnt(8)
    s_barrier
    v_mfma_f32_16x16x32_bf16 v[0:3], a[32:35], a[0:3], v[0:3]
    v_mfma_f32_16x16x32_bf16 v[0:3], a[36:39], a[16:19], v[0:3]
    v_and_b32 v122, 7, v120
    v_mul_u32_u24 v122, 7, v122
    v_mfma_f32_16x16x32_bf16 v[4:7], a[36:39], a[20:23], v[4:7]
    s_load_dwordx2 s[100:101], s[94:95], 516096
    v_lshrrev_b32 v123, 3, v120
    v_mfma_f32_16x16x32_bf16 v[4:7], a[32:35], a[4:7], v[4:7]
    v_add_u32 v123, 0, v123
    v_cmp_gt_u32 s[58:59], 2, v123
    v_mfma_f32_16x16x32_bf16 v[8:11], a[32:35], a[8:11], v[8:11]
    s_load_dwordx2 s[100:101], s[94:95], 645120
    v_add_lshl_u32 v122, v122, v123, 15
    v_mfma_f32_16x16x32_bf16 v[8:11], a[36:39], a[24:27], v[8:11]
    v_mov_b32 v123, 1073741824
    v_cndmask_b32 v122, v123, v122, s[58:59]
    v_mfma_f32_16x16x32_bf16 v[12:15], a[36:39], a[28:31], v[12:15]
    s_load_dwordx2 s[100:101], s[94:95], 774144
    v_mfma_f32_16x16x32_bf16 v[12:15], a[32:35], a[12:15], v[12:15]
    v_mfma_f32_16x16x32_bf16 v[28:31], a[40:43], a[12:15], v[28:31]
    s_load_dwordx2 s[100:101], s[94:95], 903168
    v_mfma_f32_16x16x32_bf16 v[28:31], a[44:47], a[28:31], v[28:31]
    v_mfma_f32_16x16x32_bf16 v[24:27], a[44:47], a[24:27], v[24:27]
    v_mfma_f32_16x16x32_bf16 v[24:27], a[40:43], a[8:11], v[24:27]
    v_mfma_f32_16x16x32_bf16 v[20:23], a[40:43], a[4:7], v[20:23]
    v_mfma_f32_16x16x32_bf16 v[20:23], a[44:47], a[20:23], v[20:23]
    v_mfma_f32_16x16x32_bf16 v[16:19], a[44:47], a[16:19], v[16:19]
    v_mfma_f32_16x16x32_bf16 v[16:19], a[40:43], a[0:3], v[16:19]
    v_mfma_f32_16x16x32_bf16 v[32:35], a[48:51], a[0:3], v[32:35]
    v_mfma_f32_16x16x32_bf16 v[32:35], a[52:55], a[16:19], v[32:35]
    v_mfma_f32_16x16x32_bf16 v[36:39], a[52:55], a[20:23], v[36:39]
    v_mfma_f32_16x16x32_bf16 v[36:39], a[48:51], a[4:7], v[36:39]
    v_mfma_f32_16x16x32_bf16 v[40:43], a[48:51], a[8:11], v[40:43]
    v_mfma_f32_16x16x32_bf16 v[40:43], a[52:55], a[24:27], v[40:43]
    v_mfma_f32_16x16x32_bf16 v[44:47], a[52:55], a[28:31], v[44:47]
    v_mfma_f32_16x16x32_bf16 v[44:47], a[48:51], a[12:15], v[44:47]
    v_mfma_f32_16x16x32_bf16 v[60:63], a[56:59], a[12:15], v[60:63]
    v_mfma_f32_16x16x32_bf16 v[60:63], a[60:63], a[28:31], v[60:63]
    v_mfma_f32_16x16x32_bf16 v[56:59], a[60:63], a[24:27], v[56:59]
    v_mfma_f32_16x16x32_bf16 v[56:59], a[56:59], a[8:11], v[56:59]
    v_mfma_f32_16x16x32_bf16 v[52:55], a[56:59], a[4:7], v[52:55]
    v_mfma_f32_16x16x32_bf16 v[52:55], a[60:63], a[20:23], v[52:55]
    v_mfma_f32_16x16x32_bf16 v[48:51], a[60:63], a[16:19], v[48:51]
    v_mfma_f32_16x16x32_bf16 v[48:51], a[56:59], a[0:3], v[48:51]
    v_mfma_f32_16x16x32_bf16 v[64:67], a[64:67], a[0:3], v[64:67]
    v_mfma_f32_16x16x32_bf16 v[64:67], a[68:71], a[16:19], v[64:67]
    v_mfma_f32_16x16x32_bf16 v[68:71], a[68:71], a[20:23], v[68:71]
    v_mfma_f32_16x16x32_bf16 v[68:71], a[64:67], a[4:7], v[68:71]
    v_mfma_f32_16x16x32_bf16 v[72:75], a[64:67], a[8:11], v[72:75]
    v_mfma_f32_16x16x32_bf16 v[72:75], a[68:71], a[24:27], v[72:75]
    v_mfma_f32_16x16x32_bf16 v[76:79], a[68:71], a[28:31], v[76:79]
    v_mfma_f32_16x16x32_bf16 v[76:79], a[64:67], a[12:15], v[76:79]
    v_mfma_f32_16x16x32_bf16 v[92:95], a[72:75], a[12:15], v[92:95]
    v_mfma_f32_16x16x32_bf16 v[92:95], a[76:79], a[28:31], v[92:95]
    v_mfma_f32_16x16x32_bf16 v[88:91], a[76:79], a[24:27], v[88:91]
    v_mfma_f32_16x16x32_bf16 v[88:91], a[72:75], a[8:11], v[88:91]
    v_mfma_f32_16x16x32_bf16 v[84:87], a[72:75], a[4:7], v[84:87]
    v_mfma_f32_16x16x32_bf16 v[84:87], a[76:79], a[20:23], v[84:87]
    v_mfma_f32_16x16x32_bf16 v[80:83], a[76:79], a[16:19], v[80:83]
    v_mfma_f32_16x16x32_bf16 v[80:83], a[72:75], a[0:3], v[80:83]
    v_mfma_f32_16x16x32_bf16 v[96:99], a[80:83], a[0:3], v[96:99]
    v_mfma_f32_16x16x32_bf16 v[96:99], a[84:87], a[16:19], v[96:99]
    v_mfma_f32_16x16x32_bf16 v[100:103], a[84:87], a[20:23], v[100:103]
    v_mfma_f32_16x16x32_bf16 v[100:103], a[80:83], a[4:7], v[100:103]
    s_setprio 2
    s_barrier
    v_mfma_f32_16x16x32_bf16 v[104:107], a[80:83], a[8:11], v[104:107]
    v_mfma_f32_16x16x32_bf16 v[104:107], a[84:87], a[24:27], v[104:107]
    v_mfma_f32_16x16x32_bf16 v[108:111], a[84:87], a[28:31], v[108:111]
    v_mfma_f32_16x16x32_bf16 v[108:111], a[80:83], a[12:15], v[108:111]
    s_setprio 0
fused_kernel_sb8:
    ds_read_b128 a[0:3], v152 offset:32768
    ds_read_b128 a[16:19], v153 offset:32768
    s_add_u32 m0, s55, 69632
    s_nop 0
    buffer_load_dwordx4 v112, s[4:7], s23 offen offset:0 lds
    ds_read_b128 a[4:7], v152 offset:34816
    ds_read_b128 a[20:23], v153 offset:34816
    ds_read_b128 a[8:11], v152 offset:36864
    ds_read_b128 a[24:27], v153 offset:36864
    buffer_load_dwordx4 v113, s[4:7], s23 offen offset:1024 lds
    ds_read_b128 a[12:15], v152 offset:38912
    ds_read_b128 a[28:31], v153 offset:38912
    ds_read_b64_tr_b16 a[32:33], v156 offset:0
    ds_read_b64_tr_b16 a[34:35], v156 offset:1792
    buffer_load_dwordx4 v114, s[4:7], s23 offen offset:2048 lds
    ds_read_b64_tr_b16 a[36:37], v156 offset:7168
    ds_read_b64_tr_b16 a[38:39], v156 offset:8960
    ds_read_b64_tr_b16 a[40:41], v156 offset:32
    ds_read_b64_tr_b16 a[42:43], v156 offset:1824
    buffer_load_dwordx4 v115, s[4:7], s23 offen offset:3072 lds
    s_add_u32 s23, s23, 128
    ds_read_b64_tr_b16 a[44:45], v156 offset:7200
    ds_read_b64_tr_b16 a[46:47], v156 offset:8992
    ds_read_b64_tr_b16 a[48:49], v156 offset:64
    ds_read_b64_tr_b16 a[50:51], v156 offset:1856
    s_add_u32 m0, s32, 12288
    s_nop 0
    buffer_load_dwordx4 v116, s[8:11], s24 offen offset:0 lds
    ds_read_b64_tr_b16 a[52:53], v156 offset:7232
    ds_read_b64_tr_b16 a[54:55], v156 offset:9024
    ds_read_b64_tr_b16 a[56:57], v156 offset:96
    ds_read_b64_tr_b16 a[58:59], v156 offset:1888
    buffer_load_dwordx4 v117, s[8:11], s24 offen offset:1024 lds
    ds_read_b64_tr_b16 a[60:61], v156 offset:7264
    ds_read_b64_tr_b16 a[62:63], v156 offset:9056
    ds_read_b64_tr_b16 a[64:65], v156 offset:128
    ds_read_b64_tr_b16 a[66:67], v156 offset:1920
    buffer_load_dwordx4 v118, s[8:11], s24 offen offset:2048 lds
    s_add_u32 s24, s24, 393216
    ds_read_b64_tr_b16 a[68:69], v156 offset:7296
    ds_read_b64_tr_b16 a[70:71], v156 offset:9088
    ds_read_b64_tr_b16 a[72:73], v156 offset:160
    ds_read_b64_tr_b16 a[74:75], v156 offset:1952
    buffer_load_dword v124, v122, s[16:19], s25 offen
    ds_read_b64_tr_b16 a[76:77], v156 offset:7328
    ds_read_b64_tr_b16 a[78:79], v156 offset:9120
    ds_read_b64_tr_b16 a[80:81], v157 offset:0
    ds_read_b64_tr_b16 a[82:83], v157 offset:1792
    ds_read_b64_tr_b16 a[84:85], v157 offset:7168
    ds_read_b64_tr_b16 a[86:87], v157 offset:8960
    ds_read_b32 v121, v152
    ds_read_b32 v121, v152
    ds_read_b32 v121, v152
    ds_read_b32 v121, v152
    ds_read_b32 v121, v152
    ds_read_b32 v121, v152
    ds_read_b32 v121, v152
    ds_read_b32 v121, v152
    s_waitcnt vmcnt(8) lgkmcnt(8)
    s_barrier
    v_mfma_f32_16x16x32_bf16 v[0:3], a[32:35], a[0:3], v[0:3]
    v_mfma_f32_16x16x32_bf16 v[0:3], a[36:39], a[16:19], v[0:3]
    v_and_b32 v122, 7, v120
    v_mul_u32_u24 v122, 7, v122
    v_mfma_f32_16x16x32_bf16 v[4:7], a[36:39], a[20:23], v[4:7]
    s_load_dwordx2 s[100:101], s[94:95], 1032192
    v_lshrrev_b32 v123, 3, v120
    v_mfma_f32_16x16x32_bf16 v[4:7], a[32:35], a[4:7], v[4:7]
    v_add_u32 v123, 2, v123
    v_cmp_gt_u32 s[58:59], 4, v123
    v_mfma_f32_16x16x32_bf16 v[8:11], a[32:35], a[8:11], v[8:11]
    s_add_u32 s94, s94, 1161216
    s_addc_u32 s95, s95, 0
    s_load_dwordx2 s[100:101], s[94:95], 0
    v_mfma_f32_16x16x32_bf16 v[8:11], a[36:39], a[24:27], v[8:11]
    v_add_lshl_u32 v122, v122, v123, 15
    v_mov_b32 v123, 1073741824
    v_mfma_f32_16x16x32_bf16 v[12:15], a[36:39], a[28:31], v[12:15]
    s_load_dwordx2 s[100:101], s[94:95], 129024
    v_cndmask_b32 v122, v123, v122, s[58:59]
    v_mfma_f32_16x16x32_bf16 v[12:15], a[32:35], a[12:15], v[12:15]
    v_mfma_f32_16x16x32_bf16 v[28:31], a[40:43], a[12:15], v[28:31]
    s_load_dwordx2 s[100:101], s[94:95], 258048
    v_mfma_f32_16x16x32_bf16 v[28:31], a[44:47], a[28:31], v[28:31]
    v_mfma_f32_16x16x32_bf16 v[24:27], a[44:47], a[24:27], v[24:27]
    v_mfma_f32_16x16x32_bf16 v[24:27], a[40:43], a[8:11], v[24:27]
    v_mfma_f32_16x16x32_bf16 v[20:23], a[40:43], a[4:7], v[20:23]
    v_mfma_f32_16x16x32_bf16 v[20:23], a[44:47], a[20:23], v[20:23]
    v_mfma_f32_16x16x32_bf16 v[16:19], a[44:47], a[16:19], v[16:19]
    v_mfma_f32_16x16x32_bf16 v[16:19], a[40:43], a[0:3], v[16:19]
    v_mfma_f32_16x16x32_bf16 v[32:35], a[48:51], a[0:3], v[32:35]
    v_mfma_f32_16x16x32_bf16 v[32:35], a[52:55], a[16:19], v[32:35]
    v_mfma_f32_16x16x32_bf16 v[36:39], a[52:55], a[20:23], v[36:39]
    v_mfma_f32_16x16x32_bf16 v[36:39], a[48:51], a[4:7], v[36:39]
    v_mfma_f32_16x16x32_bf16 v[40:43], a[48:51], a[8:11], v[40:43]
    v_mfma_f32_16x16x32_bf16 v[40:43], a[52:55], a[24:27], v[40:43]
    v_mfma_f32_16x16x32_bf16 v[44:47], a[52:55], a[28:31], v[44:47]
    v_mfma_f32_16x16x32_bf16 v[44:47], a[48:51], a[12:15], v[44:47]
    v_mfma_f32_16x16x32_bf16 v[60:63], a[56:59], a[12:15], v[60:63]
    v_mfma_f32_16x16x32_bf16 v[60:63], a[60:63], a[28:31], v[60:63]
    v_mfma_f32_16x16x32_bf16 v[56:59], a[60:63], a[24:27], v[56:59]
    v_mfma_f32_16x16x32_bf16 v[56:59], a[56:59], a[8:11], v[56:59]
    v_mfma_f32_16x16x32_bf16 v[52:55], a[56:59], a[4:7], v[52:55]
    v_mfma_f32_16x16x32_bf16 v[52:55], a[60:63], a[20:23], v[52:55]
    v_mfma_f32_16x16x32_bf16 v[48:51], a[60:63], a[16:19], v[48:51]
    v_mfma_f32_16x16x32_bf16 v[48:51], a[56:59], a[0:3], v[48:51]
    v_mfma_f32_16x16x32_bf16 v[64:67], a[64:67], a[0:3], v[64:67]
    v_mfma_f32_16x16x32_bf16 v[64:67], a[68:71], a[16:19], v[64:67]
    v_mfma_f32_16x16x32_bf16 v[68:71], a[68:71], a[20:23], v[68:71]
    v_mfma_f32_16x16x32_bf16 v[68:71], a[64:67], a[4:7], v[68:71]
    v_mfma_f32_16x16x32_bf16 v[72:75], a[64:67], a[8:11], v[72:75]
    v_mfma_f32_16x16x32_bf16 v[72:75], a[68:71], a[24:27], v[72:75]
    v_mfma_f32_16x16x32_bf16 v[76:79], a[68:71], a[28:31], v[76:79]
    v_mfma_f32_16x16x32_bf16 v[76:79], a[64:67], a[12:15], v[76:79]
    v_mfma_f32_16x16x32_bf16 v[92:95], a[72:75], a[12:15], v[92:95]
    v_mfma_f32_16x16x32_bf16 v[92:95], a[76:79], a[28:31], v[92:95]
    v_mfma_f32_16x16x32_bf16 v[88:91], a[76:79], a[24:27], v[88:91]
    v_mfma_f32_16x16x32_bf16 v[88:91], a[72:75], a[8:11], v[88:91]
    v_mfma_f32_16x16x32_bf16 v[84:87], a[72:75], a[4:7], v[84:87]
    v_mfma_f32_16x16x32_bf16 v[84:87], a[76:79], a[20:23], v[84:87]
    v_mfma_f32_16x16x32_bf16 v[80:83], a[76:79], a[16:19], v[80:83]
    v_mfma_f32_16x16x32_bf16 v[80:83], a[72:75], a[0:3], v[80:83]
    v_mfma_f32_16x16x32_bf16 v[96:99], a[80:83], a[0:3], v[96:99]
    v_mfma_f32_16x16x32_bf16 v[96:99], a[84:87], a[16:19], v[96:99]
    v_mfma_f32_16x16x32_bf16 v[100:103], a[84:87], a[20:23], v[100:103]
    v_mfma_f32_16x16x32_bf16 v[100:103], a[80:83], a[4:7], v[100:103]
    s_setprio 2
    s_barrier
    v_mfma_f32_16x16x32_bf16 v[104:107], a[80:83], a[8:11], v[104:107]
    v_mfma_f32_16x16x32_bf16 v[104:107], a[84:87], a[24:27], v[104:107]
    v_mfma_f32_16x16x32_bf16 v[108:111], a[84:87], a[28:31], v[108:111]
    v_mfma_f32_16x16x32_bf16 v[108:111], a[80:83], a[12:15], v[108:111]
    s_setprio 0
fused_kernel_sb9:
    ds_read_b128 a[0:3], v152 offset:0
    ds_read_b128 a[16:19], v153 offset:0
    s_add_u32 m0, s55, 36864
    s_nop 0
    buffer_load_dwordx4 v112, s[4:7], s23 offen offset:0 lds
    ds_read_b128 a[4:7], v152 offset:2048
    ds_read_b128 a[20:23], v153 offset:2048
    ds_read_b128 a[8:11], v152 offset:4096
    ds_read_b128 a[24:27], v153 offset:4096
    buffer_load_dwordx4 v113, s[4:7], s23 offen offset:1024 lds
    ds_read_b128 a[12:15], v152 offset:6144
    ds_read_b128 a[28:31], v153 offset:6144
    ds_read_b64_tr_b16 a[32:33], v156 offset:14336
    ds_read_b64_tr_b16 a[34:35], v156 offset:16128
    buffer_load_dwordx4 v114, s[4:7], s23 offen offset:2048 lds
    ds_read_b64_tr_b16 a[36:37], v156 offset:21504
    ds_read_b64_tr_b16 a[38:39], v156 offset:23296
    ds_read_b64_tr_b16 a[40:41], v156 offset:14368
    ds_read_b64_tr_b16 a[42:43], v156 offset:16160
    buffer_load_dwordx4 v115, s[4:7], s23 offen offset:3072 lds
    s_add_u32 s23, s23, 128
    ds_read_b64_tr_b16 a[44:45], v156 offset:21536
    ds_read_b64_tr_b16 a[46:47], v156 offset:23328
    ds_read_b64_tr_b16 a[48:49], v156 offset:14400
    ds_read_b64_tr_b16 a[50:51], v156 offset:16192
    s_add_u32 m0, s32, 0
    s_nop 0
    buffer_load_dwordx4 v116, s[8:11], s24 offen offset:0 lds
    ds_read_b64_tr_b16 a[52:53], v156 offset:21568
    ds_read_b64_tr_b16 a[54:55], v156 offset:23360
    ds_read_b64_tr_b16 a[56:57], v156 offset:14432
    ds_read_b64_tr_b16 a[58:59], v156 offset:16224
    buffer_load_dwordx4 v117, s[8:11], s24 offen offset:1024 lds
    ds_read_b64_tr_b16 a[60:61], v156 offset:21600
    ds_read_b64_tr_b16 a[62:63], v156 offset:23392
    ds_read_b64_tr_b16 a[64:65], v156 offset:14464
    ds_read_b64_tr_b16 a[66:67], v156 offset:16256
    buffer_load_dwordx4 v118, s[8:11], s24 offen offset:2048 lds
    s_add_u32 s24, s24, 393216
    ds_read_b64_tr_b16 a[68:69], v156 offset:21632
    ds_read_b64_tr_b16 a[70:71], v156 offset:23424
    ds_read_b64_tr_b16 a[72:73], v156 offset:14496
    ds_read_b64_tr_b16 a[74:75], v156 offset:16288
    buffer_load_dword v124, v122, s[16:19], s25 offen
    ds_read_b64_tr_b16 a[76:77], v156 offset:21664
    ds_read_b64_tr_b16 a[78:79], v156 offset:23456
    ds_read_b64_tr_b16 a[80:81], v157 offset:14336
    ds_read_b64_tr_b16 a[82:83], v157 offset:16128
    ds_read_b64_tr_b16 a[84:85], v157 offset:21504
    ds_read_b64_tr_b16 a[86:87], v157 offset:23296
    ds_read_b32 v121, v152
    ds_read_b32 v121, v152
    ds_read_b32 v121, v152
    ds_read_b32 v121, v152
    ds_read_b32 v121, v152
    ds_read_b32 v121, v152
    ds_read_b32 v121, v152
    ds_read_b32 v121, v152
    s_waitcnt vmcnt(9) lgkmcnt(8)
    s_barrier
    v_mfma_f32_16x16x32_bf16 v[0:3], a[32:35], a[0:3], v[0:3]
    v_mfma_f32_16x16x32_bf16 v[0:3], a[36:39], a[16:19], v[0:3]
    v_and_b32 v122, 7, v120
    v_mul_u32_u24 v122, 7, v122
    v_mfma_f32_16x16x32_bf16 v[4:7], a[36:39], a[20:23], v[4:7]
    s_load_dwordx2 s[100:101], s[94:95], 337920
    v_lshrrev_b32 v123, 3, v120
    v_mfma_f32_16x16x32_bf16 v[4:7], a[32:35], a[4:7], v[4:7]
    v_add_u32 v123, 4, v123
    v_cmp_gt_u32 s[58:59], 6, v123
    v_mfma_f32_16x16x32_bf16 v[8:11], a[32:35], a[8:11], v[8:11]
    v_add_lshl_u32 v122, v122, v123, 15
    v_mov_b32 v123, 1073741824
    v_mfma_f32_16x16x32_bf16 v[8:11], a[36:39], a[24:27], v[8:11]
    v_cndmask_b32 v122, v123, v122, s[58:59]
    v_mfma_f32_16x16x32_bf16 v[12:15], a[36:39], a[28:31], v[12:15]
    v_mfma_f32_16x16x32_bf16 v[12:15], a[32:35], a[12:15], v[12:15]
    v_mfma_f32_16x16x32_bf16 v[28:31], a[40:43], a[12:15], v[28:31]
    v_mfma_f32_16x16x32_bf16 v[28:31], a[44:47], a[28:31], v[28:31]
    v_mfma_f32_16x16x32_bf16 v[24:27], a[44:47], a[24:27], v[24:27]
    v_mfma_f32_16x16x32_bf16 v[24:27], a[40:43], a[8:11], v[24:27]
    v_mfma_f32_16x16x32_bf16 v[20:23], a[40:43], a[4:7], v[20:23]
    v_mfma_f32_16x16x32_bf16 v[20:23], a[44:47], a[20:23], v[20:23]
    v_mfma_f32_16x16x32_bf16 v[16:19], a[44:47], a[16:19], v[16:19]
    v_mfma_f32_16x16x32_bf16 v[16:19], a[40:43], a[0:3], v[16:19]
    v_mfma_f32_16x16x32_bf16 v[32:35], a[48:51], a[0:3], v[32:35]
    v_mfma_f32_16x16x32_bf16 v[32:35], a[52:55], a[16:19], v[32:35]
    v_mfma_f32_16x16x32_bf16 v[36:39], a[52:55], a[20:23], v[36:39]
    v_mfma_f32_16x16x32_bf16 v[36:39], a[48:51], a[4:7], v[36:39]
    v_mfma_f32_16x16x32_bf16 v[40:43], a[48:51], a[8:11], v[40:43]
    v_mfma_f32_16x16x32_bf16 v[40:43], a[52:55], a[24:27], v[40:43]
    v_mfma_f32_16x16x32_bf16 v[44:47], a[52:55], a[28:31], v[44:47]
    v_mfma_f32_16x16x32_bf16 v[44:47], a[48:51], a[12:15], v[44:47]
    v_mfma_f32_16x16x32_bf16 v[60:63], a[56:59], a[12:15], v[60:63]
    v_mfma_f32_16x16x32_bf16 v[60:63], a[60:63], a[28:31], v[60:63]
    v_mfma_f32_16x16x32_bf16 v[56:59], a[60:63], a[24:27], v[56:59]
    v_mfma_f32_16x16x32_bf16 v[56:59], a[56:59], a[8:11], v[56:59]
    v_mfma_f32_16x16x32_bf16 v[52:55], a[56:59], a[4:7], v[52:55]
    v_mfma_f32_16x16x32_bf16 v[52:55], a[60:63], a[20:23], v[52:55]
    v_mfma_f32_16x16x32_bf16 v[48:51], a[60:63], a[16:19], v[48:51]
    v_mfma_f32_16x16x32_bf16 v[48:51], a[56:59], a[0:3], v[48:51]
    v_mfma_f32_16x16x32_bf16 v[64:67], a[64:67], a[0:3], v[64:67]
    v_mfma_f32_16x16x32_bf16 v[64:67], a[68:71], a[16:19], v[64:67]
    v_mfma_f32_16x16x32_bf16 v[68:71], a[68:71], a[20:23], v[68:71]
    v_mfma_f32_16x16x32_bf16 v[68:71], a[64:67], a[4:7], v[68:71]
    v_mfma_f32_16x16x32_bf16 v[72:75], a[64:67], a[8:11], v[72:75]
    v_mfma_f32_16x16x32_bf16 v[72:75], a[68:71], a[24:27], v[72:75]
    v_mfma_f32_16x16x32_bf16 v[76:79], a[68:71], a[28:31], v[76:79]
    v_mfma_f32_16x16x32_bf16 v[76:79], a[64:67], a[12:15], v[76:79]
    v_mfma_f32_16x16x32_bf16 v[92:95], a[72:75], a[12:15], v[92:95]
    v_mfma_f32_16x16x32_bf16 v[92:95], a[76:79], a[28:31], v[92:95]
    v_mfma_f32_16x16x32_bf16 v[88:91], a[76:79], a[24:27], v[88:91]
    v_mfma_f32_16x16x32_bf16 v[88:91], a[72:75], a[8:11], v[88:91]
    v_mfma_f32_16x16x32_bf16 v[84:87], a[72:75], a[4:7], v[84:87]
    v_mfma_f32_16x16x32_bf16 v[84:87], a[76:79], a[20:23], v[84:87]
    v_mfma_f32_16x16x32_bf16 v[80:83], a[76:79], a[16:19], v[80:83]
    v_mfma_f32_16x16x32_bf16 v[80:83], a[72:75], a[0:3], v[80:83]
    v_mfma_f32_16x16x32_bf16 v[96:99], a[80:83], a[0:3], v[96:99]
    v_mfma_f32_16x16x32_bf16 v[96:99], a[84:87], a[16:19], v[96:99]
    v_mfma_f32_16x16x32_bf16 v[100:103], a[84:87], a[20:23], v[100:103]
    v_mfma_f32_16x16x32_bf16 v[100:103], a[80:83], a[4:7], v[100:103]
    s_setprio 2
    s_barrier
    v_mfma_f32_16x16x32_bf16 v[104:107], a[80:83], a[8:11], v[104:107]
    v_mfma_f32_16x16x32_bf16 v[104:107], a[84:87], a[24:27], v[104:107]
    v_mfma_f32_16x16x32_bf16 v[108:111], a[84:87], a[28:31], v[108:111]
    v_mfma_f32_16x16x32_bf16 v[108:111], a[80:83], a[12:15], v[108:111]
    s_setprio 0
fused_kernel_sb10:
    ds_read_b128 a[0:3], v154 offset:0
    ds_read_b128 a[16:19], v155 offset:0
    s_add_u32 m0, s55, 4096
    s_nop 0
    buffer_load_dwordx4 v112, s[4:7], s23 offen offset:0 lds
    ds_read_b128 a[4:7], v154 offset:2048
    ds_read_b128 a[20:23], v155 offset:2048
    ds_read_b128 a[8:11], v154 offset:4096
    ds_read_b128 a[24:27], v155 offset:4096
    buffer_load_dwordx4 v113, s[4:7], s23 offen offset:1024 lds
    ds_read_b128 a[12:15], v154 offset:6144
    ds_read_b128 a[28:31], v155 offset:6144
    ds_read_b64_tr_b16 a[32:33], v156 offset:0
    ds_read_b64_tr_b16 a[34:35], v156 offset:1792
    buffer_load_dwordx4 v114, s[4:7], s23 offen offset:2048 lds
    ds_read_b64_tr_b16 a[36:37], v156 offset:7168
    ds_read_b64_tr_b16 a[38:39], v156 offset:8960
    ds_read_b64_tr_b16 a[40:41], v156 offset:32
    ds_read_b64_tr_b16 a[42:43], v156 offset:1824
    buffer_load_dwordx4 v115, s[4:7], s23 offen offset:3072 lds
    s_add_u32 s23, s23, 128
    ds_read_b64_tr_b16 a[44:45], v156 offset:7200
    ds_read_b64_tr_b16 a[46:47], v156 offset:8992
    ds_read_b64_tr_b16 a[48:49], v156 offset:64
    ds_read_b64_tr_b16 a[50:51], v156 offset:1856
    s_add_u32 m0, s32, 12288
    s_nop 0
    buffer_load_dwordx4 v116, s[8:11], s24 offen offset:0 lds
    ds_read_b64_tr_b16 a[52:53], v156 offset:7232
    ds_read_b64_tr_b16 a[54:55], v156 offset:9024
    ds_read_b64_tr_b16 a[56:57], v156 offset:96
    ds_read_b64_tr_b16 a[58:59], v156 offset:1888
    buffer_load_dwordx4 v117, s[8:11], s24 offen offset:1024 lds
    ds_read_b64_tr_b16 a[60:61], v156 offset:7264
    ds_read_b64_tr_b16 a[62:63], v156 offset:9056
    ds_read_b64_tr_b16 a[64:65], v156 offset:128
    ds_read_b64_tr_b16 a[66:67], v156 offset:1920
    buffer_load_dwordx4 v118, s[8:11], s24 offen offset:2048 lds
    s_add_u32 s24, s24, 393216
    ds_read_b64_tr_b16 a[68:69], v156 offset:7296
    ds_read_b64_tr_b16 a[70:71], v156 offset:9088
    ds_read_b64_tr_b16 a[72:73], v156 offset:160
    ds_read_b64_tr_b16 a[74:75], v156 offset:1952
    buffer_load_dword v124, v122, s[16:19], s25 offen
    ds_read_b64_tr_b16 a[76:77], v156 offset:7328
    ds_read_b64_tr_b16 a[78:79], v156 offset:9120
    ds_read_b64_tr_b16 a[80:81], v157 offset:0
    ds_read_b64_tr_b16 a[82:83], v157 offset:1792
    ds_read_b64_tr_b16 a[84:85], v157 offset:7168
    ds_read_b64_tr_b16 a[86:87], v157 offset:8960
    ds_read_b32 v121, v152
    ds_read_b32 v121, v152
    s_waitcnt vmcnt(9) lgkmcnt(2)
    s_barrier
    v_mfma_f32_16x16x32_bf16 v[0:3], a[32:35], a[0:3], v[0:3]
    v_mfma_f32_16x16x32_bf16 v[0:3], a[36:39], a[16:19], v[0:3]
    v_and_b32 v122, 7, v120
    v_mul_u32_u24 v122, 7, v122
    v_mfma_f32_16x16x32_bf16 v[4:7], a[36:39], a[20:23], v[4:7]
    v_lshrrev_b32 v123, 3, v120
    v_add_u32 v123, 6, v123
    v_mfma_f32_16x16x32_bf16 v[4:7], a[32:35], a[4:7], v[4:7]
    v_cmp_gt_u32 s[58:59], 7, v123
    v_add_lshl_u32 v122, v122, v123, 15
    v_mfma_f32_16x16x32_bf16 v[8:11], a[32:35], a[8:11], v[8:11]
    v_mov_b32 v123, 1073741824
    v_cndmask_b32 v122, v123, v122, s[58:59]
    v_mfma_f32_16x16x32_bf16 v[8:11], a[36:39], a[24:27], v[8:11]
    v_mfma_f32_16x16x32_bf16 v[12:15], a[36:39], a[28:31], v[12:15]
    v_mfma_f32_16x16x32_bf16 v[12:15], a[32:35], a[12:15], v[12:15]
    v_mfma_f32_16x16x32_bf16 v[28:31], a[40:43], a[12:15], v[28:31]
    v_mfma_f32_16x16x32_bf16 v[28:31], a[44:47], a[28:31], v[28:31]
    v_mfma_f32_16x16x32_bf16 v[24:27], a[44:47], a[24:27], v[24:27]
    v_mfma_f32_16x16x32_bf16 v[24:27], a[40:43], a[8:11], v[24:27]
    v_mfma_f32_16x16x32_bf16 v[20:23], a[40:43], a[4:7], v[20:23]
    v_mfma_f32_16x16x32_bf16 v[20:23], a[44:47], a[20:23], v[20:23]
    v_mfma_f32_16x16x32_bf16 v[16:19], a[44:47], a[16:19], v[16:19]
    v_mfma_f32_16x16x32_bf16 v[16:19], a[40:43], a[0:3], v[16:19]
    v_mfma_f32_16x16x32_bf16 v[32:35], a[48:51], a[0:3], v[32:35]
    v_mfma_f32_16x16x32_bf16 v[32:35], a[52:55], a[16:19], v[32:35]
    v_mfma_f32_16x16x32_bf16 v[36:39], a[52:55], a[20:23], v[36:39]
    v_mfma_f32_16x16x32_bf16 v[36:39], a[48:51], a[4:7], v[36:39]
    v_mfma_f32_16x16x32_bf16 v[40:43], a[48:51], a[8:11], v[40:43]
    v_mfma_f32_16x16x32_bf16 v[40:43], a[52:55], a[24:27], v[40:43]
    v_mfma_f32_16x16x32_bf16 v[44:47], a[52:55], a[28:31], v[44:47]
    v_mfma_f32_16x16x32_bf16 v[44:47], a[48:51], a[12:15], v[44:47]
    v_mfma_f32_16x16x32_bf16 v[60:63], a[56:59], a[12:15], v[60:63]
    v_mfma_f32_16x16x32_bf16 v[60:63], a[60:63], a[28:31], v[60:63]
    v_mfma_f32_16x16x32_bf16 v[56:59], a[60:63], a[24:27], v[56:59]
    v_mfma_f32_16x16x32_bf16 v[56:59], a[56:59], a[8:11], v[56:59]
    v_mfma_f32_16x16x32_bf16 v[52:55], a[56:59], a[4:7], v[52:55]
    v_mfma_f32_16x16x32_bf16 v[52:55], a[60:63], a[20:23], v[52:55]
    v_mfma_f32_16x16x32_bf16 v[48:51], a[60:63], a[16:19], v[48:51]
    v_mfma_f32_16x16x32_bf16 v[48:51], a[56:59], a[0:3], v[48:51]
    v_mfma_f32_16x16x32_bf16 v[64:67], a[64:67], a[0:3], v[64:67]
    v_mfma_f32_16x16x32_bf16 v[64:67], a[68:71], a[16:19], v[64:67]
    v_mfma_f32_16x16x32_bf16 v[68:71], a[68:71], a[20:23], v[68:71]
    v_mfma_f32_16x16x32_bf16 v[68:71], a[64:67], a[4:7], v[68:71]
    v_mfma_f32_16x16x32_bf16 v[72:75], a[64:67], a[8:11], v[72:75]
    v_mfma_f32_16x16x32_bf16 v[72:75], a[68:71], a[24:27], v[72:75]
    v_mfma_f32_16x16x32_bf16 v[76:79], a[68:71], a[28:31], v[76:79]
    v_mfma_f32_16x16x32_bf16 v[76:79], a[64:67], a[12:15], v[76:79]
    v_mfma_f32_16x16x32_bf16 v[92:95], a[72:75], a[12:15], v[92:95]
    v_mfma_f32_16x16x32_bf16 v[92:95], a[76:79], a[28:31], v[92:95]
    v_mfma_f32_16x16x32_bf16 v[88:91], a[76:79], a[24:27], v[88:91]
    v_mfma_f32_16x16x32_bf16 v[88:91], a[72:75], a[8:11], v[88:91]
    v_mfma_f32_16x16x32_bf16 v[84:87], a[72:75], a[4:7], v[84:87]
    v_mfma_f32_16x16x32_bf16 v[84:87], a[76:79], a[20:23], v[84:87]
    v_mfma_f32_16x16x32_bf16 v[80:83], a[76:79], a[16:19], v[80:83]
    v_mfma_f32_16x16x32_bf16 v[80:83], a[72:75], a[0:3], v[80:83]
    v_mfma_f32_16x16x32_bf16 v[96:99], a[80:83], a[0:3], v[96:99]
    v_mfma_f32_16x16x32_bf16 v[96:99], a[84:87], a[16:19], v[96:99]
    v_mfma_f32_16x16x32_bf16 v[100:103], a[84:87], a[20:23], v[100:103]
    v_mfma_f32_16x16x32_bf16 v[100:103], a[80:83], a[4:7], v[100:103]
    s_setprio 2
    s_barrier
    v_mfma_f32_16x16x32_bf16 v[104:107], a[80:83], a[8:11], v[104:107]
    v_mfma_f32_16x16x32_bf16 v[104:107], a[84:87], a[24:27], v[104:107]
    v_mfma_f32_16x16x32_bf16 v[108:111], a[84:87], a[28:31], v[108:111]
    v_mfma_f32_16x16x32_bf16 v[108:111], a[80:83], a[12:15], v[108:111]
    s_setprio 0
fused_kernel_sb11:
    ds_read_b128 a[0:3], v152 offset:32768
    ds_read_b128 a[16:19], v153 offset:32768
    s_add_u32 m0, s55, 69632
    s_nop 0
    buffer_load_dwordx4 v112, s[4:7], s23 offen offset:0 lds
    ds_read_b128 a[4:7], v152 offset:34816
    ds_read_b128 a[20:23], v153 offset:34816
    ds_read_b128 a[8:11], v152 offset:36864
    ds_read_b128 a[24:27], v153 offset:36864
    buffer_load_dwordx4 v113, s[4:7], s23 offen offset:1024 lds
    ds_read_b128 a[12:15], v152 offset:38912
    ds_read_b128 a[28:31], v153 offset:38912
    ds_read_b64_tr_b16 a[32:33], v156 offset:14336
    ds_read_b64_tr_b16 a[34:35], v156 offset:16128
    buffer_load_dwordx4 v114, s[4:7], s23 offen offset:2048 lds
    ds_read_b64_tr_b16 a[36:37], v156 offset:21504
    ds_read_b64_tr_b16 a[38:39], v156 offset:23296
    ds_read_b64_tr_b16 a[40:41], v156 offset:14368
    ds_read_b64_tr_b16 a[42:43], v156 offset:16160
    buffer_load_dwordx4 v115, s[4:7], s23 offen offset:3072 lds
    s_add_u32 s23, s23, 128
    ds_read_b64_tr_b16 a[44:45], v156 offset:21536
    ds_read_b64_tr_b16 a[46:47], v156 offset:23328
    ds_read_b64_tr_b16 a[48:49], v156 offset:14400
    ds_read_b64_tr_b16 a[50:51], v156 offset:16192
    s_add_u32 m0, s32, 0
    s_nop 0
    buffer_load_dwordx4 v116, s[8:11], s24 offen offset:0 lds
    ds_read_b64_tr_b16 a[52:53], v156 offset:21568
    ds_read_b64_tr_b16 a[54:55], v156 offset:23360
    ds_read_b64_tr_b16 a[56:57], v156 offset:14432
fused_kernel_pg3:
    s_cbranch_execz fused_kernel_pg11
    ds_read_b64_tr_b16 a[58:59], v156 offset:16224
    buffer_load_dwordx4 v117, s[8:11], s24 offen offset:1024 lds
    ds_read_b64_tr_b16 a[60:61], v156 offset:21600
    ds_read_b64_tr_b16 a[62:63], v156 offset:23392
    ds_read_b64_tr_b16 a[64:65], v156 offset:14464
    ds_read_b64_tr_b16 a[66:67], v156 offset:16256
    buffer_load_dwordx4 v118, s[8:11], s24 offen offset:2048 lds
    s_add_u32 s24, s24, 393216
    ds_read_b64_tr_b16 a[68:69], v156 offset:21632
    ds_read_b64_tr_b16 a[70:71], v156 offset:23424
    ds_read_b64_tr_b16 a[72:73], v156 offset:14496
    ds_read_b64_tr_b16 a[74:75], v156 offset:16288
    buffer_load_dword v124, v122, s[16:19], s25 offen
    ds_read_b64_tr_b16 a[76:77], v156 offset:21664
    ds_read_b64_tr_b16 a[78:79], v156 offset:23456
    ds_read_b64_tr_b16 a[80:81], v157 offset:14336
    ds_read_b64_tr_b16 a[82:83], v157 offset:16128
    ds_read_b64_tr_b16 a[84:85], v157 offset:21504
    ds_read_b64_tr_b16 a[86:87], v157 offset:23296
    s_waitcnt vmcnt(9) lgkmcnt(0)
    s_barrier
    v_mfma_f32_16x16x32_bf16 v[0:3], a[32:35], a[0:3], v[0:3]
    v_mfma_f32_16x16x32_bf16 v[0:3], a[36:39], a[16:19], v[0:3]
    v_lshlrev_b32 v122, 15, v120
    v_cmp_gt_u32 s[58:59], 16, v120
    v_mfma_f32_16x16x32_bf16 v[4:7], a[36:39], a[20:23], v[4:7]
    v_mov_b32 v123, 1073741824
    v_cndmask_b32 v122, v123, v122, s[58:59]
    v_mfma_f32_16x16x32_bf16 v[4:7], a[32:35], a[4:7], v[4:7]
    v_mfma_f32_16x16x32_bf16 v[8:11], a[32:35], a[8:11], v[8:11]
    v_mfma_f32_16x16x32_bf16 v[8:11], a[36:39], a[24:27], v[8:11]
    v_mfma_f32_16x16x32_bf16 v[12:15], a[36:39], a[28:31], v[12:15]
    v_mfma_f32_16x16x32_bf16 v[12:15], a[32:35], a[12:15], v[12:15]
    v_mfma_f32_16x16x32_bf16 v[28:31], a[40:43], a[12:15], v[28:31]
    v_mfma_f32_16x16x32_bf16 v[28:31], a[44:47], a[28:31], v[28:31]
    v_mfma_f32_16x16x32_bf16 v[24:27], a[44:47], a[24:27], v[24:27]
    v_mfma_f32_16x16x32_bf16 v[24:27], a[40:43], a[8:11], v[24:27]
    v_mfma_f32_16x16x32_bf16 v[20:23], a[40:43], a[4:7], v[20:23]
    v_mfma_f32_16x16x32_bf16 v[20:23], a[44:47], a[20:23], v[20:23]
    v_mfma_f32_16x16x32_bf16 v[16:19], a[44:47], a[16:19], v[16:19]
    v_mfma_f32_16x16x32_bf16 v[16:19], a[40:43], a[0:3], v[16:19]
    v_mfma_f32_16x16x32_bf16 v[32:35], a[48:51], a[0:3], v[32:35]
    v_mfma_f32_16x16x32_bf16 v[32:35], a[52:55], a[16:19], v[32:35]
    v_mfma_f32_16x16x32_bf16 v[36:39], a[52:55], a[20:23], v[36:39]
    v_mfma_f32_16x16x32_bf16 v[36:39], a[48:51], a[4:7], v[36:39]
    v_mfma_f32_16x16x32_bf16 v[40:43], a[48:51], a[8:11], v[40:43]
    v_mfma_f32_16x16x32_bf16 v[40:43], a[52:55], a[24:27], v[40:43]
    v_mfma_f32_16x16x32_bf16 v[44:47], a[52:55], a[28:31], v[44:47]
    v_mfma_f32_16x16x32_bf16 v[44:47], a[48:51], a[12:15], v[44:47]
    v_mfma_f32_16x16x32_bf16 v[60:63], a[56:59], a[12:15], v[60:63]
    v_mfma_f32_16x16x32_bf16 v[60:63], a[60:63], a[28:31], v[60:63]
    v_mfma_f32_16x16x32_bf16 v[56:59], a[60:63], a[24:27], v[56:59]
    v_mfma_f32_16x16x32_bf16 v[56:59], a[56:59], a[8:11], v[56:59]
    v_mfma_f32_16x16x32_bf16 v[52:55], a[56:59], a[4:7], v[52:55]
    v_mfma_f32_16x16x32_bf16 v[52:55], a[60:63], a[20:23], v[52:55]
    v_mfma_f32_16x16x32_bf16 v[48:51], a[60:63], a[16:19], v[48:51]
    v_mfma_f32_16x16x32_bf16 v[48:51], a[56:59], a[0:3], v[48:51]
    v_mfma_f32_16x16x32_bf16 v[64:67], a[64:67], a[0:3], v[64:67]
    v_mfma_f32_16x16x32_bf16 v[64:67], a[68:71], a[16:19], v[64:67]
    v_mfma_f32_16x16x32_bf16 v[68:71], a[68:71], a[20:23], v[68:71]
    v_mfma_f32_16x16x32_bf16 v[68:71], a[64:67], a[4:7], v[68:71]
    v_mfma_f32_16x16x32_bf16 v[72:75], a[64:67], a[8:11], v[72:75]
    v_mfma_f32_16x16x32_bf16 v[72:75], a[68:71], a[24:27], v[72:75]
    v_mfma_f32_16x16x32_bf16 v[76:79], a[68:71], a[28:31], v[76:79]
    v_mfma_f32_16x16x32_bf16 v[76:79], a[64:67], a[12:15], v[76:79]
    v_mfma_f32_16x16x32_bf16 v[92:95], a[72:75], a[12:15], v[92:95]
    v_mfma_f32_16x16x32_bf16 v[92:95], a[76:79], a[28:31], v[92:95]
    v_mfma_f32_16x16x32_bf16 v[88:91], a[76:79], a[24:27], v[88:91]
    v_mfma_f32_16x16x32_bf16 v[88:91], a[72:75], a[8:11], v[88:91]
    v_mfma_f32_16x16x32_bf16 v[84:87], a[72:75], a[4:7], v[84:87]
    v_mfma_f32_16x16x32_bf16 v[84:87], a[76:79], a[20:23], v[84:87]
    v_mfma_f32_16x16x32_bf16 v[80:83], a[76:79], a[16:19], v[80:83]
    v_mfma_f32_16x16x32_bf16 v[80:83], a[72:75], a[0:3], v[80:83]
    v_mfma_f32_16x16x32_bf16 v[96:99], a[80:83], a[0:3], v[96:99]
    v_mfma_f32_16x16x32_bf16 v[96:99], a[84:87], a[16:19], v[96:99]
    v_mfma_f32_16x16x32_bf16 v[100:103], a[84:87], a[20:23], v[100:103]
    v_mfma_f32_16x16x32_bf16 v[100:103], a[80:83], a[4:7], v[100:103]
    s_setprio 2
    s_barrier
    v_mfma_f32_16x16x32_bf16 v[104:107], a[80:83], a[8:11], v[104:107]
    v_mfma_f32_16x16x32_bf16 v[104:107], a[84:87], a[24:27], v[104:107]
    v_mfma_f32_16x16x32_bf16 v[108:111], a[84:87], a[28:31], v[108:111]
    v_mfma_f32_16x16x32_bf16 v[108:111], a[80:83], a[12:15], v[108:111]
    s_setprio 0
fused_kernel_sb12:
    ds_read_b128 a[0:3], v152 offset:0
    ds_read_b128 a[16:19], v153 offset:0
    s_add_u32 m0, s55, 36864
    s_nop 0
    buffer_load_dwordx4 v112, s[4:7], s23 offen offset:0 lds
    ds_read_b128 a[4:7], v152 offset:2048
    ds_read_b128 a[20:23], v153 offset:2048
    ds_read_b128 a[8:11], v152 offset:4096
    ds_read_b128 a[24:27], v153 offset:4096
    buffer_load_dwordx4 v113, s[4:7], s23 offen offset:1024 lds
    ds_read_b128 a[12:15], v152 offset:6144
    ds_read_b128 a[28:31], v153 offset:6144
    ds_read_b64_tr_b16 a[32:33], v156 offset:0
    ds_read_b64_tr_b16 a[34:35], v156 offset:1792
    buffer_load_dwordx4 v114, s[4:7], s23 offen offset:2048 lds
    ds_read_b64_tr_b16 a[36:37], v156 offset:7168
    ds_read_b64_tr_b16 a[38:39], v156 offset:8960
    ds_read_b64_tr_b16 a[40:41], v156 offset:32
    ds_read_b64_tr_b16 a[42:43], v156 offset:1824
    buffer_load_dwordx4 v115, s[4:7], s23 offen offset:3072 lds
    s_add_u32 s23, s23, 128
    ds_read_b64_tr_b16 a[44:45], v156 offset:7200
    ds_read_b64_tr_b16 a[46:47], v156 offset:8992
    ds_read_b64_tr_b16 a[48:49], v156 offset:64
    ds_read_b64_tr_b16 a[50:51], v156 offset:1856
    s_add_u32 m0, s32, 12288
    s_nop 0
    buffer_load_dwordx4 v116, s[8:11], s24 offen offset:0 lds
    ds_read_b64_tr_b16 a[52:53], v156 offset:7232
    ds_read_b64_tr_b16 a[54:55], v156 offset:9024
    ds_read_b64_tr_b16 a[56:57], v156 offset:96
    ds_read_b64_tr_b16 a[58:59], v156 offset:1888
    buffer_load_dwordx4 v117, s[8:11], s24 offen offset:1024 lds
    ds_read_b64_tr_b16 a[60:61], v156 offset:7264
    ds_read_b64_tr_b16 a[62:63], v156 offset:9056
    ds_read_b64_tr_b16 a[64:65], v156 offset:128
    ds_read_b64_tr_b16 a[66:67], v156 offset:1920
    buffer_load_dwordx4 v118, s[8:11], s24 offen offset:2048 lds
    s_add_u32 s24, s24, 393216
    ds_read_b64_tr_b16 a[68:69], v156 offset:7296
    ds_read_b64_tr_b16 a[70:71], v156 offset:9088
    ds_read_b64_tr_b16 a[72:73], v156 offset:160
    ds_read_b64_tr_b16 a[74:75], v156 offset:1952
    buffer_load_dword v124, v122, s[84:87], s22 offen
    ds_read_b64_tr_b16 a[76:77], v156 offset:7328
    ds_read_b64_tr_b16 a[78:79], v156 offset:9120
    ds_read_b64_tr_b16 a[80:81], v157 offset:0
    ds_read_b64_tr_b16 a[82:83], v157 offset:1792
    ds_read_b64_tr_b16 a[84:85], v157 offset:7168
    ds_read_b64_tr_b16 a[86:87], v157 offset:8960
    s_waitcnt vmcnt(9) lgkmcnt(0)
    s_barrier
    v_mfma_f32_16x16x32_bf16 v[0:3], a[32:35], a[0:3], v[0:3]
    v_mfma_f32_16x16x32_bf16 v[0:3], a[36:39], a[16:19], v[0:3]
    v_lshlrev_b32 v149, 5, v120
    v_lshlrev_b32 v130, 9, v120
    v_mfma_f32_16x16x32_bf16 v[4:7], a[36:39], a[20:23], v[4:7]
    v_cmp_gt_u32 s[30:31], 3, v120
    v_mov_b32 v131, 1073741824
    v_mfma_f32_16x16x32_bf16 v[4:7], a[32:35], a[4:7], v[4:7]
    v_cndmask_b32 v130, v131, v130, s[30:31]
    v_mfma_f32_16x16x32_bf16 v[8:11], a[32:35], a[8:11], v[8:11]
    v_mfma_f32_16x16x32_bf16 v[8:11], a[36:39], a[24:27], v[8:11]
    v_mfma_f32_16x16x32_bf16 v[12:15], a[36:39], a[28:31], v[12:15]
    v_mfma_f32_16x16x32_bf16 v[12:15], a[32:35], a[12:15], v[12:15]
    v_mfma_f32_16x16x32_bf16 v[28:31], a[40:43], a[12:15], v[28:31]
    v_mfma_f32_16x16x32_bf16 v[28:31], a[44:47], a[28:31], v[28:31]
    v_mfma_f32_16x16x32_bf16 v[24:27], a[44:47], a[24:27], v[24:27]
    v_mfma_f32_16x16x32_bf16 v[24:27], a[40:43], a[8:11], v[24:27]
    v_mfma_f32_16x16x32_bf16 v[20:23], a[40:43], a[4:7], v[20:23]
    v_mfma_f32_16x16x32_bf16 v[20:23], a[44:47], a[20:23], v[20:23]
    v_mfma_f32_16x16x32_bf16 v[16:19], a[44:47], a[16:19], v[16:19]
    v_mfma_f32_16x16x32_bf16 v[16:19], a[40:43], a[0:3], v[16:19]
    v_mfma_f32_16x16x32_bf16 v[32:35], a[48:51], a[0:3], v[32:35]
    v_mfma_f32_16x16x32_bf16 v[32:35], a[52:55], a[16:19], v[32:35]
    v_mfma_f32_16x16x32_bf16 v[36:39], a[52:55], a[20:23], v[36:39]
    v_mfma_f32_16x16x32_bf16 v[36:39], a[48:51], a[4:7], v[36:39]
    v_mfma_f32_16x16x32_bf16 v[40:43], a[48:51], a[8:11], v[40:43]
    v_mfma_f32_16x16x32_bf16 v[40:43], a[52:55], a[24:27], v[40:43]
    v_mfma_f32_16x16x32_bf16 v[44:47], a[52:55], a[28:31], v[44:47]
    v_mfma_f32_16x16x32_bf16 v[44:47], a[48:51], a[12:15], v[44:47]
    v_mfma_f32_16x16x32_bf16 v[60:63], a[56:59], a[12:15], v[60:63]
    v_mfma_f32_16x16x32_bf16 v[60:63], a[60:63], a[28:31], v[60:63]
    v_mfma_f32_16x16x32_bf16 v[56:59], a[60:63], a[24:27], v[56:59]
    v_mfma_f32_16x16x32_bf16 v[56:59], a[56:59], a[8:11], v[56:59]
    v_mfma_f32_16x16x32_bf16 v[52:55], a[56:59], a[4:7], v[52:55]
    v_mfma_f32_16x16x32_bf16 v[52:55], a[60:63], a[20:23], v[52:55]
    v_mfma_f32_16x16x32_bf16 v[48:51], a[60:63], a[16:19], v[48:51]
    v_mfma_f32_16x16x32_bf16 v[48:51], a[56:59], a[0:3], v[48:51]
    v_mfma_f32_16x16x32_bf16 v[64:67], a[64:67], a[0:3], v[64:67]
    v_mfma_f32_16x16x32_bf16 v[64:67], a[68:71], a[16:19], v[64:67]
    v_mfma_f32_16x16x32_bf16 v[68:71], a[68:71], a[20:23], v[68:71]
    v_mfma_f32_16x16x32_bf16 v[68:71], a[64:67], a[4:7], v[68:71]
    v_mfma_f32_16x16x32_bf16 v[72:75], a[64:67], a[8:11], v[72:75]
    v_mfma_f32_16x16x32_bf16 v[72:75], a[68:71], a[24:27], v[72:75]
    v_mfma_f32_16x16x32_bf16 v[76:79], a[68:71], a[28:31], v[76:79]
    v_mfma_f32_16x16x32_bf16 v[76:79], a[64:67], a[12:15], v[76:79]
    v_mfma_f32_16x16x32_bf16 v[92:95], a[72:75], a[12:15], v[92:95]
    v_mfma_f32_16x16x32_bf16 v[92:95], a[76:79], a[28:31], v[92:95]
    v_mfma_f32_16x16x32_bf16 v[88:91], a[76:79], a[24:27], v[88:91]
    v_mfma_f32_16x16x32_bf16 v[88:91], a[72:75], a[8:11], v[88:91]
    v_mfma_f32_16x16x32_bf16 v[84:87], a[72:75], a[4:7], v[84:87]
    v_mfma_f32_16x16x32_bf16 v[84:87], a[76:79], a[20:23], v[84:87]
    v_mfma_f32_16x16x32_bf16 v[80:83], a[76:79], a[16:19], v[80:83]
    v_mfma_f32_16x16x32_bf16 v[80:83], a[72:75], a[0:3], v[80:83]
    v_mfma_f32_16x16x32_bf16 v[96:99], a[80:83], a[0:3], v[96:99]
    v_mfma_f32_16x16x32_bf16 v[96:99], a[84:87], a[16:19], v[96:99]
    v_mfma_f32_16x16x32_bf16 v[100:103], a[84:87], a[20:23], v[100:103]
    v_mfma_f32_16x16x32_bf16 v[100:103], a[80:83], a[4:7], v[100:103]
    s_setprio 2
    s_barrier
    v_mfma_f32_16x16x32_bf16 v[104:107], a[80:83], a[8:11], v[104:107]
    v_mfma_f32_16x16x32_bf16 v[104:107], a[84:87], a[24:27], v[104:107]
    v_mfma_f32_16x16x32_bf16 v[108:111], a[84:87], a[28:31], v[108:111]
    v_mfma_f32_16x16x32_bf16 v[108:111], a[80:83], a[12:15], v[108:111]
    s_setprio 0
fused_kernel_sb13:
    ds_read_b128 a[0:3], v154 offset:0
    ds_read_b128 a[16:19], v155 offset:0
    s_add_u32 m0, s55, 4096
    s_nop 0
    buffer_load_dwordx4 v112, s[4:7], s23 offen offset:0 lds
    ds_read_b128 a[4:7], v154 offset:2048
    ds_read_b128 a[20:23], v155 offset:2048
    ds_read_b128 a[8:11], v154 offset:4096
    buffer_load_dwordx4 v113, s[4:7], s23 offen offset:1024 lds
    ds_read_b128 a[24:27], v155 offset:4096
    ds_read_b128 a[12:15], v154 offset:6144
    ds_read_b128 a[28:31], v155 offset:6144
    ds_read_b64_tr_b16 a[32:33], v156 offset:14336
    buffer_load_dwordx4 v114, s[4:7], s23 offen offset:2048 lds
    ds_read_b64_tr_b16 a[34:35], v156 offset:16128
    ds_read_b64_tr_b16 a[36:37], v156 offset:21504
    ds_read_b64_tr_b16 a[38:39], v156 offset:23296
    buffer_load_dwordx4 v115, s[4:7], s23 offen offset:3072 lds
    s_add_u32 s23, s23, 128
    ds_read_b64_tr_b16 a[40:41], v156 offset:14368
    ds_read_b64_tr_b16 a[42:43], v156 offset:16160
    ds_read_b64_tr_b16 a[44:45], v156 offset:21536
    ds_read_b64_tr_b16 a[46:47], v156 offset:23328
    s_add_u32 m0, s32, 0
    s_nop 0
    buffer_load_dwordx4 v116, s[8:11], s24 offen offset:0 lds
    ds_read_b64_tr_b16 a[48:49], v156 offset:14400
    ds_read_b64_tr_b16 a[50:51], v156 offset:16192
    ds_read_b64_tr_b16 a[52:53], v156 offset:21568
    buffer_load_dwordx4 v117, s[8:11], s24 offen offset:1024 lds
    ds_read_b64_tr_b16 a[54:55], v156 offset:23360
    ds_read_b64_tr_b16 a[56:57], v156 offset:14432
    ds_read_b64_tr_b16 a[58:59], v156 offset:16224
    ds_read_b64_tr_b16 a[60:61], v156 offset:21600
    buffer_load_dwordx4 v118, s[8:11], s24 offen offset:2048 lds
    s_add_u32 s24, s24, 393216
    ds_read_b64_tr_b16 a[62:63], v156 offset:23392
    ds_read_b64_tr_b16 a[64:65], v156 offset:14464
    ds_read_b64_tr_b16 a[66:67], v156 offset:16256
    buffer_load_dword v150, v149, s[36:39], s3 offen offset:4 sc1
    ds_read_b64_tr_b16 a[68:69], v156 offset:21632
    ds_read_b64_tr_b16 a[70:71], v156 offset:23424
    ds_read_b64_tr_b16 a[72:73], v156 offset:14496
    ds_read_b64_tr_b16 a[74:75], v156 offset:16288
    buffer_load_dword v131, v130, s[12:15], s57 offen sc1
    ds_read_b64_tr_b16 a[76:77], v156 offset:21664
    ds_read_b64_tr_b16 a[78:79], v156 offset:23456
    ds_read_b64_tr_b16 a[80:81], v157 offset:14336
    ds_read_b64_tr_b16 a[82:83], v157 offset:16128
    ds_read_b64_tr_b16 a[84:85], v157 offset:21504
    ds_read_b64_tr_b16 a[86:87], v157 offset:23296
    s_waitcnt vmcnt(10) lgkmcnt(0)
    s_barrier
    v_mfma_f32_16x16x32_bf16 v[0:3], a[32:35], a[0:3], v[0:3]
    v_mfma_f32_16x16x32_bf16 v[0:3], a[36:39], a[16:19], v[0:3]
    s_and_b32 s40, s29, 7
    v_bfe_u32 v122, v120, 2, 3
    v_mfma_f32_16x16x32_bf16 v[4:7], a[36:39], a[20:23], v[4:7]
    v_lshrrev_b32 v123, 1, v122
    v_lshlrev_b32 v123, 5, v123
    v_mfma_f32_16x16x32_bf16 v[4:7], a[32:35], a[4:7], v[4:7]
    v_lshl_add_u32 v123, v122, 7, v123
    v_lshrrev_b32 v122, 5, v120
    v_mfma_f32_16x16x32_bf16 v[8:11], a[32:35], a[8:11], v[8:11]
    v_lshl_add_u32 v123, v122, 11, v123
    v_and_b32 v124, 3, v120
    v_mfma_f32_16x16x32_bf16 v[8:11], a[36:39], a[24:27], v[8:11]
    v_lshl_add_u32 v123, v124, 3, v123
    v_add_u32 v144, 65536, v123
    v_mfma_f32_16x16x32_bf16 v[12:15], a[36:39], a[28:31], v[12:15]
    v_xor_b32 v145, 32, v144
    v_xor_b32 v146, 64, v144
    v_mfma_f32_16x16x32_bf16 v[12:15], a[32:35], a[12:15], v[12:15]
    v_xor_b32 v147, 96, v144
    v_and_b32 v149, 7, v120
    v_mfma_f32_16x16x32_bf16 v[28:31], a[40:43], a[12:15], v[28:31]
    v_lshlrev_b32 v149, 2, v149
    s_and_b32 s58, s57, 0xffffffe0
    v_mfma_f32_16x16x32_bf16 v[28:31], a[44:47], a[28:31], v[28:31]
    v_mov_b32 v124, 1073741824
    v_cmp_eq_u32 vcc, 0, v120
    v_mfma_f32_16x16x32_bf16 v[24:27], a[44:47], a[24:27], v[24:27]
    v_and_b32 v123, 15, v120
    v_lshlrev_b32 v123, 4, v123
    v_mfma_f32_16x16x32_bf16 v[24:27], a[40:43], a[8:11], v[24:27]
    v_cndmask_b32 v148, v124, 0, vcc
    v_lshl_add_u32 v123, v122, 8, v123
    v_mfma_f32_16x16x32_bf16 v[20:23], a[40:43], a[4:7], v[20:23]
    v_bfe_u32 v122, v120, 4, 1
    v_lshl_add_u32 v123, v122, 3, v123
    v_mfma_f32_16x16x32_bf16 v[20:23], a[44:47], a[20:23], v[20:23]
    s_and_b32 s42, s29, 1
    s_lshl_b32 s42, s42, 9
    v_mfma_f32_16x16x32_bf16 v[16:19], a[44:47], a[16:19], v[16:19]
    v_add_u32 v143, s42, v123
    s_lshl_b32 s51, s40, 12
    v_mfma_f32_16x16x32_bf16 v[16:19], a[40:43], a[0:3], v[16:19]
    s_lshl_b32 s44, s28, 2
    s_add_u32 s44, s44, s20
    v_mfma_f32_16x16x32_bf16 v[32:35], a[48:51], a[0:3], v[32:35]
    s_lshl_b32 s44, s44, 2
    s_add_u32 s44, s44, s43
    v_mfma_f32_16x16x32_bf16 v[32:35], a[52:55], a[16:19], v[32:35]
    s_mul_i32 s44, s44, 147456
    s_xor_b32 s42, s40, 0
    v_mfma_f32_16x16x32_bf16 v[36:39], a[52:55], a[20:23], v[36:39]
    s_mul_i32 s42, s42, 7
    s_add_u32 s42, s42, 1
    v_mfma_f32_16x16x32_bf16 v[36:39], a[48:51], a[4:7], v[36:39]
    s_lshr_b32 s42, s42, 1
    s_lshl_b32 s42, s42, 12
    v_mfma_f32_16x16x32_bf16 v[40:43], a[48:51], a[8:11], v[40:43]
    s_add_u32 s64, s42, s44
    s_xor_b32 s42, s40, 1
    v_mfma_f32_16x16x32_bf16 v[40:43], a[52:55], a[24:27], v[40:43]
    s_mul_i32 s42, s42, 7
    s_add_u32 s42, s42, 1
    v_mfma_f32_16x16x32_bf16 v[44:47], a[52:55], a[28:31], v[44:47]
    s_lshr_b32 s42, s42, 1
    s_lshl_b32 s42, s42, 12
    v_mfma_f32_16x16x32_bf16 v[44:47], a[48:51], a[12:15], v[44:47]
    s_add_u32 s65, s42, s44
    s_xor_b32 s42, s40, 2
    v_mfma_f32_16x16x32_bf16 v[60:63], a[56:59], a[12:15], v[60:63]
    s_mul_i32 s42, s42, 7
    s_add_u32 s42, s42, 1
    v_mfma_f32_16x16x32_bf16 v[60:63], a[60:63], a[28:31], v[60:63]
    s_lshr_b32 s42, s42, 1
    s_lshl_b32 s42, s42, 12
    v_mfma_f32_16x16x32_bf16 v[56:59], a[60:63], a[24:27], v[56:59]
    s_add_u32 s66, s42, s44
    s_xor_b32 s42, s40, 3
    v_mfma_f32_16x16x32_bf16 v[56:59], a[56:59], a[8:11], v[56:59]
    s_mul_i32 s42, s42, 7
    s_add_u32 s42, s42, 1
    v_mfma_f32_16x16x32_bf16 v[52:55], a[56:59], a[4:7], v[52:55]
    s_lshr_b32 s42, s42, 1
    s_lshl_b32 s42, s42, 12
    v_mfma_f32_16x16x32_bf16 v[52:55], a[60:63], a[20:23], v[52:55]
    s_add_u32 s67, s42, s44
    s_xor_b32 s42, s40, 4
    v_mfma_f32_16x16x32_bf16 v[48:51], a[60:63], a[16:19], v[48:51]
    s_mul_i32 s42, s42, 7
    s_add_u32 s42, s42, 1
    v_mfma_f32_16x16x32_bf16 v[48:51], a[56:59], a[0:3], v[48:51]
    s_lshr_b32 s42, s42, 1
    s_lshl_b32 s42, s42, 12
    v_mfma_f32_16x16x32_bf16 v[64:67], a[64:67], a[0:3], v[64:67]
    s_add_u32 s70, s42, s44
    s_xor_b32 s42, s40, 5
    v_mfma_f32_16x16x32_bf16 v[64:67], a[68:71], a[16:19], v[64:67]
    s_mul_i32 s42, s42, 7
    s_add_u32 s42, s42, 1
    v_mfma_f32_16x16x32_bf16 v[68:71], a[68:71], a[20:23], v[68:71]
    s_lshr_b32 s42, s42, 1
    s_lshl_b32 s42, s42, 12
    v_mfma_f32_16x16x32_bf16 v[68:71], a[64:67], a[4:7], v[68:71]
    s_add_u32 s71, s42, s44
    s_xor_b32 s42, s40, 6
    v_mfma_f32_16x16x32_bf16 v[72:75], a[64:67], a[8:11], v[72:75]
    s_mul_i32 s42, s42, 7
    s_add_u32 s42, s42, 1
    v_mfma_f32_16x16x32_bf16 v[72:75], a[68:71], a[24:27], v[72:75]
    s_lshr_b32 s42, s42, 1
    s_lshl_b32 s42, s42, 12
    v_mfma_f32_16x16x32_bf16 v[76:79], a[68:71], a[28:31], v[76:79]
    s_add_u32 s72, s42, s44
    s_xor_b32 s42, s40, 7
    v_mfma_f32_16x16x32_bf16 v[76:79], a[64:67], a[12:15], v[76:79]
    s_mul_i32 s42, s42, 7
    s_add_u32 s42, s42, 1
    v_mfma_f32_16x16x32_bf16 v[92:95], a[72:75], a[12:15], v[92:95]
    s_lshr_b32 s42, s42, 1
    s_lshl_b32 s42, s42, 12
    v_mfma_f32_16x16x32_bf16 v[92:95], a[76:79], a[28:31], v[92:95]
    s_add_u32 s73, s42, s44
    s_and_b32 s42, s40, 1
    v_mfma_f32_16x16x32_bf16 v[88:91], a[76:79], a[24:27], v[88:91]
    s_lshl_b32 s42, s42, 14
    s_sub_u32 s27, 12288, s42
    v_mfma_f32_16x16x32_bf16 v[88:91], a[72:75], a[8:11], v[88:91]
    s_add_u32 s44, s44, 114688
    v_mfma_f32_16x16x32_bf16 v[84:87], a[72:75], a[4:7], v[84:87]
    v_mfma_f32_16x16x32_bf16 v[84:87], a[76:79], a[20:23], v[84:87]
    v_mfma_f32_16x16x32_bf16 v[80:83], a[76:79], a[16:19], v[80:83]
    v_mfma_f32_16x16x32_bf16 v[80:83], a[72:75], a[0:3], v[80:83]
    v_mfma_f32_16x16x32_bf16 v[96:99], a[80:83], a[0:3], v[96:99]
    v_mfma_f32_16x16x32_bf16 v[96:99], a[84:87], a[16:19], v[96:99]
    v_mfma_f32_16x16x32_bf16 v[100:103], a[84:87], a[20:23], v[100:103]
    v_mfma_f32_16x16x32_bf16 v[100:103], a[80:83], a[4:7], v[100:103]
    s_setprio 2
    s_barrier
    v_mfma_f32_16x16x32_bf16 v[104:107], a[80:83], a[8:11], v[104:107]
    v_mfma_f32_16x16x32_bf16 v[104:107], a[84:87], a[24:27], v[104:107]
    v_mfma_f32_16x16x32_bf16 v[108:111], a[84:87], a[28:31], v[108:111]
    v_mfma_f32_16x16x32_bf16 v[108:111], a[80:83], a[12:15], v[108:111]
    s_setprio 0
fused_kernel_sb14:
    ds_read_b128 a[0:3], v152 offset:32768
    ds_read_b128 a[16:19], v153 offset:32768
    s_add_u32 m0, s32, 12288
    s_nop 0
    buffer_load_dwordx4 v116, s[8:11], s24 offen offset:0 lds
    ds_read_b128 a[4:7], v152 offset:34816
    ds_read_b128 a[20:23], v153 offset:34816
    ds_read_b128 a[8:11], v152 offset:36864
    ds_read_b128 a[24:27], v153 offset:36864
    ds_read_b128 a[12:15], v152 offset:38912
    ds_read_b128 a[28:31], v153 offset:38912
    ds_read_b64_tr_b16 a[32:33], v156 offset:0
    ds_read_b64_tr_b16 a[34:35], v156 offset:1792
    ds_read_b64_tr_b16 a[36:37], v156 offset:7168
    ds_read_b64_tr_b16 a[38:39], v156 offset:8960
    buffer_load_dwordx4 v117, s[8:11], s24 offen offset:1024 lds
    ds_read_b64_tr_b16 a[40:41], v156 offset:32
    ds_read_b64_tr_b16 a[42:43], v156 offset:1824
    ds_read_b64_tr_b16 a[44:45], v156 offset:7200
    ds_read_b64_tr_b16 a[46:47], v156 offset:8992
    ds_read_b64_tr_b16 a[48:49], v156 offset:64
    ds_read_b64_tr_b16 a[50:51], v156 offset:1856
    ds_read_b64_tr_b16 a[52:53], v156 offset:7232
    ds_read_b64_tr_b16 a[54:55], v156 offset:9024
    ds_read_b64_tr_b16 a[56:57], v156 offset:96
    ds_read_b64_tr_b16 a[58:59], v156 offset:1888
    ds_read_b64_tr_b16 a[60:61], v156 offset:7264
    buffer_load_dwordx4 v118, s[8:11], s24 offen offset:2048 lds
    s_add_u32 s24, s24, 393216
    ds_read_b64_tr_b16 a[62:63], v156 offset:9056
    ds_read_b64_tr_b16 a[64:65], v156 offset:128
    ds_read_b64_tr_b16 a[66:67], v156 offset:1920
    ds_read_b64_tr_b16 a[68:69], v156 offset:7296
    ds_read_b64_tr_b16 a[70:71], v156 offset:9088
    ds_read_b64_tr_b16 a[72:73], v156 offset:160
    ds_read_b64_tr_b16 a[74:75], v156 offset:1952
    ds_read_b64_tr_b16 a[76:77], v156 offset:7328
    ds_read_b64_tr_b16 a[78:79], v156 offset:9120
    ds_read_b64_tr_b16 a[80:81], v157 offset:0
    ds_read_b64_tr_b16 a[82:83], v157 offset:1792
    ds_read_b64_tr_b16 a[84:85], v157 offset:7168
    ds_read_b64_tr_b16 a[86:87], v157 offset:8960
    s_waitcnt vmcnt(5) lgkmcnt(0)
    s_barrier
    v_mfma_f32_16x16x32_bf16 v[0:3], a[32:35], a[0:3], v[0:3]
    v_mfma_f32_16x16x32_bf16 v[0:3], a[36:39], a[16:19], v[0:3]
    s_waitcnt vmcnt(4)
    v_readfirstlane_b32 s26, v150
    v_mfma_f32_16x16x32_bf16 v[4:7], a[36:39], a[20:23], v[4:7]
    v_readlane_b32 s59, v150, 1
    s_nop 0
    s_or_b32 s59, s59, s26
    v_mfma_f32_16x16x32_bf16 v[4:7], a[32:35], a[4:7], v[4:7]
    s_bcnt1_i32_b32 s26, s26
    s_bcnt1_i32_b32 s59, s59
    v_mfma_f32_16x16x32_bf16 v[8:11], a[32:35], a[8:11], v[8:11]
    v_mfma_f32_16x16x32_bf16 v[8:11], a[36:39], a[24:27], v[8:11]
    v_mfma_f32_16x16x32_bf16 v[12:15], a[36:39], a[28:31], v[12:15]
    v_mfma_f32_16x16x32_bf16 v[12:15], a[32:35], a[12:15], v[12:15]
    v_mfma_f32_16x16x32_bf16 v[28:31], a[40:43], a[12:15], v[28:31]
    v_mfma_f32_16x16x32_bf16 v[28:31], a[44:47], a[28:31], v[28:31]
    v_mfma_f32_16x16x32_bf16 v[24:27], a[44:47], a[24:27], v[24:27]
    v_mfma_f32_16x16x32_bf16 v[24:27], a[40:43], a[8:11], v[24:27]
    v_mfma_f32_16x16x32_bf16 v[20:23], a[40:43], a[4:7], v[20:23]
    v_mfma_f32_16x16x32_bf16 v[20:23], a[44:47], a[20:23], v[20:23]
    v_mfma_f32_16x16x32_bf16 v[16:19], a[44:47], a[16:19], v[16:19]
    v_mfma_f32_16x16x32_bf16 v[16:19], a[40:43], a[0:3], v[16:19]
    v_mfma_f32_16x16x32_bf16 v[32:35], a[48:51], a[0:3], v[32:35]
    v_mfma_f32_16x16x32_bf16 v[32:35], a[52:55], a[16:19], v[32:35]
    v_mfma_f32_16x16x32_bf16 v[36:39], a[52:55], a[20:23], v[36:39]
    v_mfma_f32_16x16x32_bf16 v[36:39], a[48:51], a[4:7], v[36:39]
    v_mfma_f32_16x16x32_bf16 v[40:43], a[48:51], a[8:11], v[40:43]
    v_mfma_f32_16x16x32_bf16 v[40:43], a[52:55], a[24:27], v[40:43]
    v_mfma_f32_16x16x32_bf16 v[44:47], a[52:55], a[28:31], v[44:47]
    v_mfma_f32_16x16x32_bf16 v[44:47], a[48:51], a[12:15], v[44:47]
    v_mfma_f32_16x16x32_bf16 v[60:63], a[56:59], a[12:15], v[60:63]
    v_mfma_f32_16x16x32_bf16 v[60:63], a[60:63], a[28:31], v[60:63]
    v_mfma_f32_16x16x32_bf16 v[56:59], a[60:63], a[24:27], v[56:59]
    v_mfma_f32_16x16x32_bf16 v[56:59], a[56:59], a[8:11], v[56:59]
    v_mfma_f32_16x16x32_bf16 v[52:55], a[56:59], a[4:7], v[52:55]
    v_mfma_f32_16x16x32_bf16 v[52:55], a[60:63], a[20:23], v[52:55]
    v_mfma_f32_16x16x32_bf16 v[48:51], a[60:63], a[16:19], v[48:51]
    v_mfma_f32_16x16x32_bf16 v[48:51], a[56:59], a[0:3], v[48:51]
    v_mfma_f32_16x16x32_bf16 v[64:67], a[64:67], a[0:3], v[64:67]
    v_mfma_f32_16x16x32_bf16 v[64:67], a[68:71], a[16:19], v[64:67]
    v_mfma_f32_16x16x32_bf16 v[68:71], a[68:71], a[20:23], v[68:71]
    v_mfma_f32_16x16x32_bf16 v[68:71], a[64:67], a[4:7], v[68:71]
    v_mfma_f32_16x16x32_bf16 v[72:75], a[64:67], a[8:11], v[72:75]
    v_mfma_f32_16x16x32_bf16 v[72:75], a[68:71], a[24:27], v[72:75]
    v_mfma_f32_16x16x32_bf16 v[76:79], a[68:71], a[28:31], v[76:79]
    v_mfma_f32_16x16x32_bf16 v[76:79], a[64:67], a[12:15], v[76:79]
    v_mfma_f32_16x16x32_bf16 v[92:95], a[72:75], a[12:15], v[92:95]
    v_mfma_f32_16x16x32_bf16 v[92:95], a[76:79], a[28:31], v[92:95]
    v_mfma_f32_16x16x32_bf16 v[88:91], a[76:79], a[24:27], v[88:91]
    v_mfma_f32_16x16x32_bf16 v[88:91], a[72:75], a[8:11], v[88:91]
    v_mfma_f32_16x16x32_bf16 v[84:87], a[72:75], a[4:7], v[84:87]
    v_mfma_f32_16x16x32_bf16 v[84:87], a[76:79], a[20:23], v[84:87]
    v_mfma_f32_16x16x32_bf16 v[80:83], a[76:79], a[16:19], v[80:83]
    v_mfma_f32_16x16x32_bf16 v[80:83], a[72:75], a[0:3], v[80:83]
    v_mfma_f32_16x16x32_bf16 v[96:99], a[80:83], a[0:3], v[96:99]
    v_mfma_f32_16x16x32_bf16 v[96:99], a[84:87], a[16:19], v[96:99]
    v_mfma_f32_16x16x32_bf16 v[100:103], a[84:87], a[20:23], v[100:103]
    v_mfma_f32_16x16x32_bf16 v[100:103], a[80:83], a[4:7], v[100:103]
    s_setprio 2
    s_barrier
    v_mfma_f32_16x16x32_bf16 v[104:107], a[80:83], a[8:11], v[104:107]
    v_mfma_f32_16x16x32_bf16 v[104:107], a[84:87], a[24:27], v[104:107]
    v_mfma_f32_16x16x32_bf16 v[108:111], a[84:87], a[28:31], v[108:111]
    v_mfma_f32_16x16x32_bf16 v[108:111], a[80:83], a[12:15], v[108:111]
    s_setprio 0
fused_kernel_sb15:
    ds_read_b128 a[0:3], v152 offset:0
    ds_read_b128 a[16:19], v153 offset:0
    ds_read_b128 a[4:7], v152 offset:2048
    ds_read_b128 a[20:23], v153 offset:2048
    ds_read_b128 a[8:11], v152 offset:4096
    ds_read_b128 a[24:27], v153 offset:4096
    ds_read_b128 a[12:15], v152 offset:6144
    ds_read_b128 a[28:31], v153 offset:6144
    ds_read_b64_tr_b16 a[32:33], v156 offset:14336
    ds_read_b64_tr_b16 a[34:35], v156 offset:16128
    ds_read_b64_tr_b16 a[36:37], v156 offset:21504
    ds_read_b64_tr_b16 a[38:39], v156 offset:23296
    ds_read_b64_tr_b16 a[40:41], v156 offset:14368
    ds_read_b64_tr_b16 a[42:43], v156 offset:16160
    ds_read_b64_tr_b16 a[44:45], v156 offset:21536
    ds_read_b64_tr_b16 a[46:47], v156 offset:23328
    ds_read_b64_tr_b16 a[48:49], v156 offset:14400
    ds_read_b64_tr_b16 a[50:51], v156 offset:16192
    ds_read_b64_tr_b16 a[52:53], v156 offset:21568
    ds_read_b64_tr_b16 a[54:55], v156 offset:23360
    ds_read_b64_tr_b16 a[56:57], v156 offset:14432
    ds_read_b64_tr_b16 a[58:59], v156 offset:16224
    ds_read_b64_tr_b16 a[60:61], v156 offset:21600
    ds_read_b64_tr_b16 a[62:63], v156 offset:23392
    ds_read_b64_tr_b16 a[64:65], v156 offset:14464
    ds_read_b64_tr_b16 a[66:67], v156 offset:16256
    ds_read_b64_tr_b16 a[68:69], v156 offset:21632
    ds_read_b64_tr_b16 a[70:71], v156 offset:23424
    ds_read_b64_tr_b16 a[72:73], v156 offset:14496
    ds_read_b64_tr_b16 a[74:75], v156 offset:16288
    ds_read_b64_tr_b16 a[76:77], v156 offset:21664
    ds_read_b64_tr_b16 a[78:79], v156 offset:23456
    ds_read_b64_tr_b16 a[80:81], v157 offset:14336
    ds_read_b64_tr_b16 a[82:83], v157 offset:16128
    ds_read_b64_tr_b16 a[84:85], v157 offset:21504
    ds_read_b64_tr_b16 a[86:87], v157 offset:23296
    s_waitcnt vmcnt(0) lgkmcnt(0)
    s_barrier
    v_mfma_f32_16x16x32_bf16 v[0:3], a[32:35], a[0:3], v[0:3]
    s_add_u32 s53, s64, 0
    v_mfma_f32_16x16x32_bf16 v[0:3], a[36:39], a[16:19], v[0:3]
    v_mfma_f32_16x16x32_bf16 v[4:7], a[36:39], a[20:23], v[4:7]
    v_mfma_f32_16x16x32_bf16 v[4:7], a[32:35], a[4:7], v[4:7]
    v_mfma_f32_16x16x32_bf16 v[8:11], a[32:35], a[8:11], v[8:11]
    v_mfma_f32_16x16x32_bf16 v[8:11], a[36:39], a[24:27], v[8:11]
    v_mfma_f32_16x16x32_bf16 v[12:15], a[36:39], a[28:31], v[12:15]
    v_mfma_f32_16x16x32_bf16 v[12:15], a[32:35], a[12:15], v[12:15]
    v_mfma_f32_16x16x32_bf16 v[28:31], a[40:43], a[12:15], v[28:31]
    v_mfma_f32_16x16x32_bf16 v[28:31], a[44:47], a[28:31], v[28:31]
    v_mfma_f32_16x16x32_bf16 v[24:27], a[44:47], a[24:27], v[24:27]
    v_mfma_f32_16x16x32_bf16 v[24:27], a[40:43], a[8:11], v[24:27]
    v_mfma_f32_16x16x32_bf16 v[20:23], a[40:43], a[4:7], v[20:23]
    v_mfma_f32_16x16x32_bf16 v[20:23], a[44:47], a[20:23], v[20:23]
    s_nop 1
    v_cvt_pk_bf16_f32 v12, v12, v13
    v_cvt_pk_bf16_f32 v13, v14, v15
    v_mfma_f32_16x16x32_bf16 v[16:19], a[44:47], a[16:19], v[16:19]
    v_cvt_pk_bf16_f32 v14, v28, v29
    v_cvt_pk_bf16_f32 v15, v30, v31
    v_mfma_f32_16x16x32_bf16 v[16:19], a[40:43], a[0:3], v[16:19]
    v_pk_max_i16 v12, v12, 0
fused_kernel_pg4:
    s_cbranch_execz fused_kernel_pg12
    v_pk_max_i16 v13, v13, 0
    v_mfma_f32_16x16x32_bf16 v[32:35], a[48:51], a[0:3], v[32:35]
    v_pk_max_i16 v14, v14, 0
    v_pk_max_i16 v15, v15, 0
    v_mfma_f32_16x16x32_bf16 v[32:35], a[52:55], a[16:19], v[32:35]
    buffer_store_dwordx4 v[12:15], v158, s[12:15], s53 offen offset:3072 sc1
    v_mfma_f32_16x16x32_bf16 v[36:39], a[52:55], a[20:23], v[36:39]
    v_cvt_pk_bf16_f32 v8, v8, v9
    v_cvt_pk_bf16_f32 v9, v10, v11
    v_mfma_f32_16x16x32_bf16 v[36:39], a[48:51], a[4:7], v[36:39]
    v_cvt_pk_bf16_f32 v10, v24, v25
    v_cvt_pk_bf16_f32 v11, v26, v27
    v_mfma_f32_16x16x32_bf16 v[40:43], a[48:51], a[8:11], v[40:43]
    v_pk_max_i16 v8, v8, 0
    v_pk_max_i16 v9, v9, 0
    v_mfma_f32_16x16x32_bf16 v[40:43], a[52:55], a[24:27], v[40:43]
    v_pk_max_i16 v10, v10, 0
    v_pk_max_i16 v11, v11, 0
    v_mfma_f32_16x16x32_bf16 v[44:47], a[52:55], a[28:31], v[44:47]
    buffer_store_dwordx4 v[8:11], v158, s[12:15], s53 offen offset:2048 sc1
    v_mfma_f32_16x16x32_bf16 v[44:47], a[48:51], a[12:15], v[44:47]
    v_cvt_pk_bf16_f32 v4, v4, v5
    v_cvt_pk_bf16_f32 v5, v6, v7
    v_mfma_f32_16x16x32_bf16 v[60:63], a[56:59], a[12:15], v[60:63]
    v_cvt_pk_bf16_f32 v6, v20, v21
    v_cvt_pk_bf16_f32 v7, v22, v23
    v_mfma_f32_16x16x32_bf16 v[60:63], a[60:63], a[28:31], v[60:63]
    v_pk_max_i16 v4, v4, 0
    v_pk_max_i16 v5, v5, 0
    v_mfma_f32_16x16x32_bf16 v[56:59], a[60:63], a[24:27], v[56:59]
    v_pk_max_i16 v6, v6, 0
    v_pk_max_i16 v7, v7, 0
    v_mfma_f32_16x16x32_bf16 v[56:59], a[56:59], a[8:11], v[56:59]
    buffer_store_dwordx4 v[4:7], v158, s[12:15], s53 offen offset:1024 sc1
    v_mfma_f32_16x16x32_bf16 v[52:55], a[56:59], a[4:7], v[52:55]
    v_cvt_pk_bf16_f32 v0, v0, v1
    v_cvt_pk_bf16_f32 v1, v2, v3
    v_mfma_f32_16x16x32_bf16 v[52:55], a[60:63], a[20:23], v[52:55]
    v_cvt_pk_bf16_f32 v2, v16, v17
    v_cvt_pk_bf16_f32 v3, v18, v19
    v_mfma_f32_16x16x32_bf16 v[48:51], a[60:63], a[16:19], v[48:51]
    v_pk_max_i16 v0, v0, 0
    v_pk_max_i16 v1, v1, 0
    v_mfma_f32_16x16x32_bf16 v[48:51], a[56:59], a[0:3], v[48:51]
    v_pk_max_i16 v2, v2, 0
    v_pk_max_i16 v3, v3, 0
    v_mfma_f32_16x16x32_bf16 v[64:67], a[64:67], a[0:3], v[64:67]
    buffer_store_dwordx4 v[0:3], v158, s[12:15], s53 offen offset:0 sc1
    v_mfma_f32_16x16x32_bf16 v[64:67], a[68:71], a[16:19], v[64:67]
    v_cvt_pk_bf16_f32 v44, v44, v45
    v_cvt_pk_bf16_f32 v45, v46, v47
    v_mfma_f32_16x16x32_bf16 v[68:71], a[68:71], a[20:23], v[68:71]
    v_cvt_pk_bf16_f32 v46, v60, v61
    v_cvt_pk_bf16_f32 v47, v62, v63
    v_mfma_f32_16x16x32_bf16 v[68:71], a[64:67], a[4:7], v[68:71]
    v_pk_max_i16 v44, v44, 0
    v_pk_max_i16 v45, v45, 0
    v_mfma_f32_16x16x32_bf16 v[72:75], a[64:67], a[8:11], v[72:75]
    v_pk_max_i16 v46, v46, 0
    v_pk_max_i16 v47, v47, 0
    v_mfma_f32_16x16x32_bf16 v[72:75], a[68:71], a[24:27], v[72:75]
    v_cvt_pk_bf16_f32 v40, v40, v41
    v_cvt_pk_bf16_f32 v41, v42, v43
    v_mfma_f32_16x16x32_bf16 v[76:79], a[68:71], a[28:31], v[76:79]
    v_cvt_pk_bf16_f32 v42, v56, v57
    v_cvt_pk_bf16_f32 v43, v58, v59
    v_mfma_f32_16x16x32_bf16 v[76:79], a[64:67], a[12:15], v[76:79]
    v_pk_max_i16 v40, v40, 0
    v_pk_max_i16 v41, v41, 0
    v_mfma_f32_16x16x32_bf16 v[92:95], a[72:75], a[12:15], v[92:95]
    v_pk_max_i16 v42, v42, 0
    v_pk_max_i16 v43, v43, 0
    v_mfma_f32_16x16x32_bf16 v[92:95], a[76:79], a[28:31], v[92:95]
    v_cvt_pk_bf16_f32 v36, v36, v37
    v_cvt_pk_bf16_f32 v37, v38, v39
    v_mfma_f32_16x16x32_bf16 v[88:91], a[76:79], a[24:27], v[88:91]
    v_cvt_pk_bf16_f32 v38, v52, v53
    v_cvt_pk_bf16_f32 v39, v54, v55
    v_mfma_f32_16x16x32_bf16 v[88:91], a[72:75], a[8:11], v[88:91]
    v_pk_max_i16 v36, v36, 0
    v_pk_max_i16 v37, v37, 0
    v_mfma_f32_16x16x32_bf16 v[84:87], a[72:75], a[4:7], v[84:87]
    v_pk_max_i16 v38, v38, 0
    v_pk_max_i16 v39, v39, 0
    v_mfma_f32_16x16x32_bf16 v[84:87], a[76:79], a[20:23], v[84:87]
    v_cvt_pk_bf16_f32 v32, v32, v33
    v_cvt_pk_bf16_f32 v33, v34, v35
    v_mfma_f32_16x16x32_bf16 v[80:83], a[76:79], a[16:19], v[80:83]
    v_cvt_pk_bf16_f32 v34, v48, v49
    v_cvt_pk_bf16_f32 v35, v50, v51
    v_mfma_f32_16x16x32_bf16 v[80:83], a[72:75], a[0:3], v[80:83]
    v_pk_max_i16 v32, v32, 0
    v_pk_max_i16 v33, v33, 0
    v_mfma_f32_16x16x32_bf16 v[96:99], a[80:83], a[0:3], v[96:99]
    v_pk_max_i16 v34, v34, 0
    v_pk_max_i16 v35, v35, 0
    v_mfma_f32_16x16x32_bf16 v[96:99], a[84:87], a[16:19], v[96:99]
    v_cvt_pk_bf16_f32 v76, v76, v77
    v_cvt_pk_bf16_f32 v77, v78, v79
    v_mfma_f32_16x16x32_bf16 v[100:103], a[84:87], a[20:23], v[100:103]
    v_cvt_pk_bf16_f32 v78, v92, v93
    v_cvt_pk_bf16_f32 v79, v94, v95
    v_mfma_f32_16x16x32_bf16 v[100:103], a[80:83], a[4:7], v[100:103]
    s_setprio 2
    s_barrier
    v_mfma_f32_16x16x32_bf16 v[104:107], a[80:83], a[8:11], v[104:107]
    v_pk_max_i16 v76, v76, 0
    v_pk_max_i16 v77, v77, 0
    v_mfma_f32_16x16x32_bf16 v[104:107], a[84:87], a[24:27], v[104:107]
    v_pk_max_i16 v78, v78, 0
    v_pk_max_i16 v79, v79, 0
    v_mfma_f32_16x16x32_bf16 v[108:111], a[84:87], a[28:31], v[108:111]
    v_cvt_pk_bf16_f32 v72, v72, v73
    v_cvt_pk_bf16_f32 v73, v74, v75
    v_mfma_f32_16x16x32_bf16 v[108:111], a[80:83], a[12:15], v[108:111]
    s_setprio 0
    v_cvt_pk_bf16_f32 v74, v88, v89
    v_cvt_pk_bf16_f32 v75, v90, v91
    v_pk_max_i16 v72, v72, 0
    v_pk_max_i16 v73, v73, 0
    v_pk_max_i16 v74, v74, 0
    v_pk_max_i16 v75, v75, 0
    v_cvt_pk_bf16_f32 v68, v68, v69
    v_cvt_pk_bf16_f32 v69, v70, v71
    v_cvt_pk_bf16_f32 v70, v84, v85
    v_cvt_pk_bf16_f32 v71, v86, v87
    v_pk_max_i16 v68, v68, 0
    v_pk_max_i16 v69, v69, 0
    v_pk_max_i16 v70, v70, 0
    v_pk_max_i16 v71, v71, 0
    v_cvt_pk_bf16_f32 v64, v64, v65
    v_cvt_pk_bf16_f32 v65, v66, v67
    v_cvt_pk_bf16_f32 v66, v80, v81
    v_cvt_pk_bf16_f32 v67, v82, v83
    v_pk_max_i16 v64, v64, 0
    v_pk_max_i16 v65, v65, 0
    v_pk_max_i16 v66, v66, 0
    v_pk_max_i16 v67, v67, 0
    v_cvt_pk_bf16_f32 v96, v96, v97
    v_cvt_pk_bf16_f32 v97, v98, v99
    v_pk_max_i16 v96, v96, 0
    v_pk_max_i16 v97, v97, 0
    v_cvt_pk_bf16_f32 v98, v100, v101
    v_cvt_pk_bf16_f32 v99, v102, v103
    v_pk_max_i16 v98, v98, 0
    v_pk_max_i16 v99, v99, 0
    v_cvt_pk_bf16_f32 v100, v104, v105
    v_cvt_pk_bf16_f32 v101, v106, v107
    v_pk_max_i16 v100, v100, 0
    v_pk_max_i16 v101, v101, 0
    v_cvt_pk_bf16_f32 v102, v108, v109
    v_cvt_pk_bf16_f32 v103, v110, v111
    v_pk_max_i16 v102, v102, 0
    v_pk_max_i16 v103, v103, 0
    s_lshl_b32 s45, s20, 12
    s_add_u32 s45, s45, 98304
    v_add_u32 v156, s45, v158
    v_mov_b32 v157, v143
    v_add_u32 v152, 0x10000, v144
    v_add_u32 v153, 0x10000, v145
    v_add_u32 v154, 0x10000, v146
    v_add_u32 v155, 0x10000, v147
    ds_read_b64_tr_b16 v[80:81], v144 offset:0
    ds_read_b64_tr_b16 v[82:83], v144 offset:4096
    ds_read_b64_tr_b16 v[84:85], v144 offset:8192
    ds_read_b64_tr_b16 v[86:87], v144 offset:12288
    ds_read_b64_tr_b16 v[88:89], v145 offset:0
    ds_read_b64_tr_b16 v[90:91], v145 offset:4096
    ds_read_b64_tr_b16 v[92:93], v145 offset:8192
    ds_read_b64_tr_b16 v[94:95], v145 offset:12288
    ds_read_b64_tr_b16 v[104:105], v146 offset:0
    ds_read_b64_tr_b16 v[106:107], v146 offset:4096
    ds_read_b64_tr_b16 v[108:109], v146 offset:8192
    ds_read_b64_tr_b16 v[110:111], v146 offset:12288
    s_waitcnt vmcnt(0)
    v_mov_b32 v151, 1
    s_cmp_lg_u32 s26, 1
    s_cbranch_scc1 fused_kernel_sfh1
    buffer_store_dword v151, v148, s[12:15], s57 offen offset:0
fused_kernel_sfrh1:
    s_barrier
    s_waitcnt lgkmcnt(8)
    v_mfma_f32_16x16x32_bf16 a[0:3], v[80:83], v[0:3], 0
    v_mfma_f32_16x16x32_bf16 a[0:3], v[84:87], v[32:35], a[0:3]
    v_mfma_f32_16x16x32_bf16 a[4:7], v[84:87], v[36:39], 0
    v_mfma_f32_16x16x32_bf16 a[4:7], v[80:83], v[4:7], a[4:7]
    v_mfma_f32_16x16x32_bf16 a[8:11], v[80:83], v[8:11], 0
    v_mfma_f32_16x16x32_bf16 a[8:11], v[84:87], v[40:43], a[8:11]
    v_mfma_f32_16x16x32_bf16 a[12:15], v[84:87], v[44:47], 0
    v_mfma_f32_16x16x32_bf16 a[12:15], v[80:83], v[12:15], a[12:15]
    ds_read_b64_tr_b16 v[80:81], v147 offset:0
    s_waitcnt lgkmcnt(5)
    v_mfma_f32_16x16x32_bf16 a[28:31], v[88:91], v[12:15], 0
    ds_read_b64_tr_b16 v[82:83], v147 offset:4096
    v_mfma_f32_16x16x32_bf16 a[28:31], v[92:95], v[44:47], a[28:31]
    ds_read_b64_tr_b16 v[84:85], v147 offset:8192
    v_mfma_f32_16x16x32_bf16 a[24:27], v[92:95], v[40:43], 0
    ds_read_b64_tr_b16 v[86:87], v147 offset:12288
    v_mfma_f32_16x16x32_bf16 a[24:27], v[88:91], v[8:11], a[24:27]
    v_mfma_f32_16x16x32_bf16 a[20:23], v[88:91], v[4:7], 0
    v_mfma_f32_16x16x32_bf16 a[20:23], v[92:95], v[36:39], a[20:23]
    v_mfma_f32_16x16x32_bf16 a[16:19], v[92:95], v[32:35], 0
    v_mfma_f32_16x16x32_bf16 a[16:19], v[88:91], v[0:3], a[16:19]
    ds_read_b64_tr_b16 v[88:89], v144 offset:1024
    s_waitcnt lgkmcnt(5)
    v_mfma_f32_16x16x32_bf16 a[32:35], v[104:107], v[0:3], 0
    ds_read_b64_tr_b16 v[90:91], v144 offset:5120
    v_mfma_f32_16x16x32_bf16 a[32:35], v[108:111], v[32:35], a[32:35]
    ds_read_b64_tr_b16 v[92:93], v144 offset:9216
    v_mfma_f32_16x16x32_bf16 a[36:39], v[108:111], v[36:39], 0
    ds_read_b64_tr_b16 v[94:95], v144 offset:13312
    v_mfma_f32_16x16x32_bf16 a[36:39], v[104:107], v[4:7], a[36:39]
    v_mfma_f32_16x16x32_bf16 a[40:43], v[104:107], v[8:11], 0
    v_mfma_f32_16x16x32_bf16 a[40:43], v[108:111], v[40:43], a[40:43]
    v_mfma_f32_16x16x32_bf16 a[44:47], v[108:111], v[44:47], 0
    v_mfma_f32_16x16x32_bf16 a[44:47], v[104:107], v[12:15], a[44:47]
    ds_read_b64_tr_b16 v[104:105], v145 offset:1024
    s_waitcnt lgkmcnt(5)
    v_mfma_f32_16x16x32_bf16 a[60:63], v[80:83], v[12:15], 0
    ds_read_b64_tr_b16 v[106:107], v145 offset:5120
    v_mfma_f32_16x16x32_bf16 a[60:63], v[84:87], v[44:47], a[60:63]
    ds_read_b64_tr_b16 v[108:109], v145 offset:9216
    v_mfma_f32_16x16x32_bf16 a[56:59], v[84:87], v[40:43], 0
    ds_read_b64_tr_b16 v[110:111], v145 offset:13312
    v_mfma_f32_16x16x32_bf16 a[56:59], v[80:83], v[8:11], a[56:59]
    v_mfma_f32_16x16x32_bf16 a[52:55], v[80:83], v[4:7], 0
    v_mfma_f32_16x16x32_bf16 a[52:55], v[84:87], v[36:39], a[52:55]
    v_mfma_f32_16x16x32_bf16 a[48:51], v[84:87], v[32:35], 0
    v_mfma_f32_16x16x32_bf16 a[48:51], v[80:83], v[0:3], a[48:51]
    ds_read_b64_tr_b16 v[80:81], v146 offset:1024
    s_waitcnt lgkmcnt(5)
    v_mfma_f32_16x16x32_bf16 a[64:67], v[88:91], v[0:3], 0
    ds_read_b64_tr_b16 v[82:83], v146 offset:5120
    v_mfma_f32_16x16x32_bf16 a[64:67], v[92:95], v[32:35], a[64:67]
    ds_read_b64_tr_b16 v[84:85], v146 offset:9216
    v_mfma_f32_16x16x32_bf16 a[68:71], v[92:95], v[36:39], 0
    ds_read_b64_tr_b16 v[86:87], v146 offset:13312
    v_mfma_f32_16x16x32_bf16 a[68:71], v[88:91], v[4:7], a[68:71]
    v_mfma_f32_16x16x32_bf16 a[72:75], v[88:91], v[8:11], 0
    buffer_load_dword v150, v149, s[12:15], s58 offen offset:0 sc1
    v_mfma_f32_16x16x32_bf16 a[72:75], v[92:95], v[40:43], a[72:75]
    v_mfma_f32_16x16x32_bf16 a[76:79], v[92:95], v[44:47], 0
    v_mfma_f32_16x16x32_bf16 a[76:79], v[88:91], v[12:15], a[76:79]
    ds_read_b64_tr_b16 v[88:89], v147 offset:1024
    s_waitcnt lgkmcnt(5)
    v_mfma_f32_16x16x32_bf16 a[92:95], v[104:107], v[12:15], 0
    ds_read_b64_tr_b16 v[90:91], v147 offset:5120
    v_mfma_f32_16x16x32_bf16 a[92:95], v[108:111], v[44:47], a[92:95]
    ds_read_b64_tr_b16 v[92:93], v147 offset:9216
    v_mfma_f32_16x16x32_bf16 a[88:91], v[108:111], v[40:43], 0
    ds_read_b64_tr_b16 v[94:95], v147 offset:13312
    v_mfma_f32_16x16x32_bf16 a[88:91], v[104:107], v[8:11], a[88:91]
    v_mfma_f32_16x16x32_bf16 a[84:87], v[104:107], v[4:7], 0
    v_mfma_f32_16x16x32_bf16 a[84:87], v[108:111], v[36:39], a[84:87]
    v_mfma_f32_16x16x32_bf16 a[80:83], v[108:111], v[32:35], 0
    v_mfma_f32_16x16x32_bf16 a[80:83], v[104:107], v[0:3], a[80:83]
    ds_read_b64_tr_b16 v[104:105], v144 offset:16384
    s_waitcnt lgkmcnt(5)
    v_mfma_f32_16x16x32_bf16 v[112:115], v[80:83], v[0:3], 0
    ds_read_b64_tr_b16 v[106:107], v144 offset:20480
    v_mfma_f32_16x16x32_bf16 v[112:115], v[84:87], v[32:35], v[112:115]
    ds_read_b64_tr_b16 v[108:109], v145 offset:16384
    s_waitcnt vmcnt(0)
    v_cmp_gt_u32 vcc, 1, v150
    s_nop 1
    s_cbranch_vccnz fused_kernel_spin_h3
fused_kernel_ret_h3:
    v_mfma_f32_16x16x32_bf16 v[116:119], v[84:87], v[36:39], 0
    ds_read_b64_tr_b16 v[110:111], v145 offset:20480
    s_add_u32 s46, s65, 0
    v_mfma_f32_16x16x32_bf16 v[116:119], v[80:83], v[4:7], v[116:119]
    buffer_load_dwordx4 v[16:19], v158, s[12:15], s46 offen offset:0 sc1
    v_mfma_f32_16x16x32_bf16 v[120:123], v[80:83], v[8:11], 0
    v_mfma_f32_16x16x32_bf16 v[120:123], v[84:87], v[40:43], v[120:123]
    v_mfma_f32_16x16x32_bf16 v[124:127], v[84:87], v[44:47], 0
    v_mfma_f32_16x16x32_bf16 v[124:127], v[80:83], v[12:15], v[124:127]
    ds_read_b64_tr_b16 v[80:81], v146 offset:16384
    buffer_load_dwordx4 v[20:23], v158, s[12:15], s46 offen offset:1024 sc1
    s_waitcnt lgkmcnt(5)
    v_mfma_f32_16x16x32_bf16 v[140:143], v[88:91], v[12:15], 0
    ds_read_b64_tr_b16 v[82:83], v146 offset:20480
    v_mfma_f32_16x16x32_bf16 v[140:143], v[92:95], v[44:47], v[140:143]
    ds_read_b64_tr_b16 v[84:85], v147 offset:16384
    v_mfma_f32_16x16x32_bf16 v[136:139], v[92:95], v[40:43], 0
    ds_read_b64_tr_b16 v[86:87], v147 offset:20480
    v_mfma_f32_16x16x32_bf16 v[136:139], v[88:91], v[8:11], v[136:139]
    buffer_load_dwordx4 v[24:27], v158, s[12:15], s46 offen offset:2048 sc1
    v_mfma_f32_16x16x32_bf16 v[132:135], v[88:91], v[4:7], 0
    v_mfma_f32_16x16x32_bf16 v[132:135], v[92:95], v[36:39], v[132:135]
    v_mfma_f32_16x16x32_bf16 v[128:131], v[92:95], v[32:35], 0
    v_mfma_f32_16x16x32_bf16 v[128:131], v[88:91], v[0:3], v[128:131]
    ds_read_b64_tr_b16 v[88:89], v144 offset:17408
    buffer_load_dwordx4 v[28:31], v158, s[12:15], s46 offen offset:3072 sc1
    s_waitcnt lgkmcnt(7)
    v_mfma_f32_16x16x32_bf16 a[0:3], v[104:107], v[64:67], a[0:3]
    ds_read_b64_tr_b16 v[90:91], v144 offset:21504
    v_mfma_f32_16x16x32_bf16 a[4:7], v[104:107], v[68:71], a[4:7]
    ds_read_b64_tr_b16 v[92:93], v145 offset:17408
    s_add_u32 s46, s66, 0
    v_mfma_f32_16x16x32_bf16 a[8:11], v[104:107], v[72:75], a[8:11]
    ds_read_b64_tr_b16 v[94:95], v145 offset:21504
    buffer_load_dwordx4 v[48:51], v158, s[12:15], s46 offen offset:0 sc1
    v_mfma_f32_16x16x32_bf16 a[12:15], v[104:107], v[76:79], a[12:15]
    ds_read_b64_tr_b16 v[104:105], v146 offset:17408
    s_waitcnt lgkmcnt(9)
    v_mfma_f32_16x16x32_bf16 a[28:31], v[108:111], v[76:79], a[28:31]
    ds_read_b64_tr_b16 v[106:107], v146 offset:21504
    v_mfma_f32_16x16x32_bf16 a[24:27], v[108:111], v[72:75], a[24:27]
    v_mfma_f32_16x16x32_bf16 a[20:23], v[108:111], v[68:71], a[20:23]
    buffer_load_dwordx4 v[52:55], v158, s[12:15], s46 offen offset:1024 sc1
    v_mfma_f32_16x16x32_bf16 a[16:19], v[108:111], v[64:67], a[16:19]
    ds_read_b64_tr_b16 v[108:109], v147 offset:17408
    s_waitcnt lgkmcnt(9)
    v_mfma_f32_16x16x32_bf16 a[32:35], v[80:83], v[64:67], a[32:35]
    ds_read_b64_tr_b16 v[110:111], v147 offset:21504
    v_mfma_f32_16x16x32_bf16 a[36:39], v[80:83], v[68:71], a[36:39]
    v_mfma_f32_16x16x32_bf16 a[40:43], v[80:83], v[72:75], a[40:43]
    buffer_load_dwordx4 v[56:59], v158, s[12:15], s46 offen offset:2048 sc1
    v_mfma_f32_16x16x32_bf16 a[44:47], v[80:83], v[76:79], a[44:47]
    ds_read_b64_tr_b16 v[80:81], v144 offset:24576
    s_waitcnt lgkmcnt(9)
    v_mfma_f32_16x16x32_bf16 a[60:63], v[84:87], v[76:79], a[60:63]
    ds_read_b64_tr_b16 v[82:83], v144 offset:28672
    v_mfma_f32_16x16x32_bf16 a[56:59], v[84:87], v[72:75], a[56:59]
    v_mfma_f32_16x16x32_bf16 a[52:55], v[84:87], v[68:71], a[52:55]
    buffer_load_dwordx4 v[60:63], v158, s[12:15], s46 offen offset:3072 sc1
    v_mfma_f32_16x16x32_bf16 a[48:51], v[84:87], v[64:67], a[48:51]
    ds_read_b64_tr_b16 v[84:85], v145 offset:24576
    s_waitcnt lgkmcnt(9)
    v_mfma_f32_16x16x32_bf16 a[64:67], v[88:91], v[64:67], a[64:67]
    ds_read_b64_tr_b16 v[86:87], v145 offset:28672
    s_add_u32 s46, s67, 0
    v_mfma_f32_16x16x32_bf16 a[68:71], v[88:91], v[68:71], a[68:71]
    buffer_load_dwordx4 v[0:3], v158, s[12:15], s46 offen offset:0 sc1
    v_mfma_f32_16x16x32_bf16 a[72:75], v[88:91], v[72:75], a[72:75]
    v_mfma_f32_16x16x32_bf16 a[76:79], v[88:91], v[76:79], a[76:79]
    ds_read_b64_tr_b16 v[88:89], v146 offset:24576
    s_waitcnt lgkmcnt(9)
    v_mfma_f32_16x16x32_bf16 a[92:95], v[92:95], v[76:79], a[92:95]
    ds_read_b64_tr_b16 v[90:91], v146 offset:28672
    v_mfma_f32_16x16x32_bf16 a[88:91], v[92:95], v[72:75], a[88:91]
    buffer_load_dwordx4 v[4:7], v158, s[12:15], s46 offen offset:1024 sc1
    v_mfma_f32_16x16x32_bf16 a[84:87], v[92:95], v[68:71], a[84:87]
    v_mfma_f32_16x16x32_bf16 a[80:83], v[92:95], v[64:67], a[80:83]
    ds_read_b64_tr_b16 v[92:93], v147 offset:24576
    s_waitcnt lgkmcnt(9)
    v_mfma_f32_16x16x32_bf16 v[112:115], v[104:107], v[64:67], v[112:115]
    ds_read_b64_tr_b16 v[94:95], v147 offset:28672
    v_mfma_f32_16x16x32_bf16 v[116:119], v[104:107], v[68:71], v[116:119]
    buffer_load_dwordx4 v[8:11], v158, s[12:15], s46 offen offset:2048 sc1
    v_mfma_f32_16x16x32_bf16 v[120:123], v[104:107], v[72:75], v[120:123]
    v_mfma_f32_16x16x32_bf16 v[124:127], v[104:107], v[76:79], v[124:127]
    ds_read_b64_tr_b16 v[104:105], v144 offset:25600
    s_waitcnt lgkmcnt(9)
    v_mfma_f32_16x16x32_bf16 v[140:143], v[108:111], v[76:79], v[140:143]
    ds_read_b64_tr_b16 v[106:107], v144 offset:29696
    v_mfma_f32_16x16x32_bf16 v[136:139], v[108:111], v[72:75], v[136:139]
    buffer_load_dwordx4 v[12:15], v158, s[12:15], s46 offen offset:3072 sc1
    v_mfma_f32_16x16x32_bf16 v[132:135], v[108:111], v[68:71], v[132:135]
    v_mfma_f32_16x16x32_bf16 v[128:131], v[108:111], v[64:67], v[128:131]
    ds_read_b64_tr_b16 v[108:109], v145 offset:25600
    s_waitcnt vmcnt(8) lgkmcnt(9)
    v_mfma_f32_16x16x32_bf16 a[0:3], v[80:83], v[16:19], a[0:3]
    ds_read_b64_tr_b16 v[110:111], v145 offset:29696
    v_mfma_f32_16x16x32_bf16 a[4:7], v[80:83], v[20:23], a[4:7]
    v_mfma_f32_16x16x32_bf16 a[8:11], v[80:83], v[24:27], a[8:11]
    v_mfma_f32_16x16x32_bf16 a[12:15], v[80:83], v[28:31], a[12:15]
    ds_read_b64_tr_b16 v[80:81], v146 offset:25600
    s_waitcnt lgkmcnt(9)
    v_mfma_f32_16x16x32_bf16 a[28:31], v[84:87], v[28:31], a[28:31]
    ds_read_b64_tr_b16 v[82:83], v146 offset:29696
    v_mfma_f32_16x16x32_bf16 a[24:27], v[84:87], v[24:27], a[24:27]
    v_mfma_f32_16x16x32_bf16 a[20:23], v[84:87], v[20:23], a[20:23]
    v_mfma_f32_16x16x32_bf16 a[16:19], v[84:87], v[16:19], a[16:19]
    ds_read_b64_tr_b16 v[84:85], v147 offset:25600
    s_waitcnt lgkmcnt(9)
    v_mfma_f32_16x16x32_bf16 a[32:35], v[88:91], v[16:19], a[32:35]
    ds_read_b64_tr_b16 v[86:87], v147 offset:29696
    v_mfma_f32_16x16x32_bf16 a[36:39], v[88:91], v[20:23], a[36:39]
    v_mfma_f32_16x16x32_bf16 a[40:43], v[88:91], v[24:27], a[40:43]
    v_mfma_f32_16x16x32_bf16 a[44:47], v[88:91], v[28:31], a[44:47]
    s_barrier
    ds_read_b64_tr_b16 v[88:89], v144 offset:32768
    s_waitcnt lgkmcnt(9)
    v_mfma_f32_16x16x32_bf16 a[60:63], v[92:95], v[28:31], a[60:63]
    ds_read_b64_tr_b16 v[90:91], v144 offset:36864
    v_mfma_f32_16x16x32_bf16 a[56:59], v[92:95], v[24:27], a[56:59]
    v_mfma_f32_16x16x32_bf16 a[52:55], v[92:95], v[20:23], a[52:55]
    s_add_u32 s53, s64, 4096
    buffer_store_dwordx4 v[44:47], v158, s[12:15], s53 offen offset:3072 sc1
    v_mfma_f32_16x16x32_bf16 a[48:51], v[92:95], v[16:19], a[48:51]
    ds_read_b64_tr_b16 v[92:93], v144 offset:40960
    s_waitcnt lgkmcnt(9)
    v_mfma_f32_16x16x32_bf16 a[64:67], v[104:107], v[16:19], a[64:67]
    ds_read_b64_tr_b16 v[94:95], v144 offset:45056
    v_mfma_f32_16x16x32_bf16 a[68:71], v[104:107], v[20:23], a[68:71]
    v_mfma_f32_16x16x32_bf16 a[72:75], v[104:107], v[24:27], a[72:75]
    v_mfma_f32_16x16x32_bf16 a[76:79], v[104:107], v[28:31], a[76:79]
    ds_read_b64_tr_b16 v[104:105], v145 offset:32768
    s_waitcnt lgkmcnt(9)
    v_mfma_f32_16x16x32_bf16 a[92:95], v[108:111], v[28:31], a[92:95]
    ds_read_b64_tr_b16 v[106:107], v145 offset:36864
    v_mfma_f32_16x16x32_bf16 a[88:91], v[108:111], v[24:27], a[88:91]
    v_mfma_f32_16x16x32_bf16 a[84:87], v[108:111], v[20:23], a[84:87]
    v_mfma_f32_16x16x32_bf16 a[80:83], v[108:111], v[16:19], a[80:83]
    ds_read_b64_tr_b16 v[108:109], v145 offset:40960
    s_waitcnt lgkmcnt(9)
    v_mfma_f32_16x16x32_bf16 v[112:115], v[80:83], v[16:19], v[112:115]
    s_add_u32 s53, s64, 4096
    buffer_store_dwordx4 v[40:43], v158, s[12:15], s53 offen offset:2048 sc1
    ds_read_b64_tr_b16 v[110:111], v145 offset:45056
    v_mfma_f32_16x16x32_bf16 v[116:119], v[80:83], v[20:23], v[116:119]
    v_mfma_f32_16x16x32_bf16 v[120:123], v[80:83], v[24:27], v[120:123]
    v_mfma_f32_16x16x32_bf16 v[124:127], v[80:83], v[28:31], v[124:127]
    ds_read_b64_tr_b16 v[80:81], v146 offset:32768
    s_waitcnt lgkmcnt(9)
    v_mfma_f32_16x16x32_bf16 v[140:143], v[84:87], v[28:31], v[140:143]
    ds_read_b64_tr_b16 v[82:83], v146 offset:36864
    v_mfma_f32_16x16x32_bf16 v[136:139], v[84:87], v[24:27], v[136:139]
    v_mfma_f32_16x16x32_bf16 v[132:135], v[84:87], v[20:23], v[132:135]
    v_mfma_f32_16x16x32_bf16 v[128:131], v[84:87], v[16:19], v[128:131]
    ds_read_b64_tr_b16 v[84:85], v146 offset:40960
    s_waitcnt vmcnt(2) lgkmcnt(7)
    v_mfma_f32_16x16x32_bf16 a[0:3], v[88:91], v[48:51], a[0:3]
    ds_read_b64_tr_b16 v[86:87], v146 offset:45056
    s_add_u32 s46, s70, 0
    v_mfma_f32_16x16x32_bf16 a[0:3], v[92:95], v[0:3], a[0:3]
    buffer_load_dwordx4 v[16:19], v158, s[12:15], s46 offen offset:0 sc1
    v_mfma_f32_16x16x32_bf16 a[4:7], v[92:95], v[4:7], a[4:7]
    s_add_u32 s53, s64, 4096
    buffer_store_dwordx4 v[36:39], v158, s[12:15], s53 offen offset:1024 sc1
    v_mfma_f32_16x16x32_bf16 a[4:7], v[88:91], v[52:55], a[4:7]
    v_mfma_f32_16x16x32_bf16 a[8:11], v[88:91], v[56:59], a[8:11]
    v_mfma_f32_16x16x32_bf16 a[8:11], v[92:95], v[8:11], a[8:11]
    buffer_load_dwordx4 v[20:23], v158, s[12:15], s46 offen offset:1024 sc1
    v_mfma_f32_16x16x32_bf16 a[12:15], v[92:95], v[12:15], a[12:15]
    v_mfma_f32_16x16x32_bf16 a[12:15], v[88:91], v[60:63], a[12:15]
    ds_read_b64_tr_b16 v[88:89], v147 offset:32768
    s_waitcnt lgkmcnt(5)
    v_mfma_f32_16x16x32_bf16 a[28:31], v[104:107], v[60:63], a[28:31]
    ds_read_b64_tr_b16 v[90:91], v147 offset:36864
    v_mfma_f32_16x16x32_bf16 a[28:31], v[108:111], v[12:15], a[28:31]
    ds_read_b64_tr_b16 v[92:93], v147 offset:40960
    buffer_load_dwordx4 v[24:27], v158, s[12:15], s46 offen offset:2048 sc1
    v_mfma_f32_16x16x32_bf16 a[24:27], v[108:111], v[8:11], a[24:27]
    ds_read_b64_tr_b16 v[94:95], v147 offset:45056
    v_mfma_f32_16x16x32_bf16 a[24:27], v[104:107], v[56:59], a[24:27]
    v_mfma_f32_16x16x32_bf16 a[20:23], v[104:107], v[52:55], a[20:23]
    s_add_u32 s53, s64, 4096
    buffer_store_dwordx4 v[32:35], v158, s[12:15], s53 offen offset:0 sc1
    v_mfma_f32_16x16x32_bf16 a[20:23], v[108:111], v[4:7], a[20:23]
    buffer_load_dwordx4 v[28:31], v158, s[12:15], s46 offen offset:3072 sc1
    v_mfma_f32_16x16x32_bf16 a[16:19], v[108:111], v[0:3], a[16:19]
    v_mfma_f32_16x16x32_bf16 a[16:19], v[104:107], v[48:51], a[16:19]
    ds_read_b64_tr_b16 v[104:105], v144 offset:33792
    s_add_u32 s46, s71, 0
    s_waitcnt lgkmcnt(5)
    v_mfma_f32_16x16x32_bf16 a[32:35], v[80:83], v[48:51], a[32:35]
    ds_read_b64_tr_b16 v[106:107], v144 offset:37888
    buffer_load_dwordx4 v[32:35], v158, s[12:15], s46 offen offset:0 sc1
    v_mfma_f32_16x16x32_bf16 a[32:35], v[84:87], v[0:3], a[32:35]
    ds_read_b64_tr_b16 v[108:109], v144 offset:41984
    v_mfma_f32_16x16x32_bf16 a[36:39], v[84:87], v[4:7], a[36:39]
    ds_read_b64_tr_b16 v[110:111], v144 offset:46080
    v_mfma_f32_16x16x32_bf16 a[36:39], v[80:83], v[52:55], a[36:39]
    v_mfma_f32_16x16x32_bf16 a[40:43], v[80:83], v[56:59], a[40:43]
    buffer_load_dwordx4 v[36:39], v158, s[12:15], s46 offen offset:1024 sc1
    v_mfma_f32_16x16x32_bf16 a[40:43], v[84:87], v[8:11], a[40:43]
    v_mfma_f32_16x16x32_bf16 a[44:47], v[84:87], v[12:15], a[44:47]
    v_mfma_f32_16x16x32_bf16 a[44:47], v[80:83], v[60:63], a[44:47]
    ds_read_b64_tr_b16 v[80:81], v145 offset:33792
    s_waitcnt lgkmcnt(5)
    v_mfma_f32_16x16x32_bf16 a[60:63], v[88:91], v[60:63], a[60:63]
    ds_read_b64_tr_b16 v[82:83], v145 offset:37888
    buffer_load_dwordx4 v[40:43], v158, s[12:15], s46 offen offset:2048 sc1
    v_mfma_f32_16x16x32_bf16 a[60:63], v[92:95], v[12:15], a[60:63]
    ds_read_b64_tr_b16 v[84:85], v145 offset:41984
    v_mfma_f32_16x16x32_bf16 a[56:59], v[92:95], v[8:11], a[56:59]
    ds_read_b64_tr_b16 v[86:87], v145 offset:46080
    v_mfma_f32_16x16x32_bf16 a[56:59], v[88:91], v[56:59], a[56:59]
    v_mfma_f32_16x16x32_bf16 a[52:55], v[88:91], v[52:55], a[52:55]
    buffer_load_dwordx4 v[44:47], v158, s[12:15], s46 offen offset:3072 sc1
    v_mfma_f32_16x16x32_bf16 a[52:55], v[92:95], v[4:7], a[52:55]
    v_mfma_f32_16x16x32_bf16 a[48:51], v[92:95], v[0:3], a[48:51]
    v_mfma_f32_16x16x32_bf16 a[48:51], v[88:91], v[48:51], a[48:51]
    ds_read_b64_tr_b16 v[88:89], v146 offset:33792
    s_waitcnt lgkmcnt(5)
    v_mfma_f32_16x16x32_bf16 a[64:67], v[104:107], v[48:51], a[64:67]
    ds_read_b64_tr_b16 v[90:91], v146 offset:37888
    v_mfma_f32_16x16x32_bf16 a[64:67], v[108:111], v[0:3], a[64:67]
    ds_read_b64_tr_b16 v[92:93], v146 offset:41984
    v_mfma_f32_16x16x32_bf16 a[68:71], v[108:111], v[4:7], a[68:71]
    ds_read_b64_tr_b16 v[94:95], v146 offset:46080
    v_mfma_f32_16x16x32_bf16 a[68:71], v[104:107], v[52:55], a[68:71]
    v_mfma_f32_16x16x32_bf16 a[72:75], v[104:107], v[56:59], a[72:75]
    v_mfma_f32_16x16x32_bf16 a[72:75], v[108:111], v[8:11], a[72:75]
    v_mfma_f32_16x16x32_bf16 a[76:79], v[108:111], v[12:15], a[76:79]
    v_mfma_f32_16x16x32_bf16 a[76:79], v[104:107], v[60:63], a[76:79]
    ds_read_b64_tr_b16 v[104:105], v147 offset:33792
    s_waitcnt lgkmcnt(5)
    v_mfma_f32_16x16x32_bf16 a[92:95], v[80:83], v[60:63], a[92:95]
    ds_read_b64_tr_b16 v[106:107], v147 offset:37888
    v_mfma_f32_16x16x32_bf16 a[92:95], v[84:87], v[12:15], a[92:95]
    ds_read_b64_tr_b16 v[108:109], v147 offset:41984
    v_mfma_f32_16x16x32_bf16 a[88:91], v[84:87], v[8:11], a[88:91]
    s_add_u32 s53, s64, s27
    buffer_store_dwordx2 v[96:97], v157, s[12:15], s53 offen offset:0 sc1
    ds_read_b64_tr_b16 v[110:111], v147 offset:46080
    v_mfma_f32_16x16x32_bf16 a[88:91], v[80:83], v[56:59], a[88:91]
    v_mfma_f32_16x16x32_bf16 a[84:87], v[80:83], v[52:55], a[84:87]
    v_mfma_f32_16x16x32_bf16 a[84:87], v[84:87], v[4:7], a[84:87]
    v_mfma_f32_16x16x32_bf16 a[80:83], v[84:87], v[0:3], a[80:83]
    v_mfma_f32_16x16x32_bf16 a[80:83], v[80:83], v[48:51], a[80:83]
    ds_read_b64_tr_b16 v[80:81], v144 offset:49152
    s_waitcnt lgkmcnt(5)
    v_mfma_f32_16x16x32_bf16 v[112:115], v[88:91], v[48:51], v[112:115]
    ds_read_b64_tr_b16 v[82:83], v144 offset:53248
    v_mfma_f32_16x16x32_bf16 v[112:115], v[92:95], v[0:3], v[112:115]
    ds_read_b64_tr_b16 v[84:85], v144 offset:57344
    v_mfma_f32_16x16x32_bf16 v[116:119], v[92:95], v[4:7], v[116:119]
    ds_read_b64_tr_b16 v[86:87], v144 offset:61440
    v_mfma_f32_16x16x32_bf16 v[116:119], v[88:91], v[52:55], v[116:119]
    v_mfma_f32_16x16x32_bf16 v[120:123], v[88:91], v[56:59], v[120:123]
    s_add_u32 s53, s64, s27
    buffer_store_dwordx2 v[98:99], v157, s[12:15], s53 offen offset:1024 sc1
    s_waitcnt vmcnt(7)
    v_mfma_f32_16x16x32_bf16 v[120:123], v[92:95], v[8:11], v[120:123]
    v_mov_b32 v151, 2
    v_mfma_f32_16x16x32_bf16 v[124:127], v[92:95], v[12:15], v[124:127]
    s_cmp_lg_u32 s26, 1
    s_cbranch_scc1 fused_kernel_sfh2
    buffer_store_dword v151, v148, s[12:15], s57 offen offset:0
fused_kernel_sfrh2:
    v_mfma_f32_16x16x32_bf16 v[124:127], v[88:91], v[60:63], v[124:127]
    ds_read_b64_tr_b16 v[88:89], v145 offset:49152
    s_waitcnt lgkmcnt(5)
    v_mfma_f32_16x16x32_bf16 v[140:143], v[104:107], v[60:63], v[140:143]
    ds_read_b64_tr_b16 v[90:91], v145 offset:53248
    v_mfma_f32_16x16x32_bf16 v[140:143], v[108:111], v[12:15], v[140:143]
    ds_read_b64_tr_b16 v[92:93], v145 offset:57344
    v_mfma_f32_16x16x32_bf16 v[136:139], v[108:111], v[8:11], v[136:139]
    ds_read_b64_tr_b16 v[94:95], v145 offset:61440
    v_mfma_f32_16x16x32_bf16 v[136:139], v[104:107], v[56:59], v[136:139]
    v_mfma_f32_16x16x32_bf16 v[132:135], v[104:107], v[52:55], v[132:135]
fused_kernel_pg5:
    s_cbranch_execz fused_kernel_pg13
    v_mfma_f32_16x16x32_bf16 v[132:135], v[108:111], v[4:7], v[132:135]
    v_mfma_f32_16x16x32_bf16 v[128:131], v[108:111], v[0:3], v[128:131]
    s_add_u32 s53, s64, s27
    buffer_store_dwordx2 v[100:101], v157, s[12:15], s53 offen offset:2048 sc1
    v_mfma_f32_16x16x32_bf16 v[128:131], v[104:107], v[48:51], v[128:131]
    ds_read_b64_tr_b16 v[104:105], v146 offset:49152
    s_waitcnt vmcnt(4) lgkmcnt(5)
    v_mfma_f32_16x16x32_bf16 a[0:3], v[80:83], v[16:19], a[0:3]
    ds_read_b64_tr_b16 v[106:107], v146 offset:53248
    s_add_u32 s46, s72, 0
    v_mfma_f32_16x16x32_bf16 a[0:3], v[84:87], v[32:35], a[0:3]
    ds_read_b64_tr_b16 v[108:109], v146 offset:57344
    buffer_load_dwordx4 v[0:3], v158, s[12:15], s46 offen offset:0 sc1
    v_mfma_f32_16x16x32_bf16 a[4:7], v[84:87], v[36:39], a[4:7]
    ds_read_b64_tr_b16 v[110:111], v146 offset:61440
    v_mfma_f32_16x16x32_bf16 a[4:7], v[80:83], v[20:23], a[4:7]
    v_mfma_f32_16x16x32_bf16 a[8:11], v[80:83], v[24:27], a[8:11]
    v_mfma_f32_16x16x32_bf16 a[8:11], v[84:87], v[40:43], a[8:11]
    buffer_load_dwordx4 v[4:7], v158, s[12:15], s46 offen offset:1024 sc1
    v_mfma_f32_16x16x32_bf16 a[12:15], v[84:87], v[44:47], a[12:15]
    v_mfma_f32_16x16x32_bf16 a[12:15], v[80:83], v[28:31], a[12:15]
    ds_read_b64_tr_b16 v[80:81], v147 offset:49152
    s_waitcnt lgkmcnt(5)
    v_mfma_f32_16x16x32_bf16 a[28:31], v[88:91], v[28:31], a[28:31]
    s_add_u32 s53, s64, s27
    buffer_store_dwordx2 v[102:103], v157, s[12:15], s53 offen offset:3072 sc1
    ds_read_b64_tr_b16 v[82:83], v147 offset:53248
    v_mfma_f32_16x16x32_bf16 a[28:31], v[92:95], v[44:47], a[28:31]
    ds_read_b64_tr_b16 v[84:85], v147 offset:57344
    buffer_load_dwordx4 v[8:11], v158, s[12:15], s46 offen offset:2048 sc1
    v_mfma_f32_16x16x32_bf16 a[24:27], v[92:95], v[40:43], a[24:27]
    ds_read_b64_tr_b16 v[86:87], v147 offset:61440
    v_mfma_f32_16x16x32_bf16 a[24:27], v[88:91], v[24:27], a[24:27]
    ds_read_b64_tr_b16 v[96:97], v144 offset:50176
    v_mfma_f32_16x16x32_bf16 a[20:23], v[88:91], v[20:23], a[20:23]
    ds_read_b64_tr_b16 v[98:99], v144 offset:54272
    v_mfma_f32_16x16x32_bf16 a[20:23], v[92:95], v[36:39], a[20:23]
    ds_read_b64_tr_b16 v[100:101], v144 offset:58368
    buffer_load_dwordx4 v[12:15], v158, s[12:15], s46 offen offset:3072 sc1
    v_mfma_f32_16x16x32_bf16 a[16:19], v[92:95], v[32:35], a[16:19]
    ds_read_b64_tr_b16 v[102:103], v144 offset:62464
    v_mfma_f32_16x16x32_bf16 a[16:19], v[88:91], v[16:19], a[16:19]
    s_add_u32 s46, s73, 0
    s_waitcnt lgkmcnt(8)
    v_mfma_f32_16x16x32_bf16 a[32:35], v[104:107], v[16:19], a[32:35]
    ds_read_b64_tr_b16 v[88:89], v145 offset:50176
    buffer_load_dwordx4 v[48:51], v158, s[12:15], s46 offen offset:0 sc1
    v_mfma_f32_16x16x32_bf16 a[32:35], v[108:111], v[32:35], a[32:35]
    v_mfma_f32_16x16x32_bf16 a[36:39], v[108:111], v[36:39], a[36:39]
    ds_read_b64_tr_b16 v[90:91], v145 offset:54272
    v_mfma_f32_16x16x32_bf16 a[36:39], v[104:107], v[20:23], a[36:39]
    v_mfma_f32_16x16x32_bf16 a[40:43], v[104:107], v[24:27], a[40:43]
    ds_read_b64_tr_b16 v[92:93], v145 offset:58368
    buffer_load_dwordx4 v[52:55], v158, s[12:15], s46 offen offset:1024 sc1
    v_mfma_f32_16x16x32_bf16 a[40:43], v[108:111], v[40:43], a[40:43]
    v_mfma_f32_16x16x32_bf16 a[44:47], v[108:111], v[44:47], a[44:47]
    ds_read_b64_tr_b16 v[94:95], v145 offset:62464
    v_mfma_f32_16x16x32_bf16 a[44:47], v[104:107], v[28:31], a[44:47]
    s_waitcnt lgkmcnt(8)
    v_mfma_f32_16x16x32_bf16 a[60:63], v[80:83], v[28:31], a[60:63]
    ds_read_b64_tr_b16 v[104:105], v146 offset:50176
    buffer_load_dwordx4 v[56:59], v158, s[12:15], s46 offen offset:2048 sc1
    v_mfma_f32_16x16x32_bf16 a[60:63], v[84:87], v[44:47], a[60:63]
    buffer_load_dword v150, v149, s[12:15], s58 offen offset:0 sc1
    v_mfma_f32_16x16x32_bf16 a[56:59], v[84:87], v[40:43], a[56:59]
    ds_read_b64_tr_b16 v[106:107], v146 offset:54272
    v_mfma_f32_16x16x32_bf16 a[56:59], v[80:83], v[24:27], a[56:59]
    v_mfma_f32_16x16x32_bf16 a[52:55], v[80:83], v[20:23], a[52:55]
    ds_read_b64_tr_b16 v[108:109], v146 offset:58368
    buffer_load_dwordx4 v[60:63], v158, s[12:15], s46 offen offset:3072 sc1
    v_mfma_f32_16x16x32_bf16 a[52:55], v[84:87], v[36:39], a[52:55]
    v_mfma_f32_16x16x32_bf16 a[48:51], v[84:87], v[32:35], a[48:51]
    ds_read_b64_tr_b16 v[110:111], v146 offset:62464
    v_mfma_f32_16x16x32_bf16 a[48:51], v[80:83], v[16:19], a[48:51]
    s_waitcnt lgkmcnt(8)
    v_mfma_f32_16x16x32_bf16 a[64:67], v[96:99], v[16:19], a[64:67]
    ds_read_b64_tr_b16 v[80:81], v147 offset:50176
    v_mfma_f32_16x16x32_bf16 a[64:67], v[100:103], v[32:35], a[64:67]
    v_mfma_f32_16x16x32_bf16 a[68:71], v[100:103], v[36:39], a[68:71]
    ds_read_b64_tr_b16 v[82:83], v147 offset:54272
    v_mfma_f32_16x16x32_bf16 a[68:71], v[96:99], v[20:23], a[68:71]
    v_mfma_f32_16x16x32_bf16 a[72:75], v[96:99], v[24:27], a[72:75]
    ds_read_b64_tr_b16 v[84:85], v147 offset:58368
    v_mfma_f32_16x16x32_bf16 a[72:75], v[100:103], v[40:43], a[72:75]
    v_mfma_f32_16x16x32_bf16 a[76:79], v[100:103], v[44:47], a[76:79]
    ds_read_b64_tr_b16 v[86:87], v147 offset:62464
    v_mfma_f32_16x16x32_bf16 a[76:79], v[96:99], v[28:31], a[76:79]
    s_waitcnt lgkmcnt(8)
    v_mfma_f32_16x16x32_bf16 a[92:95], v[88:91], v[28:31], a[92:95]
    s_barrier
    ds_read_b64_tr_b16 v[96:97], v152 offset:0
    v_mfma_f32_16x16x32_bf16 a[92:95], v[92:95], v[44:47], a[92:95]
    v_mfma_f32_16x16x32_bf16 a[88:91], v[92:95], v[40:43], a[88:91]
    ds_read_b64_tr_b16 v[98:99], v152 offset:4096
    v_mfma_f32_16x16x32_bf16 a[88:91], v[88:91], v[24:27], a[88:91]
    v_mfma_f32_16x16x32_bf16 a[84:87], v[88:91], v[20:23], a[84:87]
    ds_read_b64_tr_b16 v[100:101], v152 offset:8192
    v_mfma_f32_16x16x32_bf16 a[84:87], v[92:95], v[36:39], a[84:87]
    v_mfma_f32_16x16x32_bf16 a[80:83], v[92:95], v[32:35], a[80:83]
    ds_read_b64_tr_b16 v[102:103], v152 offset:12288
    v_mfma_f32_16x16x32_bf16 a[80:83], v[88:91], v[16:19], a[80:83]
    s_waitcnt lgkmcnt(8)
    v_mfma_f32_16x16x32_bf16 v[112:115], v[104:107], v[16:19], v[112:115]
    s_add_u32 s53, s64, 8192
    buffer_store_dwordx4 v[76:79], v158, s[12:15], s53 offen offset:3072 sc1
    ds_read_b64_tr_b16 v[88:89], v153 offset:0
    v_mfma_f32_16x16x32_bf16 v[112:115], v[108:111], v[32:35], v[112:115]
    v_mfma_f32_16x16x32_bf16 v[116:119], v[108:111], v[36:39], v[116:119]
    ds_read_b64_tr_b16 v[90:91], v153 offset:4096
    v_mfma_f32_16x16x32_bf16 v[116:119], v[104:107], v[20:23], v[116:119]
    v_mfma_f32_16x16x32_bf16 v[120:123], v[104:107], v[24:27], v[120:123]
    ds_read_b64_tr_b16 v[92:93], v153 offset:8192
    v_mfma_f32_16x16x32_bf16 v[120:123], v[108:111], v[40:43], v[120:123]
    v_mfma_f32_16x16x32_bf16 v[124:127], v[108:111], v[44:47], v[124:127]
    ds_read_b64_tr_b16 v[94:95], v153 offset:12288
    v_mfma_f32_16x16x32_bf16 v[124:127], v[104:107], v[28:31], v[124:127]
    s_waitcnt lgkmcnt(8)
    v_mfma_f32_16x16x32_bf16 v[140:143], v[80:83], v[28:31], v[140:143]
    ds_read_b64_tr_b16 v[104:105], v154 offset:0
    v_mfma_f32_16x16x32_bf16 v[140:143], v[84:87], v[44:47], v[140:143]
    v_mfma_f32_16x16x32_bf16 v[136:139], v[84:87], v[40:43], v[136:139]
    s_add_u32 s53, s64, 8192
    buffer_store_dwordx4 v[72:75], v158, s[12:15], s53 offen offset:2048 sc1
    ds_read_b64_tr_b16 v[106:107], v154 offset:4096
    v_mfma_f32_16x16x32_bf16 v[136:139], v[80:83], v[24:27], v[136:139]
    v_mfma_f32_16x16x32_bf16 v[132:135], v[80:83], v[20:23], v[132:135]
    ds_read_b64_tr_b16 v[108:109], v154 offset:8192
    v_mfma_f32_16x16x32_bf16 v[132:135], v[84:87], v[36:39], v[132:135]
    v_mfma_f32_16x16x32_bf16 v[128:131], v[84:87], v[32:35], v[128:131]
    ds_read_b64_tr_b16 v[110:111], v154 offset:12288
    v_mfma_f32_16x16x32_bf16 v[128:131], v[80:83], v[16:19], v[128:131]
    s_waitcnt vmcnt(3)
    v_cmp_gt_u32 vcc, 2, v150
    s_nop 1
    s_cbranch_vccnz fused_kernel_spin_h10
fused_kernel_ret_h10:
    s_waitcnt vmcnt(2) lgkmcnt(8)
    v_mfma_f32_16x16x32_bf16 a[0:3], v[96:99], v[0:3], a[0:3]
    ds_read_b64_tr_b16 v[80:81], v155 offset:0
    s_add_u32 s46, s65, 4096
    v_mfma_f32_16x16x32_bf16 a[0:3], v[100:103], v[48:51], a[0:3]
    buffer_load_dwordx4 v[16:19], v158, s[12:15], s46 offen offset:0 sc1
    v_mfma_f32_16x16x32_bf16 a[4:7], v[100:103], v[52:55], a[4:7]
    ds_read_b64_tr_b16 v[82:83], v155 offset:4096
    v_mfma_f32_16x16x32_bf16 a[4:7], v[96:99], v[4:7], a[4:7]
    v_mfma_f32_16x16x32_bf16 a[8:11], v[96:99], v[8:11], a[8:11]
    s_add_u32 s53, s64, 8192
    buffer_store_dwordx4 v[68:71], v158, s[12:15], s53 offen offset:1024 sc1
    ds_read_b64_tr_b16 v[84:85], v155 offset:8192
    v_mfma_f32_16x16x32_bf16 a[8:11], v[100:103], v[56:59], a[8:11]
    buffer_load_dwordx4 v[20:23], v158, s[12:15], s46 offen offset:1024 sc1
    v_mfma_f32_16x16x32_bf16 a[12:15], v[100:103], v[60:63], a[12:15]
    ds_read_b64_tr_b16 v[86:87], v155 offset:12288
    v_mfma_f32_16x16x32_bf16 a[12:15], v[96:99], v[12:15], a[12:15]
    s_waitcnt lgkmcnt(8)
    v_mfma_f32_16x16x32_bf16 a[28:31], v[88:91], v[12:15], a[28:31]
    ds_read_b64_tr_b16 v[96:97], v152 offset:1024
    v_mfma_f32_16x16x32_bf16 a[28:31], v[92:95], v[60:63], a[28:31]
    buffer_load_dwordx4 v[24:27], v158, s[12:15], s46 offen offset:2048 sc1
    v_mfma_f32_16x16x32_bf16 a[24:27], v[92:95], v[56:59], a[24:27]
    ds_read_b64_tr_b16 v[98:99], v152 offset:5120
    v_mfma_f32_16x16x32_bf16 a[24:27], v[88:91], v[8:11], a[24:27]
    v_mfma_f32_16x16x32_bf16 a[20:23], v[88:91], v[4:7], a[20:23]
    ds_read_b64_tr_b16 v[100:101], v152 offset:9216
    v_mfma_f32_16x16x32_bf16 a[20:23], v[92:95], v[52:55], a[20:23]
    buffer_load_dwordx4 v[28:31], v158, s[12:15], s46 offen offset:3072 sc1
    v_mfma_f32_16x16x32_bf16 a[16:19], v[92:95], v[48:51], a[16:19]
    s_add_u32 s53, s64, 8192
    buffer_store_dwordx4 v[64:67], v158, s[12:15], s53 offen offset:0 sc1
    ds_read_b64_tr_b16 v[102:103], v152 offset:13312
    v_mfma_f32_16x16x32_bf16 a[16:19], v[88:91], v[0:3], a[16:19]
    s_add_u32 s46, s66, 4096
    s_waitcnt lgkmcnt(8)
    v_mfma_f32_16x16x32_bf16 a[32:35], v[104:107], v[0:3], a[32:35]
    ds_read_b64_tr_b16 v[88:89], v153 offset:1024
    buffer_load_dwordx4 v[32:35], v158, s[12:15], s46 offen offset:0 sc1
    v_mfma_f32_16x16x32_bf16 a[32:35], v[108:111], v[48:51], a[32:35]
    v_mfma_f32_16x16x32_bf16 a[36:39], v[108:111], v[52:55], a[36:39]
    ds_read_b64_tr_b16 v[90:91], v153 offset:5120
    v_mfma_f32_16x16x32_bf16 a[36:39], v[104:107], v[4:7], a[36:39]
    v_mfma_f32_16x16x32_bf16 a[40:43], v[104:107], v[8:11], a[40:43]
    ds_read_b64_tr_b16 v[92:93], v153 offset:9216
    buffer_load_dwordx4 v[36:39], v158, s[12:15], s46 offen offset:1024 sc1
    v_mfma_f32_16x16x32_bf16 a[40:43], v[108:111], v[56:59], a[40:43]
    v_mfma_f32_16x16x32_bf16 a[44:47], v[108:111], v[60:63], a[44:47]
    ds_read_b64_tr_b16 v[94:95], v153 offset:13312
    v_mfma_f32_16x16x32_bf16 a[44:47], v[104:107], v[12:15], a[44:47]
    s_waitcnt lgkmcnt(8)
    v_mfma_f32_16x16x32_bf16 a[60:63], v[80:83], v[12:15], a[60:63]
    ds_read_b64_tr_b16 v[104:105], v154 offset:1024
    buffer_load_dwordx4 v[40:43], v158, s[12:15], s46 offen offset:2048 sc1
    v_mfma_f32_16x16x32_bf16 a[60:63], v[84:87], v[60:63], a[60:63]
    v_mfma_f32_16x16x32_bf16 a[56:59], v[84:87], v[56:59], a[56:59]
    ds_read_b64_tr_b16 v[106:107], v154 offset:5120
    v_mfma_f32_16x16x32_bf16 a[56:59], v[80:83], v[8:11], a[56:59]
    v_mfma_f32_16x16x32_bf16 a[52:55], v[80:83], v[4:7], a[52:55]
    ds_read_b64_tr_b16 v[108:109], v154 offset:9216
    buffer_load_dwordx4 v[44:47], v158, s[12:15], s46 offen offset:3072 sc1
    v_mfma_f32_16x16x32_bf16 a[52:55], v[84:87], v[52:55], a[52:55]
    v_mfma_f32_16x16x32_bf16 a[48:51], v[84:87], v[48:51], a[48:51]
    ds_read_b64_tr_b16 v[110:111], v154 offset:13312
    s_add_u32 s46, s67, 4096
    v_mfma_f32_16x16x32_bf16 a[48:51], v[80:83], v[0:3], a[48:51]
    buffer_load_dwordx4 v[64:67], v158, s[12:15], s46 offen offset:0 sc1
    s_waitcnt lgkmcnt(8)
    v_mfma_f32_16x16x32_bf16 a[64:67], v[96:99], v[0:3], a[64:67]
    ds_read_b64_tr_b16 v[80:81], v155 offset:1024
    v_mfma_f32_16x16x32_bf16 a[64:67], v[100:103], v[48:51], a[64:67]
    v_mfma_f32_16x16x32_bf16 a[68:71], v[100:103], v[52:55], a[68:71]
    ds_read_b64_tr_b16 v[82:83], v155 offset:5120
    v_mfma_f32_16x16x32_bf16 a[68:71], v[96:99], v[4:7], a[68:71]
    buffer_load_dwordx4 v[68:71], v158, s[12:15], s46 offen offset:1024 sc1
    v_mfma_f32_16x16x32_bf16 a[72:75], v[96:99], v[8:11], a[72:75]
    ds_read_b64_tr_b16 v[84:85], v155 offset:9216
    v_mfma_f32_16x16x32_bf16 a[72:75], v[100:103], v[56:59], a[72:75]
    v_mfma_f32_16x16x32_bf16 a[76:79], v[100:103], v[60:63], a[76:79]
    ds_read_b64_tr_b16 v[86:87], v155 offset:13312
    v_mfma_f32_16x16x32_bf16 a[76:79], v[96:99], v[12:15], a[76:79]
    buffer_load_dwordx4 v[72:75], v158, s[12:15], s46 offen offset:2048 sc1
    s_waitcnt lgkmcnt(8)
    v_mfma_f32_16x16x32_bf16 a[92:95], v[88:91], v[12:15], a[92:95]
    ds_read_b64_tr_b16 v[96:97], v152 offset:16384
    v_mfma_f32_16x16x32_bf16 a[92:95], v[92:95], v[60:63], a[92:95]
    v_mfma_f32_16x16x32_bf16 a[88:91], v[92:95], v[56:59], a[88:91]
    ds_read_b64_tr_b16 v[98:99], v152 offset:20480
    v_mfma_f32_16x16x32_bf16 a[88:91], v[88:91], v[8:11], a[88:91]
    buffer_load_dwordx4 v[76:79], v158, s[12:15], s46 offen offset:3072 sc1
    v_mfma_f32_16x16x32_bf16 a[84:87], v[88:91], v[4:7], a[84:87]
    ds_read_b64_tr_b16 v[100:101], v152 offset:24576
    v_mfma_f32_16x16x32_bf16 a[84:87], v[92:95], v[52:55], a[84:87]
    v_mfma_f32_16x16x32_bf16 a[80:83], v[92:95], v[48:51], a[80:83]
    ds_read_b64_tr_b16 v[102:103], v152 offset:28672
    v_mfma_f32_16x16x32_bf16 a[80:83], v[88:91], v[0:3], a[80:83]
    s_waitcnt lgkmcnt(8)
    v_mfma_f32_16x16x32_bf16 v[112:115], v[104:107], v[0:3], v[112:115]
    ds_read_b64_tr_b16 v[88:89], v153 offset:16384
    v_mfma_f32_16x16x32_bf16 v[112:115], v[108:111], v[48:51], v[112:115]
    v_mfma_f32_16x16x32_bf16 v[116:119], v[108:111], v[52:55], v[116:119]
    ds_read_b64_tr_b16 v[90:91], v153 offset:20480
    v_mfma_f32_16x16x32_bf16 v[116:119], v[104:107], v[4:7], v[116:119]
    v_mfma_f32_16x16x32_bf16 v[120:123], v[104:107], v[8:11], v[120:123]
    ds_read_b64_tr_b16 v[92:93], v153 offset:24576
    v_mfma_f32_16x16x32_bf16 v[120:123], v[108:111], v[56:59], v[120:123]
    v_mfma_f32_16x16x32_bf16 v[124:127], v[108:111], v[60:63], v[124:127]
    ds_read_b64_tr_b16 v[94:95], v153 offset:28672
    v_mfma_f32_16x16x32_bf16 v[124:127], v[104:107], v[12:15], v[124:127]
    s_waitcnt lgkmcnt(8)
    v_mfma_f32_16x16x32_bf16 v[140:143], v[80:83], v[12:15], v[140:143]
    ds_read_b64_tr_b16 v[104:105], v154 offset:16384
    v_mfma_f32_16x16x32_bf16 v[140:143], v[84:87], v[60:63], v[140:143]
    v_mfma_f32_16x16x32_bf16 v[136:139], v[84:87], v[56:59], v[136:139]
    ds_read_b64_tr_b16 v[106:107], v154 offset:20480
    v_mfma_f32_16x16x32_bf16 v[136:139], v[80:83], v[8:11], v[136:139]
    v_mfma_f32_16x16x32_bf16 v[132:135], v[80:83], v[4:7], v[132:135]
    ds_read_b64_tr_b16 v[108:109], v154 offset:24576
    v_mfma_f32_16x16x32_bf16 v[132:135], v[84:87], v[52:55], v[132:135]
    v_mfma_f32_16x16x32_bf16 v[128:131], v[84:87], v[48:51], v[128:131]
    ds_read_b64_tr_b16 v[110:111], v154 offset:28672
    v_mfma_f32_16x16x32_bf16 v[128:131], v[80:83], v[0:3], v[128:131]
    s_waitcnt vmcnt(4) lgkmcnt(8)
    v_mfma_f32_16x16x32_bf16 a[0:3], v[96:99], v[16:19], a[0:3]
    ds_read_b64_tr_b16 v[80:81], v155 offset:16384
    s_add_u32 s46, s70, 4096
    v_mfma_f32_16x16x32_bf16 a[0:3], v[100:103], v[32:35], a[0:3]
    buffer_load_dwordx4 v[0:3], v158, s[12:15], s46 offen offset:0 sc1
    v_mfma_f32_16x16x32_bf16 a[4:7], v[100:103], v[36:39], a[4:7]
    ds_read_b64_tr_b16 v[82:83], v155 offset:20480
    v_mfma_f32_16x16x32_bf16 a[4:7], v[96:99], v[20:23], a[4:7]
    v_mfma_f32_16x16x32_bf16 a[8:11], v[96:99], v[24:27], a[8:11]
    ds_read_b64_tr_b16 v[84:85], v155 offset:24576
    v_mfma_f32_16x16x32_bf16 a[8:11], v[100:103], v[40:43], a[8:11]
    buffer_load_dwordx4 v[4:7], v158, s[12:15], s46 offen offset:1024 sc1
    v_mfma_f32_16x16x32_bf16 a[12:15], v[100:103], v[44:47], a[12:15]
    ds_read_b64_tr_b16 v[86:87], v155 offset:28672
    v_mfma_f32_16x16x32_bf16 a[12:15], v[96:99], v[28:31], a[12:15]
    s_waitcnt lgkmcnt(8)
    v_mfma_f32_16x16x32_bf16 a[28:31], v[88:91], v[28:31], a[28:31]
    ds_read_b64_tr_b16 v[96:97], v152 offset:17408
    v_mfma_f32_16x16x32_bf16 a[28:31], v[92:95], v[44:47], a[28:31]
    buffer_load_dwordx4 v[8:11], v158, s[12:15], s46 offen offset:2048 sc1
    v_mfma_f32_16x16x32_bf16 a[24:27], v[92:95], v[40:43], a[24:27]
    ds_read_b64_tr_b16 v[98:99], v152 offset:21504
    v_mov_b32 v151, 3
    v_mfma_f32_16x16x32_bf16 a[24:27], v[88:91], v[24:27], a[24:27]
    s_cmp_lg_u32 s26, 1
    s_cbranch_scc1 fused_kernel_sfh3
    buffer_store_dword v151, v148, s[12:15], s57 offen offset:0
fused_kernel_sfrh3:
    v_mfma_f32_16x16x32_bf16 a[20:23], v[88:91], v[20:23], a[20:23]
    ds_read_b64_tr_b16 v[100:101], v152 offset:25600
    v_mfma_f32_16x16x32_bf16 a[20:23], v[92:95], v[36:39], a[20:23]
    buffer_load_dwordx4 v[12:15], v158, s[12:15], s46 offen offset:3072 sc1
    v_mfma_f32_16x16x32_bf16 a[16:19], v[92:95], v[32:35], a[16:19]
    ds_read_b64_tr_b16 v[102:103], v152 offset:29696
    v_mfma_f32_16x16x32_bf16 a[16:19], v[88:91], v[16:19], a[16:19]
    s_add_u32 s46, s71, 4096
    s_waitcnt lgkmcnt(8)
    v_mfma_f32_16x16x32_bf16 a[32:35], v[104:107], v[16:19], a[32:35]
    ds_read_b64_tr_b16 v[88:89], v153 offset:17408
    buffer_load_dwordx4 v[48:51], v158, s[12:15], s46 offen offset:0 sc1
    v_mfma_f32_16x16x32_bf16 a[32:35], v[108:111], v[32:35], a[32:35]
    v_mfma_f32_16x16x32_bf16 a[36:39], v[108:111], v[36:39], a[36:39]
    ds_read_b64_tr_b16 v[90:91], v153 offset:21504
    v_mfma_f32_16x16x32_bf16 a[36:39], v[104:107], v[20:23], a[36:39]
    v_mfma_f32_16x16x32_bf16 a[40:43], v[104:107], v[24:27], a[40:43]
    ds_read_b64_tr_b16 v[92:93], v153 offset:25600
    buffer_load_dwordx4 v[52:55], v158, s[12:15], s46 offen offset:1024 sc1
    v_mfma_f32_16x16x32_bf16 a[40:43], v[108:111], v[40:43], a[40:43]
    v_mfma_f32_16x16x32_bf16 a[44:47], v[108:111], v[44:47], a[44:47]
    ds_read_b64_tr_b16 v[94:95], v153 offset:29696
    v_mfma_f32_16x16x32_bf16 a[44:47], v[104:107], v[28:31], a[44:47]
    s_waitcnt lgkmcnt(8)
    v_mfma_f32_16x16x32_bf16 a[60:63], v[80:83], v[28:31], a[60:63]
    ds_read_b64_tr_b16 v[104:105], v154 offset:17408
    buffer_load_dwordx4 v[56:59], v158, s[12:15], s46 offen offset:2048 sc1
    v_mfma_f32_16x16x32_bf16 a[60:63], v[84:87], v[44:47], a[60:63]
    v_mfma_f32_16x16x32_bf16 a[56:59], v[84:87], v[40:43], a[56:59]
    ds_read_b64_tr_b16 v[106:107], v154 offset:21504
    v_mfma_f32_16x16x32_bf16 a[56:59], v[80:83], v[24:27], a[56:59]
    v_mfma_f32_16x16x32_bf16 a[52:55], v[80:83], v[20:23], a[52:55]
    ds_read_b64_tr_b16 v[108:109], v154 offset:25600
    buffer_load_dwordx4 v[60:63], v158, s[12:15], s46 offen offset:3072 sc1
    v_mfma_f32_16x16x32_bf16 a[52:55], v[84:87], v[36:39], a[52:55]
    v_mfma_f32_16x16x32_bf16 a[48:51], v[84:87], v[32:35], a[48:51]
    ds_read_b64_tr_b16 v[110:111], v154 offset:29696
    v_mfma_f32_16x16x32_bf16 a[48:51], v[80:83], v[16:19], a[48:51]
    s_waitcnt lgkmcnt(8)
    v_mfma_f32_16x16x32_bf16 a[64:67], v[96:99], v[16:19], a[64:67]
    ds_read_b64_tr_b16 v[80:81], v155 offset:17408
    v_mfma_f32_16x16x32_bf16 a[64:67], v[100:103], v[32:35], a[64:67]
    v_mfma_f32_16x16x32_bf16 a[68:71], v[100:103], v[36:39], a[68:71]
    ds_read_b64_tr_b16 v[82:83], v155 offset:21504
    v_mfma_f32_16x16x32_bf16 a[68:71], v[96:99], v[20:23], a[68:71]
    v_mfma_f32_16x16x32_bf16 a[72:75], v[96:99], v[24:27], a[72:75]
    ds_read_b64_tr_b16 v[84:85], v155 offset:25600
    v_mfma_f32_16x16x32_bf16 a[72:75], v[100:103], v[40:43], a[72:75]
    v_mfma_f32_16x16x32_bf16 a[76:79], v[100:103], v[44:47], a[76:79]
    ds_read_b64_tr_b16 v[86:87], v155 offset:29696
    v_mfma_f32_16x16x32_bf16 a[76:79], v[96:99], v[28:31], a[76:79]
    s_waitcnt lgkmcnt(8)
    v_mfma_f32_16x16x32_bf16 a[92:95], v[88:91], v[28:31], a[92:95]
    s_barrier
    ds_read_b64_tr_b16 v[96:97], v144 offset:0
    v_mfma_f32_16x16x32_bf16 a[92:95], v[92:95], v[44:47], a[92:95]
    v_mfma_f32_16x16x32_bf16 a[88:91], v[92:95], v[40:43], a[88:91]
    ds_read_b64_tr_b16 v[98:99], v144 offset:4096
    v_mfma_f32_16x16x32_bf16 a[88:91], v[88:91], v[24:27], a[88:91]
    v_mfma_f32_16x16x32_bf16 a[84:87], v[88:91], v[20:23], a[84:87]
    ds_read_b64_tr_b16 v[100:101], v144 offset:8192
    v_mfma_f32_16x16x32_bf16 a[84:87], v[92:95], v[36:39], a[84:87]
    v_mfma_f32_16x16x32_bf16 a[80:83], v[92:95], v[32:35], a[80:83]
    ds_read_b64_tr_b16 v[102:103], v144 offset:12288
    v_mfma_f32_16x16x32_bf16 a[80:83], v[88:91], v[16:19], a[80:83]
    s_waitcnt lgkmcnt(8)
    v_mfma_f32_16x16x32_bf16 v[112:115], v[104:107], v[16:19], v[112:115]
    ds_read_b64_tr_b16 v[88:89], v145 offset:0
    v_mfma_f32_16x16x32_bf16 v[112:115], v[108:111], v[32:35], v[112:115]
    v_mfma_f32_16x16x32_bf16 v[116:119], v[108:111], v[36:39], v[116:119]
    ds_read_b64_tr_b16 v[90:91], v145 offset:4096
    v_mfma_f32_16x16x32_bf16 v[116:119], v[104:107], v[20:23], v[116:119]
    v_mfma_f32_16x16x32_bf16 v[120:123], v[104:107], v[24:27], v[120:123]
    ds_read_b64_tr_b16 v[92:93], v145 offset:8192
    v_mfma_f32_16x16x32_bf16 v[120:123], v[108:111], v[40:43], v[120:123]
    v_mfma_f32_16x16x32_bf16 v[124:127], v[108:111], v[44:47], v[124:127]
    ds_read_b64_tr_b16 v[94:95], v145 offset:12288
    v_mfma_f32_16x16x32_bf16 v[124:127], v[104:107], v[28:31], v[124:127]
    s_waitcnt lgkmcnt(8)
    v_mfma_f32_16x16x32_bf16 v[140:143], v[80:83], v[28:31], v[140:143]
    ds_read_b64_tr_b16 v[104:105], v146 offset:0
    v_mfma_f32_16x16x32_bf16 v[140:143], v[84:87], v[44:47], v[140:143]
    v_mfma_f32_16x16x32_bf16 v[136:139], v[84:87], v[40:43], v[136:139]
    ds_read_b64_tr_b16 v[106:107], v146 offset:4096
    v_mfma_f32_16x16x32_bf16 v[136:139], v[80:83], v[24:27], v[136:139]
    v_mfma_f32_16x16x32_bf16 v[132:135], v[80:83], v[20:23], v[132:135]
    ds_read_b64_tr_b16 v[108:109], v146 offset:8192
    v_mfma_f32_16x16x32_bf16 v[132:135], v[84:87], v[36:39], v[132:135]
    v_mfma_f32_16x16x32_bf16 v[128:131], v[84:87], v[32:35], v[128:131]
    ds_read_b64_tr_b16 v[110:111], v146 offset:12288
    v_mfma_f32_16x16x32_bf16 v[128:131], v[80:83], v[16:19], v[128:131]
    s_waitcnt vmcnt(4) lgkmcnt(8)
    v_mfma_f32_16x16x32_bf16 a[0:3], v[96:99], v[64:67], a[0:3]
    ds_read_b64_tr_b16 v[80:81], v147 offset:0
    s_add_u32 s46, s72, 4096
    v_mfma_f32_16x16x32_bf16 a[0:3], v[100:103], v[0:3], a[0:3]
    buffer_load_dwordx4 v[16:19], v158, s[12:15], s46 offen offset:0 sc1
    v_mfma_f32_16x16x32_bf16 a[4:7], v[100:103], v[4:7], a[4:7]
    ds_read_b64_tr_b16 v[82:83], v147 offset:4096
    v_mfma_f32_16x16x32_bf16 a[4:7], v[96:99], v[68:71], a[4:7]
    v_mfma_f32_16x16x32_bf16 a[8:11], v[96:99], v[72:75], a[8:11]
    ds_read_b64_tr_b16 v[84:85], v147 offset:8192
    v_mfma_f32_16x16x32_bf16 a[8:11], v[100:103], v[8:11], a[8:11]
    buffer_load_dwordx4 v[20:23], v158, s[12:15], s46 offen offset:1024 sc1
    v_mfma_f32_16x16x32_bf16 a[12:15], v[100:103], v[12:15], a[12:15]
    ds_read_b64_tr_b16 v[86:87], v147 offset:12288
    v_mfma_f32_16x16x32_bf16 a[12:15], v[96:99], v[76:79], a[12:15]
    s_waitcnt lgkmcnt(8)
    v_mfma_f32_16x16x32_bf16 a[28:31], v[88:91], v[76:79], a[28:31]
    ds_read_b64_tr_b16 v[96:97], v144 offset:1024
    v_mfma_f32_16x16x32_bf16 a[28:31], v[92:95], v[12:15], a[28:31]
    buffer_load_dwordx4 v[24:27], v158, s[12:15], s46 offen offset:2048 sc1
    v_mfma_f32_16x16x32_bf16 a[24:27], v[92:95], v[8:11], a[24:27]
    ds_read_b64_tr_b16 v[98:99], v144 offset:5120
    v_mfma_f32_16x16x32_bf16 a[24:27], v[88:91], v[72:75], a[24:27]
    v_mfma_f32_16x16x32_bf16 a[20:23], v[88:91], v[68:71], a[20:23]
    ds_read_b64_tr_b16 v[100:101], v144 offset:9216
    v_mfma_f32_16x16x32_bf16 a[20:23], v[92:95], v[4:7], a[20:23]
    buffer_load_dwordx4 v[28:31], v158, s[12:15], s46 offen offset:3072 sc1
    v_mfma_f32_16x16x32_bf16 a[16:19], v[92:95], v[0:3], a[16:19]
    ds_read_b64_tr_b16 v[102:103], v144 offset:13312
    v_mfma_f32_16x16x32_bf16 a[16:19], v[88:91], v[64:67], a[16:19]
    s_add_u32 s46, s73, 4096
    s_waitcnt lgkmcnt(8)
    v_mfma_f32_16x16x32_bf16 a[32:35], v[104:107], v[64:67], a[32:35]
    ds_read_b64_tr_b16 v[88:89], v145 offset:1024
    buffer_load_dwordx4 v[32:35], v158, s[12:15], s46 offen offset:0 sc1
    v_mfma_f32_16x16x32_bf16 a[32:35], v[108:111], v[0:3], a[32:35]
    v_mfma_f32_16x16x32_bf16 a[36:39], v[108:111], v[4:7], a[36:39]
    ds_read_b64_tr_b16 v[90:91], v145 offset:5120
    v_mfma_f32_16x16x32_bf16 a[36:39], v[104:107], v[68:71], a[36:39]
    v_mfma_f32_16x16x32_bf16 a[40:43], v[104:107], v[72:75], a[40:43]
    ds_read_b64_tr_b16 v[92:93], v145 offset:9216
    buffer_load_dwordx4 v[36:39], v158, s[12:15], s46 offen offset:1024 sc1
    v_mfma_f32_16x16x32_bf16 a[40:43], v[108:111], v[8:11], a[40:43]
    v_mfma_f32_16x16x32_bf16 a[44:47], v[108:111], v[12:15], a[44:47]
    ds_read_b64_tr_b16 v[94:95], v145 offset:13312
    v_mfma_f32_16x16x32_bf16 a[44:47], v[104:107], v[76:79], a[44:47]
    s_waitcnt lgkmcnt(8)
    v_mfma_f32_16x16x32_bf16 a[60:63], v[80:83], v[76:79], a[60:63]
    ds_read_b64_tr_b16 v[104:105], v146 offset:1024
    buffer_load_dwordx4 v[40:43], v158, s[12:15], s46 offen offset:2048 sc1
    v_mfma_f32_16x16x32_bf16 a[60:63], v[84:87], v[12:15], a[60:63]
    buffer_load_dword v150, v149, s[12:15], s58 offen offset:0 sc1
    v_mfma_f32_16x16x32_bf16 a[56:59], v[84:87], v[8:11], a[56:59]
    ds_read_b64_tr_b16 v[106:107], v146 offset:5120
    v_mfma_f32_16x16x32_bf16 a[56:59], v[80:83], v[72:75], a[56:59]
    v_mfma_f32_16x16x32_bf16 a[52:55], v[80:83], v[68:71], a[52:55]
    ds_read_b64_tr_b16 v[108:109], v146 offset:9216
    buffer_load_dwordx4 v[44:47], v158, s[12:15], s46 offen offset:3072 sc1
    v_mfma_f32_16x16x32_bf16 a[52:55], v[84:87], v[4:7], a[52:55]
    v_mfma_f32_16x16x32_bf16 a[48:51], v[84:87], v[0:3], a[48:51]
    ds_read_b64_tr_b16 v[110:111], v146 offset:13312
    v_mfma_f32_16x16x32_bf16 a[48:51], v[80:83], v[64:67], a[48:51]
    s_waitcnt lgkmcnt(8)
    v_mfma_f32_16x16x32_bf16 a[64:67], v[96:99], v[64:67], a[64:67]
    ds_read_b64_tr_b16 v[80:81], v147 offset:1024
    v_mfma_f32_16x16x32_bf16 a[64:67], v[100:103], v[0:3], a[64:67]
    v_mfma_f32_16x16x32_bf16 a[68:71], v[100:103], v[4:7], a[68:71]
    ds_read_b64_tr_b16 v[82:83], v147 offset:5120
    v_mfma_f32_16x16x32_bf16 a[68:71], v[96:99], v[68:71], a[68:71]
    v_mfma_f32_16x16x32_bf16 a[72:75], v[96:99], v[72:75], a[72:75]
    ds_read_b64_tr_b16 v[84:85], v147 offset:9216
    v_mfma_f32_16x16x32_bf16 a[72:75], v[100:103], v[8:11], a[72:75]
    v_mfma_f32_16x16x32_bf16 a[76:79], v[100:103], v[12:15], a[76:79]
    ds_read_b64_tr_b16 v[86:87], v147 offset:13312
    v_mfma_f32_16x16x32_bf16 a[76:79], v[96:99], v[76:79], a[76:79]
    s_waitcnt lgkmcnt(8)
    v_mfma_f32_16x16x32_bf16 a[92:95], v[88:91], v[76:79], a[92:95]
    ds_read_b64_tr_b16 v[96:97], v144 offset:16384
    v_mfma_f32_16x16x32_bf16 a[92:95], v[92:95], v[12:15], a[92:95]
    v_mfma_f32_16x16x32_bf16 a[88:91], v[92:95], v[8:11], a[88:91]
    ds_read_b64_tr_b16 v[98:99], v144 offset:20480
    v_mfma_f32_16x16x32_bf16 a[88:91], v[88:91], v[72:75], a[88:91]
    v_mfma_f32_16x16x32_bf16 a[84:87], v[88:91], v[68:71], a[84:87]
    ds_read_b64_tr_b16 v[100:101], v144 offset:24576
    v_mfma_f32_16x16x32_bf16 a[84:87], v[92:95], v[4:7], a[84:87]
    v_mfma_f32_16x16x32_bf16 a[80:83], v[92:95], v[0:3], a[80:83]
    ds_read_b64_tr_b16 v[102:103], v144 offset:28672
    v_mfma_f32_16x16x32_bf16 a[80:83], v[88:91], v[64:67], a[80:83]
    s_waitcnt lgkmcnt(8)
    v_mfma_f32_16x16x32_bf16 v[112:115], v[104:107], v[64:67], v[112:115]
    ds_read_b64_tr_b16 v[88:89], v145 offset:16384
    v_mfma_f32_16x16x32_bf16 v[112:115], v[108:111], v[0:3], v[112:115]
    v_mfma_f32_16x16x32_bf16 v[116:119], v[108:111], v[4:7], v[116:119]
    ds_read_b64_tr_b16 v[90:91], v145 offset:20480
    v_mfma_f32_16x16x32_bf16 v[116:119], v[104:107], v[68:71], v[116:119]
    v_mfma_f32_16x16x32_bf16 v[120:123], v[104:107], v[72:75], v[120:123]
    ds_read_b64_tr_b16 v[92:93], v145 offset:24576
    v_mfma_f32_16x16x32_bf16 v[120:123], v[108:111], v[8:11], v[120:123]
    v_mfma_f32_16x16x32_bf16 v[124:127], v[108:111], v[12:15], v[124:127]
    ds_read_b64_tr_b16 v[94:95], v145 offset:28672
    v_mfma_f32_16x16x32_bf16 v[124:127], v[104:107], v[76:79], v[124:127]
    s_waitcnt lgkmcnt(8)
    v_mfma_f32_16x16x32_bf16 v[140:143], v[80:83], v[76:79], v[140:143]
    ds_read_b64_tr_b16 v[104:105], v146 offset:16384
    v_mfma_f32_16x16x32_bf16 v[140:143], v[84:87], v[12:15], v[140:143]
    v_mfma_f32_16x16x32_bf16 v[136:139], v[84:87], v[8:11], v[136:139]
    ds_read_b64_tr_b16 v[106:107], v146 offset:20480
    v_mfma_f32_16x16x32_bf16 v[136:139], v[80:83], v[72:75], v[136:139]
    v_mfma_f32_16x16x32_bf16 v[132:135], v[80:83], v[68:71], v[132:135]
    ds_read_b64_tr_b16 v[108:109], v146 offset:24576
    v_mfma_f32_16x16x32_bf16 v[132:135], v[84:87], v[4:7], v[132:135]
    v_mfma_f32_16x16x32_bf16 v[128:131], v[84:87], v[0:3], v[128:131]
    ds_read_b64_tr_b16 v[110:111], v146 offset:28672
    v_mfma_f32_16x16x32_bf16 v[128:131], v[80:83], v[64:67], v[128:131]
    s_waitcnt vmcnt(1)
    v_cmp_gt_u32 vcc, 3, v150
    s_nop 1
    s_cbranch_vccnz fused_kernel_spin_h17
fused_kernel_ret_h17:
    s_waitcnt lgkmcnt(8)
    v_mfma_f32_16x16x32_bf16 a[0:3], v[96:99], v[48:51], a[0:3]
    ds_read_b64_tr_b16 v[80:81], v147 offset:16384
    s_add_u32 s46, s64, s27
    v_mfma_f32_16x16x32_bf16 a[0:3], v[100:103], v[16:19], a[0:3]
    buffer_load_dwordx4 v[0:3], v158, s[12:15], s46 offen offset:0 sc1
    v_mfma_f32_16x16x32_bf16 a[4:7], v[100:103], v[20:23], a[4:7]
    ds_read_b64_tr_b16 v[82:83], v147 offset:20480
    v_mfma_f32_16x16x32_bf16 a[4:7], v[96:99], v[52:55], a[4:7]
    v_mfma_f32_16x16x32_bf16 a[8:11], v[96:99], v[56:59], a[8:11]
    ds_read_b64_tr_b16 v[84:85], v147 offset:24576
    v_mfma_f32_16x16x32_bf16 a[8:11], v[100:103], v[24:27], a[8:11]
    buffer_load_dwordx4 v[4:7], v158, s[12:15], s46 offen offset:1024 sc1
    v_mfma_f32_16x16x32_bf16 a[12:15], v[100:103], v[28:31], a[12:15]
    ds_read_b64_tr_b16 v[86:87], v147 offset:28672
    v_mfma_f32_16x16x32_bf16 a[12:15], v[96:99], v[60:63], a[12:15]
    s_waitcnt lgkmcnt(8)
    v_mfma_f32_16x16x32_bf16 a[28:31], v[88:91], v[60:63], a[28:31]
    ds_read_b64_tr_b16 v[96:97], v144 offset:17408
    v_mfma_f32_16x16x32_bf16 a[28:31], v[92:95], v[28:31], a[28:31]
    buffer_load_dwordx4 v[8:11], v158, s[12:15], s46 offen offset:2048 sc1
    v_mfma_f32_16x16x32_bf16 a[24:27], v[92:95], v[24:27], a[24:27]
    ds_read_b64_tr_b16 v[98:99], v144 offset:21504
    v_mfma_f32_16x16x32_bf16 a[24:27], v[88:91], v[56:59], a[24:27]
    v_mfma_f32_16x16x32_bf16 a[20:23], v[88:91], v[52:55], a[20:23]
    ds_read_b64_tr_b16 v[100:101], v144 offset:25600
    v_mfma_f32_16x16x32_bf16 a[20:23], v[92:95], v[20:23], a[20:23]
    buffer_load_dwordx4 v[12:15], v158, s[12:15], s46 offen offset:3072 sc1
    v_mfma_f32_16x16x32_bf16 a[16:19], v[92:95], v[16:19], a[16:19]
    ds_read_b64_tr_b16 v[102:103], v144 offset:29696
    v_mfma_f32_16x16x32_bf16 a[16:19], v[88:91], v[48:51], a[16:19]
    s_add_u32 s46, s66, s27
    s_waitcnt lgkmcnt(8)
    v_mfma_f32_16x16x32_bf16 a[32:35], v[104:107], v[48:51], a[32:35]
    ds_read_b64_tr_b16 v[88:89], v145 offset:17408
    buffer_load_dwordx4 v[64:67], v158, s[12:15], s46 offen offset:0 sc1
    v_mfma_f32_16x16x32_bf16 a[32:35], v[108:111], v[16:19], a[32:35]
    v_mfma_f32_16x16x32_bf16 a[36:39], v[108:111], v[20:23], a[36:39]
    ds_read_b64_tr_b16 v[90:91], v145 offset:21504
    v_mfma_f32_16x16x32_bf16 a[36:39], v[104:107], v[52:55], a[36:39]
    v_mfma_f32_16x16x32_bf16 a[40:43], v[104:107], v[56:59], a[40:43]
    ds_read_b64_tr_b16 v[92:93], v145 offset:25600
fused_kernel_pg6:
    s_cbranch_execz fused_kernel_pg14
    buffer_load_dwordx4 v[68:71], v158, s[12:15], s46 offen offset:1024 sc1
    v_mfma_f32_16x16x32_bf16 a[40:43], v[108:111], v[24:27], a[40:43]
    v_mfma_f32_16x16x32_bf16 a[44:47], v[108:111], v[28:31], a[44:47]
    ds_read_b64_tr_b16 v[94:95], v145 offset:29696
    v_mfma_f32_16x16x32_bf16 a[44:47], v[104:107], v[60:63], a[44:47]
    s_waitcnt lgkmcnt(8)
    v_mfma_f32_16x16x32_bf16 a[60:63], v[80:83], v[60:63], a[60:63]
    ds_read_b64_tr_b16 v[104:105], v146 offset:17408
    buffer_load_dwordx4 v[72:75], v158, s[12:15], s46 offen offset:2048 sc1
    v_mfma_f32_16x16x32_bf16 a[60:63], v[84:87], v[28:31], a[60:63]
    v_mfma_f32_16x16x32_bf16 a[56:59], v[84:87], v[24:27], a[56:59]
    ds_read_b64_tr_b16 v[106:107], v146 offset:21504
    v_mfma_f32_16x16x32_bf16 a[56:59], v[80:83], v[56:59], a[56:59]
    v_mfma_f32_16x16x32_bf16 a[52:55], v[80:83], v[52:55], a[52:55]
    ds_read_b64_tr_b16 v[108:109], v146 offset:25600
    buffer_load_dwordx4 v[76:79], v158, s[12:15], s46 offen offset:3072 sc1
    v_mfma_f32_16x16x32_bf16 a[52:55], v[84:87], v[20:23], a[52:55]
    v_mfma_f32_16x16x32_bf16 a[48:51], v[84:87], v[16:19], a[48:51]
    ds_read_b64_tr_b16 v[110:111], v146 offset:29696
    v_mfma_f32_16x16x32_bf16 a[48:51], v[80:83], v[48:51], a[48:51]
    s_waitcnt lgkmcnt(8)
    v_mfma_f32_16x16x32_bf16 a[64:67], v[96:99], v[48:51], a[64:67]
    ds_read_b64_tr_b16 v[80:81], v147 offset:17408
    v_mfma_f32_16x16x32_bf16 a[64:67], v[100:103], v[16:19], a[64:67]
    v_mfma_f32_16x16x32_bf16 a[68:71], v[100:103], v[20:23], a[68:71]
    ds_read_b64_tr_b16 v[82:83], v147 offset:21504
    v_mfma_f32_16x16x32_bf16 a[68:71], v[96:99], v[52:55], a[68:71]
    v_mfma_f32_16x16x32_bf16 a[72:75], v[96:99], v[56:59], a[72:75]
    ds_read_b64_tr_b16 v[84:85], v147 offset:25600
    v_mfma_f32_16x16x32_bf16 a[72:75], v[100:103], v[24:27], a[72:75]
    v_mfma_f32_16x16x32_bf16 a[76:79], v[100:103], v[28:31], a[76:79]
    ds_read_b64_tr_b16 v[86:87], v147 offset:29696
    v_mfma_f32_16x16x32_bf16 a[76:79], v[96:99], v[60:63], a[76:79]
    s_waitcnt lgkmcnt(8)
    v_mfma_f32_16x16x32_bf16 a[92:95], v[88:91], v[60:63], a[92:95]
    s_barrier
    ds_read_b64_tr_b16 v[96:97], v144 offset:32768
    v_mfma_f32_16x16x32_bf16 a[92:95], v[92:95], v[28:31], a[92:95]
    v_mfma_f32_16x16x32_bf16 a[88:91], v[92:95], v[24:27], a[88:91]
    ds_read_b64_tr_b16 v[98:99], v144 offset:36864
    v_mfma_f32_16x16x32_bf16 a[88:91], v[88:91], v[56:59], a[88:91]
    v_mfma_f32_16x16x32_bf16 a[84:87], v[88:91], v[52:55], a[84:87]
    ds_read_b64_tr_b16 v[100:101], v144 offset:40960
    v_mfma_f32_16x16x32_bf16 a[84:87], v[92:95], v[20:23], a[84:87]
    v_mfma_f32_16x16x32_bf16 a[80:83], v[92:95], v[16:19], a[80:83]
    ds_read_b64_tr_b16 v[102:103], v144 offset:45056
    v_mfma_f32_16x16x32_bf16 a[80:83], v[88:91], v[48:51], a[80:83]
    s_waitcnt lgkmcnt(8)
    v_mfma_f32_16x16x32_bf16 v[112:115], v[104:107], v[48:51], v[112:115]
    ds_read_b64_tr_b16 v[88:89], v145 offset:32768
    v_mfma_f32_16x16x32_bf16 v[112:115], v[108:111], v[16:19], v[112:115]
    v_mfma_f32_16x16x32_bf16 v[116:119], v[108:111], v[20:23], v[116:119]
    ds_read_b64_tr_b16 v[90:91], v145 offset:36864
    v_mfma_f32_16x16x32_bf16 v[116:119], v[104:107], v[52:55], v[116:119]
    v_mfma_f32_16x16x32_bf16 v[120:123], v[104:107], v[56:59], v[120:123]
    ds_read_b64_tr_b16 v[92:93], v145 offset:40960
    v_mfma_f32_16x16x32_bf16 v[120:123], v[108:111], v[24:27], v[120:123]
    v_mfma_f32_16x16x32_bf16 v[124:127], v[108:111], v[28:31], v[124:127]
    ds_read_b64_tr_b16 v[94:95], v145 offset:45056
    v_mfma_f32_16x16x32_bf16 v[124:127], v[104:107], v[60:63], v[124:127]
    s_waitcnt lgkmcnt(8)
    v_mfma_f32_16x16x32_bf16 v[140:143], v[80:83], v[60:63], v[140:143]
    ds_read_b64_tr_b16 v[104:105], v146 offset:32768
    v_mfma_f32_16x16x32_bf16 v[140:143], v[84:87], v[28:31], v[140:143]
    v_mfma_f32_16x16x32_bf16 v[136:139], v[84:87], v[24:27], v[136:139]
    ds_read_b64_tr_b16 v[106:107], v146 offset:36864
    v_mfma_f32_16x16x32_bf16 v[136:139], v[80:83], v[56:59], v[136:139]
    v_mfma_f32_16x16x32_bf16 v[132:135], v[80:83], v[52:55], v[132:135]
    ds_read_b64_tr_b16 v[108:109], v146 offset:40960
    v_mfma_f32_16x16x32_bf16 v[132:135], v[84:87], v[20:23], v[132:135]
    v_mfma_f32_16x16x32_bf16 v[128:131], v[84:87], v[16:19], v[128:131]
    ds_read_b64_tr_b16 v[110:111], v146 offset:45056
    v_mfma_f32_16x16x32_bf16 v[128:131], v[80:83], v[48:51], v[128:131]
    s_waitcnt vmcnt(4) lgkmcnt(8)
    v_mfma_f32_16x16x32_bf16 a[0:3], v[96:99], v[32:35], a[0:3]
    ds_read_b64_tr_b16 v[80:81], v147 offset:32768
    s_add_u32 s46, s70, s27
    v_mfma_f32_16x16x32_bf16 a[0:3], v[100:103], v[0:3], a[0:3]
    buffer_load_dwordx4 v[16:19], v158, s[12:15], s46 offen offset:0 sc1
    v_mfma_f32_16x16x32_bf16 a[4:7], v[100:103], v[4:7], a[4:7]
    ds_read_b64_tr_b16 v[82:83], v147 offset:36864
    v_mfma_f32_16x16x32_bf16 a[4:7], v[96:99], v[36:39], a[4:7]
    v_mfma_f32_16x16x32_bf16 a[8:11], v[96:99], v[40:43], a[8:11]
    ds_read_b64_tr_b16 v[84:85], v147 offset:40960
    v_mfma_f32_16x16x32_bf16 a[8:11], v[100:103], v[8:11], a[8:11]
    buffer_load_dwordx4 v[20:23], v158, s[12:15], s46 offen offset:1024 sc1
    v_mfma_f32_16x16x32_bf16 a[12:15], v[100:103], v[12:15], a[12:15]
    ds_read_b64_tr_b16 v[86:87], v147 offset:45056
    v_mfma_f32_16x16x32_bf16 a[12:15], v[96:99], v[44:47], a[12:15]
    s_waitcnt lgkmcnt(8)
    v_mfma_f32_16x16x32_bf16 a[28:31], v[88:91], v[44:47], a[28:31]
    ds_read_b64_tr_b16 v[96:97], v144 offset:33792
    v_mfma_f32_16x16x32_bf16 a[28:31], v[92:95], v[12:15], a[28:31]
    buffer_load_dwordx4 v[24:27], v158, s[12:15], s46 offen offset:2048 sc1
    v_mfma_f32_16x16x32_bf16 a[24:27], v[92:95], v[8:11], a[24:27]
    ds_read_b64_tr_b16 v[98:99], v144 offset:37888
    v_mfma_f32_16x16x32_bf16 a[24:27], v[88:91], v[40:43], a[24:27]
    v_mfma_f32_16x16x32_bf16 a[20:23], v[88:91], v[36:39], a[20:23]
    ds_read_b64_tr_b16 v[100:101], v144 offset:41984
    v_mfma_f32_16x16x32_bf16 a[20:23], v[92:95], v[4:7], a[20:23]
    buffer_load_dwordx4 v[28:31], v158, s[12:15], s46 offen offset:3072 sc1
    v_mfma_f32_16x16x32_bf16 a[16:19], v[92:95], v[0:3], a[16:19]
    ds_read_b64_tr_b16 v[102:103], v144 offset:46080
    v_mfma_f32_16x16x32_bf16 a[16:19], v[88:91], v[32:35], a[16:19]
    s_add_u32 s46, s72, s27
    s_waitcnt lgkmcnt(8)
    v_mfma_f32_16x16x32_bf16 a[32:35], v[104:107], v[32:35], a[32:35]
    ds_read_b64_tr_b16 v[88:89], v145 offset:33792
    buffer_load_dwordx4 v[48:51], v158, s[12:15], s46 offen offset:0 sc1
    v_mfma_f32_16x16x32_bf16 a[32:35], v[108:111], v[0:3], a[32:35]
    v_mfma_f32_16x16x32_bf16 a[36:39], v[108:111], v[4:7], a[36:39]
    ds_read_b64_tr_b16 v[90:91], v145 offset:37888
    v_mfma_f32_16x16x32_bf16 a[36:39], v[104:107], v[36:39], a[36:39]
    v_mfma_f32_16x16x32_bf16 a[40:43], v[104:107], v[40:43], a[40:43]
    ds_read_b64_tr_b16 v[92:93], v145 offset:41984
    buffer_load_dwordx4 v[52:55], v158, s[12:15], s46 offen offset:1024 sc1
    v_mfma_f32_16x16x32_bf16 a[40:43], v[108:111], v[8:11], a[40:43]
    v_mfma_f32_16x16x32_bf16 a[44:47], v[108:111], v[12:15], a[44:47]
    ds_read_b64_tr_b16 v[94:95], v145 offset:46080
    v_mfma_f32_16x16x32_bf16 a[44:47], v[104:107], v[44:47], a[44:47]
    s_waitcnt lgkmcnt(8)
    v_mfma_f32_16x16x32_bf16 a[60:63], v[80:83], v[44:47], a[60:63]
    ds_read_b64_tr_b16 v[104:105], v146 offset:33792
    buffer_load_dwordx4 v[56:59], v158, s[12:15], s46 offen offset:2048 sc1
    v_mfma_f32_16x16x32_bf16 a[60:63], v[84:87], v[12:15], a[60:63]
    v_mfma_f32_16x16x32_bf16 a[56:59], v[84:87], v[8:11], a[56:59]
    ds_read_b64_tr_b16 v[106:107], v146 offset:37888
    v_mfma_f32_16x16x32_bf16 a[56:59], v[80:83], v[40:43], a[56:59]
    v_mfma_f32_16x16x32_bf16 a[52:55], v[80:83], v[36:39], a[52:55]
    ds_read_b64_tr_b16 v[108:109], v146 offset:41984
    buffer_load_dwordx4 v[60:63], v158, s[12:15], s46 offen offset:3072 sc1
    v_mfma_f32_16x16x32_bf16 a[52:55], v[84:87], v[4:7], a[52:55]
    v_mfma_f32_16x16x32_bf16 a[48:51], v[84:87], v[0:3], a[48:51]
    ds_read_b64_tr_b16 v[110:111], v146 offset:46080
    v_mfma_f32_16x16x32_bf16 a[48:51], v[80:83], v[32:35], a[48:51]
    s_waitcnt lgkmcnt(8)
    v_mfma_f32_16x16x32_bf16 a[64:67], v[96:99], v[32:35], a[64:67]
    ds_read_b64_tr_b16 v[80:81], v147 offset:33792
    v_mfma_f32_16x16x32_bf16 a[64:67], v[100:103], v[0:3], a[64:67]
    v_mfma_f32_16x16x32_bf16 a[68:71], v[100:103], v[4:7], a[68:71]
    ds_read_b64_tr_b16 v[82:83], v147 offset:37888
    v_mfma_f32_16x16x32_bf16 a[68:71], v[96:99], v[36:39], a[68:71]
    v_mfma_f32_16x16x32_bf16 a[72:75], v[96:99], v[40:43], a[72:75]
    ds_read_b64_tr_b16 v[84:85], v147 offset:41984
    v_mfma_f32_16x16x32_bf16 a[72:75], v[100:103], v[8:11], a[72:75]
    v_mfma_f32_16x16x32_bf16 a[76:79], v[100:103], v[12:15], a[76:79]
    ds_read_b64_tr_b16 v[86:87], v147 offset:46080
    v_mfma_f32_16x16x32_bf16 a[76:79], v[96:99], v[44:47], a[76:79]
    s_waitcnt lgkmcnt(8)
    v_mfma_f32_16x16x32_bf16 a[92:95], v[88:91], v[44:47], a[92:95]
    ds_read_b64_tr_b16 v[96:97], v144 offset:49152
    v_mfma_f32_16x16x32_bf16 a[92:95], v[92:95], v[12:15], a[92:95]
    v_mfma_f32_16x16x32_bf16 a[88:91], v[92:95], v[8:11], a[88:91]
    ds_read_b64_tr_b16 v[98:99], v144 offset:53248
    v_mfma_f32_16x16x32_bf16 a[88:91], v[88:91], v[40:43], a[88:91]
    v_mfma_f32_16x16x32_bf16 a[84:87], v[88:91], v[36:39], a[84:87]
    ds_read_b64_tr_b16 v[100:101], v144 offset:57344
    v_mfma_f32_16x16x32_bf16 a[84:87], v[92:95], v[4:7], a[84:87]
    v_mfma_f32_16x16x32_bf16 a[80:83], v[92:95], v[0:3], a[80:83]
    ds_read_b64_tr_b16 v[102:103], v144 offset:61440
    v_mfma_f32_16x16x32_bf16 a[80:83], v[88:91], v[32:35], a[80:83]
    s_waitcnt lgkmcnt(8)
    v_mfma_f32_16x16x32_bf16 v[112:115], v[104:107], v[32:35], v[112:115]
    ds_read_b64_tr_b16 v[88:89], v145 offset:49152
    v_mfma_f32_16x16x32_bf16 v[112:115], v[108:111], v[0:3], v[112:115]
    v_mfma_f32_16x16x32_bf16 v[116:119], v[108:111], v[4:7], v[116:119]
    ds_read_b64_tr_b16 v[90:91], v145 offset:53248
    v_mfma_f32_16x16x32_bf16 v[116:119], v[104:107], v[36:39], v[116:119]
    v_mfma_f32_16x16x32_bf16 v[120:123], v[104:107], v[40:43], v[120:123]
    ds_read_b64_tr_b16 v[92:93], v145 offset:57344
    v_mfma_f32_16x16x32_bf16 v[120:123], v[108:111], v[8:11], v[120:123]
    v_mfma_f32_16x16x32_bf16 v[124:127], v[108:111], v[12:15], v[124:127]
    ds_read_b64_tr_b16 v[94:95], v145 offset:61440
    v_mfma_f32_16x16x32_bf16 v[124:127], v[104:107], v[44:47], v[124:127]
    s_waitcnt lgkmcnt(8)
    v_mfma_f32_16x16x32_bf16 v[140:143], v[80:83], v[44:47], v[140:143]
    ds_read_b64_tr_b16 v[104:105], v146 offset:49152
    v_mfma_f32_16x16x32_bf16 v[140:143], v[84:87], v[12:15], v[140:143]
    v_mfma_f32_16x16x32_bf16 v[136:139], v[84:87], v[8:11], v[136:139]
    ds_read_b64_tr_b16 v[106:107], v146 offset:53248
    v_mfma_f32_16x16x32_bf16 v[136:139], v[80:83], v[40:43], v[136:139]
    v_mfma_f32_16x16x32_bf16 v[132:135], v[80:83], v[36:39], v[132:135]
    ds_read_b64_tr_b16 v[108:109], v146 offset:57344
    v_mfma_f32_16x16x32_bf16 v[132:135], v[84:87], v[4:7], v[132:135]
    v_mfma_f32_16x16x32_bf16 v[128:131], v[84:87], v[0:3], v[128:131]
    ds_read_b64_tr_b16 v[110:111], v146 offset:61440
    v_mfma_f32_16x16x32_bf16 v[128:131], v[80:83], v[32:35], v[128:131]
    s_waitcnt vmcnt(4) lgkmcnt(8)
    v_mfma_f32_16x16x32_bf16 a[0:3], v[96:99], v[64:67], a[0:3]
    ds_read_b64_tr_b16 v[80:81], v147 offset:49152
    s_add_u32 s46, s65, 8192
    v_mfma_f32_16x16x32_bf16 a[0:3], v[100:103], v[16:19], a[0:3]
    buffer_load_dwordx4 v[0:3], v158, s[12:15], s46 offen offset:0 sc1
    v_mfma_f32_16x16x32_bf16 a[4:7], v[100:103], v[20:23], a[4:7]
    ds_read_b64_tr_b16 v[82:83], v147 offset:53248
    v_mfma_f32_16x16x32_bf16 a[4:7], v[96:99], v[68:71], a[4:7]
    v_mfma_f32_16x16x32_bf16 a[8:11], v[96:99], v[72:75], a[8:11]
    ds_read_b64_tr_b16 v[84:85], v147 offset:57344
    v_mfma_f32_16x16x32_bf16 a[8:11], v[100:103], v[24:27], a[8:11]
    buffer_load_dwordx4 v[4:7], v158, s[12:15], s46 offen offset:1024 sc1
    v_mfma_f32_16x16x32_bf16 a[12:15], v[100:103], v[28:31], a[12:15]
    ds_read_b64_tr_b16 v[86:87], v147 offset:61440
    v_mfma_f32_16x16x32_bf16 a[12:15], v[96:99], v[76:79], a[12:15]
    s_waitcnt lgkmcnt(8)
    v_mfma_f32_16x16x32_bf16 a[28:31], v[88:91], v[76:79], a[28:31]
    ds_read_b64_tr_b16 v[96:97], v144 offset:50176
    v_mfma_f32_16x16x32_bf16 a[28:31], v[92:95], v[28:31], a[28:31]
    buffer_load_dwordx4 v[8:11], v158, s[12:15], s46 offen offset:2048 sc1
    v_mfma_f32_16x16x32_bf16 a[24:27], v[92:95], v[24:27], a[24:27]
    ds_read_b64_tr_b16 v[98:99], v144 offset:54272
    v_mfma_f32_16x16x32_bf16 a[24:27], v[88:91], v[72:75], a[24:27]
    v_mfma_f32_16x16x32_bf16 a[20:23], v[88:91], v[68:71], a[20:23]
    ds_read_b64_tr_b16 v[100:101], v144 offset:58368
    v_mfma_f32_16x16x32_bf16 a[20:23], v[92:95], v[20:23], a[20:23]
    buffer_load_dwordx4 v[12:15], v158, s[12:15], s46 offen offset:3072 sc1
    v_mfma_f32_16x16x32_bf16 a[16:19], v[92:95], v[16:19], a[16:19]
    ds_read_b64_tr_b16 v[102:103], v144 offset:62464
    v_mfma_f32_16x16x32_bf16 a[16:19], v[88:91], v[64:67], a[16:19]
    s_add_u32 s46, s66, 8192
    s_waitcnt lgkmcnt(8)
    v_mfma_f32_16x16x32_bf16 a[32:35], v[104:107], v[64:67], a[32:35]
    ds_read_b64_tr_b16 v[88:89], v145 offset:50176
    buffer_load_dwordx4 v[32:35], v158, s[12:15], s46 offen offset:0 sc1
    v_mfma_f32_16x16x32_bf16 a[32:35], v[108:111], v[16:19], a[32:35]
    v_mfma_f32_16x16x32_bf16 a[36:39], v[108:111], v[20:23], a[36:39]
    ds_read_b64_tr_b16 v[90:91], v145 offset:54272
    v_mfma_f32_16x16x32_bf16 a[36:39], v[104:107], v[68:71], a[36:39]
    v_mfma_f32_16x16x32_bf16 a[40:43], v[104:107], v[72:75], a[40:43]
    ds_read_b64_tr_b16 v[92:93], v145 offset:58368
    buffer_load_dwordx4 v[36:39], v158, s[12:15], s46 offen offset:1024 sc1
    v_mfma_f32_16x16x32_bf16 a[40:43], v[108:111], v[24:27], a[40:43]
    v_mfma_f32_16x16x32_bf16 a[44:47], v[108:111], v[28:31], a[44:47]
    ds_read_b64_tr_b16 v[94:95], v145 offset:62464
    v_mfma_f32_16x16x32_bf16 a[44:47], v[104:107], v[76:79], a[44:47]
    s_waitcnt lgkmcnt(8)
    v_mfma_f32_16x16x32_bf16 a[60:63], v[80:83], v[76:79], a[60:63]
    ds_read_b64_tr_b16 v[104:105], v146 offset:50176
    buffer_load_dwordx4 v[40:43], v158, s[12:15], s46 offen offset:2048 sc1
    v_mfma_f32_16x16x32_bf16 a[60:63], v[84:87], v[28:31], a[60:63]
    v_mfma_f32_16x16x32_bf16 a[56:59], v[84:87], v[24:27], a[56:59]
    ds_read_b64_tr_b16 v[106:107], v146 offset:54272
    v_mfma_f32_16x16x32_bf16 a[56:59], v[80:83], v[72:75], a[56:59]
    v_mfma_f32_16x16x32_bf16 a[52:55], v[80:83], v[68:71], a[52:55]
    ds_read_b64_tr_b16 v[108:109], v146 offset:58368
    buffer_load_dwordx4 v[44:47], v158, s[12:15], s46 offen offset:3072 sc1
    v_mfma_f32_16x16x32_bf16 a[52:55], v[84:87], v[20:23], a[52:55]
    v_mfma_f32_16x16x32_bf16 a[48:51], v[84:87], v[16:19], a[48:51]
    ds_read_b64_tr_b16 v[110:111], v146 offset:62464
    v_mfma_f32_16x16x32_bf16 a[48:51], v[80:83], v[64:67], a[48:51]
    s_waitcnt lgkmcnt(8)
    v_mfma_f32_16x16x32_bf16 a[64:67], v[96:99], v[64:67], a[64:67]
    ds_read_b64_tr_b16 v[80:81], v147 offset:50176
    v_mfma_f32_16x16x32_bf16 a[64:67], v[100:103], v[16:19], a[64:67]
    v_mfma_f32_16x16x32_bf16 a[68:71], v[100:103], v[20:23], a[68:71]
    ds_read_b64_tr_b16 v[82:83], v147 offset:54272
    v_mfma_f32_16x16x32_bf16 a[68:71], v[96:99], v[68:71], a[68:71]
    v_mfma_f32_16x16x32_bf16 a[72:75], v[96:99], v[72:75], a[72:75]
    ds_read_b64_tr_b16 v[84:85], v147 offset:58368
    v_mfma_f32_16x16x32_bf16 a[72:75], v[100:103], v[24:27], a[72:75]
    v_mfma_f32_16x16x32_bf16 a[76:79], v[100:103], v[28:31], a[76:79]
    ds_read_b64_tr_b16 v[86:87], v147 offset:62464
    v_mfma_f32_16x16x32_bf16 a[76:79], v[96:99], v[76:79], a[76:79]
    s_waitcnt lgkmcnt(8)
    v_mfma_f32_16x16x32_bf16 a[92:95], v[88:91], v[76:79], a[92:95]
    s_barrier
    ds_read_b64_tr_b16 v[96:97], v152 offset:0
    v_mfma_f32_16x16x32_bf16 a[92:95], v[92:95], v[28:31], a[92:95]
    v_mfma_f32_16x16x32_bf16 a[88:91], v[92:95], v[24:27], a[88:91]
    ds_read_b64_tr_b16 v[98:99], v152 offset:4096
    v_mfma_f32_16x16x32_bf16 a[88:91], v[88:91], v[72:75], a[88:91]
    v_mfma_f32_16x16x32_bf16 a[84:87], v[88:91], v[68:71], a[84:87]
    ds_read_b64_tr_b16 v[100:101], v152 offset:8192
    v_mfma_f32_16x16x32_bf16 a[84:87], v[92:95], v[20:23], a[84:87]
    v_mfma_f32_16x16x32_bf16 a[80:83], v[92:95], v[16:19], a[80:83]
    ds_read_b64_tr_b16 v[102:103], v152 offset:12288
    v_mfma_f32_16x16x32_bf16 a[80:83], v[88:91], v[64:67], a[80:83]
    s_waitcnt lgkmcnt(8)
    v_mfma_f32_16x16x32_bf16 v[112:115], v[104:107], v[64:67], v[112:115]
    ds_read_b64_tr_b16 v[88:89], v153 offset:0
    v_mfma_f32_16x16x32_bf16 v[112:115], v[108:111], v[16:19], v[112:115]
    v_mfma_f32_16x16x32_bf16 v[116:119], v[108:111], v[20:23], v[116:119]
    ds_read_b64_tr_b16 v[90:91], v153 offset:4096
    v_mfma_f32_16x16x32_bf16 v[116:119], v[104:107], v[68:71], v[116:119]
    v_mfma_f32_16x16x32_bf16 v[120:123], v[104:107], v[72:75], v[120:123]
    ds_read_b64_tr_b16 v[92:93], v153 offset:8192
    v_mfma_f32_16x16x32_bf16 v[120:123], v[108:111], v[24:27], v[120:123]
    v_mfma_f32_16x16x32_bf16 v[124:127], v[108:111], v[28:31], v[124:127]
    ds_read_b64_tr_b16 v[94:95], v153 offset:12288
    v_mfma_f32_16x16x32_bf16 v[124:127], v[104:107], v[76:79], v[124:127]
    s_waitcnt lgkmcnt(8)
    v_mfma_f32_16x16x32_bf16 v[140:143], v[80:83], v[76:79], v[140:143]
    ds_read_b64_tr_b16 v[104:105], v154 offset:0
    v_mfma_f32_16x16x32_bf16 v[140:143], v[84:87], v[28:31], v[140:143]
    v_mfma_f32_16x16x32_bf16 v[136:139], v[84:87], v[24:27], v[136:139]
    ds_read_b64_tr_b16 v[106:107], v154 offset:4096
    v_mfma_f32_16x16x32_bf16 v[136:139], v[80:83], v[72:75], v[136:139]
    v_mfma_f32_16x16x32_bf16 v[132:135], v[80:83], v[68:71], v[132:135]
    ds_read_b64_tr_b16 v[108:109], v154 offset:8192
    v_mfma_f32_16x16x32_bf16 v[132:135], v[84:87], v[20:23], v[132:135]
    v_mfma_f32_16x16x32_bf16 v[128:131], v[84:87], v[16:19], v[128:131]
    ds_read_b64_tr_b16 v[110:111], v154 offset:12288
    v_mfma_f32_16x16x32_bf16 v[128:131], v[80:83], v[64:67], v[128:131]
    s_waitcnt vmcnt(4) lgkmcnt(8)
    v_mfma_f32_16x16x32_bf16 a[0:3], v[96:99], v[48:51], a[0:3]
    ds_read_b64_tr_b16 v[80:81], v155 offset:0
    s_add_u32 s46, s67, 8192
    v_mfma_f32_16x16x32_bf16 a[0:3], v[100:103], v[0:3], a[0:3]
    buffer_load_dwordx4 v[16:19], v158, s[12:15], s46 offen offset:0 sc1
    v_mfma_f32_16x16x32_bf16 a[4:7], v[100:103], v[4:7], a[4:7]
    ds_read_b64_tr_b16 v[82:83], v155 offset:4096
    v_mfma_f32_16x16x32_bf16 a[4:7], v[96:99], v[52:55], a[4:7]
    v_mfma_f32_16x16x32_bf16 a[8:11], v[96:99], v[56:59], a[8:11]
    ds_read_b64_tr_b16 v[84:85], v155 offset:8192
    v_mfma_f32_16x16x32_bf16 a[8:11], v[100:103], v[8:11], a[8:11]
    buffer_load_dwordx4 v[20:23], v158, s[12:15], s46 offen offset:1024 sc1
    v_mfma_f32_16x16x32_bf16 a[12:15], v[100:103], v[12:15], a[12:15]
    ds_read_b64_tr_b16 v[86:87], v155 offset:12288
    v_mfma_f32_16x16x32_bf16 a[12:15], v[96:99], v[60:63], a[12:15]
    s_waitcnt lgkmcnt(8)
    v_mfma_f32_16x16x32_bf16 a[28:31], v[88:91], v[60:63], a[28:31]
    ds_read_b64_tr_b16 v[96:97], v152 offset:1024
    v_mfma_f32_16x16x32_bf16 a[28:31], v[92:95], v[12:15], a[28:31]
    buffer_load_dwordx4 v[24:27], v158, s[12:15], s46 offen offset:2048 sc1
    v_mfma_f32_16x16x32_bf16 a[24:27], v[92:95], v[8:11], a[24:27]
    ds_read_b64_tr_b16 v[98:99], v152 offset:5120
    v_mfma_f32_16x16x32_bf16 a[24:27], v[88:91], v[56:59], a[24:27]
    v_mfma_f32_16x16x32_bf16 a[20:23], v[88:91], v[52:55], a[20:23]
    ds_read_b64_tr_b16 v[100:101], v152 offset:9216
    v_mfma_f32_16x16x32_bf16 a[20:23], v[92:95], v[4:7], a[20:23]
    buffer_load_dwordx4 v[28:31], v158, s[12:15], s46 offen offset:3072 sc1
    v_mfma_f32_16x16x32_bf16 a[16:19], v[92:95], v[0:3], a[16:19]
    ds_read_b64_tr_b16 v[102:103], v152 offset:13312
    v_mfma_f32_16x16x32_bf16 a[16:19], v[88:91], v[48:51], a[16:19]
    s_add_u32 s46, s70, 8192
    s_waitcnt lgkmcnt(8)
    v_mfma_f32_16x16x32_bf16 a[32:35], v[104:107], v[48:51], a[32:35]
    ds_read_b64_tr_b16 v[88:89], v153 offset:1024
    buffer_load_dwordx4 v[64:67], v158, s[12:15], s46 offen offset:0 sc1
    v_mfma_f32_16x16x32_bf16 a[32:35], v[108:111], v[0:3], a[32:35]
    v_mfma_f32_16x16x32_bf16 a[36:39], v[108:111], v[4:7], a[36:39]
    ds_read_b64_tr_b16 v[90:91], v153 offset:5120
    v_mfma_f32_16x16x32_bf16 a[36:39], v[104:107], v[52:55], a[36:39]
    v_mfma_f32_16x16x32_bf16 a[40:43], v[104:107], v[56:59], a[40:43]
    ds_read_b64_tr_b16 v[92:93], v153 offset:9216
    buffer_load_dwordx4 v[68:71], v158, s[12:15], s46 offen offset:1024 sc1
    v_mfma_f32_16x16x32_bf16 a[40:43], v[108:111], v[8:11], a[40:43]
    v_mfma_f32_16x16x32_bf16 a[44:47], v[108:111], v[12:15], a[44:47]
    ds_read_b64_tr_b16 v[94:95], v153 offset:13312
    v_mfma_f32_16x16x32_bf16 a[44:47], v[104:107], v[60:63], a[44:47]
    s_waitcnt lgkmcnt(8)
    v_mfma_f32_16x16x32_bf16 a[60:63], v[80:83], v[60:63], a[60:63]
    ds_read_b64_tr_b16 v[104:105], v154 offset:1024
    buffer_load_dwordx4 v[72:75], v158, s[12:15], s46 offen offset:2048 sc1
    v_mfma_f32_16x16x32_bf16 a[60:63], v[84:87], v[12:15], a[60:63]
    v_mfma_f32_16x16x32_bf16 a[56:59], v[84:87], v[8:11], a[56:59]
    ds_read_b64_tr_b16 v[106:107], v154 offset:5120
    v_mfma_f32_16x16x32_bf16 a[56:59], v[80:83], v[56:59], a[56:59]
    v_mfma_f32_16x16x32_bf16 a[52:55], v[80:83], v[52:55], a[52:55]
    ds_read_b64_tr_b16 v[108:109], v154 offset:9216
    buffer_load_dwordx4 v[76:79], v158, s[12:15], s46 offen offset:3072 sc1
    v_mfma_f32_16x16x32_bf16 a[52:55], v[84:87], v[4:7], a[52:55]
    v_mfma_f32_16x16x32_bf16 a[48:51], v[84:87], v[0:3], a[48:51]
    ds_read_b64_tr_b16 v[110:111], v154 offset:13312
    v_mfma_f32_16x16x32_bf16 a[48:51], v[80:83], v[48:51], a[48:51]
    s_waitcnt lgkmcnt(8)
    v_mfma_f32_16x16x32_bf16 a[64:67], v[96:99], v[48:51], a[64:67]
    ds_read_b64_tr_b16 v[80:81], v155 offset:1024
    v_mfma_f32_16x16x32_bf16 a[64:67], v[100:103], v[0:3], a[64:67]
    v_mfma_f32_16x16x32_bf16 a[68:71], v[100:103], v[4:7], a[68:71]
    ds_read_b64_tr_b16 v[82:83], v155 offset:5120
    v_mfma_f32_16x16x32_bf16 a[68:71], v[96:99], v[52:55], a[68:71]
    v_mfma_f32_16x16x32_bf16 a[72:75], v[96:99], v[56:59], a[72:75]
    ds_read_b64_tr_b16 v[84:85], v155 offset:9216
    v_mfma_f32_16x16x32_bf16 a[72:75], v[100:103], v[8:11], a[72:75]
    v_mfma_f32_16x16x32_bf16 a[76:79], v[100:103], v[12:15], a[76:79]
    ds_read_b64_tr_b16 v[86:87], v155 offset:13312
    v_mfma_f32_16x16x32_bf16 a[76:79], v[96:99], v[60:63], a[76:79]
    s_waitcnt lgkmcnt(8)
    v_mfma_f32_16x16x32_bf16 a[92:95], v[88:91], v[60:63], a[92:95]
    ds_read_b64_tr_b16 v[96:97], v152 offset:16384
    v_mfma_f32_16x16x32_bf16 a[92:95], v[92:95], v[12:15], a[92:95]
    v_mfma_f32_16x16x32_bf16 a[88:91], v[92:95], v[8:11], a[88:91]
    ds_read_b64_tr_b16 v[98:99], v152 offset:20480
    v_mfma_f32_16x16x32_bf16 a[88:91], v[88:91], v[56:59], a[88:91]
    v_mfma_f32_16x16x32_bf16 a[84:87], v[88:91], v[52:55], a[84:87]
    ds_read_b64_tr_b16 v[100:101], v153 offset:16384
    v_mfma_f32_16x16x32_bf16 a[84:87], v[92:95], v[4:7], a[84:87]
    v_mfma_f32_16x16x32_bf16 a[80:83], v[92:95], v[0:3], a[80:83]
    ds_read_b64_tr_b16 v[102:103], v153 offset:20480
    v_mfma_f32_16x16x32_bf16 a[80:83], v[88:91], v[48:51], a[80:83]
    s_waitcnt lgkmcnt(8)
    v_mfma_f32_16x16x32_bf16 v[112:115], v[104:107], v[48:51], v[112:115]
    ds_read_b64_tr_b16 v[88:89], v154 offset:16384
    v_mfma_f32_16x16x32_bf16 v[112:115], v[108:111], v[0:3], v[112:115]
    v_mfma_f32_16x16x32_bf16 v[116:119], v[108:111], v[4:7], v[116:119]
    ds_read_b64_tr_b16 v[90:91], v154 offset:20480
    v_mfma_f32_16x16x32_bf16 v[116:119], v[104:107], v[52:55], v[116:119]
    v_mfma_f32_16x16x32_bf16 v[120:123], v[104:107], v[56:59], v[120:123]
    ds_read_b64_tr_b16 v[92:93], v155 offset:16384
    v_mfma_f32_16x16x32_bf16 v[120:123], v[108:111], v[8:11], v[120:123]
    v_mfma_f32_16x16x32_bf16 v[124:127], v[108:111], v[12:15], v[124:127]
    ds_read_b64_tr_b16 v[94:95], v155 offset:20480
    v_mfma_f32_16x16x32_bf16 v[124:127], v[104:107], v[60:63], v[124:127]
    s_waitcnt lgkmcnt(8)
    v_mfma_f32_16x16x32_bf16 v[140:143], v[80:83], v[60:63], v[140:143]
    ds_read_b64_tr_b16 v[104:105], v152 offset:17408
    v_mfma_f32_16x16x32_bf16 v[140:143], v[84:87], v[12:15], v[140:143]
    v_mfma_f32_16x16x32_bf16 v[136:139], v[84:87], v[8:11], v[136:139]
    ds_read_b64_tr_b16 v[106:107], v152 offset:21504
    v_mfma_f32_16x16x32_bf16 v[136:139], v[80:83], v[56:59], v[136:139]
    v_mfma_f32_16x16x32_bf16 v[132:135], v[80:83], v[52:55], v[132:135]
    ds_read_b64_tr_b16 v[108:109], v153 offset:17408
    v_mfma_f32_16x16x32_bf16 v[132:135], v[84:87], v[4:7], v[132:135]
    v_mfma_f32_16x16x32_bf16 v[128:131], v[84:87], v[0:3], v[128:131]
    ds_read_b64_tr_b16 v[110:111], v153 offset:21504
    v_mfma_f32_16x16x32_bf16 v[128:131], v[80:83], v[48:51], v[128:131]
    s_waitcnt vmcnt(8) lgkmcnt(10)
    v_mfma_f32_16x16x32_bf16 a[0:3], v[96:99], v[32:35], a[0:3]
    ds_read_b64_tr_b16 v[80:81], v154 offset:17408
    s_add_u32 s46, s71, 8192
    v_mfma_f32_16x16x32_bf16 a[4:7], v[96:99], v[36:39], a[4:7]
    buffer_load_dwordx4 v[0:3], v158, s[12:15], s46 offen offset:0 sc1
    v_mfma_f32_16x16x32_bf16 a[8:11], v[96:99], v[40:43], a[8:11]
    ds_read_b64_tr_b16 v[82:83], v154 offset:21504
    v_mfma_f32_16x16x32_bf16 a[12:15], v[96:99], v[44:47], a[12:15]
    s_waitcnt lgkmcnt(10)
    v_mfma_f32_16x16x32_bf16 a[28:31], v[100:103], v[44:47], a[28:31]
    ds_read_b64_tr_b16 v[84:85], v155 offset:17408
    v_mfma_f32_16x16x32_bf16 a[24:27], v[100:103], v[40:43], a[24:27]
    buffer_load_dwordx4 v[4:7], v158, s[12:15], s46 offen offset:1024 sc1
    v_mfma_f32_16x16x32_bf16 a[20:23], v[100:103], v[36:39], a[20:23]
    ds_read_b64_tr_b16 v[86:87], v155 offset:21504
    v_mfma_f32_16x16x32_bf16 a[16:19], v[100:103], v[32:35], a[16:19]
    s_waitcnt lgkmcnt(10)
    v_mfma_f32_16x16x32_bf16 a[32:35], v[88:91], v[32:35], a[32:35]
    ds_read_b64_tr_b16 v[96:97], v152 offset:24576
    v_mfma_f32_16x16x32_bf16 a[36:39], v[88:91], v[36:39], a[36:39]
    buffer_load_dwordx4 v[8:11], v158, s[12:15], s46 offen offset:2048 sc1
    v_mfma_f32_16x16x32_bf16 a[40:43], v[88:91], v[40:43], a[40:43]
    ds_read_b64_tr_b16 v[98:99], v152 offset:28672
    v_mfma_f32_16x16x32_bf16 a[44:47], v[88:91], v[44:47], a[44:47]
    s_waitcnt lgkmcnt(10)
    v_mfma_f32_16x16x32_bf16 a[60:63], v[92:95], v[44:47], a[60:63]
    ds_read_b64_tr_b16 v[100:101], v153 offset:24576
    v_mfma_f32_16x16x32_bf16 a[56:59], v[92:95], v[40:43], a[56:59]
    buffer_load_dwordx4 v[12:15], v158, s[12:15], s46 offen offset:3072 sc1
    v_mfma_f32_16x16x32_bf16 a[52:55], v[92:95], v[36:39], a[52:55]
    ds_read_b64_tr_b16 v[102:103], v153 offset:28672
    v_mfma_f32_16x16x32_bf16 a[48:51], v[92:95], v[32:35], a[48:51]
    s_add_u32 s46, s72, 8192
    s_waitcnt lgkmcnt(10)
    v_mfma_f32_16x16x32_bf16 a[64:67], v[104:107], v[32:35], a[64:67]
    ds_read_b64_tr_b16 v[88:89], v154 offset:24576
    buffer_load_dwordx4 v[48:51], v158, s[12:15], s46 offen offset:0 sc1
    v_mfma_f32_16x16x32_bf16 a[68:71], v[104:107], v[36:39], a[68:71]
    v_mfma_f32_16x16x32_bf16 a[72:75], v[104:107], v[40:43], a[72:75]
    ds_read_b64_tr_b16 v[90:91], v154 offset:28672
    v_mfma_f32_16x16x32_bf16 a[76:79], v[104:107], v[44:47], a[76:79]
    s_waitcnt lgkmcnt(10)
    v_mfma_f32_16x16x32_bf16 a[92:95], v[108:111], v[44:47], a[92:95]
    ds_read_b64_tr_b16 v[92:93], v155 offset:24576
    buffer_load_dwordx4 v[52:55], v158, s[12:15], s46 offen offset:1024 sc1
    v_mfma_f32_16x16x32_bf16 a[88:91], v[108:111], v[40:43], a[88:91]
    v_mfma_f32_16x16x32_bf16 a[84:87], v[108:111], v[36:39], a[84:87]
    ds_read_b64_tr_b16 v[94:95], v155 offset:28672
    v_mfma_f32_16x16x32_bf16 a[80:83], v[108:111], v[32:35], a[80:83]
    s_waitcnt lgkmcnt(10)
    v_mfma_f32_16x16x32_bf16 v[112:115], v[80:83], v[32:35], v[112:115]
    ds_read_b64_tr_b16 v[104:105], v152 offset:25600
    buffer_load_dwordx4 v[56:59], v158, s[12:15], s46 offen offset:2048 sc1
    v_mfma_f32_16x16x32_bf16 v[116:119], v[80:83], v[36:39], v[116:119]
    v_bfe_u32 v157, v158, 4, 2
    v_lshlrev_b32 v157, 7, v157
    s_and_b32 s45, s57, 0xfffffe7f
    v_mfma_f32_16x16x32_bf16 v[120:123], v[80:83], v[40:43], v[120:123]
    ds_read_b64_tr_b16 v[106:107], v152 offset:29696
    buffer_load_dword v149, v157, s[12:15], s45 offen offset:1536 sc1
    v_mfma_f32_16x16x32_bf16 v[124:127], v[80:83], v[44:47], v[124:127]
    s_waitcnt lgkmcnt(10)
    v_mfma_f32_16x16x32_bf16 v[140:143], v[84:87], v[44:47], v[140:143]
    ds_read_b64_tr_b16 v[108:109], v153 offset:25600
    buffer_load_dwordx4 v[60:63], v158, s[12:15], s46 offen offset:3072 sc1
    v_mfma_f32_16x16x32_bf16 v[136:139], v[84:87], v[40:43], v[136:139]
    v_mfma_f32_16x16x32_bf16 v[132:135], v[84:87], v[36:39], v[132:135]
    ds_read_b64_tr_b16 v[110:111], v153 offset:29696
    v_mfma_f32_16x16x32_bf16 v[128:131], v[84:87], v[32:35], v[128:131]
    s_waitcnt vmcnt(13) lgkmcnt(10)
    v_mfma_f32_16x16x32_bf16 a[0:3], v[96:99], v[16:19], a[0:3]
    ds_read_b64_tr_b16 v[80:81], v154 offset:25600
    s_add_u32 s46, s73, 8192
    v_mfma_f32_16x16x32_bf16 a[4:7], v[96:99], v[20:23], a[4:7]
    buffer_load_dwordx4 v[32:35], v158, s[12:15], s46 offen offset:0 sc1
    v_mfma_f32_16x16x32_bf16 a[8:11], v[96:99], v[24:27], a[8:11]
    ds_read_b64_tr_b16 v[82:83], v154 offset:29696
    v_mfma_f32_16x16x32_bf16 a[12:15], v[96:99], v[28:31], a[12:15]
    s_waitcnt lgkmcnt(10)
    v_mfma_f32_16x16x32_bf16 a[28:31], v[100:103], v[28:31], a[28:31]
    ds_read_b64_tr_b16 v[84:85], v155 offset:25600
    v_mfma_f32_16x16x32_bf16 a[24:27], v[100:103], v[24:27], a[24:27]
    buffer_load_dwordx4 v[36:39], v158, s[12:15], s46 offen offset:1024 sc1
    v_mfma_f32_16x16x32_bf16 a[20:23], v[100:103], v[20:23], a[20:23]
    ds_read_b64_tr_b16 v[86:87], v155 offset:29696
    v_mfma_f32_16x16x32_bf16 a[16:19], v[100:103], v[16:19], a[16:19]
    s_waitcnt lgkmcnt(10)
    v_mfma_f32_16x16x32_bf16 a[32:35], v[88:91], v[16:19], a[32:35]
    s_barrier
    ds_read_b64_tr_b16 v[96:97], v146 offset:0
    v_mfma_f32_16x16x32_bf16 a[36:39], v[88:91], v[20:23], a[36:39]
    s_setprio 2
    buffer_load_dwordx4 v[40:43], v158, s[12:15], s46 offen offset:2048 sc1
    v_mfma_f32_16x16x32_bf16 a[40:43], v[88:91], v[24:27], a[40:43]
    ds_read_b64_tr_b16 v[98:99], v146 offset:4096
    v_lshrrev_b32 v150, 8, v158
    v_mfma_f32_16x16x32_bf16 a[44:47], v[88:91], v[28:31], a[44:47]
    v_bfe_u32 v151, v158, 6, 2
    s_waitcnt lgkmcnt(10)
    v_mfma_f32_16x16x32_bf16 a[60:63], v[92:95], v[28:31], a[60:63]
    ds_read_b64_tr_b16 v[100:101], v146 offset:8192
    v_mov_b32 v154, 0x3f80
    v_mfma_f32_16x16x32_bf16 a[56:59], v[92:95], v[24:27], a[56:59]
    buffer_load_dwordx4 v[44:47], v158, s[12:15], s46 offen offset:3072 sc1
    v_mfma_f32_16x16x32_bf16 a[52:55], v[92:95], v[20:23], a[52:55]
    ds_read_b64_tr_b16 v[102:103], v146 offset:12288
    v_cmp_eq_u32 s[30:31], v150, v151
    v_mfma_f32_16x16x32_bf16 a[48:51], v[92:95], v[16:19], a[48:51]
    v_and_b32 v155, 0x30, v158
    s_waitcnt lgkmcnt(10)
    v_mfma_f32_16x16x32_bf16 a[64:67], v[104:107], v[16:19], a[64:67]
    ds_read_b64_tr_b16 v[88:89], v147 offset:0
    v_mov_b32 v151, 0
    v_mfma_f32_16x16x32_bf16 a[68:71], v[104:107], v[20:23], a[68:71]
    v_cndmask_b32 v150, 0, v154, s[30:31]
    v_mfma_f32_16x16x32_bf16 a[72:75], v[104:107], v[24:27], a[72:75]
    ds_read_b64_tr_b16 v[90:91], v147 offset:4096
    v_mov_b32 v154, 0
    v_mfma_f32_16x16x32_bf16 a[76:79], v[104:107], v[28:31], a[76:79]
    v_lshlrev_b64 v[152:153], v155, v[150:151]
    s_waitcnt lgkmcnt(10)
    v_mfma_f32_16x16x32_bf16 a[92:95], v[108:111], v[28:31], a[92:95]
fused_kernel_pg7:
    s_cbranch_execz fused_kernel_pg15
    ds_read_b64_tr_b16 v[92:93], v147 offset:8192
    v_mov_b32 v150, 0
    v_mfma_f32_16x16x32_bf16 a[88:91], v[108:111], v[24:27], a[88:91]
    v_mov_b32 v155, 0
    v_mfma_f32_16x16x32_bf16 a[84:87], v[108:111], v[20:23], a[84:87]
    ds_read_b64_tr_b16 v[94:95], v147 offset:12288
    v_mfma_f32_16x16x32_bf16 a[80:83], v[108:111], v[16:19], a[80:83]
    s_waitcnt lgkmcnt(10)
    v_mfma_f32_16x16x32_bf16 v[112:115], v[80:83], v[16:19], v[112:115]
    ds_read_b64_tr_b16 v[104:105], v146 offset:16384
    v_mfma_f32_16x16x32_bf16 v[116:119], v[80:83], v[20:23], v[116:119]
    v_mfma_f32_16x16x32_bf16 v[120:123], v[80:83], v[24:27], v[120:123]
    ds_read_b64_tr_b16 v[106:107], v146 offset:20480
    v_mfma_f32_16x16x32_bf16 v[124:127], v[80:83], v[28:31], v[124:127]
    s_waitcnt lgkmcnt(10)
    v_mfma_f32_16x16x32_bf16 v[140:143], v[84:87], v[28:31], v[140:143]
    ds_read_b64_tr_b16 v[108:109], v146 offset:24576
    v_mfma_f32_16x16x32_bf16 v[136:139], v[84:87], v[24:27], v[136:139]
    v_mfma_f32_16x16x32_bf16 v[132:135], v[84:87], v[20:23], v[132:135]
    ds_read_b64_tr_b16 v[110:111], v146 offset:28672
    v_mfma_f32_16x16x32_bf16 v[128:131], v[84:87], v[16:19], v[128:131]
    s_waitcnt vmcnt(9) lgkmcnt(8)
    v_mfma_f32_16x16x32_bf16 a[32:35], v[96:99], v[64:67], a[32:35]
    ds_read_b64_tr_b16 v[80:81], v147 offset:16384
    v_mfma_f32_16x16x32_bf16 a[32:35], v[100:103], v[0:3], a[32:35]
    v_mfma_f32_16x16x32_bf16 a[36:39], v[100:103], v[4:7], a[36:39]
    ds_read_b64_tr_b16 v[82:83], v147 offset:20480
    v_mfma_f32_16x16x32_bf16 a[36:39], v[96:99], v[68:71], a[36:39]
    v_mfma_f32_16x16x32_bf16 a[40:43], v[96:99], v[72:75], a[40:43]
    ds_read_b64_tr_b16 v[84:85], v147 offset:24576
    v_mfma_f32_16x16x32_bf16 a[40:43], v[100:103], v[8:11], a[40:43]
    v_mfma_f32_16x16x32_bf16 a[44:47], v[100:103], v[12:15], a[44:47]
    ds_read_b64_tr_b16 v[86:87], v147 offset:28672
    v_mfma_f32_16x16x32_bf16 a[44:47], v[96:99], v[76:79], a[44:47]
    s_waitcnt lgkmcnt(8)
    v_mfma_f32_16x16x32_bf16 a[60:63], v[88:91], v[76:79], a[60:63]
    v_mfma_f32_16x16x32_bf16 a[60:63], v[92:95], v[12:15], a[60:63]
    v_mfma_f32_16x16x32_bf16 a[56:59], v[92:95], v[8:11], a[56:59]
    v_mfma_f32_16x16x32_bf16 a[56:59], v[88:91], v[72:75], a[56:59]
    v_mfma_f32_16x16x32_bf16 a[52:55], v[88:91], v[68:71], a[52:55]
    v_mfma_f32_16x16x32_bf16 a[52:55], v[92:95], v[4:7], a[52:55]
    v_mfma_f32_16x16x32_bf16 a[48:51], v[92:95], v[0:3], a[48:51]
    v_mfma_f32_16x16x32_bf16 a[48:51], v[88:91], v[64:67], a[48:51]
    s_waitcnt vmcnt(0) lgkmcnt(4)
    v_mfma_f32_16x16x32_bf16 a[32:35], v[104:107], v[48:51], a[32:35]
    ds_read_b64_tr_b16 v[88:89], v144 offset:1024
    v_mfma_f32_16x16x32_bf16 a[32:35], v[108:111], v[32:35], a[32:35]
    v_mfma_f32_16x16x32_bf16 a[36:39], v[108:111], v[36:39], a[36:39]
    ds_read_b64_tr_b16 v[90:91], v144 offset:5120
    v_mfma_f32_16x16x32_bf16 a[36:39], v[104:107], v[52:55], a[36:39]
    s_barrier
    v_mfma_f32_16x16x32_bf16 a[40:43], v[104:107], v[56:59], a[40:43]
    ds_read_b64_tr_b16 v[92:93], v144 offset:9216
    ds_read_b128 v[16:19], v156 offset:0
    v_mfma_f32_16x16x32_bf16 a[40:43], v[108:111], v[40:43], a[40:43]
    ds_read_b128 v[20:23], v156 offset:1024
    v_mfma_f32_16x16x32_bf16 a[44:47], v[108:111], v[44:47], a[44:47]
    ds_read_b64_tr_b16 v[94:95], v144 offset:13312
    ds_read_b128 v[24:27], v156 offset:2048
    v_mfma_f32_16x16x32_bf16 a[44:47], v[104:107], v[60:63], a[44:47]
    ds_read_b128 v[28:31], v156 offset:3072
    s_waitcnt lgkmcnt(8)
    v_mfma_f32_16x16x32_bf16 a[60:63], v[80:83], v[60:63], a[60:63]
    ds_read_b64_tr_b16 v[104:105], v145 offset:1024
    v_mfma_f32_16x16x32_bf16 a[60:63], v[84:87], v[44:47], a[60:63]
    v_mfma_f32_16x16x32_bf16 a[56:59], v[84:87], v[40:43], a[56:59]
    ds_read_b64_tr_b16 v[106:107], v145 offset:5120
    v_mfma_f32_16x16x32_bf16 a[56:59], v[80:83], v[56:59], a[56:59]
    v_mfma_f32_16x16x32_bf16 a[52:55], v[80:83], v[52:55], a[52:55]
    ds_read_b64_tr_b16 v[108:109], v145 offset:9216
    v_mfma_f32_16x16x32_bf16 a[52:55], v[84:87], v[36:39], a[52:55]
    v_mfma_f32_16x16x32_bf16 a[48:51], v[84:87], v[32:35], a[48:51]
    ds_read_b64_tr_b16 v[110:111], v145 offset:13312
    v_mfma_f32_16x16x32_bf16 a[48:51], v[80:83], v[48:51], a[48:51]
    s_xor_b32 s48, s62, 4259840
    s_waitcnt lgkmcnt(4)
    v_mfma_f32_16x16x32_bf16 a[32:35], v[152:155], v[16:19], a[32:35]
    ds_read_b64_tr_b16 v[80:81], v144 offset:17408
    v_cmp_gt_u32 vcc, 1, v149
    s_nop 1
    s_cbranch_vccnz fused_kernel_spin_rdy
fused_kernel_ret_rdy:
    v_mfma_f32_16x16x32_bf16 a[36:39], v[152:155], v[20:23], a[36:39]
    v_mfma_f32_16x16x32_bf16 a[40:43], v[152:155], v[24:27], a[40:43]
    ds_read_b64_tr_b16 v[82:83], v144 offset:21504
    v_mfma_f32_16x16x32_bf16 a[44:47], v[152:155], v[28:31], a[44:47]
    v_mfma_f32_16x16x32_bf16 a[48:51], v[150:153], v[16:19], a[48:51]
    ds_read_b64_tr_b16 v[84:85], v144 offset:25600
    v_mfma_f32_16x16x32_bf16 a[52:55], v[150:153], v[20:23], a[52:55]
    v_mfma_f32_16x16x32_bf16 a[56:59], v[150:153], v[24:27], a[56:59]
    ds_read_b64_tr_b16 v[86:87], v144 offset:29696
    v_mfma_f32_16x16x32_bf16 a[60:63], v[150:153], v[28:31], a[60:63]
    v_mfma_f32_16x16x32_bf16 a[76:79], v[88:91], v[76:79], a[76:79]
    v_accvgpr_read_b32 v96, a32
    v_accvgpr_read_b32 v97, a33
    v_mfma_f32_16x16x32_bf16 a[76:79], v[92:95], v[12:15], a[76:79]
    v_accvgpr_read_b32 v98, a34
    v_accvgpr_read_b32 v99, a35
    v_mfma_f32_16x16x32_bf16 a[72:75], v[92:95], v[8:11], a[72:75]
    v_accvgpr_read_b32 v100, a48
    v_accvgpr_read_b32 v101, a49
    v_mfma_f32_16x16x32_bf16 a[72:75], v[88:91], v[72:75], a[72:75]
    v_accvgpr_read_b32 v102, a50
    v_accvgpr_read_b32 v103, a51
    v_mfma_f32_16x16x32_bf16 a[68:71], v[88:91], v[68:71], a[68:71]
    v_cvt_pk_bf16_f32 v96, v96, v97
    v_cvt_pk_bf16_f32 v97, v98, v99
    v_mfma_f32_16x16x32_bf16 a[68:71], v[92:95], v[4:7], a[68:71]
    v_cvt_pk_bf16_f32 v98, v100, v101
    v_cvt_pk_bf16_f32 v99, v102, v103
    v_mfma_f32_16x16x32_bf16 a[64:67], v[92:95], v[0:3], a[64:67]
    buffer_store_dwordx4 v[96:99], v158, s[12:15], s48 offen offset:0 sc1
    v_mfma_f32_16x16x32_bf16 a[64:67], v[88:91], v[64:67], a[64:67]
    ds_read_b64_tr_b16 v[88:89], v145 offset:17408
    v_accvgpr_read_b32 v96, a36
    s_waitcnt lgkmcnt(5)
    v_mfma_f32_16x16x32_bf16 a[80:83], v[104:107], v[64:67], a[80:83]
    ds_read_b64_tr_b16 v[90:91], v145 offset:21504
    v_accvgpr_read_b32 v97, a37
    v_mfma_f32_16x16x32_bf16 a[80:83], v[108:111], v[0:3], a[80:83]
    ds_read_b64_tr_b16 v[92:93], v145 offset:25600
    v_accvgpr_read_b32 v98, a38
    v_mfma_f32_16x16x32_bf16 a[84:87], v[108:111], v[4:7], a[84:87]
    ds_read_b64_tr_b16 v[94:95], v145 offset:29696
    v_accvgpr_read_b32 v99, a39
    v_mfma_f32_16x16x32_bf16 a[84:87], v[104:107], v[68:71], a[84:87]
    v_accvgpr_read_b32 v100, a52
    v_accvgpr_read_b32 v101, a53
    v_mfma_f32_16x16x32_bf16 a[88:91], v[104:107], v[72:75], a[88:91]
    v_accvgpr_read_b32 v102, a54
    v_accvgpr_read_b32 v103, a55
    v_mfma_f32_16x16x32_bf16 a[88:91], v[108:111], v[8:11], a[88:91]
    v_cvt_pk_bf16_f32 v96, v96, v97
    v_cvt_pk_bf16_f32 v97, v98, v99
    v_mfma_f32_16x16x32_bf16 a[92:95], v[108:111], v[12:15], a[92:95]
    v_cvt_pk_bf16_f32 v98, v100, v101
    v_cvt_pk_bf16_f32 v99, v102, v103
    v_mfma_f32_16x16x32_bf16 a[92:95], v[104:107], v[76:79], a[92:95]
    buffer_store_dwordx4 v[96:99], v158, s[12:15], s48 offen offset:1024 sc1
    s_waitcnt lgkmcnt(4)
    v_mfma_f32_16x16x32_bf16 a[76:79], v[80:83], v[60:63], a[76:79]
    ds_read_b64_tr_b16 v[104:105], v146 offset:1024
    s_xor_b32 s48, s62, 6356992
    v_mfma_f32_16x16x32_bf16 a[76:79], v[84:87], v[44:47], a[76:79]
    v_accvgpr_read_b32 v96, a40
    v_accvgpr_read_b32 v97, a41
    v_mfma_f32_16x16x32_bf16 a[72:75], v[84:87], v[40:43], a[72:75]
    ds_read_b64_tr_b16 v[106:107], v146 offset:5120
    v_accvgpr_read_b32 v98, a42
    v_accvgpr_read_b32 v99, a43
    v_accvgpr_read_b32 v100, a56
    v_accvgpr_read_b32 v101, a57
    v_accvgpr_read_b32 v102, a58
    v_accvgpr_read_b32 v103, a59
    v_cvt_pk_bf16_f32 v96, v96, v97
    v_cvt_pk_bf16_f32 v97, v98, v99
    v_cvt_pk_bf16_f32 v98, v100, v101
    v_cvt_pk_bf16_f32 v99, v102, v103
    buffer_store_dwordx4 v[96:99], v158, s[12:15], s48 offen offset:0 sc1
    s_nop 1
    v_accvgpr_read_b32 v96, a44
    v_accvgpr_read_b32 v97, a45
    v_accvgpr_read_b32 v98, a46
    v_accvgpr_read_b32 v99, a47
    v_accvgpr_read_b32 v100, a60
    v_accvgpr_read_b32 v101, a61
    v_accvgpr_read_b32 v102, a62
    v_accvgpr_read_b32 v103, a63
    v_cvt_pk_bf16_f32 v96, v96, v97
    v_cvt_pk_bf16_f32 v97, v98, v99
    v_cvt_pk_bf16_f32 v98, v100, v101
    v_cvt_pk_bf16_f32 v99, v102, v103
    buffer_store_dwordx4 v[96:99], v158, s[12:15], s48 offen offset:1024 sc1
    v_mfma_f32_16x16x32_bf16 a[72:75], v[80:83], v[56:59], a[72:75]
    s_barrier
    v_mfma_f32_16x16x32_bf16 a[68:71], v[80:83], v[52:55], a[68:71]
    ds_read_b64_tr_b16 v[108:109], v146 offset:9216
    ds_read_b128 v[16:19], v156 offset:16384
    v_mfma_f32_16x16x32_bf16 a[68:71], v[84:87], v[36:39], a[68:71]
    ds_read_b128 v[20:23], v156 offset:17408
    v_mfma_f32_16x16x32_bf16 a[64:67], v[84:87], v[32:35], a[64:67]
    ds_read_b64_tr_b16 v[110:111], v146 offset:13312
    ds_read_b128 v[24:27], v156 offset:18432
    v_mfma_f32_16x16x32_bf16 a[64:67], v[80:83], v[48:51], a[64:67]
    ds_read_b128 v[28:31], v156 offset:19456
    s_waitcnt lgkmcnt(8)
    v_mfma_f32_16x16x32_bf16 a[80:83], v[88:91], v[48:51], a[80:83]
    ds_read_b64_tr_b16 v[80:81], v147 offset:1024
    v_mfma_f32_16x16x32_bf16 a[80:83], v[92:95], v[32:35], a[80:83]
    v_mfma_f32_16x16x32_bf16 a[84:87], v[92:95], v[36:39], a[84:87]
    ds_read_b64_tr_b16 v[82:83], v147 offset:5120
    v_mfma_f32_16x16x32_bf16 a[84:87], v[88:91], v[52:55], a[84:87]
    v_mfma_f32_16x16x32_bf16 a[88:91], v[88:91], v[56:59], a[88:91]
    ds_read_b64_tr_b16 v[84:85], v147 offset:9216
    v_mfma_f32_16x16x32_bf16 a[88:91], v[92:95], v[40:43], a[88:91]
    v_mfma_f32_16x16x32_bf16 a[92:95], v[92:95], v[44:47], a[92:95]
    ds_read_b64_tr_b16 v[86:87], v147 offset:13312
    v_mfma_f32_16x16x32_bf16 a[92:95], v[88:91], v[60:63], a[92:95]
    s_waitcnt lgkmcnt(4)
    v_mfma_f32_16x16x32_bf16 a[64:67], v[152:155], v[16:19], a[64:67]
    ds_read_b64_tr_b16 v[88:89], v146 offset:17408
    v_mfma_f32_16x16x32_bf16 a[68:71], v[152:155], v[20:23], a[68:71]
    v_mfma_f32_16x16x32_bf16 a[72:75], v[152:155], v[24:27], a[72:75]
    ds_read_b64_tr_b16 v[90:91], v146 offset:21504
    v_mfma_f32_16x16x32_bf16 a[76:79], v[152:155], v[28:31], a[76:79]
    v_mfma_f32_16x16x32_bf16 a[80:83], v[150:153], v[16:19], a[80:83]
    ds_read_b64_tr_b16 v[92:93], v146 offset:25600
    v_mfma_f32_16x16x32_bf16 a[84:87], v[150:153], v[20:23], a[84:87]
    v_mov_b32 v149, 4
    s_waitcnt vmcnt(0)
    v_mfma_f32_16x16x32_bf16 a[88:91], v[150:153], v[24:27], a[88:91]
    ds_read_b64_tr_b16 v[94:95], v146 offset:29696
    buffer_store_dword v149, v148, s[12:15], s57 offen sc1
    v_mfma_f32_16x16x32_bf16 a[92:95], v[150:153], v[28:31], a[92:95]
    s_xor_b32 s48, s62, 8519680
    v_mfma_f32_16x16x32_bf16 v[112:115], v[104:107], v[64:67], v[112:115]
    v_accvgpr_read_b32 v96, a64
    v_accvgpr_read_b32 v97, a65
    v_mfma_f32_16x16x32_bf16 v[112:115], v[108:111], v[0:3], v[112:115]
    v_accvgpr_read_b32 v98, a66
    v_accvgpr_read_b32 v99, a67
    v_mfma_f32_16x16x32_bf16 v[116:119], v[108:111], v[4:7], v[116:119]
    v_accvgpr_read_b32 v100, a80
    v_accvgpr_read_b32 v101, a81
    v_mfma_f32_16x16x32_bf16 v[116:119], v[104:107], v[68:71], v[116:119]
    v_accvgpr_read_b32 v102, a82
    v_accvgpr_read_b32 v103, a83
    v_mfma_f32_16x16x32_bf16 v[120:123], v[104:107], v[72:75], v[120:123]
    v_cvt_pk_bf16_f32 v96, v96, v97
    v_cvt_pk_bf16_f32 v97, v98, v99
    v_mfma_f32_16x16x32_bf16 v[120:123], v[108:111], v[8:11], v[120:123]
    v_cvt_pk_bf16_f32 v98, v100, v101
    v_cvt_pk_bf16_f32 v99, v102, v103
    v_mfma_f32_16x16x32_bf16 v[124:127], v[108:111], v[12:15], v[124:127]
    buffer_store_dwordx4 v[96:99], v158, s[12:15], s48 offen offset:0 sc1
    v_mfma_f32_16x16x32_bf16 v[124:127], v[104:107], v[76:79], v[124:127]
    ds_read_b64_tr_b16 v[104:105], v147 offset:17408
    v_accvgpr_read_b32 v96, a68
    s_waitcnt lgkmcnt(5)
    v_mfma_f32_16x16x32_bf16 v[140:143], v[80:83], v[76:79], v[140:143]
    ds_read_b64_tr_b16 v[106:107], v147 offset:21504
    v_accvgpr_read_b32 v97, a69
    v_mfma_f32_16x16x32_bf16 v[140:143], v[84:87], v[12:15], v[140:143]
    ds_read_b64_tr_b16 v[108:109], v147 offset:25600
    v_accvgpr_read_b32 v98, a70
    v_mfma_f32_16x16x32_bf16 v[136:139], v[84:87], v[8:11], v[136:139]
    ds_read_b64_tr_b16 v[110:111], v147 offset:29696
    v_accvgpr_read_b32 v99, a71
    v_mfma_f32_16x16x32_bf16 v[136:139], v[80:83], v[72:75], v[136:139]
    v_accvgpr_read_b32 v100, a84
    v_accvgpr_read_b32 v101, a85
    v_mfma_f32_16x16x32_bf16 v[132:135], v[80:83], v[68:71], v[132:135]
    v_accvgpr_read_b32 v102, a86
    v_accvgpr_read_b32 v103, a87
    v_mfma_f32_16x16x32_bf16 v[132:135], v[84:87], v[4:7], v[132:135]
    v_cvt_pk_bf16_f32 v96, v96, v97
    v_cvt_pk_bf16_f32 v97, v98, v99
    v_mfma_f32_16x16x32_bf16 v[128:131], v[84:87], v[0:3], v[128:131]
    v_cvt_pk_bf16_f32 v98, v100, v101
    v_cvt_pk_bf16_f32 v99, v102, v103
    v_mfma_f32_16x16x32_bf16 v[128:131], v[80:83], v[64:67], v[128:131]
    buffer_store_dwordx4 v[96:99], v158, s[12:15], s48 offen offset:1024 sc1
    s_waitcnt lgkmcnt(4)
    v_mfma_f32_16x16x32_bf16 v[112:115], v[88:91], v[48:51], v[112:115]
    ds_read_b64_tr_b16 v[80:81], v144 offset:0
    s_xor_b32 s48, s62, 10616832
    v_mfma_f32_16x16x32_bf16 v[112:115], v[92:95], v[32:35], v[112:115]
    v_accvgpr_read_b32 v96, a72
    v_accvgpr_read_b32 v97, a73
    v_mfma_f32_16x16x32_bf16 v[116:119], v[92:95], v[36:39], v[116:119]
    ds_read_b64_tr_b16 v[82:83], v144 offset:4096
    v_accvgpr_read_b32 v98, a74
    v_accvgpr_read_b32 v99, a75
    v_accvgpr_read_b32 v100, a88
    v_accvgpr_read_b32 v101, a89
    v_accvgpr_read_b32 v102, a90
    v_accvgpr_read_b32 v103, a91
    v_cvt_pk_bf16_f32 v96, v96, v97
    v_cvt_pk_bf16_f32 v97, v98, v99
    v_cvt_pk_bf16_f32 v98, v100, v101
    v_cvt_pk_bf16_f32 v99, v102, v103
    buffer_store_dwordx4 v[96:99], v158, s[12:15], s48 offen offset:0 sc1
    s_nop 1
    v_accvgpr_read_b32 v96, a76
    v_accvgpr_read_b32 v97, a77
    v_accvgpr_read_b32 v98, a78
    v_accvgpr_read_b32 v99, a79
    v_accvgpr_read_b32 v100, a92
    v_accvgpr_read_b32 v101, a93
    v_accvgpr_read_b32 v102, a94
    v_accvgpr_read_b32 v103, a95
    v_cvt_pk_bf16_f32 v96, v96, v97
    v_cvt_pk_bf16_f32 v97, v98, v99
    v_cvt_pk_bf16_f32 v98, v100, v101
    v_cvt_pk_bf16_f32 v99, v102, v103
    buffer_store_dwordx4 v[96:99], v158, s[12:15], s48 offen offset:1024 sc1
    v_mov_b32 v149, 5
    s_waitcnt vmcnt(0)
    buffer_store_dword v149, v148, s[12:15], s57 offen sc1
    v_mfma_f32_16x16x32_bf16 v[116:119], v[88:91], v[52:55], v[116:119]
    s_barrier
    s_xor_b32 s48, s62, 12779520
    v_mfma_f32_16x16x32_bf16 v[120:123], v[88:91], v[56:59], v[120:123]
    ds_read_b64_tr_b16 v[84:85], v144 offset:8192
    ds_read_b128 v[16:19], v156 offset:32768
    v_mfma_f32_16x16x32_bf16 v[120:123], v[92:95], v[40:43], v[120:123]
    ds_read_b128 v[20:23], v156 offset:33792
    v_mfma_f32_16x16x32_bf16 v[124:127], v[92:95], v[44:47], v[124:127]
    ds_read_b64_tr_b16 v[86:87], v144 offset:12288
    ds_read_b128 v[24:27], v156 offset:34816
    v_mfma_f32_16x16x32_bf16 v[124:127], v[88:91], v[60:63], v[124:127]
    ds_read_b128 v[28:31], v156 offset:35840
    s_waitcnt lgkmcnt(8)
    v_mfma_f32_16x16x32_bf16 v[140:143], v[104:107], v[60:63], v[140:143]
    ds_read_b64_tr_b16 v[88:89], v145 offset:0
    v_mfma_f32_16x16x32_bf16 v[140:143], v[108:111], v[44:47], v[140:143]
    v_mfma_f32_16x16x32_bf16 v[136:139], v[108:111], v[40:43], v[136:139]
    ds_read_b64_tr_b16 v[90:91], v145 offset:4096
    v_mfma_f32_16x16x32_bf16 v[136:139], v[104:107], v[56:59], v[136:139]
    v_mfma_f32_16x16x32_bf16 v[132:135], v[104:107], v[52:55], v[132:135]
    ds_read_b64_tr_b16 v[92:93], v145 offset:8192
    v_mfma_f32_16x16x32_bf16 v[132:135], v[108:111], v[36:39], v[132:135]
    v_mfma_f32_16x16x32_bf16 v[128:131], v[108:111], v[32:35], v[128:131]
    ds_read_b64_tr_b16 v[94:95], v145 offset:12288
    v_mfma_f32_16x16x32_bf16 v[128:131], v[104:107], v[48:51], v[128:131]
    s_waitcnt lgkmcnt(4)
    v_mfma_f32_16x16x32_bf16 v[112:115], v[152:155], v[16:19], v[112:115]
    ds_read_b64_tr_b16 v[104:105], v144 offset:16384
    v_mfma_f32_16x16x32_bf16 v[116:119], v[152:155], v[20:23], v[116:119]
    v_mfma_f32_16x16x32_bf16 v[120:123], v[152:155], v[24:27], v[120:123]
    ds_read_b64_tr_b16 v[106:107], v144 offset:20480
    v_mfma_f32_16x16x32_bf16 v[124:127], v[152:155], v[28:31], v[124:127]
    v_mfma_f32_16x16x32_bf16 v[128:131], v[150:153], v[16:19], v[128:131]
    ds_read_b64_tr_b16 v[108:109], v144 offset:24576
    v_mfma_f32_16x16x32_bf16 v[132:135], v[150:153], v[20:23], v[132:135]
    v_mfma_f32_16x16x32_bf16 v[136:139], v[150:153], v[24:27], v[136:139]
    ds_read_b64_tr_b16 v[110:111], v144 offset:28672
    v_mfma_f32_16x16x32_bf16 v[140:143], v[150:153], v[28:31], v[140:143]
    v_mfma_f32_16x16x32_bf16 a[12:15], v[80:83], v[76:79], a[12:15]
    v_cvt_pk_bf16_f32 v112, v112, v113
    v_cvt_pk_bf16_f32 v113, v114, v115
    v_mfma_f32_16x16x32_bf16 a[12:15], v[84:87], v[12:15], a[12:15]
    v_cvt_pk_bf16_f32 v114, v128, v129
    v_cvt_pk_bf16_f32 v115, v130, v131
    v_mfma_f32_16x16x32_bf16 a[8:11], v[84:87], v[8:11], a[8:11]
    buffer_store_dwordx4 v[112:115], v158, s[12:15], s48 offen offset:0 sc1
    v_mfma_f32_16x16x32_bf16 a[8:11], v[80:83], v[72:75], a[8:11]
    v_cvt_pk_bf16_f32 v116, v116, v117
    v_cvt_pk_bf16_f32 v117, v118, v119
    v_mfma_f32_16x16x32_bf16 a[4:7], v[80:83], v[68:71], a[4:7]
    v_cvt_pk_bf16_f32 v118, v132, v133
    v_cvt_pk_bf16_f32 v119, v134, v135
    v_mfma_f32_16x16x32_bf16 a[4:7], v[84:87], v[4:7], a[4:7]
    buffer_store_dwordx4 v[116:119], v158, s[12:15], s48 offen offset:1024 sc1
    v_mfma_f32_16x16x32_bf16 a[0:3], v[84:87], v[0:3], a[0:3]
    s_xor_b32 s48, s62, 14876672
    v_cvt_pk_bf16_f32 v120, v120, v121
    v_mfma_f32_16x16x32_bf16 a[0:3], v[80:83], v[64:67], a[0:3]
    ds_read_b64_tr_b16 v[80:81], v145 offset:16384
    v_cvt_pk_bf16_f32 v121, v122, v123
    s_waitcnt lgkmcnt(5)
    v_mfma_f32_16x16x32_bf16 a[16:19], v[88:91], v[64:67], a[16:19]
    ds_read_b64_tr_b16 v[82:83], v145 offset:20480
    v_cvt_pk_bf16_f32 v122, v136, v137
    v_mfma_f32_16x16x32_bf16 a[16:19], v[92:95], v[0:3], a[16:19]
    ds_read_b64_tr_b16 v[84:85], v145 offset:24576
    v_cvt_pk_bf16_f32 v123, v138, v139
    v_mfma_f32_16x16x32_bf16 a[20:23], v[92:95], v[4:7], a[20:23]
    ds_read_b64_tr_b16 v[86:87], v145 offset:28672
    buffer_store_dwordx4 v[120:123], v158, s[12:15], s48 offen offset:0 sc1
    v_mfma_f32_16x16x32_bf16 a[20:23], v[88:91], v[68:71], a[20:23]
    v_cvt_pk_bf16_f32 v124, v124, v125
    v_cvt_pk_bf16_f32 v125, v126, v127
    v_mfma_f32_16x16x32_bf16 a[24:27], v[88:91], v[72:75], a[24:27]
    v_cvt_pk_bf16_f32 v126, v140, v141
    v_cvt_pk_bf16_f32 v127, v142, v143
    v_mfma_f32_16x16x32_bf16 a[24:27], v[92:95], v[8:11], a[24:27]
    buffer_store_dwordx4 v[124:127], v158, s[12:15], s48 offen offset:1024 sc1
    v_mfma_f32_16x16x32_bf16 a[28:31], v[92:95], v[12:15], a[28:31]
    v_mfma_f32_16x16x32_bf16 a[28:31], v[88:91], v[76:79], a[28:31]
    s_waitcnt lgkmcnt(4)
    v_mfma_f32_16x16x32_bf16 a[12:15], v[104:107], v[60:63], a[12:15]
    v_mfma_f32_16x16x32_bf16 a[12:15], v[108:111], v[44:47], a[12:15]
    v_mfma_f32_16x16x32_bf16 a[8:11], v[108:111], v[40:43], a[8:11]
    v_mfma_f32_16x16x32_bf16 a[8:11], v[104:107], v[56:59], a[8:11]
    v_mfma_f32_16x16x32_bf16 a[4:7], v[104:107], v[52:55], a[4:7]
    v_mfma_f32_16x16x32_bf16 a[4:7], v[108:111], v[36:39], a[4:7]
    v_mfma_f32_16x16x32_bf16 a[0:3], v[108:111], v[32:35], a[0:3]
    v_mfma_f32_16x16x32_bf16 a[0:3], v[104:107], v[48:51], a[0:3]
    s_waitcnt lgkmcnt(0)
    v_mfma_f32_16x16x32_bf16 a[16:19], v[80:83], v[48:51], a[16:19]
    v_mfma_f32_16x16x32_bf16 a[16:19], v[84:87], v[32:35], a[16:19]
    v_mfma_f32_16x16x32_bf16 a[20:23], v[84:87], v[36:39], a[20:23]
    v_mfma_f32_16x16x32_bf16 a[20:23], v[80:83], v[52:55], a[20:23]
    v_mfma_f32_16x16x32_bf16 a[24:27], v[80:83], v[56:59], a[24:27]
    v_mfma_f32_16x16x32_bf16 a[24:27], v[84:87], v[40:43], a[24:27]
    s_nop 0
    v_accvgpr_read_b32 v128, a0
    v_accvgpr_read_b32 v129, a1
    v_mfma_f32_16x16x32_bf16 a[28:31], v[84:87], v[44:47], a[28:31]
    v_accvgpr_read_b32 v130, a2
    v_accvgpr_read_b32 v131, a3
    v_mfma_f32_16x16x32_bf16 a[28:31], v[80:83], v[60:63], a[28:31]
    v_accvgpr_read_b32 v132, a16
    v_accvgpr_read_b32 v133, a17
    v_accvgpr_read_b32 v134, a18
    v_accvgpr_read_b32 v135, a19
    v_cvt_pk_bf16_f32 v128, v128, v129
    v_cvt_pk_bf16_f32 v129, v130, v131
    v_cvt_pk_bf16_f32 v130, v132, v133
    v_cvt_pk_bf16_f32 v131, v134, v135
    ds_write_b128 v156, v[128:131] offset:49152
    v_accvgpr_read_b32 v136, a4
    v_accvgpr_read_b32 v137, a5
    v_accvgpr_read_b32 v138, a6
    v_accvgpr_read_b32 v139, a7
    v_accvgpr_read_b32 v140, a20
    v_accvgpr_read_b32 v141, a21
    v_accvgpr_read_b32 v142, a22
    v_accvgpr_read_b32 v143, a23
    v_cvt_pk_bf16_f32 v136, v136, v137
    v_cvt_pk_bf16_f32 v137, v138, v139
    v_cvt_pk_bf16_f32 v138, v140, v141
    v_cvt_pk_bf16_f32 v139, v142, v143
    ds_write_b128 v156, v[136:139] offset:50176
    v_accvgpr_read_b32 v128, a8
    v_accvgpr_read_b32 v129, a9
    v_accvgpr_read_b32 v130, a10
    v_accvgpr_read_b32 v131, a11
    v_accvgpr_read_b32 v132, a24
    v_accvgpr_read_b32 v133, a25
    v_accvgpr_read_b32 v134, a26
    v_accvgpr_read_b32 v135, a27
    v_cvt_pk_bf16_f32 v128, v128, v129
    v_cvt_pk_bf16_f32 v129, v130, v131
    v_cvt_pk_bf16_f32 v130, v132, v133
    v_cvt_pk_bf16_f32 v131, v134, v135
    ds_write_b128 v156, v[128:131] offset:51200
    v_accvgpr_read_b32 v136, a12
    v_accvgpr_read_b32 v137, a13
    v_accvgpr_read_b32 v138, a14
    v_accvgpr_read_b32 v139, a15
    v_accvgpr_read_b32 v140, a28
    v_accvgpr_read_b32 v141, a29
    v_accvgpr_read_b32 v142, a30
    v_accvgpr_read_b32 v143, a31
    v_cvt_pk_bf16_f32 v136, v136, v137
    v_cvt_pk_bf16_f32 v137, v138, v139
    v_cvt_pk_bf16_f32 v138, v140, v141
    v_cvt_pk_bf16_f32 v139, v142, v143
    ds_write_b128 v156, v[136:139] offset:52224
    s_waitcnt lgkmcnt(0)
    s_barrier
    s_endpgm
fused_kernel_A:
    s_sub_u32 s23, 458752, s23
    s_mov_b32 s10, 7340032
    s_mul_i32 s42, s29, 224
    s_mul_i32 s45, s20, 114688
    s_add_u32 s42, s42, s45
    s_movk_i32 s46, 4682
    s_mul_i32 s32, s20, 3584
    s_add_u32 s32, s32, 98304
    v_add_u32 v122, 0, v120
    v_mul_u32_u24 v123, s46, v122
    v_lshrrev_b32 v123, 16, v123
    v_mul_u32_u24 v124, 14, v123
    v_sub_u32 v124, v122, v124
    v_and_b32 v125, 3, v123
    v_bfe_u32 v126, v123, 2, 1
    v_lshl_add_u32 v125, v126, 3, v125
    v_bfe_u32 v126, v123, 3, 1
    v_lshl_add_u32 v125, v126, 2, v125
    v_mul_u32_u24 v125, 7168, v125
    v_lshl_add_u32 v125, v124, 4, v125
    s_sub_u32 s44, s42, 0
    v_add_u32 v116, s44, v125
    v_add_u32 v122, 64, v120
    v_mul_u32_u24 v123, s46, v122
    v_lshrrev_b32 v123, 16, v123
    v_mul_u32_u24 v124, 14, v123
    v_sub_u32 v124, v122, v124
    v_and_b32 v125, 3, v123
    v_bfe_u32 v126, v123, 2, 1
    v_lshl_add_u32 v125, v126, 3, v125
    v_bfe_u32 v126, v123, 3, 1
    v_lshl_add_u32 v125, v126, 2, v125
    v_mul_u32_u24 v125, 7168, v125
    v_lshl_add_u32 v125, v124, 4, v125
    s_sub_u32 s44, s42, 1024
    v_add_u32 v117, s44, v125
    v_add_u32 v122, 128, v120
    v_mul_u32_u24 v123, s46, v122
    v_lshrrev_b32 v123, 16, v123
    v_mul_u32_u24 v124, 14, v123
    v_sub_u32 v124, v122, v124
    v_and_b32 v125, 3, v123
    v_bfe_u32 v126, v123, 2, 1
    v_lshl_add_u32 v125, v126, 3, v125
    v_bfe_u32 v126, v123, 3, 1
    v_lshl_add_u32 v125, v126, 2, v125
    v_mul_u32_u24 v125, 7168, v125
    v_lshl_add_u32 v125, v124, 4, v125
    s_sub_u32 s44, s42, 2048
    v_add_u32 v118, s44, v125
    v_add_u32 v122, 192, v120
    v_mul_u32_u24 v123, s46, v122
    v_lshrrev_b32 v123, 16, v123
    v_mul_u32_u24 v124, 14, v123
    v_sub_u32 v124, v122, v124
    v_and_b32 v125, 3, v123
    v_bfe_u32 v126, v123, 2, 1
    v_lshl_add_u32 v125, v126, 3, v125
    v_bfe_u32 v126, v123, 3, 1
    v_lshl_add_u32 v125, v126, 2, v125
    v_mul_u32_u24 v125, 7168, v125
    v_lshl_add_u32 v125, v124, 4, v125
    s_sub_u32 s44, s42, 3072
    v_add_u32 v119, s44, v125
    s_min_u32 s47, s47, 251
    s_mul_i32 s49, s47, 293
    s_lshr_b32 s49, s49, 12
    s_mul_i32 s50, s49, 5376
    s_lshl_b32 s49, s47, 7
    s_add_u32 s49, s49, s50
    s_mul_i32 s50, s43, 1792
    s_add_u32 s49, s49, s50
    s_add_u32 s49, s49, 60
    s_waitcnt lgkmcnt(0)
    s_mov_b32 s4, s64
    s_and_b32 s5, s65, 0xffff
    s_mov_b32 s8, s72
    s_and_b32 s9, s73, 0xffff
    s_add_u32 m0, s55, 0
    s_nop 0
    buffer_load_dwordx4 v112, s[4:7], s23 offen offset:0 lds
    buffer_load_dwordx4 v113, s[4:7], s23 offen offset:1024 lds
    buffer_load_dwordx4 v114, s[4:7], s23 offen offset:2048 lds
    buffer_load_dwordx4 v115, s[4:7], s23 offen offset:3072 lds
    s_add_u32 s23, s23, 128
    s_add_u32 m0, s32, 0
    s_nop 0
    buffer_load_dwordx4 v116, s[8:11], s24 offen offset:0 lds
    buffer_load_dwordx4 v117, s[8:11], s24 offen offset:1024 lds
    buffer_load_dwordx4 v118, s[8:11], s24 offen offset:2048 lds
    s_mov_b32 exec_hi, 0
    buffer_load_dwordx4 v119, s[8:11], s24 offen offset:3072 lds
    s_mov_b32 exec_hi, -1
    s_add_u32 s24, s24, 458752
    s_add_u32 s94, s72, s49
    s_addc_u32 s95, s73, 0
    s_add_u32 s94, s94, 1376256
    s_addc_u32 s95, s95, 0
    s_load_dwordx2 s[100:101], s[94:95], 0
fused_kernel_pg8:
    s_cbranch_execz fused_kernel_pgrA
    s_load_dwordx2 s[100:101], s[94:95], 129024
    s_load_dwordx2 s[100:101], s[94:95], 258048
    s_load_dwordx2 s[100:101], s[94:95], 387072
    v_and_b32 v122, 15, v120
    v_lshlrev_b32 v123, 7, v122
    v_lshrrev_b32 v124, 4, v120
    v_and_b32 v125, 7, v120
    v_xor_b32 v125, v125, v124
    v_lshl_add_u32 v123, v125, 4, v123
    v_add_u32 v152, s55, v123
    v_xor_b32 v153, 64, v152
    v_add_u32 v154, 0x10000, v152
    v_add_u32 v155, 0x10000, v153
    v_bfe_u32 v125, v120, 2, 2
    v_bfe_u32 v126, v120, 4, 1
    v_lshl_add_u32 v125, v126, 2, v125
    v_lshrrev_b32 v127, 5, v120
    v_and_b32 v128, 3, v120
    v_lshlrev_b32 v128, 3, v128
    s_lshl_b32 s42, s28, 5
    s_add_u32 s42, s42, s29
    s_lshl_b32 s57, s28, 2
    s_add_u32 s57, s57, s20
    s_lshl_b32 s57, s57, 4
    s_add_u32 s57, s57, s43
    s_lshl_b32 s57, s57, 5
    s_and_b32 s41, s29, 7
    s_add_u32 s57, s57, s41
    s_lshl_b32 s57, s57, 2
    s_add_u32 s57, s57, 35667968
    s_lshl_b32 s62, s42, 2
    s_add_u32 s62, s62, s20
    s_lshl_b32 s62, s62, 11
    s_add_u32 s62, s62, 50331648
    s_lshl_b32 s3, s28, 3
    s_add_u32 s3, s3, s43
    s_lshl_b32 s3, s3, 2
    s_mov_b32 s12, s82
    s_and_b32 s13, s83, 0xffff
    s_mov_b32 s14, 67108864
    s_mov_b32 s15, 0x20000
    v_mul_u32_u24 v129, 3072, v127
    v_lshl_add_u32 v129, v125, 6, v129
    v_lshl_add_u32 v129, v126, 5, v129
    v_add_u32 v129, v129, v128
    v_add_u32 v156, 126976, v129
    v_xor_b32 v157, 32, v156
    s_lshl_b32 s63, s42, 15
    s_add_u32 s63, s63, 18874368
    s_lshl_b32 s48, s42, 3
    s_lshl_b32 s41, s20, 1
    s_add_u32 s48, s48, s41
    s_lshl_b32 s49, s48, 11
    s_mov_b32 s36, s80
    s_and_b32 s37, s81, 0xffff
    s_mov_b32 s38, 256
    s_mov_b32 s39, 0x20000
    s_mov_b32 s84, s76
    s_and_b32 s85, s77, 0xffff
    s_mov_b32 s86, 2048
    s_mov_b32 s87, 0x20000
    s_mov_b32 s16, s74
    s_and_b32 s17, s75, 0xffff
    s_mov_b32 s18, 7340032
    s_mov_b32 s19, 0x20000
    s_cmp_eq_u32 s20, 0
    s_cselect_b32 s38, 256, 0
    s_cselect_b32 s33, 32, 0
    v_accvgpr_write_b32 a88, -1
    v_accvgpr_write_b32 a89, -1
    v_accvgpr_write_b32 a90, -1
    v_accvgpr_write_b32 a91, -1
    s_mov_b64 exec, 0
    s_cmp_eq_u32 s20, 0
    s_cbranch_scc1 fused_kernel_pg5
    s_cmp_eq_u32 s20, 1
    s_cbranch_scc1 fused_kernel_pg6
    s_cmp_eq_u32 s20, 2
    s_cbranch_scc1 fused_kernel_pg7
    s_branch fused_kernel_pg8
fused_kernel_pgrA:
    s_mov_b64 exec, -1
    s_waitcnt vmcnt(4)
    s_add_u32 m0, s32, 14336
    s_nop 0
    buffer_load_dwordx4 v116, s[8:11], s24 offen offset:0 lds
    buffer_load_dwordx4 v117, s[8:11], s24 offen offset:1024 lds
    buffer_load_dwordx4 v118, s[8:11], s24 offen offset:2048 lds
    s_mov_b32 exec_hi, 0
    buffer_load_dwordx4 v119, s[8:11], s24 offen offset:3072 lds
    s_mov_b32 exec_hi, -1
    s_add_u32 s24, s24, 458752
    s_add_u32 m0, s55, 65536
    s_nop 0
    buffer_load_dwordx4 v112, s[4:7], s23 offen offset:0 lds
    buffer_load_dwordx4 v113, s[4:7], s23 offen offset:1024 lds
    buffer_load_dwordx4 v114, s[4:7], s23 offen offset:2048 lds
    buffer_load_dwordx4 v115, s[4:7], s23 offen offset:3072 lds
    s_add_u32 s23, s23, 128
    s_waitcnt vmcnt(8)
    s_barrier
    s_barrier
fused_kernel_sa0:
    ds_read_b128 a[0:3], v152 offset:0
    ds_read_b128 a[16:19], v153 offset:0
    ds_read_b128 a[4:7], v152 offset:2048
    ds_read_b128 a[20:23], v153 offset:2048
    ds_read_b128 a[8:11], v152 offset:4096
    ds_read_b128 a[24:27], v153 offset:4096
    s_add_u32 m0, s32, 0
    s_nop 0
    buffer_load_dwordx4 v116, s[8:11], s24 offen offset:0 lds
    ds_read_b128 a[12:15], v152 offset:6144
    ds_read_b128 a[28:31], v153 offset:6144
    buffer_load_dwordx4 v117, s[8:11], s24 offen offset:1024 lds
    ds_read_b64_tr_b16 a[32:33], v156 offset:1024
    ds_read_b64_tr_b16 a[34:35], v156 offset:1536
    buffer_load_dwordx4 v118, s[8:11], s24 offen offset:2048 lds
    ds_read_b64_tr_b16 a[36:37], v156 offset:7168
    ds_read_b64_tr_b16 a[38:39], v156 offset:7680
    s_mov_b32 exec_hi, 0
    buffer_load_dwordx4 v119, s[8:11], s24 offen offset:3072 lds
    s_mov_b32 exec_hi, -1
    s_add_u32 s24, s24, 458752
    ds_read_b64_tr_b16 a[40:41], v157 offset:1024
    ds_read_b64_tr_b16 a[42:43], v157 offset:1536
    s_add_u32 m0, s55, 32768
    s_nop 0
    buffer_load_dwordx4 v112, s[4:7], s23 offen offset:0 lds
    ds_read_b64_tr_b16 a[44:45], v157 offset:7168
    ds_read_b64_tr_b16 a[46:47], v157 offset:7680
    buffer_load_dwordx4 v113, s[4:7], s23 offen offset:1024 lds
    ds_read_b64_tr_b16 a[48:49], v156 offset:2048
    ds_read_b64_tr_b16 a[50:51], v156 offset:2560
    ds_read_b64_tr_b16 a[52:53], v156 offset:8192
    buffer_load_dwordx4 v114, s[4:7], s23 offen offset:2048 lds
    ds_read_b64_tr_b16 a[54:55], v156 offset:8704
    ds_read_b64_tr_b16 a[56:57], v157 offset:2048
    buffer_load_dwordx4 v115, s[4:7], s23 offen offset:3072 lds
    s_add_u32 s23, s23, 128
    ds_read_b64_tr_b16 a[58:59], v157 offset:2560
    ds_read_b64_tr_b16 a[60:61], v157 offset:8192
    s_waitcnt lgkmcnt(15)
    s_add_u32 m0, s55, 0
    s_nop 0
    buffer_load_dwordx4 v112, s[4:7], s23 offen offset:0 lds
    ds_read_b64_tr_b16 a[62:63], v157 offset:8704
    ds_read_b64_tr_b16 a[64:65], v156 offset:0
    buffer_load_dwordx4 v113, s[4:7], s23 offen offset:1024 lds
    ds_read_b64_tr_b16 a[66:67], v156 offset:512
    ds_read_b64_tr_b16 a[68:69], v156 offset:6144
    buffer_load_dwordx4 v114, s[4:7], s23 offen offset:2048 lds
    ds_read_b64_tr_b16 a[70:71], v156 offset:6656
    ds_read_b64_tr_b16 a[72:73], v157 offset:0
    buffer_load_dwordx4 v115, s[4:7], s23 offen offset:3072 lds
    s_add_u32 s23, s23, 128
    ds_read_b64_tr_b16 a[74:75], v157 offset:512
    ds_read_b64_tr_b16 a[76:77], v157 offset:6144
    ds_read_b64_tr_b16 a[78:79], v157 offset:6656
    ds_read_b32 v121, v152
    ds_read_b32 v121, v152
    ds_read_b32 v121, v152
    ds_read_b32 v121, v152
    ds_read_b32 v121, v152
    ds_read_b32 v121, v152
    ds_read_b32 v121, v152
    ds_read_b32 v121, v152
    s_waitcnt vmcnt(12) lgkmcnt(8)
    s_barrier
    v_mfma_f32_16x16x32_bf16 v[0:3], a[32:35], a[0:3], 0
    v_mfma_f32_16x16x32_bf16 v[0:3], a[36:39], a[16:19], v[0:3]
    v_mfma_f32_16x16x32_bf16 v[4:7], a[36:39], a[20:23], 0
    s_load_dwordx2 s[100:101], s[94:95], 516096
    v_mfma_f32_16x16x32_bf16 v[4:7], a[32:35], a[4:7], v[4:7]
    v_mfma_f32_16x16x32_bf16 v[8:11], a[32:35], a[8:11], 0
    s_load_dwordx2 s[100:101], s[94:95], 645120
    v_mfma_f32_16x16x32_bf16 v[8:11], a[36:39], a[24:27], v[8:11]
    v_mfma_f32_16x16x32_bf16 v[12:15], a[36:39], a[28:31], 0
    s_load_dwordx2 s[100:101], s[94:95], 774144
    v_mfma_f32_16x16x32_bf16 v[12:15], a[32:35], a[12:15], v[12:15]
    v_mfma_f32_16x16x32_bf16 v[28:31], a[40:43], a[12:15], 0
    s_load_dwordx2 s[100:101], s[94:95], 903168
    v_mfma_f32_16x16x32_bf16 v[28:31], a[44:47], a[28:31], v[28:31]
    v_mfma_f32_16x16x32_bf16 v[24:27], a[44:47], a[24:27], 0
    s_load_dwordx2 s[100:101], s[94:95], 1032192
    v_mfma_f32_16x16x32_bf16 v[24:27], a[40:43], a[8:11], v[24:27]
    v_mfma_f32_16x16x32_bf16 v[20:23], a[40:43], a[4:7], 0
    v_mfma_f32_16x16x32_bf16 v[20:23], a[44:47], a[20:23], v[20:23]
    v_mfma_f32_16x16x32_bf16 v[16:19], a[44:47], a[16:19], 0
    v_mfma_f32_16x16x32_bf16 v[16:19], a[40:43], a[0:3], v[16:19]
    v_mfma_f32_16x16x32_bf16 v[32:35], a[0:3], a[48:51], 0
    v_mfma_f32_16x16x32_bf16 v[32:35], a[16:19], a[52:55], v[32:35]
    v_mfma_f32_16x16x32_bf16 v[36:39], a[20:23], a[52:55], 0
    v_mfma_f32_16x16x32_bf16 v[36:39], a[4:7], a[48:51], v[36:39]
    v_mfma_f32_16x16x32_bf16 v[40:43], a[8:11], a[48:51], 0
    v_mfma_f32_16x16x32_bf16 v[40:43], a[24:27], a[52:55], v[40:43]
    v_mfma_f32_16x16x32_bf16 v[44:47], a[28:31], a[52:55], 0
    v_mfma_f32_16x16x32_bf16 v[44:47], a[12:15], a[48:51], v[44:47]
    v_mfma_f32_16x16x32_bf16 v[60:63], a[12:15], a[56:59], 0
    v_mfma_f32_16x16x32_bf16 v[60:63], a[28:31], a[60:63], v[60:63]
    v_mfma_f32_16x16x32_bf16 v[56:59], a[24:27], a[60:63], 0
    v_mfma_f32_16x16x32_bf16 v[56:59], a[8:11], a[56:59], v[56:59]
    v_mfma_f32_16x16x32_bf16 v[52:55], a[4:7], a[56:59], 0
    v_mfma_f32_16x16x32_bf16 v[52:55], a[20:23], a[60:63], v[52:55]
    v_mfma_f32_16x16x32_bf16 v[48:51], a[16:19], a[60:63], 0
    v_mfma_f32_16x16x32_bf16 v[48:51], a[0:3], a[56:59], v[48:51]
    v_mfma_f32_16x16x32_bf16 v[64:67], a[64:67], a[0:3], 0
    v_mfma_f32_16x16x32_bf16 v[64:67], a[68:71], a[16:19], v[64:67]
    v_mfma_f32_16x16x32_bf16 v[68:71], a[68:71], a[20:23], 0
    v_mfma_f32_16x16x32_bf16 v[68:71], a[64:67], a[4:7], v[68:71]
    v_mfma_f32_16x16x32_bf16 v[72:75], a[64:67], a[8:11], 0
    v_mfma_f32_16x16x32_bf16 v[72:75], a[68:71], a[24:27], v[72:75]
    v_mfma_f32_16x16x32_bf16 v[76:79], a[68:71], a[28:31], 0
    v_mfma_f32_16x16x32_bf16 v[76:79], a[64:67], a[12:15], v[76:79]
    v_mfma_f32_16x16x32_bf16 v[92:95], a[72:75], a[12:15], 0
    v_mfma_f32_16x16x32_bf16 v[92:95], a[76:79], a[28:31], v[92:95]
    v_mfma_f32_16x16x32_bf16 v[88:91], a[76:79], a[24:27], 0
    v_mfma_f32_16x16x32_bf16 v[88:91], a[72:75], a[8:11], v[88:91]
    s_setprio 2
    s_barrier
    v_mfma_f32_16x16x32_bf16 v[84:87], a[72:75], a[4:7], 0
    v_mfma_f32_16x16x32_bf16 v[84:87], a[76:79], a[20:23], v[84:87]
    v_mfma_f32_16x16x32_bf16 v[80:83], a[76:79], a[16:19], 0
    v_mfma_f32_16x16x32_bf16 v[80:83], a[72:75], a[0:3], v[80:83]
    s_setprio 0
fused_kernel_sa1:
    ds_read_b128 a[0:3], v154 offset:0
    ds_read_b128 a[16:19], v155 offset:0
    ds_read_b128 a[4:7], v154 offset:2048
    ds_read_b128 a[20:23], v155 offset:2048
    ds_read_b128 a[8:11], v154 offset:4096
    ds_read_b128 a[24:27], v155 offset:4096
    s_add_u32 m0, s32, 14336
    s_nop 0
    buffer_load_dwordx4 v116, s[8:11], s24 offen offset:0 lds
    ds_read_b128 a[12:15], v154 offset:6144
    ds_read_b128 a[28:31], v155 offset:6144
    buffer_load_dwordx4 v117, s[8:11], s24 offen offset:1024 lds
    ds_read_b64_tr_b16 a[32:33], v156 offset:13312
    ds_read_b64_tr_b16 a[34:35], v156 offset:13824
    ds_read_b64_tr_b16 a[36:37], v156 offset:19456
    buffer_load_dwordx4 v118, s[8:11], s24 offen offset:2048 lds
    ds_read_b64_tr_b16 a[38:39], v156 offset:19968
    ds_read_b64_tr_b16 a[40:41], v157 offset:13312
    ds_read_b64_tr_b16 a[42:43], v157 offset:13824
    s_mov_b32 exec_hi, 0
    buffer_load_dwordx4 v119, s[8:11], s24 offen offset:3072 lds
    s_mov_b32 exec_hi, -1
    s_add_u32 s24, s24, 458752
    ds_read_b64_tr_b16 a[44:45], v157 offset:19456
    ds_read_b64_tr_b16 a[46:47], v157 offset:19968
    ds_read_b64_tr_b16 a[48:49], v156 offset:14336
    s_waitcnt lgkmcnt(9)
    s_add_u32 m0, s55, 65536
    s_nop 0
    buffer_load_dwordx4 v112, s[4:7], s23 offen offset:0 lds
    ds_read_b64_tr_b16 a[50:51], v156 offset:14848
    ds_read_b64_tr_b16 a[52:53], v156 offset:20480
    ds_read_b64_tr_b16 a[54:55], v156 offset:20992
    buffer_load_dwordx4 v113, s[4:7], s23 offen offset:1024 lds
    ds_read_b64_tr_b16 a[56:57], v157 offset:14336
    ds_read_b64_tr_b16 a[58:59], v157 offset:14848
    ds_read_b64_tr_b16 a[60:61], v157 offset:20480
    buffer_load_dwordx4 v114, s[4:7], s23 offen offset:2048 lds
    ds_read_b64_tr_b16 a[62:63], v157 offset:20992
    ds_read_b64_tr_b16 a[64:65], v156 offset:12288
    ds_read_b64_tr_b16 a[66:67], v156 offset:12800
    buffer_load_dwordx4 v115, s[4:7], s23 offen offset:3072 lds
    s_add_u32 s23, s23, 128
    ds_read_b64_tr_b16 a[68:69], v156 offset:18432
    ds_read_b64_tr_b16 a[70:71], v156 offset:18944
    ds_read_b64_tr_b16 a[72:73], v157 offset:12288
    buffer_load_dwordx4 v[96:99], v158, s[84:87], 0 offen offset:0
    buffer_load_dwordx4 v[100:103], v158, s[4:7], s49 offen offset:0
    buffer_load_dwordx4 v[104:107], v158, s[4:7], s49 offen offset:2048
    ds_read_b64_tr_b16 a[74:75], v157 offset:12800
    ds_read_b64_tr_b16 a[76:77], v157 offset:18432
    ds_read_b64_tr_b16 a[78:79], v157 offset:18944
    ds_read_b32 v121, v152
    ds_read_b32 v121, v152
    ds_read_b32 v121, v152
    ds_read_b32 v121, v152
    ds_read_b32 v121, v152
    ds_read_b32 v121, v152
    ds_read_b32 v121, v152
    ds_read_b32 v121, v152
    ds_read_b32 v121, v152
    ds_read_b32 v121, v152
    s_waitcnt vmcnt(15) lgkmcnt(10)
    s_barrier
    v_mfma_f32_16x16x32_bf16 v[0:3], a[32:35], a[0:3], v[0:3]
    v_mfma_f32_16x16x32_bf16 v[0:3], a[36:39], a[16:19], v[0:3]
    v_mfma_f32_16x16x32_bf16 v[4:7], a[36:39], a[20:23], v[4:7]
    s_add_u32 s94, s94, 1161216
    s_addc_u32 s95, s95, 0
    s_load_dwordx2 s[100:101], s[94:95], 0
    v_mfma_f32_16x16x32_bf16 v[4:7], a[32:35], a[4:7], v[4:7]
    v_mfma_f32_16x16x32_bf16 v[8:11], a[32:35], a[8:11], v[8:11]
    s_load_dwordx2 s[100:101], s[94:95], 129024
    v_mfma_f32_16x16x32_bf16 v[8:11], a[36:39], a[24:27], v[8:11]
    v_mfma_f32_16x16x32_bf16 v[12:15], a[36:39], a[28:31], v[12:15]
    s_load_dwordx2 s[100:101], s[94:95], 258048
    v_mfma_f32_16x16x32_bf16 v[12:15], a[32:35], a[12:15], v[12:15]
    v_mfma_f32_16x16x32_bf16 v[28:31], a[40:43], a[12:15], v[28:31]
    s_load_dwordx2 s[100:101], s[94:95], 387072
    v_mfma_f32_16x16x32_bf16 v[28:31], a[44:47], a[28:31], v[28:31]
    v_mfma_f32_16x16x32_bf16 v[24:27], a[44:47], a[24:27], v[24:27]
    s_load_dwordx2 s[100:101], s[94:95], 516096
    v_mfma_f32_16x16x32_bf16 v[24:27], a[40:43], a[8:11], v[24:27]
    v_mfma_f32_16x16x32_bf16 v[20:23], a[40:43], a[4:7], v[20:23]
    v_mfma_f32_16x16x32_bf16 v[20:23], a[44:47], a[20:23], v[20:23]
    v_mfma_f32_16x16x32_bf16 v[16:19], a[44:47], a[16:19], v[16:19]
    v_mfma_f32_16x16x32_bf16 v[16:19], a[40:43], a[0:3], v[16:19]
    v_mfma_f32_16x16x32_bf16 v[32:35], a[0:3], a[48:51], v[32:35]
    v_mfma_f32_16x16x32_bf16 v[32:35], a[16:19], a[52:55], v[32:35]
    v_mfma_f32_16x16x32_bf16 v[36:39], a[20:23], a[52:55], v[36:39]
    v_mfma_f32_16x16x32_bf16 v[36:39], a[4:7], a[48:51], v[36:39]
    v_mfma_f32_16x16x32_bf16 v[40:43], a[8:11], a[48:51], v[40:43]
    v_mfma_f32_16x16x32_bf16 v[40:43], a[24:27], a[52:55], v[40:43]
    v_mfma_f32_16x16x32_bf16 v[44:47], a[28:31], a[52:55], v[44:47]
    v_mfma_f32_16x16x32_bf16 v[44:47], a[12:15], a[48:51], v[44:47]
    v_mfma_f32_16x16x32_bf16 v[60:63], a[12:15], a[56:59], v[60:63]
    v_mfma_f32_16x16x32_bf16 v[60:63], a[28:31], a[60:63], v[60:63]
    v_mfma_f32_16x16x32_bf16 v[56:59], a[24:27], a[60:63], v[56:59]
    v_mfma_f32_16x16x32_bf16 v[56:59], a[8:11], a[56:59], v[56:59]
    v_mfma_f32_16x16x32_bf16 v[52:55], a[4:7], a[56:59], v[52:55]
    v_mfma_f32_16x16x32_bf16 v[52:55], a[20:23], a[60:63], v[52:55]
    v_mfma_f32_16x16x32_bf16 v[48:51], a[16:19], a[60:63], v[48:51]
    v_mfma_f32_16x16x32_bf16 v[48:51], a[0:3], a[56:59], v[48:51]
    v_mfma_f32_16x16x32_bf16 v[64:67], a[64:67], a[0:3], v[64:67]
    v_mfma_f32_16x16x32_bf16 v[64:67], a[68:71], a[16:19], v[64:67]
    v_mfma_f32_16x16x32_bf16 v[68:71], a[68:71], a[20:23], v[68:71]
    v_mfma_f32_16x16x32_bf16 v[68:71], a[64:67], a[4:7], v[68:71]
    v_mfma_f32_16x16x32_bf16 v[72:75], a[64:67], a[8:11], v[72:75]
    v_mfma_f32_16x16x32_bf16 v[72:75], a[68:71], a[24:27], v[72:75]
    v_mfma_f32_16x16x32_bf16 v[76:79], a[68:71], a[28:31], v[76:79]
    v_mfma_f32_16x16x32_bf16 v[76:79], a[64:67], a[12:15], v[76:79]
    v_mfma_f32_16x16x32_bf16 v[92:95], a[72:75], a[12:15], v[92:95]
    v_mfma_f32_16x16x32_bf16 v[92:95], a[76:79], a[28:31], v[92:95]
    v_mfma_f32_16x16x32_bf16 v[88:91], a[76:79], a[24:27], v[88:91]
    v_mfma_f32_16x16x32_bf16 v[88:91], a[72:75], a[8:11], v[88:91]
    s_setprio 2
    s_barrier
    v_mfma_f32_16x16x32_bf16 v[84:87], a[72:75], a[4:7], v[84:87]
    v_mfma_f32_16x16x32_bf16 v[84:87], a[76:79], a[20:23], v[84:87]
    v_mfma_f32_16x16x32_bf16 v[80:83], a[76:79], a[16:19], v[80:83]
    v_mfma_f32_16x16x32_bf16 v[80:83], a[72:75], a[0:3], v[80:83]
    s_setprio 0
fused_kernel_sa2:
    ds_read_b128 a[0:3], v152 offset:32768
    ds_read_b128 a[16:19], v153 offset:32768
    ds_read_b128 a[4:7], v152 offset:34816
    ds_read_b128 a[20:23], v153 offset:34816
    ds_read_b128 a[8:11], v152 offset:36864
    ds_read_b128 a[24:27], v153 offset:36864
    s_add_u32 m0, s32, 0
    s_nop 0
    buffer_load_dwordx4 v116, s[8:11], s24 offen offset:0 lds
    ds_read_b128 a[12:15], v152 offset:38912
    ds_read_b128 a[28:31], v153 offset:38912
    ds_read_b64_tr_b16 a[32:33], v156 offset:1024
    buffer_load_dwordx4 v117, s[8:11], s24 offen offset:1024 lds
    ds_read_b64_tr_b16 a[34:35], v156 offset:1536
    ds_read_b64_tr_b16 a[36:37], v156 offset:7168
    ds_read_b64_tr_b16 a[38:39], v156 offset:7680
    buffer_load_dwordx4 v118, s[8:11], s24 offen offset:2048 lds
    ds_read_b64_tr_b16 a[40:41], v157 offset:1024
    ds_read_b64_tr_b16 a[42:43], v157 offset:1536
    ds_read_b64_tr_b16 a[44:45], v157 offset:7168
    s_mov_b32 exec_hi, 0
    buffer_load_dwordx4 v119, s[8:11], s24 offen offset:3072 lds
    s_mov_b32 exec_hi, -1
    s_add_u32 s24, s24, 458752
    ds_read_b64_tr_b16 a[46:47], v157 offset:7680
    ds_read_b64_tr_b16 a[48:49], v156 offset:2048
    ds_read_b64_tr_b16 a[50:51], v156 offset:2560
    ds_read_b64_tr_b16 a[52:53], v156 offset:8192
    s_waitcnt lgkmcnt(11)
    s_add_u32 m0, s55, 32768
    s_nop 0
    buffer_load_dwordx4 v112, s[4:7], s23 offen offset:0 lds
    ds_read_b64_tr_b16 a[54:55], v156 offset:8704
    ds_read_b64_tr_b16 a[56:57], v157 offset:2048
    ds_read_b64_tr_b16 a[58:59], v157 offset:2560
    buffer_load_dwordx4 v113, s[4:7], s23 offen offset:1024 lds
    ds_read_b64_tr_b16 a[60:61], v157 offset:8192
    ds_read_b64_tr_b16 a[62:63], v157 offset:8704
    ds_read_b64_tr_b16 a[64:65], v156 offset:0
    buffer_load_dwordx4 v114, s[4:7], s23 offen offset:2048 lds
    ds_read_b64_tr_b16 a[66:67], v156 offset:512
    ds_read_b64_tr_b16 a[68:69], v156 offset:6144
    ds_read_b64_tr_b16 a[70:71], v156 offset:6656
    buffer_load_dwordx4 v115, s[4:7], s23 offen offset:3072 lds
    s_add_u32 s23, s23, 128
    ds_read_b64_tr_b16 a[72:73], v157 offset:0
    ds_read_b64_tr_b16 a[74:75], v157 offset:512
    ds_read_b64_tr_b16 a[76:77], v157 offset:6144
    ds_read_b64_tr_b16 a[78:79], v157 offset:6656
    ds_read_b32 v121, v152
    ds_read_b32 v121, v152
    ds_read_b32 v121, v152
    ds_read_b32 v121, v152
    ds_read_b32 v121, v152
    ds_read_b32 v121, v152
    ds_read_b32 v121, v152
    ds_read_b32 v121, v152
    ds_read_b32 v121, v152
    ds_read_b32 v121, v152
    s_waitcnt vmcnt(15) lgkmcnt(10)
    s_barrier
    v_mfma_f32_16x16x32_bf16 v[0:3], a[32:35], a[0:3], v[0:3]
    v_mfma_f32_16x16x32_bf16 v[0:3], a[36:39], a[16:19], v[0:3]
    s_waitcnt vmcnt(8)
    v_mov_b32 v108, 0x3f803f80
    v_mfma_f32_16x16x32_bf16 v[4:7], a[36:39], a[20:23], v[4:7]
    s_load_dwordx2 s[100:101], s[94:95], 645120
    v_mov_b32 v109, 0x3f803f80
    v_mfma_f32_16x16x32_bf16 v[4:7], a[32:35], a[4:7], v[4:7]
    v_mov_b32 v110, 0x3f803f80
    v_mov_b32 v111, 0x3f803f80
    v_mfma_f32_16x16x32_bf16 v[8:11], a[32:35], a[8:11], v[8:11]
    s_load_dwordx2 s[100:101], s[94:95], 774144
    v_lshlrev_b32 v122, 16, v96
    v_mfma_f32_16x16x32_bf16 v[8:11], a[36:39], a[24:27], v[8:11]
    v_and_b32 v123, 0xffff0000, v96
    v_lshlrev_b32 v124, 16, v100
    v_mfma_f32_16x16x32_bf16 v[12:15], a[36:39], a[28:31], v[12:15]
    s_load_dwordx2 s[100:101], s[94:95], 903168
    v_and_b32 v100, 0xffff0000, v100
    v_mfma_f32_16x16x32_bf16 v[12:15], a[32:35], a[12:15], v[12:15]
    v_mul_f32 v124, v124, v122
    v_mul_f32 v100, v100, v123
    v_mfma_f32_16x16x32_bf16 v[28:31], a[40:43], a[12:15], v[28:31]
    s_load_dwordx2 s[100:101], s[94:95], 1032192
    v_cvt_pk_bf16_f32 v100, v124, v100
    v_mfma_f32_16x16x32_bf16 v[28:31], a[44:47], a[28:31], v[28:31]
    v_lshlrev_b32 v125, 16, v104
    v_and_b32 v104, 0xffff0000, v104
    v_mfma_f32_16x16x32_bf16 v[24:27], a[44:47], a[24:27], v[24:27]
    s_add_u32 s94, s94, 1161216
    s_addc_u32 s95, s95, 0
    s_load_dwordx2 s[100:101], s[94:95], 0
    v_mfma_f32_16x16x32_bf16 v[24:27], a[40:43], a[8:11], v[24:27]
    v_mul_f32 v125, v125, v122
    v_mul_f32 v104, v104, v123
    v_mfma_f32_16x16x32_bf16 v[20:23], a[40:43], a[4:7], v[20:23]
    v_cvt_pk_bf16_f32 v104, v125, v104
    v_lshlrev_b32 v122, 16, v97
    v_mfma_f32_16x16x32_bf16 v[20:23], a[44:47], a[20:23], v[20:23]
    v_and_b32 v123, 0xffff0000, v97
    v_lshlrev_b32 v124, 16, v101
    v_mfma_f32_16x16x32_bf16 v[16:19], a[44:47], a[16:19], v[16:19]
    v_and_b32 v101, 0xffff0000, v101
    v_mul_f32 v124, v124, v122
    v_mfma_f32_16x16x32_bf16 v[16:19], a[40:43], a[0:3], v[16:19]
    v_mul_f32 v101, v101, v123
    v_cvt_pk_bf16_f32 v101, v124, v101
    v_mfma_f32_16x16x32_bf16 v[32:35], a[0:3], a[48:51], v[32:35]
    v_lshlrev_b32 v125, 16, v105
    v_and_b32 v105, 0xffff0000, v105
    v_mfma_f32_16x16x32_bf16 v[32:35], a[16:19], a[52:55], v[32:35]
    v_mul_f32 v125, v125, v122
    v_mul_f32 v105, v105, v123
    v_mfma_f32_16x16x32_bf16 v[36:39], a[20:23], a[52:55], v[36:39]
    v_cvt_pk_bf16_f32 v105, v125, v105
    v_lshlrev_b32 v122, 16, v98
    v_mfma_f32_16x16x32_bf16 v[36:39], a[4:7], a[48:51], v[36:39]
    v_and_b32 v123, 0xffff0000, v98
    v_lshlrev_b32 v124, 16, v102
    v_mfma_f32_16x16x32_bf16 v[40:43], a[8:11], a[48:51], v[40:43]
    v_and_b32 v102, 0xffff0000, v102
    v_mul_f32 v124, v124, v122
    v_mfma_f32_16x16x32_bf16 v[40:43], a[24:27], a[52:55], v[40:43]
    v_mul_f32 v102, v102, v123
    v_cvt_pk_bf16_f32 v102, v124, v102
    v_mfma_f32_16x16x32_bf16 v[44:47], a[28:31], a[52:55], v[44:47]
    v_lshlrev_b32 v125, 16, v106
    v_and_b32 v106, 0xffff0000, v106
    v_mfma_f32_16x16x32_bf16 v[44:47], a[12:15], a[48:51], v[44:47]
    v_mul_f32 v125, v125, v122
    v_mul_f32 v106, v106, v123
    v_mfma_f32_16x16x32_bf16 v[60:63], a[12:15], a[56:59], v[60:63]
    v_cvt_pk_bf16_f32 v106, v125, v106
    v_lshlrev_b32 v122, 16, v99
    v_mfma_f32_16x16x32_bf16 v[60:63], a[28:31], a[60:63], v[60:63]
    v_and_b32 v123, 0xffff0000, v99
    v_lshlrev_b32 v124, 16, v103
    v_mfma_f32_16x16x32_bf16 v[56:59], a[24:27], a[60:63], v[56:59]
    v_and_b32 v103, 0xffff0000, v103
    v_mul_f32 v124, v124, v122
    v_mfma_f32_16x16x32_bf16 v[56:59], a[8:11], a[56:59], v[56:59]
    v_mul_f32 v103, v103, v123
    v_cvt_pk_bf16_f32 v103, v124, v103
    v_mfma_f32_16x16x32_bf16 v[52:55], a[4:7], a[56:59], v[52:55]
    v_lshlrev_b32 v125, 16, v107
    v_and_b32 v107, 0xffff0000, v107
    v_mfma_f32_16x16x32_bf16 v[52:55], a[20:23], a[60:63], v[52:55]
    v_mul_f32 v125, v125, v122
    v_mul_f32 v107, v107, v123
    v_mfma_f32_16x16x32_bf16 v[48:51], a[16:19], a[60:63], v[48:51]
    v_cvt_pk_bf16_f32 v107, v125, v107
    v_mfma_f32_16x16x32_bf16 v[134:137], v[108:111], v[100:103], 0
    v_mfma_f32_16x16x32_bf16 v[48:51], a[0:3], a[56:59], v[48:51]
    v_mfma_f32_16x16x32_bf16 v[138:141], v[108:111], v[104:107], 0
    v_lshlrev_b32 v123, 9, v120
    v_mfma_f32_16x16x32_bf16 v[64:67], a[64:67], a[0:3], v[64:67]
    v_mov_b32 v147, 0
    v_mov_b32 v124, 1073741824
    v_mfma_f32_16x16x32_bf16 v[64:67], a[68:71], a[16:19], v[64:67]
    v_cmp_gt_u32 s[40:41], 4, v120
    v_cmp_eq_u32 vcc, 0, v120
    v_mfma_f32_16x16x32_bf16 v[68:71], a[68:71], a[20:23], v[68:71]
    v_mov_b32 v151, 1
    v_cndmask_b32 v123, v124, v123, s[40:41]
    v_mfma_f32_16x16x32_bf16 v[68:71], a[64:67], a[4:7], v[68:71]
    v_cndmask_b32 v148, v124, 0, vcc
    buffer_store_dword v147, v123, s[12:15], s57 offen sc1
    v_mfma_f32_16x16x32_bf16 v[72:75], a[64:67], a[8:11], v[72:75]
    v_and_b32 v146, 7, v120
    v_lshlrev_b32 v146, 5, v146
    v_mfma_f32_16x16x32_bf16 v[72:75], a[68:71], a[24:27], v[72:75]
    s_getreg_b32 s40, hwreg(HW_REG_XCC_ID)
    s_and_b32 s40, s40, 15
    v_mfma_f32_16x16x32_bf16 v[76:79], a[68:71], a[28:31], v[76:79]
    s_lshl_b32 s40, 1, s40
    v_mov_b32 v122, s40
    v_mfma_f32_16x16x32_bf16 v[76:79], a[64:67], a[12:15], v[76:79]
    buffer_atomic_or v122, v148, s[36:39], s3 offen offset:4 sc1
    v_mfma_f32_16x16x32_bf16 v[92:95], a[72:75], a[12:15], v[92:95]
    v_mfma_f32_16x16x32_bf16 v[92:95], a[76:79], a[28:31], v[92:95]
    v_mfma_f32_16x16x32_bf16 v[88:91], a[76:79], a[24:27], v[88:91]
    v_mfma_f32_16x16x32_bf16 v[88:91], a[72:75], a[8:11], v[88:91]
    s_setprio 2
    s_barrier
    v_mfma_f32_16x16x32_bf16 v[84:87], a[72:75], a[4:7], v[84:87]
    v_mfma_f32_16x16x32_bf16 v[84:87], a[76:79], a[20:23], v[84:87]
    v_mfma_f32_16x16x32_bf16 v[80:83], a[76:79], a[16:19], v[80:83]
    v_mfma_f32_16x16x32_bf16 v[80:83], a[72:75], a[0:3], v[80:83]
    s_setprio 0
fused_kernel_sa3:
    ds_read_b128 a[0:3], v152 offset:0
    ds_read_b128 a[16:19], v153 offset:0
    ds_read_b128 a[4:7], v152 offset:2048
    ds_read_b128 a[20:23], v153 offset:2048
    ds_read_b128 a[8:11], v152 offset:4096
    ds_read_b128 a[24:27], v153 offset:4096
    s_add_u32 m0, s32, 14336
    s_nop 0
    buffer_load_dwordx4 v116, s[8:11], s24 offen offset:0 lds
    ds_read_b128 a[12:15], v152 offset:6144
    ds_read_b128 a[28:31], v153 offset:6144
    buffer_load_dwordx4 v117, s[8:11], s24 offen offset:1024 lds
    ds_read_b64_tr_b16 a[32:33], v156 offset:13312
    ds_read_b64_tr_b16 a[34:35], v156 offset:13824
    ds_read_b64_tr_b16 a[36:37], v156 offset:19456
    buffer_load_dwordx4 v118, s[8:11], s24 offen offset:2048 lds
    ds_read_b64_tr_b16 a[38:39], v156 offset:19968
    ds_read_b64_tr_b16 a[40:41], v157 offset:13312
    ds_read_b64_tr_b16 a[42:43], v157 offset:13824
    s_mov_b32 exec_hi, 0
    buffer_load_dwordx4 v119, s[8:11], s24 offen offset:3072 lds
    s_mov_b32 exec_hi, -1
    s_add_u32 s24, s24, 458752
    ds_read_b64_tr_b16 a[44:45], v157 offset:19456
    ds_read_b64_tr_b16 a[46:47], v157 offset:19968
    ds_read_b64_tr_b16 a[48:49], v156 offset:14336
    s_waitcnt lgkmcnt(9)
    s_add_u32 m0, s55, 0
    s_nop 0
    buffer_load_dwordx4 v112, s[4:7], s23 offen offset:0 lds
    ds_read_b64_tr_b16 a[50:51], v156 offset:14848
    ds_read_b64_tr_b16 a[52:53], v156 offset:20480
    ds_read_b64_tr_b16 a[54:55], v156 offset:20992
    buffer_load_dwordx4 v113, s[4:7], s23 offen offset:1024 lds
    ds_read_b64_tr_b16 a[56:57], v157 offset:14336
    ds_read_b64_tr_b16 a[58:59], v157 offset:14848
    ds_read_b64_tr_b16 a[60:61], v157 offset:20480
    buffer_load_dwordx4 v114, s[4:7], s23 offen offset:2048 lds
    ds_read_b64_tr_b16 a[62:63], v157 offset:20992
    ds_read_b64_tr_b16 a[64:65], v156 offset:12288
    ds_read_b64_tr_b16 a[66:67], v156 offset:12800
    buffer_load_dwordx4 v115, s[4:7], s23 offen offset:3072 lds
    s_add_u32 s23, s23, 128
    ds_read_b64_tr_b16 a[68:69], v156 offset:18432
    ds_read_b64_tr_b16 a[70:71], v156 offset:18944
    ds_read_b64_tr_b16 a[72:73], v157 offset:12288
fused_kernel_pg9:
    s_cbranch_execz fused_kernel_pgrB
    buffer_load_dwordx4 v[96:99], v158, s[84:87], 0 offen offset:1024
    buffer_load_dwordx4 v[100:103], v158, s[4:7], s49 offen offset:1024
    buffer_load_dwordx4 v[104:107], v158, s[4:7], s49 offen offset:3072
    ds_read_b64_tr_b16 a[74:75], v157 offset:12800
    ds_read_b64_tr_b16 a[76:77], v157 offset:18432
    ds_read_b64_tr_b16 a[78:79], v157 offset:18944
    ds_read_b32 v121, v152
    ds_read_b32 v121, v152
    ds_read_b32 v121, v152
    ds_read_b32 v121, v152
    ds_read_b32 v121, v152
    ds_read_b32 v121, v152
    ds_read_b32 v121, v152
    ds_read_b32 v121, v152
    ds_read_b32 v121, v152
    ds_read_b32 v121, v152
    s_waitcnt vmcnt(17) lgkmcnt(10)
    s_barrier
    v_mfma_f32_16x16x32_bf16 v[0:3], a[32:35], a[0:3], v[0:3]
    v_mfma_f32_16x16x32_bf16 v[0:3], a[36:39], a[16:19], v[0:3]
    v_mfma_f32_16x16x32_bf16 v[4:7], a[36:39], a[20:23], v[4:7]
    s_load_dwordx2 s[100:101], s[94:95], 129024
    v_mfma_f32_16x16x32_bf16 v[4:7], a[32:35], a[4:7], v[4:7]
    v_mfma_f32_16x16x32_bf16 v[8:11], a[32:35], a[8:11], v[8:11]
    s_load_dwordx2 s[100:101], s[94:95], 258048
    v_mfma_f32_16x16x32_bf16 v[8:11], a[36:39], a[24:27], v[8:11]
    v_mfma_f32_16x16x32_bf16 v[12:15], a[36:39], a[28:31], v[12:15]
    s_load_dwordx2 s[100:101], s[94:95], 387072
    v_mfma_f32_16x16x32_bf16 v[12:15], a[32:35], a[12:15], v[12:15]
    v_mfma_f32_16x16x32_bf16 v[28:31], a[40:43], a[12:15], v[28:31]
    s_load_dwordx2 s[100:101], s[94:95], 516096
    v_mfma_f32_16x16x32_bf16 v[28:31], a[44:47], a[28:31], v[28:31]
    v_mfma_f32_16x16x32_bf16 v[24:27], a[44:47], a[24:27], v[24:27]
    s_load_dwordx2 s[100:101], s[94:95], 645120
    v_mfma_f32_16x16x32_bf16 v[24:27], a[40:43], a[8:11], v[24:27]
    v_mfma_f32_16x16x32_bf16 v[20:23], a[40:43], a[4:7], v[20:23]
    v_mfma_f32_16x16x32_bf16 v[20:23], a[44:47], a[20:23], v[20:23]
    v_mfma_f32_16x16x32_bf16 v[16:19], a[44:47], a[16:19], v[16:19]
    v_mfma_f32_16x16x32_bf16 v[16:19], a[40:43], a[0:3], v[16:19]
    v_mfma_f32_16x16x32_bf16 v[32:35], a[0:3], a[48:51], v[32:35]
    v_mfma_f32_16x16x32_bf16 v[32:35], a[16:19], a[52:55], v[32:35]
    v_mfma_f32_16x16x32_bf16 v[36:39], a[20:23], a[52:55], v[36:39]
    v_mfma_f32_16x16x32_bf16 v[36:39], a[4:7], a[48:51], v[36:39]
    v_mfma_f32_16x16x32_bf16 v[40:43], a[8:11], a[48:51], v[40:43]
    v_mfma_f32_16x16x32_bf16 v[40:43], a[24:27], a[52:55], v[40:43]
    v_mfma_f32_16x16x32_bf16 v[44:47], a[28:31], a[52:55], v[44:47]
    v_mfma_f32_16x16x32_bf16 v[44:47], a[12:15], a[48:51], v[44:47]
    v_mfma_f32_16x16x32_bf16 v[60:63], a[12:15], a[56:59], v[60:63]
    v_mfma_f32_16x16x32_bf16 v[60:63], a[28:31], a[60:63], v[60:63]
    v_mfma_f32_16x16x32_bf16 v[56:59], a[24:27], a[60:63], v[56:59]
    v_mfma_f32_16x16x32_bf16 v[56:59], a[8:11], a[56:59], v[56:59]
    v_mfma_f32_16x16x32_bf16 v[52:55], a[4:7], a[56:59], v[52:55]
    v_mfma_f32_16x16x32_bf16 v[52:55], a[20:23], a[60:63], v[52:55]
    v_mfma_f32_16x16x32_bf16 v[48:51], a[16:19], a[60:63], v[48:51]
    v_mfma_f32_16x16x32_bf16 v[48:51], a[0:3], a[56:59], v[48:51]
    v_mfma_f32_16x16x32_bf16 v[64:67], a[64:67], a[0:3], v[64:67]
    v_mfma_f32_16x16x32_bf16 v[64:67], a[68:71], a[16:19], v[64:67]
    v_mfma_f32_16x16x32_bf16 v[68:71], a[68:71], a[20:23], v[68:71]
    v_mfma_f32_16x16x32_bf16 v[68:71], a[64:67], a[4:7], v[68:71]
    v_mfma_f32_16x16x32_bf16 v[72:75], a[64:67], a[8:11], v[72:75]
    v_mfma_f32_16x16x32_bf16 v[72:75], a[68:71], a[24:27], v[72:75]
    v_mfma_f32_16x16x32_bf16 v[76:79], a[68:71], a[28:31], v[76:79]
    v_mfma_f32_16x16x32_bf16 v[76:79], a[64:67], a[12:15], v[76:79]
    v_mfma_f32_16x16x32_bf16 v[92:95], a[72:75], a[12:15], v[92:95]
    v_mfma_f32_16x16x32_bf16 v[92:95], a[76:79], a[28:31], v[92:95]
    v_mfma_f32_16x16x32_bf16 v[88:91], a[76:79], a[24:27], v[88:91]
    v_mfma_f32_16x16x32_bf16 v[88:91], a[72:75], a[8:11], v[88:91]
    s_setprio 2
    s_barrier
    v_mfma_f32_16x16x32_bf16 v[84:87], a[72:75], a[4:7], v[84:87]
    v_mfma_f32_16x16x32_bf16 v[84:87], a[76:79], a[20:23], v[84:87]
    v_mfma_f32_16x16x32_bf16 v[80:83], a[76:79], a[16:19], v[80:83]
    v_mfma_f32_16x16x32_bf16 v[80:83], a[72:75], a[0:3], v[80:83]
    s_setprio 0
fused_kernel_sa4:
    ds_read_b128 a[0:3], v154 offset:0
    ds_read_b128 a[16:19], v155 offset:0
    ds_read_b128 a[4:7], v154 offset:2048
    ds_read_b128 a[20:23], v155 offset:2048
    ds_read_b128 a[8:11], v154 offset:4096
    ds_read_b128 a[24:27], v155 offset:4096
    s_add_u32 m0, s32, 0
    s_nop 0
    buffer_load_dwordx4 v116, s[8:11], s24 offen offset:0 lds
    ds_read_b128 a[12:15], v154 offset:6144
    ds_read_b128 a[28:31], v155 offset:6144
    ds_read_b64_tr_b16 a[32:33], v156 offset:1024
    buffer_load_dwordx4 v117, s[8:11], s24 offen offset:1024 lds
    ds_read_b64_tr_b16 a[34:35], v156 offset:1536
    ds_read_b64_tr_b16 a[36:37], v156 offset:7168
    ds_read_b64_tr_b16 a[38:39], v156 offset:7680
    buffer_load_dwordx4 v118, s[8:11], s24 offen offset:2048 lds
    ds_read_b64_tr_b16 a[40:41], v157 offset:1024
    ds_read_b64_tr_b16 a[42:43], v157 offset:1536
    ds_read_b64_tr_b16 a[44:45], v157 offset:7168
    s_mov_b32 exec_hi, 0
    buffer_load_dwordx4 v119, s[8:11], s24 offen offset:3072 lds
    s_mov_b32 exec_hi, -1
    s_add_u32 s24, s24, 458752
    ds_read_b64_tr_b16 a[46:47], v157 offset:7680
    ds_read_b64_tr_b16 a[48:49], v156 offset:2048
    ds_read_b64_tr_b16 a[50:51], v156 offset:2560
    ds_read_b64_tr_b16 a[52:53], v156 offset:8192
    s_waitcnt lgkmcnt(11)
    s_add_u32 m0, s55, 65536
    s_nop 0
    buffer_load_dwordx4 v112, s[4:7], s23 offen offset:0 lds
    ds_read_b64_tr_b16 a[54:55], v156 offset:8704
    ds_read_b64_tr_b16 a[56:57], v157 offset:2048
    ds_read_b64_tr_b16 a[58:59], v157 offset:2560
    buffer_load_dwordx4 v113, s[4:7], s23 offen offset:1024 lds
    ds_read_b64_tr_b16 a[60:61], v157 offset:8192
    ds_read_b64_tr_b16 a[62:63], v157 offset:8704
    ds_read_b64_tr_b16 a[64:65], v156 offset:0
    buffer_load_dwordx4 v114, s[4:7], s23 offen offset:2048 lds
    ds_read_b64_tr_b16 a[66:67], v156 offset:512
    ds_read_b64_tr_b16 a[68:69], v156 offset:6144
    ds_read_b64_tr_b16 a[70:71], v156 offset:6656
    buffer_load_dwordx4 v115, s[4:7], s23 offen offset:3072 lds
    s_add_u32 s23, s23, 128
    ds_read_b64_tr_b16 a[72:73], v157 offset:0
    ds_read_b64_tr_b16 a[74:75], v157 offset:512
    ds_read_b64_tr_b16 a[76:77], v157 offset:6144
    ds_read_b64_tr_b16 a[78:79], v157 offset:6656
    ds_read_b32 v121, v152
    ds_read_b32 v121, v152
    ds_read_b32 v121, v152
    ds_read_b32 v121, v152
    ds_read_b32 v121, v152
    ds_read_b32 v121, v152
    ds_read_b32 v121, v152
    ds_read_b32 v121, v152
    ds_read_b32 v121, v152
    ds_read_b32 v121, v152
    s_waitcnt vmcnt(15) lgkmcnt(10)
    s_barrier
    v_mfma_f32_16x16x32_bf16 v[0:3], a[32:35], a[0:3], v[0:3]
    v_mfma_f32_16x16x32_bf16 v[0:3], a[36:39], a[16:19], v[0:3]
    s_waitcnt vmcnt(8)
    v_lshlrev_b32 v122, 16, v96
    v_mfma_f32_16x16x32_bf16 v[4:7], a[36:39], a[20:23], v[4:7]
    s_load_dwordx2 s[100:101], s[94:95], 774144
    v_and_b32 v123, 0xffff0000, v96
    v_mfma_f32_16x16x32_bf16 v[4:7], a[32:35], a[4:7], v[4:7]
    v_lshlrev_b32 v124, 16, v100
    v_and_b32 v100, 0xffff0000, v100
    v_mfma_f32_16x16x32_bf16 v[8:11], a[32:35], a[8:11], v[8:11]
    s_load_dwordx2 s[100:101], s[94:95], 903168
    v_mul_f32 v124, v124, v122
    v_mfma_f32_16x16x32_bf16 v[8:11], a[36:39], a[24:27], v[8:11]
    v_mul_f32 v100, v100, v123
    v_cvt_pk_bf16_f32 v100, v124, v100
    v_mfma_f32_16x16x32_bf16 v[12:15], a[36:39], a[28:31], v[12:15]
    s_load_dwordx2 s[100:101], s[94:95], 1032192
    v_lshlrev_b32 v125, 16, v104
    v_mfma_f32_16x16x32_bf16 v[12:15], a[32:35], a[12:15], v[12:15]
    v_and_b32 v104, 0xffff0000, v104
    v_mul_f32 v125, v125, v122
    v_mfma_f32_16x16x32_bf16 v[28:31], a[40:43], a[12:15], v[28:31]
    s_add_u32 s94, s94, 1161216
    s_addc_u32 s95, s95, 0
    s_load_dwordx2 s[100:101], s[94:95], 0
    v_mfma_f32_16x16x32_bf16 v[28:31], a[44:47], a[28:31], v[28:31]
    v_mul_f32 v104, v104, v123
    v_cvt_pk_bf16_f32 v104, v125, v104
    v_mfma_f32_16x16x32_bf16 v[24:27], a[44:47], a[24:27], v[24:27]
    s_load_dwordx2 s[100:101], s[94:95], 129024
    v_lshlrev_b32 v122, 16, v97
    v_mfma_f32_16x16x32_bf16 v[24:27], a[40:43], a[8:11], v[24:27]
    v_and_b32 v123, 0xffff0000, v97
    v_lshlrev_b32 v124, 16, v101
    v_mfma_f32_16x16x32_bf16 v[20:23], a[40:43], a[4:7], v[20:23]
    v_and_b32 v101, 0xffff0000, v101
    v_mul_f32 v124, v124, v122
    v_mfma_f32_16x16x32_bf16 v[20:23], a[44:47], a[20:23], v[20:23]
    v_mul_f32 v101, v101, v123
    v_cvt_pk_bf16_f32 v101, v124, v101
    v_mfma_f32_16x16x32_bf16 v[16:19], a[44:47], a[16:19], v[16:19]
    v_lshlrev_b32 v125, 16, v105
    v_and_b32 v105, 0xffff0000, v105
    v_mfma_f32_16x16x32_bf16 v[16:19], a[40:43], a[0:3], v[16:19]
    v_mul_f32 v125, v125, v122
    v_mul_f32 v105, v105, v123
    v_mfma_f32_16x16x32_bf16 v[32:35], a[0:3], a[48:51], v[32:35]
    v_cvt_pk_bf16_f32 v105, v125, v105
    v_lshlrev_b32 v122, 16, v98
    v_mfma_f32_16x16x32_bf16 v[32:35], a[16:19], a[52:55], v[32:35]
    v_and_b32 v123, 0xffff0000, v98
    v_lshlrev_b32 v124, 16, v102
    v_mfma_f32_16x16x32_bf16 v[36:39], a[20:23], a[52:55], v[36:39]
    v_and_b32 v102, 0xffff0000, v102
    v_mul_f32 v124, v124, v122
    v_mfma_f32_16x16x32_bf16 v[36:39], a[4:7], a[48:51], v[36:39]
    v_mul_f32 v102, v102, v123
    v_cvt_pk_bf16_f32 v102, v124, v102
    v_mfma_f32_16x16x32_bf16 v[40:43], a[8:11], a[48:51], v[40:43]
    v_lshlrev_b32 v125, 16, v106
    v_and_b32 v106, 0xffff0000, v106
    v_mfma_f32_16x16x32_bf16 v[40:43], a[24:27], a[52:55], v[40:43]
    v_mul_f32 v125, v125, v122
    v_mul_f32 v106, v106, v123
    v_mfma_f32_16x16x32_bf16 v[44:47], a[28:31], a[52:55], v[44:47]
    v_cvt_pk_bf16_f32 v106, v125, v106
    v_lshlrev_b32 v122, 16, v99
    v_mfma_f32_16x16x32_bf16 v[44:47], a[12:15], a[48:51], v[44:47]
    v_and_b32 v123, 0xffff0000, v99
    v_lshlrev_b32 v124, 16, v103
    v_mfma_f32_16x16x32_bf16 v[60:63], a[12:15], a[56:59], v[60:63]
    v_and_b32 v103, 0xffff0000, v103
    v_mul_f32 v124, v124, v122
    v_mfma_f32_16x16x32_bf16 v[60:63], a[28:31], a[60:63], v[60:63]
    v_mul_f32 v103, v103, v123
    v_cvt_pk_bf16_f32 v103, v124, v103
    v_mfma_f32_16x16x32_bf16 v[56:59], a[24:27], a[60:63], v[56:59]
    v_lshlrev_b32 v125, 16, v107
    v_and_b32 v107, 0xffff0000, v107
    v_mfma_f32_16x16x32_bf16 v[56:59], a[8:11], a[56:59], v[56:59]
    v_mul_f32 v125, v125, v122
    v_mul_f32 v107, v107, v123
    v_mfma_f32_16x16x32_bf16 v[52:55], a[4:7], a[56:59], v[52:55]
    v_cvt_pk_bf16_f32 v107, v125, v107
    v_mfma_f32_16x16x32_bf16 v[134:137], v[108:111], v[100:103], v[134:137]
    v_mfma_f32_16x16x32_bf16 v[52:55], a[20:23], a[60:63], v[52:55]
    v_mfma_f32_16x16x32_bf16 v[138:141], v[108:111], v[104:107], v[138:141]
    s_lshl_b32 s48, s48, 2
    v_mfma_f32_16x16x32_bf16 v[48:51], a[16:19], a[60:63], v[48:51]
    s_add_u32 s48, s48, 35651584
    v_lshrrev_b32 v122, 3, v120
    v_mfma_f32_16x16x32_bf16 v[48:51], a[0:3], a[56:59], v[48:51]
    v_mov_b32 v124, 1073741824
    v_and_b32 v125, 31, v120
    v_mfma_f32_16x16x32_bf16 v[64:67], a[64:67], a[0:3], v[64:67]
    v_cmp_eq_u32 vcc, 0, v125
    s_nop 1
    v_cndmask_b32 v122, v124, v122, vcc
    v_mfma_f32_16x16x32_bf16 v[64:67], a[68:71], a[16:19], v[64:67]
    v_mov_b32_dpp v134, v138 quad_perm:[0,1,2,3] row_mask:0xc bank_mask:0xf
    s_nop 1
    v_add_f32_dpp v134, v134, v134 row_ror:8 row_mask:0xf bank_mask:0xf
    v_mfma_f32_16x16x32_bf16 v[68:71], a[68:71], a[20:23], v[68:71]
    s_nop 0
    v_add_f32_dpp v134, v134, v134 row_ror:4 row_mask:0xf bank_mask:0xf
    s_nop 1
    v_add_f32_dpp v134, v134, v134 row_ror:2 row_mask:0xf bank_mask:0xf
    v_mfma_f32_16x16x32_bf16 v[68:71], a[64:67], a[4:7], v[68:71]
    s_nop 0
    v_add_f32_dpp v134, v134, v134 row_ror:1 row_mask:0xf bank_mask:0xf
    v_cvt_pk_bf16_f32 v134, v134, v134
    v_mfma_f32_16x16x32_bf16 v[72:75], a[64:67], a[8:11], v[72:75]
    v_lshlrev_b32 v134, 16, v134
    v_mul_f32 v134, 0xbfb8aa3b, v134
    v_mfma_f32_16x16x32_bf16 v[72:75], a[68:71], a[24:27], v[72:75]
    v_exp_f32 v134, v134
    v_mfma_f32_16x16x32_bf16 v[76:79], a[68:71], a[28:31], v[76:79]
    v_add_f32 v134, 1.0, v134
    v_rcp_f32 v134, v134
    v_mfma_f32_16x16x32_bf16 v[76:79], a[64:67], a[12:15], v[76:79]
    v_cvt_pk_bf16_f32 v134, v134, v134
    v_lshlrev_b32 v134, 16, v134
    v_mfma_f32_16x16x32_bf16 v[92:95], a[72:75], a[12:15], v[92:95]
    buffer_store_dword v134, v122, s[12:15], s48 offen sc1
    v_mfma_f32_16x16x32_bf16 v[92:95], a[76:79], a[28:31], v[92:95]
    v_mfma_f32_16x16x32_bf16 v[88:91], a[76:79], a[24:27], v[88:91]
    v_mfma_f32_16x16x32_bf16 v[88:91], a[72:75], a[8:11], v[88:91]
    s_setprio 2
    s_barrier
    v_mfma_f32_16x16x32_bf16 v[84:87], a[72:75], a[4:7], v[84:87]
    v_mfma_f32_16x16x32_bf16 v[84:87], a[76:79], a[20:23], v[84:87]
    v_mfma_f32_16x16x32_bf16 v[80:83], a[76:79], a[16:19], v[80:83]
    v_mfma_f32_16x16x32_bf16 v[80:83], a[72:75], a[0:3], v[80:83]
    s_setprio 0
fused_kernel_sa5:
    ds_read_b128 a[0:3], v152 offset:32768
    ds_read_b128 a[16:19], v153 offset:32768
    ds_read_b128 a[4:7], v152 offset:34816
    ds_read_b128 a[20:23], v153 offset:34816
    ds_read_b128 a[8:11], v152 offset:36864
    ds_read_b128 a[24:27], v153 offset:36864
    s_add_u32 m0, s32, 14336
    s_nop 0
    buffer_load_dwordx4 v116, s[8:11], s24 offen offset:0 lds
    ds_read_b128 a[12:15], v152 offset:38912
    ds_read_b128 a[28:31], v153 offset:38912
    ds_read_b64_tr_b16 a[32:33], v156 offset:13312
    buffer_load_dwordx4 v117, s[8:11], s24 offen offset:1024 lds
    ds_read_b64_tr_b16 a[34:35], v156 offset:13824
    ds_read_b64_tr_b16 a[36:37], v156 offset:19456
    ds_read_b64_tr_b16 a[38:39], v156 offset:19968
    buffer_load_dwordx4 v118, s[8:11], s24 offen offset:2048 lds
    ds_read_b64_tr_b16 a[40:41], v157 offset:13312
    ds_read_b64_tr_b16 a[42:43], v157 offset:13824
    ds_read_b64_tr_b16 a[44:45], v157 offset:19456
    s_mov_b32 exec_hi, 0
    buffer_load_dwordx4 v119, s[8:11], s24 offen offset:3072 lds
    s_mov_b32 exec_hi, -1
    s_add_u32 s24, s24, 458752
    ds_read_b64_tr_b16 a[46:47], v157 offset:19968
    ds_read_b64_tr_b16 a[48:49], v156 offset:14336
    ds_read_b64_tr_b16 a[50:51], v156 offset:14848
    ds_read_b64_tr_b16 a[52:53], v156 offset:20480
    s_waitcnt lgkmcnt(11)
    s_add_u32 m0, s55, 32768
    s_nop 0
    buffer_load_dwordx4 v112, s[4:7], s23 offen offset:0 lds
    ds_read_b64_tr_b16 a[54:55], v156 offset:20992
    ds_read_b64_tr_b16 a[56:57], v157 offset:14336
    ds_read_b64_tr_b16 a[58:59], v157 offset:14848
    buffer_load_dwordx4 v113, s[4:7], s23 offen offset:1024 lds
    ds_read_b64_tr_b16 a[60:61], v157 offset:20480
    ds_read_b64_tr_b16 a[62:63], v157 offset:20992
    ds_read_b64_tr_b16 a[64:65], v156 offset:12288
    buffer_load_dwordx4 v114, s[4:7], s23 offen offset:2048 lds
    ds_read_b64_tr_b16 a[66:67], v156 offset:12800
    ds_read_b64_tr_b16 a[68:69], v156 offset:18432
    ds_read_b64_tr_b16 a[70:71], v156 offset:18944
    buffer_load_dwordx4 v115, s[4:7], s23 offen offset:3072 lds
    s_add_u32 s23, s23, 128
    ds_read_b64_tr_b16 a[72:73], v157 offset:12288
    ds_read_b64_tr_b16 a[74:75], v157 offset:12800
    ds_read_b64_tr_b16 a[76:77], v157 offset:18432
    ds_read_b64_tr_b16 a[78:79], v157 offset:18944
    ds_read_b32 v121, v152
    ds_read_b32 v121, v152
    ds_read_b32 v121, v152
    ds_read_b32 v121, v152
    ds_read_b32 v121, v152
    ds_read_b32 v121, v152
    ds_read_b32 v121, v152
    ds_read_b32 v121, v152
    ds_read_b32 v121, v152
    ds_read_b32 v121, v152
    s_waitcnt vmcnt(13) lgkmcnt(10)
    s_barrier
    v_mfma_f32_16x16x32_bf16 v[0:3], a[32:35], a[0:3], v[0:3]
    v_mfma_f32_16x16x32_bf16 v[0:3], a[36:39], a[16:19], v[0:3]
    v_mfma_f32_16x16x32_bf16 v[4:7], a[36:39], a[20:23], v[4:7]
    s_load_dwordx2 s[100:101], s[94:95], 258048
    v_mfma_f32_16x16x32_bf16 v[4:7], a[32:35], a[4:7], v[4:7]
    v_mfma_f32_16x16x32_bf16 v[8:11], a[32:35], a[8:11], v[8:11]
    s_load_dwordx2 s[100:101], s[94:95], 387072
    v_mfma_f32_16x16x32_bf16 v[8:11], a[36:39], a[24:27], v[8:11]
    v_mfma_f32_16x16x32_bf16 v[12:15], a[36:39], a[28:31], v[12:15]
    s_load_dwordx2 s[100:101], s[94:95], 516096
    v_mfma_f32_16x16x32_bf16 v[12:15], a[32:35], a[12:15], v[12:15]
    v_mfma_f32_16x16x32_bf16 v[28:31], a[40:43], a[12:15], v[28:31]
    s_load_dwordx2 s[100:101], s[94:95], 645120
    v_mfma_f32_16x16x32_bf16 v[28:31], a[44:47], a[28:31], v[28:31]
    v_mfma_f32_16x16x32_bf16 v[24:27], a[44:47], a[24:27], v[24:27]
    s_load_dwordx2 s[100:101], s[94:95], 774144
    v_mfma_f32_16x16x32_bf16 v[24:27], a[40:43], a[8:11], v[24:27]
    v_mfma_f32_16x16x32_bf16 v[20:23], a[40:43], a[4:7], v[20:23]
    v_mfma_f32_16x16x32_bf16 v[20:23], a[44:47], a[20:23], v[20:23]
    v_mfma_f32_16x16x32_bf16 v[16:19], a[44:47], a[16:19], v[16:19]
    v_mfma_f32_16x16x32_bf16 v[16:19], a[40:43], a[0:3], v[16:19]
    v_mfma_f32_16x16x32_bf16 v[32:35], a[0:3], a[48:51], v[32:35]
    v_mfma_f32_16x16x32_bf16 v[32:35], a[16:19], a[52:55], v[32:35]
    v_mfma_f32_16x16x32_bf16 v[36:39], a[20:23], a[52:55], v[36:39]
    v_mfma_f32_16x16x32_bf16 v[36:39], a[4:7], a[48:51], v[36:39]
    v_mfma_f32_16x16x32_bf16 v[40:43], a[8:11], a[48:51], v[40:43]
    v_mfma_f32_16x16x32_bf16 v[40:43], a[24:27], a[52:55], v[40:43]
    v_mfma_f32_16x16x32_bf16 v[44:47], a[28:31], a[52:55], v[44:47]
    v_mfma_f32_16x16x32_bf16 v[44:47], a[12:15], a[48:51], v[44:47]
    v_mfma_f32_16x16x32_bf16 v[60:63], a[12:15], a[56:59], v[60:63]
    v_mfma_f32_16x16x32_bf16 v[60:63], a[28:31], a[60:63], v[60:63]
    v_mfma_f32_16x16x32_bf16 v[56:59], a[24:27], a[60:63], v[56:59]
    v_mfma_f32_16x16x32_bf16 v[56:59], a[8:11], a[56:59], v[56:59]
    v_mfma_f32_16x16x32_bf16 v[52:55], a[4:7], a[56:59], v[52:55]
    v_mfma_f32_16x16x32_bf16 v[52:55], a[20:23], a[60:63], v[52:55]
    v_mfma_f32_16x16x32_bf16 v[48:51], a[16:19], a[60:63], v[48:51]
    v_mfma_f32_16x16x32_bf16 v[48:51], a[0:3], a[56:59], v[48:51]
    v_mfma_f32_16x16x32_bf16 v[64:67], a[64:67], a[0:3], v[64:67]
    v_mfma_f32_16x16x32_bf16 v[64:67], a[68:71], a[16:19], v[64:67]
    v_mfma_f32_16x16x32_bf16 v[68:71], a[68:71], a[20:23], v[68:71]
    v_mfma_f32_16x16x32_bf16 v[68:71], a[64:67], a[4:7], v[68:71]
    v_mfma_f32_16x16x32_bf16 v[72:75], a[64:67], a[8:11], v[72:75]
    v_mfma_f32_16x16x32_bf16 v[72:75], a[68:71], a[24:27], v[72:75]
    v_mfma_f32_16x16x32_bf16 v[76:79], a[68:71], a[28:31], v[76:79]
    v_mfma_f32_16x16x32_bf16 v[76:79], a[64:67], a[12:15], v[76:79]
    v_mfma_f32_16x16x32_bf16 v[92:95], a[72:75], a[12:15], v[92:95]
    v_mfma_f32_16x16x32_bf16 v[92:95], a[76:79], a[28:31], v[92:95]
    v_mfma_f32_16x16x32_bf16 v[88:91], a[76:79], a[24:27], v[88:91]
    v_mfma_f32_16x16x32_bf16 v[88:91], a[72:75], a[8:11], v[88:91]
    s_setprio 2
    s_barrier
    v_mfma_f32_16x16x32_bf16 v[84:87], a[72:75], a[4:7], v[84:87]
    v_mfma_f32_16x16x32_bf16 v[84:87], a[76:79], a[20:23], v[84:87]
    v_mfma_f32_16x16x32_bf16 v[80:83], a[76:79], a[16:19], v[80:83]
    v_mfma_f32_16x16x32_bf16 v[80:83], a[72:75], a[0:3], v[80:83]
    s_setprio 0
fused_kernel_sa6:
    ds_read_b128 a[0:3], v152 offset:0
    ds_read_b128 a[16:19], v153 offset:0
    ds_read_b128 a[4:7], v152 offset:2048
    ds_read_b128 a[20:23], v153 offset:2048
    ds_read_b128 a[8:11], v152 offset:4096
    ds_read_b128 a[24:27], v153 offset:4096
    s_add_u32 m0, s32, 0
    s_nop 0
    buffer_load_dwordx4 v116, s[8:11], s24 offen offset:0 lds
    ds_read_b128 a[12:15], v152 offset:6144
    ds_read_b128 a[28:31], v153 offset:6144
    ds_read_b64_tr_b16 a[32:33], v156 offset:1024
    buffer_load_dwordx4 v117, s[8:11], s24 offen offset:1024 lds
    ds_read_b64_tr_b16 a[34:35], v156 offset:1536
    ds_read_b64_tr_b16 a[36:37], v156 offset:7168
    ds_read_b64_tr_b16 a[38:39], v156 offset:7680
    buffer_load_dwordx4 v118, s[8:11], s24 offen offset:2048 lds
    ds_read_b64_tr_b16 a[40:41], v157 offset:1024
    ds_read_b64_tr_b16 a[42:43], v157 offset:1536
    ds_read_b64_tr_b16 a[44:45], v157 offset:7168
    s_mov_b32 exec_hi, 0
    buffer_load_dwordx4 v119, s[8:11], s24 offen offset:3072 lds
    s_mov_b32 exec_hi, -1
    s_add_u32 s24, s24, 458752
    ds_read_b64_tr_b16 a[46:47], v157 offset:7680
    ds_read_b64_tr_b16 a[48:49], v156 offset:2048
    ds_read_b64_tr_b16 a[50:51], v156 offset:2560
    ds_read_b64_tr_b16 a[52:53], v156 offset:8192
    s_waitcnt lgkmcnt(11)
    s_add_u32 m0, s55, 0
    s_nop 0
    buffer_load_dwordx4 v112, s[4:7], s23 offen offset:0 lds
    ds_read_b64_tr_b16 a[54:55], v156 offset:8704
    ds_read_b64_tr_b16 a[56:57], v157 offset:2048
    ds_read_b64_tr_b16 a[58:59], v157 offset:2560
    buffer_load_dwordx4 v113, s[4:7], s23 offen offset:1024 lds
    ds_read_b64_tr_b16 a[60:61], v157 offset:8192
    ds_read_b64_tr_b16 a[62:63], v157 offset:8704
    ds_read_b64_tr_b16 a[64:65], v156 offset:0
    buffer_load_dwordx4 v114, s[4:7], s23 offen offset:2048 lds
    ds_read_b64_tr_b16 a[66:67], v156 offset:512
    ds_read_b64_tr_b16 a[68:69], v156 offset:6144
    ds_read_b64_tr_b16 a[70:71], v156 offset:6656
    buffer_load_dwordx4 v115, s[4:7], s23 offen offset:3072 lds
    s_add_u32 s23, s23, 128
    ds_read_b64_tr_b16 a[72:73], v157 offset:0
    ds_read_b64_tr_b16 a[74:75], v157 offset:512
    ds_read_b64_tr_b16 a[76:77], v157 offset:6144
    ds_read_b64_tr_b16 a[78:79], v157 offset:6656
    ds_read_b32 v121, v152
    ds_read_b32 v121, v152
    ds_read_b32 v121, v152
    ds_read_b32 v121, v152
    ds_read_b32 v121, v152
    ds_read_b32 v121, v152
    ds_read_b32 v121, v152
    ds_read_b32 v121, v152
    ds_read_b32 v121, v152
    ds_read_b32 v121, v152
    s_waitcnt vmcnt(12) lgkmcnt(10)
    s_barrier
    v_mfma_f32_16x16x32_bf16 v[0:3], a[32:35], a[0:3], v[0:3]
    v_mfma_f32_16x16x32_bf16 v[0:3], a[36:39], a[16:19], v[0:3]
    v_mfma_f32_16x16x32_bf16 v[4:7], a[36:39], a[20:23], v[4:7]
    s_load_dwordx2 s[100:101], s[94:95], 903168
    v_mfma_f32_16x16x32_bf16 v[4:7], a[32:35], a[4:7], v[4:7]
    v_mfma_f32_16x16x32_bf16 v[8:11], a[32:35], a[8:11], v[8:11]
    s_load_dwordx2 s[100:101], s[94:95], 1032192
    v_mfma_f32_16x16x32_bf16 v[8:11], a[36:39], a[24:27], v[8:11]
    v_mfma_f32_16x16x32_bf16 v[12:15], a[36:39], a[28:31], v[12:15]
    s_add_u32 s94, s94, 1161216
    s_addc_u32 s95, s95, 0
    s_load_dwordx2 s[100:101], s[94:95], 0
    v_mfma_f32_16x16x32_bf16 v[12:15], a[32:35], a[12:15], v[12:15]
    v_mfma_f32_16x16x32_bf16 v[28:31], a[40:43], a[12:15], v[28:31]
    s_load_dwordx2 s[100:101], s[94:95], 129024
    v_mfma_f32_16x16x32_bf16 v[28:31], a[44:47], a[28:31], v[28:31]
    v_mfma_f32_16x16x32_bf16 v[24:27], a[44:47], a[24:27], v[24:27]
    s_load_dwordx2 s[100:101], s[94:95], 258048
    v_mfma_f32_16x16x32_bf16 v[24:27], a[40:43], a[8:11], v[24:27]
    v_mfma_f32_16x16x32_bf16 v[20:23], a[40:43], a[4:7], v[20:23]
    v_mfma_f32_16x16x32_bf16 v[20:23], a[44:47], a[20:23], v[20:23]
    v_mfma_f32_16x16x32_bf16 v[16:19], a[44:47], a[16:19], v[16:19]
    v_mfma_f32_16x16x32_bf16 v[16:19], a[40:43], a[0:3], v[16:19]
    v_mfma_f32_16x16x32_bf16 v[32:35], a[0:3], a[48:51], v[32:35]
    v_mfma_f32_16x16x32_bf16 v[32:35], a[16:19], a[52:55], v[32:35]
    v_mfma_f32_16x16x32_bf16 v[36:39], a[20:23], a[52:55], v[36:39]
    v_mfma_f32_16x16x32_bf16 v[36:39], a[4:7], a[48:51], v[36:39]
    v_mfma_f32_16x16x32_bf16 v[40:43], a[8:11], a[48:51], v[40:43]
    v_mfma_f32_16x16x32_bf16 v[40:43], a[24:27], a[52:55], v[40:43]
    v_mfma_f32_16x16x32_bf16 v[44:47], a[28:31], a[52:55], v[44:47]
    v_mfma_f32_16x16x32_bf16 v[44:47], a[12:15], a[48:51], v[44:47]
    v_mfma_f32_16x16x32_bf16 v[60:63], a[12:15], a[56:59], v[60:63]
    v_mfma_f32_16x16x32_bf16 v[60:63], a[28:31], a[60:63], v[60:63]
    v_mfma_f32_16x16x32_bf16 v[56:59], a[24:27], a[60:63], v[56:59]
    v_mfma_f32_16x16x32_bf16 v[56:59], a[8:11], a[56:59], v[56:59]
    v_mfma_f32_16x16x32_bf16 v[52:55], a[4:7], a[56:59], v[52:55]
    v_mfma_f32_16x16x32_bf16 v[52:55], a[20:23], a[60:63], v[52:55]
    v_mfma_f32_16x16x32_bf16 v[48:51], a[16:19], a[60:63], v[48:51]
    v_mfma_f32_16x16x32_bf16 v[48:51], a[0:3], a[56:59], v[48:51]
    v_mfma_f32_16x16x32_bf16 v[64:67], a[64:67], a[0:3], v[64:67]
    v_mfma_f32_16x16x32_bf16 v[64:67], a[68:71], a[16:19], v[64:67]
    v_mfma_f32_16x16x32_bf16 v[68:71], a[68:71], a[20:23], v[68:71]
    v_mfma_f32_16x16x32_bf16 v[68:71], a[64:67], a[4:7], v[68:71]
    v_mfma_f32_16x16x32_bf16 v[72:75], a[64:67], a[8:11], v[72:75]
    v_mfma_f32_16x16x32_bf16 v[72:75], a[68:71], a[24:27], v[72:75]
    v_mfma_f32_16x16x32_bf16 v[76:79], a[68:71], a[28:31], v[76:79]
    v_mfma_f32_16x16x32_bf16 v[76:79], a[64:67], a[12:15], v[76:79]
    v_mfma_f32_16x16x32_bf16 v[92:95], a[72:75], a[12:15], v[92:95]
    v_mfma_f32_16x16x32_bf16 v[92:95], a[76:79], a[28:31], v[92:95]
    v_mfma_f32_16x16x32_bf16 v[88:91], a[76:79], a[24:27], v[88:91]
    v_mfma_f32_16x16x32_bf16 v[88:91], a[72:75], a[8:11], v[88:91]
    s_setprio 2
    s_barrier
    v_mfma_f32_16x16x32_bf16 v[84:87], a[72:75], a[4:7], v[84:87]
    v_mfma_f32_16x16x32_bf16 v[84:87], a[76:79], a[20:23], v[84:87]
    v_mfma_f32_16x16x32_bf16 v[80:83], a[76:79], a[16:19], v[80:83]
    v_mfma_f32_16x16x32_bf16 v[80:83], a[72:75], a[0:3], v[80:83]
    s_setprio 0
fused_kernel_sa7:
    ds_read_b128 a[0:3], v154 offset:0
    ds_read_b128 a[16:19], v155 offset:0
    ds_read_b128 a[4:7], v154 offset:2048
    ds_read_b128 a[20:23], v155 offset:2048
    ds_read_b128 a[8:11], v154 offset:4096
    ds_read_b128 a[24:27], v155 offset:4096
    s_add_u32 m0, s32, 14336
    s_nop 0
    buffer_load_dwordx4 v116, s[8:11], s24 offen offset:0 lds
    ds_read_b128 a[12:15], v154 offset:6144
    ds_read_b128 a[28:31], v155 offset:6144
    ds_read_b64_tr_b16 a[32:33], v156 offset:13312
    buffer_load_dwordx4 v117, s[8:11], s24 offen offset:1024 lds
    ds_read_b64_tr_b16 a[34:35], v156 offset:13824
    ds_read_b64_tr_b16 a[36:37], v156 offset:19456
    ds_read_b64_tr_b16 a[38:39], v156 offset:19968
    buffer_load_dwordx4 v118, s[8:11], s24 offen offset:2048 lds
    ds_read_b64_tr_b16 a[40:41], v157 offset:13312
    ds_read_b64_tr_b16 a[42:43], v157 offset:13824
    ds_read_b64_tr_b16 a[44:45], v157 offset:19456
    s_mov_b32 exec_hi, 0
    buffer_load_dwordx4 v119, s[8:11], s24 offen offset:3072 lds
    s_mov_b32 exec_hi, -1
    s_add_u32 s24, s24, 458752
    ds_read_b64_tr_b16 a[46:47], v157 offset:19968
    ds_read_b64_tr_b16 a[48:49], v156 offset:14336
    ds_read_b64_tr_b16 a[50:51], v156 offset:14848
    ds_read_b64_tr_b16 a[52:53], v156 offset:20480
    s_waitcnt lgkmcnt(11)
    s_add_u32 m0, s55, 65536
    s_nop 0
    buffer_load_dwordx4 v112, s[4:7], s23 offen offset:0 lds
    ds_read_b64_tr_b16 a[54:55], v156 offset:20992
    ds_read_b64_tr_b16 a[56:57], v157 offset:14336
    ds_read_b64_tr_b16 a[58:59], v157 offset:14848
    buffer_load_dwordx4 v113, s[4:7], s23 offen offset:1024 lds
    ds_read_b64_tr_b16 a[60:61], v157 offset:20480
    ds_read_b64_tr_b16 a[62:63], v157 offset:20992
    ds_read_b64_tr_b16 a[64:65], v156 offset:12288
    buffer_load_dwordx4 v114, s[4:7], s23 offen offset:2048 lds
    ds_read_b64_tr_b16 a[66:67], v156 offset:12800
    ds_read_b64_tr_b16 a[68:69], v156 offset:18432
    ds_read_b64_tr_b16 a[70:71], v156 offset:18944
    buffer_load_dwordx4 v115, s[4:7], s23 offen offset:3072 lds
    s_add_u32 s23, s23, 128
    ds_read_b64_tr_b16 a[72:73], v157 offset:12288
    ds_read_b64_tr_b16 a[74:75], v157 offset:12800
    ds_read_b64_tr_b16 a[76:77], v157 offset:18432
    ds_read_b64_tr_b16 a[78:79], v157 offset:18944
    ds_read_b32 v121, v152
fused_kernel_pg10:
    s_cbranch_execz fused_kernel_pgrB
    ds_read_b32 v121, v152
    ds_read_b32 v121, v152
    ds_read_b32 v121, v152
    ds_read_b32 v121, v152
    ds_read_b32 v121, v152
    ds_read_b32 v121, v152
    ds_read_b32 v121, v152
    ds_read_b32 v121, v152
    ds_read_b32 v121, v152
    s_waitcnt vmcnt(12) lgkmcnt(10)
    s_barrier
    v_mfma_f32_16x16x32_bf16 v[0:3], a[32:35], a[0:3], v[0:3]
    v_mfma_f32_16x16x32_bf16 v[0:3], a[36:39], a[16:19], v[0:3]
    v_mfma_f32_16x16x32_bf16 v[4:7], a[36:39], a[20:23], v[4:7]
    s_load_dwordx2 s[100:101], s[94:95], 387072
    v_mfma_f32_16x16x32_bf16 v[4:7], a[32:35], a[4:7], v[4:7]
    v_mfma_f32_16x16x32_bf16 v[8:11], a[32:35], a[8:11], v[8:11]
    s_load_dwordx2 s[100:101], s[94:95], 516096
    v_mfma_f32_16x16x32_bf16 v[8:11], a[36:39], a[24:27], v[8:11]
    v_mfma_f32_16x16x32_bf16 v[12:15], a[36:39], a[28:31], v[12:15]
    s_load_dwordx2 s[100:101], s[94:95], 645120
    v_mfma_f32_16x16x32_bf16 v[12:15], a[32:35], a[12:15], v[12:15]
    v_mfma_f32_16x16x32_bf16 v[28:31], a[40:43], a[12:15], v[28:31]
    s_load_dwordx2 s[100:101], s[94:95], 774144
    v_mfma_f32_16x16x32_bf16 v[28:31], a[44:47], a[28:31], v[28:31]
    v_mfma_f32_16x16x32_bf16 v[24:27], a[44:47], a[24:27], v[24:27]
    s_load_dwordx2 s[100:101], s[94:95], 903168
    v_mfma_f32_16x16x32_bf16 v[24:27], a[40:43], a[8:11], v[24:27]
    v_mfma_f32_16x16x32_bf16 v[20:23], a[40:43], a[4:7], v[20:23]
    v_mfma_f32_16x16x32_bf16 v[20:23], a[44:47], a[20:23], v[20:23]
    v_mfma_f32_16x16x32_bf16 v[16:19], a[44:47], a[16:19], v[16:19]
    s_lshl_b32 s40, s28, 5
    buffer_atomic_add v151, v148, s[36:39], s40 offen sc1
    v_mfma_f32_16x16x32_bf16 v[16:19], a[40:43], a[0:3], v[16:19]
    v_mfma_f32_16x16x32_bf16 v[32:35], a[0:3], a[48:51], v[32:35]
    v_mfma_f32_16x16x32_bf16 v[32:35], a[16:19], a[52:55], v[32:35]
    v_mfma_f32_16x16x32_bf16 v[36:39], a[20:23], a[52:55], v[36:39]
    v_mfma_f32_16x16x32_bf16 v[36:39], a[4:7], a[48:51], v[36:39]
    v_mfma_f32_16x16x32_bf16 v[40:43], a[8:11], a[48:51], v[40:43]
    v_mfma_f32_16x16x32_bf16 v[40:43], a[24:27], a[52:55], v[40:43]
    v_mfma_f32_16x16x32_bf16 v[44:47], a[28:31], a[52:55], v[44:47]
    v_mfma_f32_16x16x32_bf16 v[44:47], a[12:15], a[48:51], v[44:47]
    v_mfma_f32_16x16x32_bf16 v[60:63], a[12:15], a[56:59], v[60:63]
    v_mfma_f32_16x16x32_bf16 v[60:63], a[28:31], a[60:63], v[60:63]
    v_mfma_f32_16x16x32_bf16 v[56:59], a[24:27], a[60:63], v[56:59]
    v_mfma_f32_16x16x32_bf16 v[56:59], a[8:11], a[56:59], v[56:59]
    v_mfma_f32_16x16x32_bf16 v[52:55], a[4:7], a[56:59], v[52:55]
    v_mfma_f32_16x16x32_bf16 v[52:55], a[20:23], a[60:63], v[52:55]
    v_mfma_f32_16x16x32_bf16 v[48:51], a[16:19], a[60:63], v[48:51]
    v_mfma_f32_16x16x32_bf16 v[48:51], a[0:3], a[56:59], v[48:51]
    v_mfma_f32_16x16x32_bf16 v[64:67], a[64:67], a[0:3], v[64:67]
    v_mfma_f32_16x16x32_bf16 v[64:67], a[68:71], a[16:19], v[64:67]
    v_mfma_f32_16x16x32_bf16 v[68:71], a[68:71], a[20:23], v[68:71]
    v_mfma_f32_16x16x32_bf16 v[68:71], a[64:67], a[4:7], v[68:71]
    v_mfma_f32_16x16x32_bf16 v[72:75], a[64:67], a[8:11], v[72:75]
    v_mfma_f32_16x16x32_bf16 v[72:75], a[68:71], a[24:27], v[72:75]
    v_mfma_f32_16x16x32_bf16 v[76:79], a[68:71], a[28:31], v[76:79]
    v_mfma_f32_16x16x32_bf16 v[76:79], a[64:67], a[12:15], v[76:79]
    v_mfma_f32_16x16x32_bf16 v[92:95], a[72:75], a[12:15], v[92:95]
    v_mfma_f32_16x16x32_bf16 v[92:95], a[76:79], a[28:31], v[92:95]
    v_mfma_f32_16x16x32_bf16 v[88:91], a[76:79], a[24:27], v[88:91]
    v_mfma_f32_16x16x32_bf16 v[88:91], a[72:75], a[8:11], v[88:91]
    s_setprio 2
    s_barrier
    v_mfma_f32_16x16x32_bf16 v[84:87], a[72:75], a[4:7], v[84:87]
    v_mfma_f32_16x16x32_bf16 v[84:87], a[76:79], a[20:23], v[84:87]
    v_mfma_f32_16x16x32_bf16 v[80:83], a[76:79], a[16:19], v[80:83]
    v_mfma_f32_16x16x32_bf16 v[80:83], a[72:75], a[0:3], v[80:83]
    s_setprio 0
fused_kernel_sa8:
    ds_read_b128 a[0:3], v152 offset:32768
    ds_read_b128 a[16:19], v153 offset:32768
    ds_read_b128 a[4:7], v152 offset:34816
    ds_read_b128 a[20:23], v153 offset:34816
    ds_read_b128 a[8:11], v152 offset:36864
    ds_read_b128 a[24:27], v153 offset:36864
    s_add_u32 m0, s32, 0
    s_nop 0
    buffer_load_dwordx4 v116, s[8:11], s24 offen offset:0 lds
    ds_read_b128 a[12:15], v152 offset:38912
    ds_read_b128 a[28:31], v153 offset:38912
    ds_read_b64_tr_b16 a[32:33], v156 offset:1024
    buffer_load_dwordx4 v117, s[8:11], s24 offen offset:1024 lds
    ds_read_b64_tr_b16 a[34:35], v156 offset:1536
    ds_read_b64_tr_b16 a[36:37], v156 offset:7168
    ds_read_b64_tr_b16 a[38:39], v156 offset:7680
    buffer_load_dwordx4 v118, s[8:11], s24 offen offset:2048 lds
    ds_read_b64_tr_b16 a[40:41], v157 offset:1024
    ds_read_b64_tr_b16 a[42:43], v157 offset:1536
    ds_read_b64_tr_b16 a[44:45], v157 offset:7168
    s_mov_b32 exec_hi, 0
    buffer_load_dwordx4 v119, s[8:11], s24 offen offset:3072 lds
    s_mov_b32 exec_hi, -1
    s_add_u32 s24, s24, 458752
    ds_read_b64_tr_b16 a[46:47], v157 offset:7680
    ds_read_b64_tr_b16 a[48:49], v156 offset:2048
    ds_read_b64_tr_b16 a[50:51], v156 offset:2560
    ds_read_b64_tr_b16 a[52:53], v156 offset:8192
    s_waitcnt lgkmcnt(11)
    s_add_u32 m0, s55, 32768
    s_nop 0
    buffer_load_dwordx4 v112, s[4:7], s23 offen offset:0 lds
    ds_read_b64_tr_b16 a[54:55], v156 offset:8704
    ds_read_b64_tr_b16 a[56:57], v157 offset:2048
    ds_read_b64_tr_b16 a[58:59], v157 offset:2560
    buffer_load_dwordx4 v113, s[4:7], s23 offen offset:1024 lds
    ds_read_b64_tr_b16 a[60:61], v157 offset:8192
    ds_read_b64_tr_b16 a[62:63], v157 offset:8704
    ds_read_b64_tr_b16 a[64:65], v156 offset:0
    buffer_load_dwordx4 v114, s[4:7], s23 offen offset:2048 lds
    ds_read_b64_tr_b16 a[66:67], v156 offset:512
    ds_read_b64_tr_b16 a[68:69], v156 offset:6144
    ds_read_b64_tr_b16 a[70:71], v156 offset:6656
    buffer_load_dwordx4 v115, s[4:7], s23 offen offset:3072 lds
    s_add_u32 s23, s23, 128
    ds_read_b64_tr_b16 a[72:73], v157 offset:0
    ds_read_b64_tr_b16 a[74:75], v157 offset:512
    ds_read_b64_tr_b16 a[76:77], v157 offset:6144
    ds_read_b64_tr_b16 a[78:79], v157 offset:6656
    ds_read_b32 v121, v152
    ds_read_b32 v121, v152
    ds_read_b32 v121, v152
    ds_read_b32 v121, v152
    ds_read_b32 v121, v152
    ds_read_b32 v121, v152
    ds_read_b32 v121, v152
    ds_read_b32 v121, v152
    ds_read_b32 v121, v152
    ds_read_b32 v121, v152
    s_waitcnt vmcnt(13) lgkmcnt(10)
    s_barrier
    v_mfma_f32_16x16x32_bf16 v[0:3], a[32:35], a[0:3], v[0:3]
    v_mfma_f32_16x16x32_bf16 v[0:3], a[36:39], a[16:19], v[0:3]
    v_mfma_f32_16x16x32_bf16 v[4:7], a[36:39], a[20:23], v[4:7]
    s_load_dwordx2 s[100:101], s[94:95], 1032192
    v_mfma_f32_16x16x32_bf16 v[4:7], a[32:35], a[4:7], v[4:7]
    v_mfma_f32_16x16x32_bf16 v[8:11], a[32:35], a[8:11], v[8:11]
    s_add_u32 s94, s94, 1161216
    s_addc_u32 s95, s95, 0
    s_load_dwordx2 s[100:101], s[94:95], 0
    v_mfma_f32_16x16x32_bf16 v[8:11], a[36:39], a[24:27], v[8:11]
    v_mfma_f32_16x16x32_bf16 v[12:15], a[36:39], a[28:31], v[12:15]
    s_load_dwordx2 s[100:101], s[94:95], 28672
    v_mfma_f32_16x16x32_bf16 v[12:15], a[32:35], a[12:15], v[12:15]
    v_mfma_f32_16x16x32_bf16 v[28:31], a[40:43], a[12:15], v[28:31]
    v_mfma_f32_16x16x32_bf16 v[28:31], a[44:47], a[28:31], v[28:31]
    v_mfma_f32_16x16x32_bf16 v[24:27], a[44:47], a[24:27], v[24:27]
    v_mfma_f32_16x16x32_bf16 v[24:27], a[40:43], a[8:11], v[24:27]
    v_mfma_f32_16x16x32_bf16 v[20:23], a[40:43], a[4:7], v[20:23]
    v_mfma_f32_16x16x32_bf16 v[20:23], a[44:47], a[20:23], v[20:23]
    v_mfma_f32_16x16x32_bf16 v[16:19], a[44:47], a[16:19], v[16:19]
    v_mfma_f32_16x16x32_bf16 v[16:19], a[40:43], a[0:3], v[16:19]
    v_mfma_f32_16x16x32_bf16 v[32:35], a[0:3], a[48:51], v[32:35]
    v_mfma_f32_16x16x32_bf16 v[32:35], a[16:19], a[52:55], v[32:35]
    v_mfma_f32_16x16x32_bf16 v[36:39], a[20:23], a[52:55], v[36:39]
    v_mfma_f32_16x16x32_bf16 v[36:39], a[4:7], a[48:51], v[36:39]
    v_mfma_f32_16x16x32_bf16 v[40:43], a[8:11], a[48:51], v[40:43]
    v_mfma_f32_16x16x32_bf16 v[40:43], a[24:27], a[52:55], v[40:43]
    v_mfma_f32_16x16x32_bf16 v[44:47], a[28:31], a[52:55], v[44:47]
    v_mfma_f32_16x16x32_bf16 v[44:47], a[12:15], a[48:51], v[44:47]
    v_mfma_f32_16x16x32_bf16 v[60:63], a[12:15], a[56:59], v[60:63]
    v_mfma_f32_16x16x32_bf16 v[60:63], a[28:31], a[60:63], v[60:63]
    v_mfma_f32_16x16x32_bf16 v[56:59], a[24:27], a[60:63], v[56:59]
    v_mfma_f32_16x16x32_bf16 v[56:59], a[8:11], a[56:59], v[56:59]
    v_mfma_f32_16x16x32_bf16 v[52:55], a[4:7], a[56:59], v[52:55]
    v_mfma_f32_16x16x32_bf16 v[52:55], a[20:23], a[60:63], v[52:55]
    v_mfma_f32_16x16x32_bf16 v[48:51], a[16:19], a[60:63], v[48:51]
    v_mfma_f32_16x16x32_bf16 v[48:51], a[0:3], a[56:59], v[48:51]
    v_mfma_f32_16x16x32_bf16 v[64:67], a[64:67], a[0:3], v[64:67]
    v_mfma_f32_16x16x32_bf16 v[64:67], a[68:71], a[16:19], v[64:67]
    v_mfma_f32_16x16x32_bf16 v[68:71], a[68:71], a[20:23], v[68:71]
    v_mfma_f32_16x16x32_bf16 v[68:71], a[64:67], a[4:7], v[68:71]
    v_mfma_f32_16x16x32_bf16 v[72:75], a[64:67], a[8:11], v[72:75]
    v_mfma_f32_16x16x32_bf16 v[72:75], a[68:71], a[24:27], v[72:75]
    v_mfma_f32_16x16x32_bf16 v[76:79], a[68:71], a[28:31], v[76:79]
    v_mfma_f32_16x16x32_bf16 v[76:79], a[64:67], a[12:15], v[76:79]
    v_mfma_f32_16x16x32_bf16 v[92:95], a[72:75], a[12:15], v[92:95]
    v_mfma_f32_16x16x32_bf16 v[92:95], a[76:79], a[28:31], v[92:95]
    v_mfma_f32_16x16x32_bf16 v[88:91], a[76:79], a[24:27], v[88:91]
    v_mfma_f32_16x16x32_bf16 v[88:91], a[72:75], a[8:11], v[88:91]
    s_setprio 2
    s_barrier
    v_mfma_f32_16x16x32_bf16 v[84:87], a[72:75], a[4:7], v[84:87]
    v_mfma_f32_16x16x32_bf16 v[84:87], a[76:79], a[20:23], v[84:87]
    v_mfma_f32_16x16x32_bf16 v[80:83], a[76:79], a[16:19], v[80:83]
    v_mfma_f32_16x16x32_bf16 v[80:83], a[72:75], a[0:3], v[80:83]
    s_setprio 0
fused_kernel_sa9:
    ds_read_b128 a[0:3], v152 offset:0
    ds_read_b128 a[16:19], v153 offset:0
    ds_read_b128 a[4:7], v152 offset:2048
    ds_read_b128 a[20:23], v153 offset:2048
    ds_read_b128 a[8:11], v152 offset:4096
    ds_read_b128 a[24:27], v153 offset:4096
    s_add_u32 m0, s32, 14336
    s_nop 0
    buffer_load_dwordx4 v116, s[8:11], s24 offen offset:0 lds
    ds_read_b128 a[12:15], v152 offset:6144
    ds_read_b128 a[28:31], v153 offset:6144
    ds_read_b64_tr_b16 a[32:33], v156 offset:13312
    buffer_load_dwordx4 v117, s[8:11], s24 offen offset:1024 lds
    ds_read_b64_tr_b16 a[34:35], v156 offset:13824
    ds_read_b64_tr_b16 a[36:37], v156 offset:19456
    ds_read_b64_tr_b16 a[38:39], v156 offset:19968
    buffer_load_dwordx4 v118, s[8:11], s24 offen offset:2048 lds
    ds_read_b64_tr_b16 a[40:41], v157 offset:13312
    ds_read_b64_tr_b16 a[42:43], v157 offset:13824
    ds_read_b64_tr_b16 a[44:45], v157 offset:19456
    s_mov_b32 exec_hi, 0
    buffer_load_dwordx4 v119, s[8:11], s24 offen offset:3072 lds
    s_mov_b32 exec_hi, -1
    s_add_u32 s24, s24, 458752
    ds_read_b64_tr_b16 a[46:47], v157 offset:19968
    ds_read_b64_tr_b16 a[48:49], v156 offset:14336
    ds_read_b64_tr_b16 a[50:51], v156 offset:14848
    ds_read_b64_tr_b16 a[52:53], v156 offset:20480
    s_waitcnt lgkmcnt(11)
    s_add_u32 m0, s55, 0
    s_nop 0
    buffer_load_dwordx4 v112, s[4:7], s23 offen offset:0 lds
    ds_read_b64_tr_b16 a[54:55], v156 offset:20992
    ds_read_b64_tr_b16 a[56:57], v157 offset:14336
    ds_read_b64_tr_b16 a[58:59], v157 offset:14848
    buffer_load_dwordx4 v113, s[4:7], s23 offen offset:1024 lds
    ds_read_b64_tr_b16 a[60:61], v157 offset:20480
    ds_read_b64_tr_b16 a[62:63], v157 offset:20992
    ds_read_b64_tr_b16 a[64:65], v156 offset:12288
    buffer_load_dwordx4 v114, s[4:7], s23 offen offset:2048 lds
    ds_read_b64_tr_b16 a[66:67], v156 offset:12800
    ds_read_b64_tr_b16 a[68:69], v156 offset:18432
    ds_read_b64_tr_b16 a[70:71], v156 offset:18944
    buffer_load_dwordx4 v115, s[4:7], s23 offen offset:3072 lds
    s_add_u32 s23, s23, 128
    ds_read_b64_tr_b16 a[72:73], v157 offset:12288
    ds_read_b64_tr_b16 a[74:75], v157 offset:12800
    ds_read_b64_tr_b16 a[76:77], v157 offset:18432
    ds_read_b64_tr_b16 a[78:79], v157 offset:18944
    ds_read_b32 v121, v152
    ds_read_b32 v121, v152
    ds_read_b32 v121, v152
    ds_read_b32 v121, v152
    ds_read_b32 v121, v152
    ds_read_b32 v121, v152
    s_waitcnt vmcnt(12) lgkmcnt(6)
    s_barrier
    v_mfma_f32_16x16x32_bf16 v[0:3], a[32:35], a[0:3], v[0:3]
    v_mfma_f32_16x16x32_bf16 v[0:3], a[36:39], a[16:19], v[0:3]
    s_and_b32 s40, s29, 7
    s_mul_i32 s41, s43, 1835008
    v_mfma_f32_16x16x32_bf16 v[4:7], a[36:39], a[20:23], v[4:7]
    s_lshr_b32 s42, s43, 1
    s_lshl_b32 s42, s42, 7
    v_mfma_f32_16x16x32_bf16 v[4:7], a[32:35], a[4:7], v[4:7]
    s_add_u32 s41, s41, s42
    s_lshl_b32 s56, s29, 16
    v_mfma_f32_16x16x32_bf16 v[8:11], a[32:35], a[8:11], v[8:11]
    s_add_u32 s56, s56, s42
    s_lshl_b32 s54, s20, 11
    v_mfma_f32_16x16x32_bf16 v[8:11], a[36:39], a[24:27], v[8:11]
    v_lshrrev_b32 v122, 3, v120
    v_bfe_u32 v123, v120, 1, 2
    v_mfma_f32_16x16x32_bf16 v[12:15], a[36:39], a[28:31], v[12:15]
    v_lshrrev_b32 v124, 4, v120
    v_xor_b32 v123, v123, v124
    v_mfma_f32_16x16x32_bf16 v[12:15], a[32:35], a[12:15], v[12:15]
    s_and_b32 s42, s43, 1
    s_lshl_b32 s42, s42, 1
    v_mfma_f32_16x16x32_bf16 v[28:31], a[40:43], a[12:15], v[28:31]
    v_xor_b32 v123, s42, v123
    v_and_b32 v124, 1, v120
    v_mfma_f32_16x16x32_bf16 v[28:31], a[44:47], a[28:31], v[28:31]
    v_lshlrev_b32 v124, 4, v124
    v_lshl_add_u32 v123, v123, 5, v124
    v_mfma_f32_16x16x32_bf16 v[24:27], a[44:47], a[24:27], v[24:27]
    s_lshl_b32 s42, s40, 8
    v_add_u32 v123, s42, v123
    v_mfma_f32_16x16x32_bf16 v[24:27], a[40:43], a[8:11], v[24:27]
    s_lshl_b32 s42, s20, 3
    v_add_u32 v124, s42, v122
    v_mfma_f32_16x16x32_bf16 v[20:23], a[40:43], a[4:7], v[20:23]
    v_lshl_add_u32 v144, v124, 11, v123
    v_and_b32 v124, 4, v122
    v_mfma_f32_16x16x32_bf16 v[20:23], a[44:47], a[20:23], v[20:23]
    v_add_u32 v124, v124, v122
    s_and_b32 s42, s20, 1
    v_mfma_f32_16x16x32_bf16 v[16:19], a[44:47], a[16:19], v[16:19]
    s_lshl_b32 s42, s42, 4
    s_lshl_b32 s45, s20, 1
    v_mfma_f32_16x16x32_bf16 v[16:19], a[40:43], a[0:3], v[16:19]
    s_and_b32 s45, s45, 4
    s_add_u32 s42, s42, s45
    v_mfma_f32_16x16x32_bf16 v[32:35], a[0:3], a[48:51], v[32:35]
    v_add_u32 v124, s42, v124
    v_lshl_add_u32 v145, v124, 11, v123
    v_mfma_f32_16x16x32_bf16 v[32:35], a[16:19], a[52:55], v[32:35]
    s_xor_b32 s42, s40, 0
    s_mul_i32 s42, s42, 7
    v_mfma_f32_16x16x32_bf16 v[36:39], a[20:23], a[52:55], v[36:39]
    s_add_u32 s42, s42, 1
    s_lshr_b32 s42, s42, 1
    v_mfma_f32_16x16x32_bf16 v[36:39], a[4:7], a[48:51], v[36:39]
    s_lshl_b32 s42, s42, 16
    s_add_u32 s64, s42, s41
    v_mfma_f32_16x16x32_bf16 v[40:43], a[8:11], a[48:51], v[40:43]
    s_xor_b32 s42, s40, 1
    s_mul_i32 s42, s42, 7
    v_mfma_f32_16x16x32_bf16 v[40:43], a[24:27], a[52:55], v[40:43]
    s_add_u32 s42, s42, 1
    s_lshr_b32 s42, s42, 1
    v_mfma_f32_16x16x32_bf16 v[44:47], a[28:31], a[52:55], v[44:47]
    s_lshl_b32 s42, s42, 16
    s_add_u32 s65, s42, s41
    v_mfma_f32_16x16x32_bf16 v[44:47], a[12:15], a[48:51], v[44:47]
    s_xor_b32 s42, s40, 2
    s_mul_i32 s42, s42, 7
    v_mfma_f32_16x16x32_bf16 v[60:63], a[12:15], a[56:59], v[60:63]
    s_add_u32 s42, s42, 1
    s_lshr_b32 s42, s42, 1
    v_mfma_f32_16x16x32_bf16 v[60:63], a[28:31], a[60:63], v[60:63]
    s_lshl_b32 s42, s42, 16
    s_add_u32 s66, s42, s41
    v_mfma_f32_16x16x32_bf16 v[56:59], a[24:27], a[60:63], v[56:59]
    s_xor_b32 s42, s40, 3
    s_mul_i32 s42, s42, 7
    v_mfma_f32_16x16x32_bf16 v[56:59], a[8:11], a[56:59], v[56:59]
    s_add_u32 s42, s42, 1
    s_lshr_b32 s42, s42, 1
    v_mfma_f32_16x16x32_bf16 v[52:55], a[4:7], a[56:59], v[52:55]
    s_lshl_b32 s42, s42, 16
    s_add_u32 s67, s42, s41
    v_mfma_f32_16x16x32_bf16 v[52:55], a[20:23], a[60:63], v[52:55]
    s_xor_b32 s42, s40, 4
    s_mul_i32 s42, s42, 7
    v_mfma_f32_16x16x32_bf16 v[48:51], a[16:19], a[60:63], v[48:51]
    s_add_u32 s42, s42, 1
    s_lshr_b32 s42, s42, 1
    v_mfma_f32_16x16x32_bf16 v[48:51], a[0:3], a[56:59], v[48:51]
    s_lshl_b32 s42, s42, 16
    s_add_u32 s70, s42, s41
    v_mfma_f32_16x16x32_bf16 v[64:67], a[64:67], a[0:3], v[64:67]
    s_xor_b32 s42, s40, 5
    s_mul_i32 s42, s42, 7
    v_mfma_f32_16x16x32_bf16 v[64:67], a[68:71], a[16:19], v[64:67]
    s_add_u32 s42, s42, 1
    s_lshr_b32 s42, s42, 1
    v_mfma_f32_16x16x32_bf16 v[68:71], a[68:71], a[20:23], v[68:71]
    s_lshl_b32 s42, s42, 16
    s_add_u32 s71, s42, s41
    v_mfma_f32_16x16x32_bf16 v[68:71], a[64:67], a[4:7], v[68:71]
    s_xor_b32 s42, s40, 6
    s_mul_i32 s42, s42, 7
    v_mfma_f32_16x16x32_bf16 v[72:75], a[64:67], a[8:11], v[72:75]
    s_add_u32 s42, s42, 1
    s_lshr_b32 s42, s42, 1
    v_mfma_f32_16x16x32_bf16 v[72:75], a[68:71], a[24:27], v[72:75]
    s_lshl_b32 s42, s42, 16
    s_add_u32 s72, s42, s41
    v_mfma_f32_16x16x32_bf16 v[76:79], a[68:71], a[28:31], v[76:79]
    s_xor_b32 s42, s40, 7
    s_mul_i32 s42, s42, 7
    v_mfma_f32_16x16x32_bf16 v[76:79], a[64:67], a[12:15], v[76:79]
    s_add_u32 s42, s42, 1
    s_lshr_b32 s42, s42, 1
    v_mfma_f32_16x16x32_bf16 v[92:95], a[72:75], a[12:15], v[92:95]
    s_lshl_b32 s42, s42, 16
    s_add_u32 s73, s42, s41
    v_mfma_f32_16x16x32_bf16 v[92:95], a[76:79], a[28:31], v[92:95]
    s_and_b32 s42, s40, 1
    s_lshl_b32 s42, s42, 18
    v_mfma_f32_16x16x32_bf16 v[88:91], a[76:79], a[24:27], v[88:91]
    s_sub_u32 s27, 196608, s42
    s_mov_b32 s84, s68
    v_mfma_f32_16x16x32_bf16 v[88:91], a[72:75], a[8:11], v[88:91]
    s_setprio 2
    s_barrier
    v_mfma_f32_16x16x32_bf16 v[84:87], a[72:75], a[4:7], v[84:87]
    v_mfma_f32_16x16x32_bf16 v[84:87], a[76:79], a[20:23], v[84:87]
    v_mfma_f32_16x16x32_bf16 v[80:83], a[76:79], a[16:19], v[80:83]
    v_mfma_f32_16x16x32_bf16 v[80:83], a[72:75], a[0:3], v[80:83]
    s_setprio 0
fused_kernel_sa10:
    ds_read_b128 a[0:3], v154 offset:0
    ds_read_b128 a[16:19], v155 offset:0
    ds_read_b128 a[4:7], v154 offset:2048
    ds_read_b128 a[20:23], v155 offset:2048
    ds_read_b128 a[8:11], v154 offset:4096
    ds_read_b128 a[24:27], v155 offset:4096
    buffer_load_dword v150, v146, s[36:39], 0 offen sc1
    ds_read_b128 a[12:15], v154 offset:6144
    ds_read_b128 a[28:31], v155 offset:6144
    s_add_u32 m0, s32, 0
    s_nop 0
    buffer_load_dwordx4 v116, s[8:11], s24 offen offset:0 lds
    ds_read_b64_tr_b16 a[32:33], v156 offset:1024
    ds_read_b64_tr_b16 a[34:35], v156 offset:1536
    ds_read_b64_tr_b16 a[36:37], v156 offset:7168
    buffer_load_dwordx4 v117, s[8:11], s24 offen offset:1024 lds
    ds_read_b64_tr_b16 a[38:39], v156 offset:7680
    ds_read_b64_tr_b16 a[40:41], v157 offset:1024
    ds_read_b64_tr_b16 a[42:43], v157 offset:1536
    buffer_load_dwordx4 v118, s[8:11], s24 offen offset:2048 lds
    ds_read_b64_tr_b16 a[44:45], v157 offset:7168
    ds_read_b64_tr_b16 a[46:47], v157 offset:7680
    ds_read_b64_tr_b16 a[48:49], v156 offset:2048
    s_mov_b32 exec_hi, 0
    buffer_load_dwordx4 v119, s[8:11], s24 offen offset:3072 lds
    s_mov_b32 exec_hi, -1
    s_add_u32 s24, s24, 458752
    ds_read_b64_tr_b16 a[50:51], v156 offset:2560
    ds_read_b64_tr_b16 a[52:53], v156 offset:8192
    ds_read_b64_tr_b16 a[54:55], v156 offset:8704
    s_waitcnt lgkmcnt(12)
    s_add_u32 m0, s55, 65536
    s_nop 0
    buffer_load_dwordx4 v112, s[4:7], s23 offen offset:0 lds
    ds_read_b64_tr_b16 a[56:57], v157 offset:2048
    ds_read_b64_tr_b16 a[58:59], v157 offset:2560
    ds_read_b64_tr_b16 a[60:61], v157 offset:8192
    buffer_load_dwordx4 v113, s[4:7], s23 offen offset:1024 lds
    ds_read_b64_tr_b16 a[62:63], v157 offset:8704
    ds_read_b64_tr_b16 a[64:65], v156 offset:0
    ds_read_b64_tr_b16 a[66:67], v156 offset:512
    buffer_load_dwordx4 v114, s[4:7], s23 offen offset:2048 lds
    ds_read_b64_tr_b16 a[68:69], v156 offset:6144
    ds_read_b64_tr_b16 a[70:71], v156 offset:6656
    ds_read_b64_tr_b16 a[72:73], v157 offset:0
    buffer_load_dwordx4 v115, s[4:7], s23 offen offset:3072 lds
    s_add_u32 s23, s23, 128
    ds_read_b64_tr_b16 a[74:75], v157 offset:512
    ds_read_b64_tr_b16 a[76:77], v157 offset:6144
    ds_read_b64_tr_b16 a[78:79], v157 offset:6656
    s_waitcnt vmcnt(13) lgkmcnt(0)
    s_barrier
    v_mfma_f32_16x16x32_bf16 v[0:3], a[32:35], a[0:3], v[0:3]
    v_mfma_f32_16x16x32_bf16 v[0:3], a[36:39], a[16:19], v[0:3]
    s_and_b32 s85, s69, 0xffff
    s_mov_b32 s86, 2097152
    v_mfma_f32_16x16x32_bf16 v[4:7], a[36:39], a[20:23], v[4:7]
    v_mfma_f32_16x16x32_bf16 v[4:7], a[32:35], a[4:7], v[4:7]
    v_mfma_f32_16x16x32_bf16 v[8:11], a[32:35], a[8:11], v[8:11]
    v_mfma_f32_16x16x32_bf16 v[8:11], a[36:39], a[24:27], v[8:11]
    v_mfma_f32_16x16x32_bf16 v[12:15], a[36:39], a[28:31], v[12:15]
    v_mfma_f32_16x16x32_bf16 v[12:15], a[32:35], a[12:15], v[12:15]
    v_mfma_f32_16x16x32_bf16 v[28:31], a[40:43], a[12:15], v[28:31]
    v_mfma_f32_16x16x32_bf16 v[28:31], a[44:47], a[28:31], v[28:31]
    v_mfma_f32_16x16x32_bf16 v[24:27], a[44:47], a[24:27], v[24:27]
    v_mfma_f32_16x16x32_bf16 v[24:27], a[40:43], a[8:11], v[24:27]
    v_mfma_f32_16x16x32_bf16 v[20:23], a[40:43], a[4:7], v[20:23]
    v_mfma_f32_16x16x32_bf16 v[20:23], a[44:47], a[20:23], v[20:23]
    v_mfma_f32_16x16x32_bf16 v[16:19], a[44:47], a[16:19], v[16:19]
    v_mfma_f32_16x16x32_bf16 v[16:19], a[40:43], a[0:3], v[16:19]
    v_mfma_f32_16x16x32_bf16 v[32:35], a[0:3], a[48:51], v[32:35]
    v_mfma_f32_16x16x32_bf16 v[32:35], a[16:19], a[52:55], v[32:35]
    v_mfma_f32_16x16x32_bf16 v[36:39], a[20:23], a[52:55], v[36:39]
    v_mfma_f32_16x16x32_bf16 v[36:39], a[4:7], a[48:51], v[36:39]
    v_mfma_f32_16x16x32_bf16 v[40:43], a[8:11], a[48:51], v[40:43]
    v_mfma_f32_16x16x32_bf16 v[40:43], a[24:27], a[52:55], v[40:43]
    v_mfma_f32_16x16x32_bf16 v[44:47], a[28:31], a[52:55], v[44:47]
    v_mfma_f32_16x16x32_bf16 v[44:47], a[12:15], a[48:51], v[44:47]
    v_mfma_f32_16x16x32_bf16 v[60:63], a[12:15], a[56:59], v[60:63]
    v_mfma_f32_16x16x32_bf16 v[60:63], a[28:31], a[60:63], v[60:63]
    v_mfma_f32_16x16x32_bf16 v[56:59], a[24:27], a[60:63], v[56:59]
    v_mfma_f32_16x16x32_bf16 v[56:59], a[8:11], a[56:59], v[56:59]
    v_mfma_f32_16x16x32_bf16 v[52:55], a[4:7], a[56:59], v[52:55]
    v_mfma_f32_16x16x32_bf16 v[52:55], a[20:23], a[60:63], v[52:55]
    v_mfma_f32_16x16x32_bf16 v[48:51], a[16:19], a[60:63], v[48:51]
    v_mfma_f32_16x16x32_bf16 v[48:51], a[0:3], a[56:59], v[48:51]
    v_mfma_f32_16x16x32_bf16 v[64:67], a[64:67], a[0:3], v[64:67]
    v_mfma_f32_16x16x32_bf16 v[64:67], a[68:71], a[16:19], v[64:67]
    v_mfma_f32_16x16x32_bf16 v[68:71], a[68:71], a[20:23], v[68:71]
    v_mfma_f32_16x16x32_bf16 v[68:71], a[64:67], a[4:7], v[68:71]
    v_mfma_f32_16x16x32_bf16 v[72:75], a[64:67], a[8:11], v[72:75]
    v_mfma_f32_16x16x32_bf16 v[72:75], a[68:71], a[24:27], v[72:75]
    v_mfma_f32_16x16x32_bf16 v[76:79], a[68:71], a[28:31], v[76:79]
    v_mfma_f32_16x16x32_bf16 v[76:79], a[64:67], a[12:15], v[76:79]
    v_mfma_f32_16x16x32_bf16 v[92:95], a[72:75], a[12:15], v[92:95]
    v_mfma_f32_16x16x32_bf16 v[92:95], a[76:79], a[28:31], v[92:95]
    v_mfma_f32_16x16x32_bf16 v[88:91], a[76:79], a[24:27], v[88:91]
    v_mfma_f32_16x16x32_bf16 v[88:91], a[72:75], a[8:11], v[88:91]
    s_setprio 2
    s_barrier
    v_mfma_f32_16x16x32_bf16 v[84:87], a[72:75], a[4:7], v[84:87]
    v_mfma_f32_16x16x32_bf16 v[84:87], a[76:79], a[20:23], v[84:87]
    v_mfma_f32_16x16x32_bf16 v[80:83], a[76:79], a[16:19], v[80:83]
    v_mfma_f32_16x16x32_bf16 v[80:83], a[72:75], a[0:3], v[80:83]
    s_setprio 0
fused_kernel_sa11:
    ds_read_b128 a[0:3], v152 offset:32768
    ds_read_b128 a[16:19], v153 offset:32768
    ds_read_b128 a[4:7], v152 offset:34816
    ds_read_b128 a[20:23], v153 offset:34816
    ds_read_b128 a[8:11], v152 offset:36864
    ds_read_b128 a[24:27], v153 offset:36864
    s_add_u32 m0, s32, 14336
    s_nop 0
    buffer_load_dwordx4 v116, s[8:11], s24 offen offset:0 lds
    ds_read_b128 a[12:15], v152 offset:38912
    ds_read_b128 a[28:31], v153 offset:38912
    ds_read_b64_tr_b16 a[32:33], v156 offset:13312
    buffer_load_dwordx4 v117, s[8:11], s24 offen offset:1024 lds
    ds_read_b64_tr_b16 a[34:35], v156 offset:13824
    ds_read_b64_tr_b16 a[36:37], v156 offset:19456
    ds_read_b64_tr_b16 a[38:39], v156 offset:19968
    buffer_load_dwordx4 v118, s[8:11], s24 offen offset:2048 lds
    ds_read_b64_tr_b16 a[40:41], v157 offset:13312
    ds_read_b64_tr_b16 a[42:43], v157 offset:13824
    ds_read_b64_tr_b16 a[44:45], v157 offset:19456
    s_mov_b32 exec_hi, 0
    buffer_load_dwordx4 v119, s[8:11], s24 offen offset:3072 lds
    s_mov_b32 exec_hi, -1
    s_add_u32 s24, s24, 458752
    ds_read_b64_tr_b16 a[46:47], v157 offset:19968
    ds_read_b64_tr_b16 a[48:49], v156 offset:14336
    ds_read_b64_tr_b16 a[50:51], v156 offset:14848
    ds_read_b64_tr_b16 a[52:53], v156 offset:20480
    s_waitcnt lgkmcnt(11)
    s_add_u32 m0, s55, 32768
    s_nop 0
    buffer_load_dwordx4 v112, s[4:7], s23 offen offset:0 lds
    ds_read_b64_tr_b16 a[54:55], v156 offset:20992
    ds_read_b64_tr_b16 a[56:57], v157 offset:14336
    ds_read_b64_tr_b16 a[58:59], v157 offset:14848
    buffer_load_dwordx4 v113, s[4:7], s23 offen offset:1024 lds
    ds_read_b64_tr_b16 a[60:61], v157 offset:20480
    ds_read_b64_tr_b16 a[62:63], v157 offset:20992
    ds_read_b64_tr_b16 a[64:65], v156 offset:12288
    buffer_load_dwordx4 v114, s[4:7], s23 offen offset:2048 lds
    ds_read_b64_tr_b16 a[66:67], v156 offset:12800
    ds_read_b64_tr_b16 a[68:69], v156 offset:18432
    ds_read_b64_tr_b16 a[70:71], v156 offset:18944
    buffer_load_dwordx4 v115, s[4:7], s23 offen offset:3072 lds
    s_add_u32 s23, s23, 128
    ds_read_b64_tr_b16 a[72:73], v157 offset:12288
    ds_read_b64_tr_b16 a[74:75], v157 offset:12800
    ds_read_b64_tr_b16 a[76:77], v157 offset:18432
    ds_read_b64_tr_b16 a[78:79], v157 offset:18944
    s_waitcnt vmcnt(12) lgkmcnt(0)
    s_barrier
    v_mfma_f32_16x16x32_bf16 v[0:3], a[32:35], a[0:3], v[0:3]
    v_mfma_f32_16x16x32_bf16 v[0:3], a[36:39], a[16:19], v[0:3]
    v_mfma_f32_16x16x32_bf16 v[4:7], a[36:39], a[20:23], v[4:7]
    v_mfma_f32_16x16x32_bf16 v[4:7], a[32:35], a[4:7], v[4:7]
    v_mfma_f32_16x16x32_bf16 v[8:11], a[32:35], a[8:11], v[8:11]
    v_mfma_f32_16x16x32_bf16 v[8:11], a[36:39], a[24:27], v[8:11]
    v_mfma_f32_16x16x32_bf16 v[12:15], a[36:39], a[28:31], v[12:15]
    v_mfma_f32_16x16x32_bf16 v[12:15], a[32:35], a[12:15], v[12:15]
    v_mfma_f32_16x16x32_bf16 v[28:31], a[40:43], a[12:15], v[28:31]
    v_mfma_f32_16x16x32_bf16 v[28:31], a[44:47], a[28:31], v[28:31]
    v_mfma_f32_16x16x32_bf16 v[24:27], a[44:47], a[24:27], v[24:27]
    v_mfma_f32_16x16x32_bf16 v[24:27], a[40:43], a[8:11], v[24:27]
    v_mfma_f32_16x16x32_bf16 v[20:23], a[40:43], a[4:7], v[20:23]
    v_mfma_f32_16x16x32_bf16 v[20:23], a[44:47], a[20:23], v[20:23]
    v_mfma_f32_16x16x32_bf16 v[16:19], a[44:47], a[16:19], v[16:19]
    v_mfma_f32_16x16x32_bf16 v[16:19], a[40:43], a[0:3], v[16:19]
    v_mfma_f32_16x16x32_bf16 v[32:35], a[0:3], a[48:51], v[32:35]
    v_mfma_f32_16x16x32_bf16 v[32:35], a[16:19], a[52:55], v[32:35]
    v_mfma_f32_16x16x32_bf16 v[36:39], a[20:23], a[52:55], v[36:39]
    v_mfma_f32_16x16x32_bf16 v[36:39], a[4:7], a[48:51], v[36:39]
    v_mfma_f32_16x16x32_bf16 v[40:43], a[8:11], a[48:51], v[40:43]
    v_mfma_f32_16x16x32_bf16 v[40:43], a[24:27], a[52:55], v[40:43]
    v_mfma_f32_16x16x32_bf16 v[44:47], a[28:31], a[52:55], v[44:47]
    v_mfma_f32_16x16x32_bf16 v[44:47], a[12:15], a[48:51], v[44:47]
    v_mfma_f32_16x16x32_bf16 v[60:63], a[12:15], a[56:59], v[60:63]
    v_mfma_f32_16x16x32_bf16 v[60:63], a[28:31], a[60:63], v[60:63]
    v_mfma_f32_16x16x32_bf16 v[56:59], a[24:27], a[60:63], v[56:59]
    v_mfma_f32_16x16x32_bf16 v[56:59], a[8:11], a[56:59], v[56:59]
    v_mfma_f32_16x16x32_bf16 v[52:55], a[4:7], a[56:59], v[52:55]
    v_mfma_f32_16x16x32_bf16 v[52:55], a[20:23], a[60:63], v[52:55]
    v_mfma_f32_16x16x32_bf16 v[48:51], a[16:19], a[60:63], v[48:51]
    v_mfma_f32_16x16x32_bf16 v[48:51], a[0:3], a[56:59], v[48:51]
    v_mfma_f32_16x16x32_bf16 v[64:67], a[64:67], a[0:3], v[64:67]
    v_mfma_f32_16x16x32_bf16 v[64:67], a[68:71], a[16:19], v[64:67]
    v_mfma_f32_16x16x32_bf16 v[68:71], a[68:71], a[20:23], v[68:71]
    v_mfma_f32_16x16x32_bf16 v[68:71], a[64:67], a[4:7], v[68:71]
    v_mfma_f32_16x16x32_bf16 v[72:75], a[64:67], a[8:11], v[72:75]
    v_mfma_f32_16x16x32_bf16 v[72:75], a[68:71], a[24:27], v[72:75]
    v_mfma_f32_16x16x32_bf16 v[76:79], a[68:71], a[28:31], v[76:79]
    v_mfma_f32_16x16x32_bf16 v[76:79], a[64:67], a[12:15], v[76:79]
fused_kernel_pg11:
    s_cbranch_execz fused_kernel_pgrB
    v_mfma_f32_16x16x32_bf16 v[92:95], a[72:75], a[12:15], v[92:95]
    v_mfma_f32_16x16x32_bf16 v[92:95], a[76:79], a[28:31], v[92:95]
    v_mfma_f32_16x16x32_bf16 v[88:91], a[76:79], a[24:27], v[88:91]
    v_mfma_f32_16x16x32_bf16 v[88:91], a[72:75], a[8:11], v[88:91]
    s_setprio 2
    s_barrier
    v_mfma_f32_16x16x32_bf16 v[84:87], a[72:75], a[4:7], v[84:87]
    v_mfma_f32_16x16x32_bf16 v[84:87], a[76:79], a[20:23], v[84:87]
    v_mfma_f32_16x16x32_bf16 v[80:83], a[76:79], a[16:19], v[80:83]
    v_mfma_f32_16x16x32_bf16 v[80:83], a[72:75], a[0:3], v[80:83]
    s_setprio 0
fused_kernel_sa12:
    ds_read_b128 a[0:3], v152 offset:0
    ds_read_b128 a[16:19], v153 offset:0
    ds_read_b128 a[4:7], v152 offset:2048
    ds_read_b128 a[20:23], v153 offset:2048
    ds_read_b128 a[8:11], v152 offset:4096
    ds_read_b128 a[24:27], v153 offset:4096
    s_add_u32 m0, s32, 0
    s_nop 0
    buffer_load_dwordx4 v116, s[8:11], s24 offen offset:0 lds
    ds_read_b128 a[12:15], v152 offset:6144
    ds_read_b128 a[28:31], v153 offset:6144
    ds_read_b64_tr_b16 a[32:33], v156 offset:1024
    buffer_load_dwordx4 v117, s[8:11], s24 offen offset:1024 lds
    ds_read_b64_tr_b16 a[34:35], v156 offset:1536
    ds_read_b64_tr_b16 a[36:37], v156 offset:7168
    ds_read_b64_tr_b16 a[38:39], v156 offset:7680
    buffer_load_dwordx4 v118, s[8:11], s24 offen offset:2048 lds
    ds_read_b64_tr_b16 a[40:41], v157 offset:1024
    ds_read_b64_tr_b16 a[42:43], v157 offset:1536
    ds_read_b64_tr_b16 a[44:45], v157 offset:7168
    s_mov_b32 exec_hi, 0
    buffer_load_dwordx4 v119, s[8:11], s24 offen offset:3072 lds
    s_mov_b32 exec_hi, -1
    s_add_u32 s24, s24, 458752
    ds_read_b64_tr_b16 a[46:47], v157 offset:7680
    ds_read_b64_tr_b16 a[48:49], v156 offset:2048
    ds_read_b64_tr_b16 a[50:51], v156 offset:2560
    ds_read_b64_tr_b16 a[52:53], v156 offset:8192
    s_waitcnt lgkmcnt(11)
    s_add_u32 m0, s55, 0
    s_nop 0
    buffer_load_dwordx4 v112, s[4:7], s23 offen offset:0 lds
    ds_read_b64_tr_b16 a[54:55], v156 offset:8704
    ds_read_b64_tr_b16 a[56:57], v157 offset:2048
    ds_read_b64_tr_b16 a[58:59], v157 offset:2560
    buffer_load_dwordx4 v113, s[4:7], s23 offen offset:1024 lds
    ds_read_b64_tr_b16 a[60:61], v157 offset:8192
    ds_read_b64_tr_b16 a[62:63], v157 offset:8704
    ds_read_b64_tr_b16 a[64:65], v156 offset:0
    buffer_load_dwordx4 v114, s[4:7], s23 offen offset:2048 lds
    ds_read_b64_tr_b16 a[66:67], v156 offset:512
    ds_read_b64_tr_b16 a[68:69], v156 offset:6144
    ds_read_b64_tr_b16 a[70:71], v156 offset:6656
    buffer_load_dwordx4 v115, s[4:7], s23 offen offset:3072 lds
    s_add_u32 s23, s23, 128
    ds_read_b64_tr_b16 a[72:73], v157 offset:0
    ds_read_b64_tr_b16 a[74:75], v157 offset:512
    ds_read_b64_tr_b16 a[76:77], v157 offset:6144
    ds_read_b64_tr_b16 a[78:79], v157 offset:6656
    v_cmp_ne_u32 vcc, s33, v150
    s_nop 1
    s_cbranch_vccnz fused_kernel_spin_g
fused_kernel_ret_g:
    s_waitcnt vmcnt(12) lgkmcnt(0)
    s_barrier
    v_mfma_f32_16x16x32_bf16 v[0:3], a[32:35], a[0:3], v[0:3]
    v_mfma_f32_16x16x32_bf16 v[0:3], a[36:39], a[16:19], v[0:3]
    v_and_b32 v131, 15, v120
    v_lshlrev_b32 v131, 2, v131
    v_mfma_f32_16x16x32_bf16 v[4:7], a[36:39], a[20:23], v[4:7]
    s_lshl_b32 s22, s28, 10
    s_lshl_b32 s41, s20, 7
    v_mfma_f32_16x16x32_bf16 v[4:7], a[32:35], a[4:7], v[4:7]
    s_add_u32 s22, s22, 35651584
    s_add_u32 s25, s22, s41
    v_mfma_f32_16x16x32_bf16 v[8:11], a[32:35], a[8:11], v[8:11]
    s_sub_u32 s22, s22, s41
    v_mfma_f32_16x16x32_bf16 v[8:11], a[36:39], a[24:27], v[8:11]
    v_mfma_f32_16x16x32_bf16 v[12:15], a[36:39], a[28:31], v[12:15]
    v_mfma_f32_16x16x32_bf16 v[12:15], a[32:35], a[12:15], v[12:15]
    v_mfma_f32_16x16x32_bf16 v[28:31], a[40:43], a[12:15], v[28:31]
    v_mfma_f32_16x16x32_bf16 v[28:31], a[44:47], a[28:31], v[28:31]
    v_mfma_f32_16x16x32_bf16 v[24:27], a[44:47], a[24:27], v[24:27]
    v_mfma_f32_16x16x32_bf16 v[24:27], a[40:43], a[8:11], v[24:27]
    v_mfma_f32_16x16x32_bf16 v[20:23], a[40:43], a[4:7], v[20:23]
    v_mfma_f32_16x16x32_bf16 v[20:23], a[44:47], a[20:23], v[20:23]
    v_mfma_f32_16x16x32_bf16 v[16:19], a[44:47], a[16:19], v[16:19]
    v_mfma_f32_16x16x32_bf16 v[16:19], a[40:43], a[0:3], v[16:19]
    v_mfma_f32_16x16x32_bf16 v[32:35], a[0:3], a[48:51], v[32:35]
    v_mfma_f32_16x16x32_bf16 v[32:35], a[16:19], a[52:55], v[32:35]
    v_mfma_f32_16x16x32_bf16 v[36:39], a[20:23], a[52:55], v[36:39]
    v_mfma_f32_16x16x32_bf16 v[36:39], a[4:7], a[48:51], v[36:39]
    v_mfma_f32_16x16x32_bf16 v[40:43], a[8:11], a[48:51], v[40:43]
    v_mfma_f32_16x16x32_bf16 v[40:43], a[24:27], a[52:55], v[40:43]
    v_mfma_f32_16x16x32_bf16 v[44:47], a[28:31], a[52:55], v[44:47]
    v_mfma_f32_16x16x32_bf16 v[44:47], a[12:15], a[48:51], v[44:47]
    v_mfma_f32_16x16x32_bf16 v[60:63], a[12:15], a[56:59], v[60:63]
    v_mfma_f32_16x16x32_bf16 v[60:63], a[28:31], a[60:63], v[60:63]
    v_mfma_f32_16x16x32_bf16 v[56:59], a[24:27], a[60:63], v[56:59]
    v_mfma_f32_16x16x32_bf16 v[56:59], a[8:11], a[56:59], v[56:59]
    v_mfma_f32_16x16x32_bf16 v[52:55], a[4:7], a[56:59], v[52:55]
    v_mfma_f32_16x16x32_bf16 v[52:55], a[20:23], a[60:63], v[52:55]
    v_mfma_f32_16x16x32_bf16 v[48:51], a[16:19], a[60:63], v[48:51]
    v_mfma_f32_16x16x32_bf16 v[48:51], a[0:3], a[56:59], v[48:51]
    v_mfma_f32_16x16x32_bf16 v[64:67], a[64:67], a[0:3], v[64:67]
    v_mfma_f32_16x16x32_bf16 v[64:67], a[68:71], a[16:19], v[64:67]
    v_mfma_f32_16x16x32_bf16 v[68:71], a[68:71], a[20:23], v[68:71]
    v_mfma_f32_16x16x32_bf16 v[68:71], a[64:67], a[4:7], v[68:71]
    v_mfma_f32_16x16x32_bf16 v[72:75], a[64:67], a[8:11], v[72:75]
    v_mfma_f32_16x16x32_bf16 v[72:75], a[68:71], a[24:27], v[72:75]
    v_mfma_f32_16x16x32_bf16 v[76:79], a[68:71], a[28:31], v[76:79]
    v_mfma_f32_16x16x32_bf16 v[76:79], a[64:67], a[12:15], v[76:79]
    v_mfma_f32_16x16x32_bf16 v[92:95], a[72:75], a[12:15], v[92:95]
    v_mfma_f32_16x16x32_bf16 v[92:95], a[76:79], a[28:31], v[92:95]
    v_mfma_f32_16x16x32_bf16 v[88:91], a[76:79], a[24:27], v[88:91]
    v_mfma_f32_16x16x32_bf16 v[88:91], a[72:75], a[8:11], v[88:91]
    s_setprio 2
    s_barrier
    v_mfma_f32_16x16x32_bf16 v[84:87], a[72:75], a[4:7], v[84:87]
    v_mfma_f32_16x16x32_bf16 v[84:87], a[76:79], a[20:23], v[84:87]
    v_mfma_f32_16x16x32_bf16 v[80:83], a[76:79], a[16:19], v[80:83]
    v_mfma_f32_16x16x32_bf16 v[80:83], a[72:75], a[0:3], v[80:83]
    s_setprio 0
fused_kernel_sa13:
    ds_read_b128 a[0:3], v154 offset:0
    ds_read_b128 a[16:19], v155 offset:0
    ds_read_b128 a[4:7], v154 offset:2048
    ds_read_b128 a[20:23], v155 offset:2048
    ds_read_b128 a[8:11], v154 offset:4096
    ds_read_b128 a[24:27], v155 offset:4096
    s_add_u32 m0, s32, 14336
    s_nop 0
    buffer_load_dwordx4 v116, s[8:11], s24 offen offset:0 lds
    ds_read_b128 a[12:15], v154 offset:6144
    ds_read_b128 a[28:31], v155 offset:6144
    buffer_load_dwordx4 v117, s[8:11], s24 offen offset:1024 lds
    ds_read_b64_tr_b16 a[32:33], v156 offset:13312
    ds_read_b64_tr_b16 a[34:35], v156 offset:13824
    ds_read_b64_tr_b16 a[36:37], v156 offset:19456
    buffer_load_dwordx4 v118, s[8:11], s24 offen offset:2048 lds
    ds_read_b64_tr_b16 a[38:39], v156 offset:19968
    ds_read_b64_tr_b16 a[40:41], v157 offset:13312
    ds_read_b64_tr_b16 a[42:43], v157 offset:13824
    s_mov_b32 exec_hi, 0
    buffer_load_dwordx4 v119, s[8:11], s24 offen offset:3072 lds
    s_mov_b32 exec_hi, -1
    s_add_u32 s24, s24, 458752
    ds_read_b64_tr_b16 a[44:45], v157 offset:19456
    ds_read_b64_tr_b16 a[46:47], v157 offset:19968
    ds_read_b64_tr_b16 a[48:49], v156 offset:14336
    s_mov_b32 s38, 256
    buffer_load_dword v150, v146, s[36:39], s3 offen offset:4 sc1
    ds_read_b64_tr_b16 a[50:51], v156 offset:14848
    ds_read_b64_tr_b16 a[52:53], v156 offset:20480
    ds_read_b64_tr_b16 a[54:55], v156 offset:20992
    buffer_load_dword v140, v131, s[12:15], s22 offen offset:896 sc1
    ds_read_b64_tr_b16 a[56:57], v157 offset:14336
    ds_read_b64_tr_b16 a[58:59], v157 offset:14848
    ds_read_b64_tr_b16 a[60:61], v157 offset:20480
    buffer_load_dword v141, v131, s[12:15], s22 offen offset:960 sc1
    ds_read_b64_tr_b16 a[62:63], v157 offset:20992
    ds_read_b64_tr_b16 a[64:65], v156 offset:12288
    ds_read_b64_tr_b16 a[66:67], v156 offset:12800
    buffer_load_dword v142, v131, s[12:15], s25 offen offset:0 sc1
    ds_read_b64_tr_b16 a[68:69], v156 offset:18432
    ds_read_b64_tr_b16 a[70:71], v156 offset:18944
    ds_read_b64_tr_b16 a[72:73], v157 offset:12288
    buffer_load_dword v143, v131, s[12:15], s25 offen offset:64 sc1
    ds_read_b64_tr_b16 a[74:75], v157 offset:12800
    ds_read_b64_tr_b16 a[76:77], v157 offset:18432
    ds_read_b64_tr_b16 a[78:79], v157 offset:18944
    s_waitcnt vmcnt(13) lgkmcnt(0)
    s_barrier
    v_mfma_f32_16x16x32_bf16 v[0:3], a[32:35], a[0:3], v[0:3]
    v_mfma_f32_16x16x32_bf16 v[0:3], a[36:39], a[16:19], v[0:3]
    s_lshl_b32 s75, s20, 12
    s_sub_u32 s74, 28672, s75
    v_mfma_f32_16x16x32_bf16 v[4:7], a[36:39], a[20:23], v[4:7]
    v_add_u32 v132, s74, v158
    v_add_u32 v133, s75, v158
    v_mfma_f32_16x16x32_bf16 v[4:7], a[32:35], a[4:7], v[4:7]
    s_add_u32 s60, s63, s74
    s_add_u32 s61, s63, s75
    v_mfma_f32_16x16x32_bf16 v[8:11], a[32:35], a[8:11], v[8:11]
    s_sub_u32 s88, s60, 1048576
    s_sub_u32 s89, s61, 1048576
    v_mfma_f32_16x16x32_bf16 v[8:11], a[36:39], a[24:27], v[8:11]
    s_sub_u32 s49, s57, 7680
    s_lshl_b32 s92, s20, 1
    v_mfma_f32_16x16x32_bf16 v[12:15], a[36:39], a[28:31], v[12:15]
    s_add_u32 s92, s92, 2
    s_mov_b32 s90, 0x3e8293ee
    v_mfma_f32_16x16x32_bf16 v[12:15], a[32:35], a[12:15], v[12:15]
    s_mov_b32 s4, s82
    s_mov_b32 s5, s13
    v_mfma_f32_16x16x32_bf16 v[28:31], a[40:43], a[12:15], v[28:31]
    s_mov_b32 s8, s82
    s_mov_b32 s9, s13
    v_mfma_f32_16x16x32_bf16 v[28:31], a[44:47], a[28:31], v[28:31]
    s_cmp_eq_u32 s28, 7
    s_cselect_b32 s10, 0, 67108864
    v_mfma_f32_16x16x32_bf16 v[24:27], a[44:47], a[24:27], v[24:27]
    s_cmp_eq_u32 s28, 0
    s_cselect_b32 s6, 0, 67108864
    v_mfma_f32_16x16x32_bf16 v[24:27], a[40:43], a[8:11], v[24:27]
    s_cselect_b32 s49, s57, s49
    s_cselect_b32 s50, 0, 1
    v_mfma_f32_16x16x32_bf16 v[20:23], a[40:43], a[4:7], v[20:23]
    s_cselect_b32 s91, 0xf149f2ca, 0
    s_cselect_b32 s92, s92, 99
    v_mfma_f32_16x16x32_bf16 v[20:23], a[44:47], a[20:23], v[20:23]
    s_and_b32 s58, s57, 0xffffffe0
    v_and_b32 v149, 7, v120
    v_mfma_f32_16x16x32_bf16 v[16:19], a[44:47], a[16:19], v[16:19]
    v_lshlrev_b32 v149, 2, v149
    s_and_b32 s51, s29, 7
    v_mfma_f32_16x16x32_bf16 v[16:19], a[40:43], a[0:3], v[16:19]
    s_lshl_b32 s51, s51, 12
    s_lshl_b32 s44, s28, 2
    v_mfma_f32_16x16x32_bf16 v[32:35], a[0:3], a[48:51], v[32:35]
    s_add_u32 s44, s44, s20
    s_lshl_b32 s44, s44, 2
    v_mfma_f32_16x16x32_bf16 v[32:35], a[16:19], a[52:55], v[32:35]
    s_add_u32 s44, s44, s43
    s_mul_i32 s44, s44, 147456
    v_mfma_f32_16x16x32_bf16 v[36:39], a[20:23], a[52:55], v[36:39]
    s_add_u32 s44, s44, 114688
    v_mfma_f32_16x16x32_bf16 v[36:39], a[4:7], a[48:51], v[36:39]
    v_mfma_f32_16x16x32_bf16 v[40:43], a[8:11], a[48:51], v[40:43]
    v_mfma_f32_16x16x32_bf16 v[40:43], a[24:27], a[52:55], v[40:43]
    v_mfma_f32_16x16x32_bf16 v[44:47], a[28:31], a[52:55], v[44:47]
    v_mfma_f32_16x16x32_bf16 v[44:47], a[12:15], a[48:51], v[44:47]
    v_mfma_f32_16x16x32_bf16 v[60:63], a[12:15], a[56:59], v[60:63]
    v_mfma_f32_16x16x32_bf16 v[60:63], a[28:31], a[60:63], v[60:63]
    v_mfma_f32_16x16x32_bf16 v[56:59], a[24:27], a[60:63], v[56:59]
    v_mfma_f32_16x16x32_bf16 v[56:59], a[8:11], a[56:59], v[56:59]
    v_mfma_f32_16x16x32_bf16 v[52:55], a[4:7], a[56:59], v[52:55]
    v_mfma_f32_16x16x32_bf16 v[52:55], a[20:23], a[60:63], v[52:55]
    v_mfma_f32_16x16x32_bf16 v[48:51], a[16:19], a[60:63], v[48:51]
    v_mfma_f32_16x16x32_bf16 v[48:51], a[0:3], a[56:59], v[48:51]
    v_mfma_f32_16x16x32_bf16 v[64:67], a[64:67], a[0:3], v[64:67]
    v_mfma_f32_16x16x32_bf16 v[64:67], a[68:71], a[16:19], v[64:67]
    v_mfma_f32_16x16x32_bf16 v[68:71], a[68:71], a[20:23], v[68:71]
    v_mfma_f32_16x16x32_bf16 v[68:71], a[64:67], a[4:7], v[68:71]
    v_mfma_f32_16x16x32_bf16 v[72:75], a[64:67], a[8:11], v[72:75]
    v_mfma_f32_16x16x32_bf16 v[72:75], a[68:71], a[24:27], v[72:75]
    v_mfma_f32_16x16x32_bf16 v[76:79], a[68:71], a[28:31], v[76:79]
    v_mfma_f32_16x16x32_bf16 v[76:79], a[64:67], a[12:15], v[76:79]
    v_mfma_f32_16x16x32_bf16 v[92:95], a[72:75], a[12:15], v[92:95]
    v_mfma_f32_16x16x32_bf16 v[92:95], a[76:79], a[28:31], v[92:95]
    v_mfma_f32_16x16x32_bf16 v[88:91], a[76:79], a[24:27], v[88:91]
    v_mfma_f32_16x16x32_bf16 v[88:91], a[72:75], a[8:11], v[88:91]
    s_setprio 2
    s_barrier
    v_mfma_f32_16x16x32_bf16 v[84:87], a[72:75], a[4:7], v[84:87]
    v_mfma_f32_16x16x32_bf16 v[84:87], a[76:79], a[20:23], v[84:87]
    v_mfma_f32_16x16x32_bf16 v[80:83], a[76:79], a[16:19], v[80:83]
    v_mfma_f32_16x16x32_bf16 v[80:83], a[72:75], a[0:3], v[80:83]
    s_setprio 0
fused_kernel_sa14:
    ds_read_b128 a[0:3], v152 offset:32768
    ds_read_b128 a[16:19], v153 offset:32768
    ds_read_b128 a[4:7], v152 offset:34816
    ds_read_b128 a[20:23], v153 offset:34816
    ds_read_b128 a[8:11], v152 offset:36864
    ds_read_b128 a[24:27], v153 offset:36864
    s_add_u32 m0, s54, 65536
    s_add_u32 s47, s64, 0
    buffer_load_dwordx4 v144, s[16:19], s47 offen lds
    ds_read_b128 a[12:15], v152 offset:38912
    ds_read_b128 a[28:31], v153 offset:38912
    ds_read_b64_tr_b16 a[32:33], v156 offset:1024
    s_add_u32 m0, s54, 66560
    s_xor_b32 s47, s47, 128
    buffer_load_dwordx4 v144, s[16:19], s47 offen lds
    ds_read_b64_tr_b16 a[34:35], v156 offset:1536
    ds_read_b64_tr_b16 a[36:37], v156 offset:7168
    ds_read_b64_tr_b16 a[38:39], v156 offset:7680
    s_add_u32 m0, s54, 73728
    s_add_u32 s47, s64, 65536
    buffer_load_dwordx4 v144, s[16:19], s47 offen lds
    ds_read_b64_tr_b16 a[40:41], v157 offset:1024
    ds_read_b64_tr_b16 a[42:43], v157 offset:1536
    ds_read_b64_tr_b16 a[44:45], v157 offset:7168
    s_add_u32 m0, s54, 74752
    s_xor_b32 s47, s47, 128
    buffer_load_dwordx4 v144, s[16:19], s47 offen lds
    ds_read_b64_tr_b16 a[46:47], v157 offset:7680
    ds_read_b64_tr_b16 a[48:49], v156 offset:2048
    ds_read_b64_tr_b16 a[50:51], v156 offset:2560
    ds_read_b64_tr_b16 a[52:53], v156 offset:8192
    s_add_u32 m0, s54, 81920
    s_add_u32 s47, s64, 131072
    buffer_load_dwordx4 v144, s[16:19], s47 offen lds
    ds_read_b64_tr_b16 a[54:55], v156 offset:8704
    ds_read_b64_tr_b16 a[56:57], v157 offset:2048
    ds_read_b64_tr_b16 a[58:59], v157 offset:2560
    s_add_u32 m0, s54, 82944
    s_xor_b32 s47, s47, 128
    buffer_load_dwordx4 v144, s[16:19], s47 offen lds
    ds_read_b64_tr_b16 a[60:61], v157 offset:8192
    ds_read_b64_tr_b16 a[62:63], v157 offset:8704
    ds_read_b64_tr_b16 a[64:65], v156 offset:0
    s_add_u32 m0, s54, 90112
    s_add_u32 s47, s65, 0
    buffer_load_dwordx4 v144, s[16:19], s47 offen lds
    ds_read_b64_tr_b16 a[66:67], v156 offset:512
    ds_read_b64_tr_b16 a[68:69], v156 offset:6144
    ds_read_b64_tr_b16 a[70:71], v156 offset:6656
    s_add_u32 m0, s54, 91136
    s_xor_b32 s47, s47, 128
    buffer_load_dwordx4 v144, s[16:19], s47 offen lds
    ds_read_b64_tr_b16 a[72:73], v157 offset:0
    ds_read_b64_tr_b16 a[74:75], v157 offset:512
    ds_read_b64_tr_b16 a[76:77], v157 offset:6144
    ds_read_b64_tr_b16 a[78:79], v157 offset:6656
    s_waitcnt vmcnt(13) lgkmcnt(0)
    s_barrier
    v_mfma_f32_16x16x32_bf16 v[0:3], a[32:35], a[0:3], v[0:3]
    v_mfma_f32_16x16x32_bf16 v[0:3], a[36:39], a[16:19], v[0:3]
    s_waitcnt vmcnt(12)
    v_readfirstlane_b32 s26, v150
    v_mfma_f32_16x16x32_bf16 v[4:7], a[36:39], a[20:23], v[4:7]
    v_readlane_b32 s59, v150, 1
    s_nop 0
    s_or_b32 s59, s59, s26
    v_mfma_f32_16x16x32_bf16 v[4:7], a[32:35], a[4:7], v[4:7]
    s_bcnt1_i32_b32 s26, s26
    s_bcnt1_i32_b32 s59, s59
    v_mfma_f32_16x16x32_bf16 v[8:11], a[32:35], a[8:11], v[8:11]
    v_bfe_u32 v138, v158, 4, 4
    v_lshrrev_b32 v139, 8, v158
    v_mfma_f32_16x16x32_bf16 v[8:11], a[36:39], a[24:27], v[8:11]
    v_lshlrev_b32 v139, 2, v139
    v_sub_u32 v138, v138, v139
    v_mfma_f32_16x16x32_bf16 v[12:15], a[36:39], a[28:31], v[12:15]
    v_mov_b32 v139, 0xf149f2ca
    v_mov_b32 v134, s91
    v_mfma_f32_16x16x32_bf16 v[12:15], a[32:35], a[12:15], v[12:15]
    v_mov_b32 v135, 0x3f803f80
    v_cmp_gt_i32 s[30:31], 0, v138
    v_mfma_f32_16x16x32_bf16 v[28:31], a[40:43], a[12:15], v[28:31]
    v_accvgpr_write_b32 a92, v135
    v_cndmask_b32 v120, v139, v134, s[30:31]
    v_mfma_f32_16x16x32_bf16 v[28:31], a[44:47], a[28:31], v[28:31]
    v_cndmask_b32 v124, 0, v139, s[30:31]
    v_cmp_gt_i32 s[30:31], 1, v138
    v_mfma_f32_16x16x32_bf16 v[24:27], a[44:47], a[24:27], v[24:27]
    v_accvgpr_write_b32 a93, v135
    v_cndmask_b32 v121, v139, v134, s[30:31]
    v_mfma_f32_16x16x32_bf16 v[24:27], a[40:43], a[8:11], v[24:27]
    v_cndmask_b32 v125, 0, v139, s[30:31]
    v_cmp_gt_i32 s[30:31], 2, v138
    v_mfma_f32_16x16x32_bf16 v[20:23], a[40:43], a[4:7], v[20:23]
    v_accvgpr_write_b32 a94, v135
    v_cndmask_b32 v122, v139, v134, s[30:31]
    v_mfma_f32_16x16x32_bf16 v[20:23], a[44:47], a[20:23], v[20:23]
    v_cndmask_b32 v126, 0, v139, s[30:31]
    v_cmp_gt_i32 s[30:31], 3, v138
    v_mfma_f32_16x16x32_bf16 v[16:19], a[44:47], a[16:19], v[16:19]
    v_accvgpr_write_b32 a95, v135
    v_cndmask_b32 v123, v139, v134, s[30:31]
    v_mfma_f32_16x16x32_bf16 v[16:19], a[40:43], a[0:3], v[16:19]
    v_cndmask_b32 v127, 0, v139, s[30:31]
    v_mfma_f32_16x16x32_bf16 v[32:35], a[0:3], a[48:51], v[32:35]
    v_mfma_f32_16x16x32_bf16 v[32:35], a[16:19], a[52:55], v[32:35]
    v_mfma_f32_16x16x32_bf16 v[36:39], a[20:23], a[52:55], v[36:39]
    v_mfma_f32_16x16x32_bf16 v[36:39], a[4:7], a[48:51], v[36:39]
    v_mfma_f32_16x16x32_bf16 v[40:43], a[8:11], a[48:51], v[40:43]
    v_mfma_f32_16x16x32_bf16 v[40:43], a[24:27], a[52:55], v[40:43]
    v_mfma_f32_16x16x32_bf16 v[44:47], a[28:31], a[52:55], v[44:47]
    v_mfma_f32_16x16x32_bf16 v[44:47], a[12:15], a[48:51], v[44:47]
    v_mfma_f32_16x16x32_bf16 v[60:63], a[12:15], a[56:59], v[60:63]
    v_mfma_f32_16x16x32_bf16 v[60:63], a[28:31], a[60:63], v[60:63]
    v_mfma_f32_16x16x32_bf16 v[56:59], a[24:27], a[60:63], v[56:59]
    v_mfma_f32_16x16x32_bf16 v[56:59], a[8:11], a[56:59], v[56:59]
    v_mfma_f32_16x16x32_bf16 v[52:55], a[4:7], a[56:59], v[52:55]
    v_mfma_f32_16x16x32_bf16 v[52:55], a[20:23], a[60:63], v[52:55]
    v_mfma_f32_16x16x32_bf16 v[48:51], a[16:19], a[60:63], v[48:51]
    v_mfma_f32_16x16x32_bf16 v[48:51], a[0:3], a[56:59], v[48:51]
    v_mfma_f32_16x16x32_bf16 v[64:67], a[64:67], a[0:3], v[64:67]
    v_mfma_f32_16x16x32_bf16 v[64:67], a[68:71], a[16:19], v[64:67]
    v_mfma_f32_16x16x32_bf16 v[68:71], a[68:71], a[20:23], v[68:71]
    v_mfma_f32_16x16x32_bf16 v[68:71], a[64:67], a[4:7], v[68:71]
    v_mfma_f32_16x16x32_bf16 v[72:75], a[64:67], a[8:11], v[72:75]
    v_mfma_f32_16x16x32_bf16 v[72:75], a[68:71], a[24:27], v[72:75]
    v_mfma_f32_16x16x32_bf16 v[76:79], a[68:71], a[28:31], v[76:79]
    v_mfma_f32_16x16x32_bf16 v[76:79], a[64:67], a[12:15], v[76:79]
    v_mfma_f32_16x16x32_bf16 v[92:95], a[72:75], a[12:15], v[92:95]
    v_mfma_f32_16x16x32_bf16 v[92:95], a[76:79], a[28:31], v[92:95]
    v_mfma_f32_16x16x32_bf16 v[88:91], a[76:79], a[24:27], v[88:91]
    v_mfma_f32_16x16x32_bf16 v[88:91], a[72:75], a[8:11], v[88:91]
    s_setprio 2
    s_barrier
    v_mfma_f32_16x16x32_bf16 v[84:87], a[72:75], a[4:7], v[84:87]
    v_mfma_f32_16x16x32_bf16 v[84:87], a[76:79], a[20:23], v[84:87]
    v_mfma_f32_16x16x32_bf16 v[80:83], a[76:79], a[16:19], v[80:83]
    v_mfma_f32_16x16x32_bf16 v[80:83], a[72:75], a[0:3], v[80:83]
    s_setprio 0
fused_kernel_sa15:
    ds_read_b128 a[0:3], v152 offset:0
    ds_read_b128 a[16:19], v153 offset:0
    ds_read_b128 a[4:7], v152 offset:2048
    ds_read_b128 a[20:23], v153 offset:2048
    ds_read_b128 a[8:11], v152 offset:4096
    ds_read_b128 a[24:27], v153 offset:4096
    s_add_u32 m0, s54, 98304
    s_add_u32 s47, s66, 0
    buffer_load_dwordx4 v144, s[16:19], s47 offen lds
    ds_read_b128 a[12:15], v152 offset:6144
    ds_read_b128 a[28:31], v153 offset:6144
    ds_read_b64_tr_b16 a[32:33], v156 offset:13312
    s_add_u32 m0, s54, 99328
    s_xor_b32 s47, s47, 128
    buffer_load_dwordx4 v144, s[16:19], s47 offen lds
    ds_read_b64_tr_b16 a[34:35], v156 offset:13824
    ds_read_b64_tr_b16 a[36:37], v156 offset:19456
    ds_read_b64_tr_b16 a[38:39], v156 offset:19968
    s_add_u32 m0, s54, 106496
    s_add_u32 s47, s67, 0
    buffer_load_dwordx4 v144, s[16:19], s47 offen lds
    ds_read_b64_tr_b16 a[40:41], v157 offset:13312
    ds_read_b64_tr_b16 a[42:43], v157 offset:13824
    ds_read_b64_tr_b16 a[44:45], v157 offset:19456
    s_add_u32 m0, s54, 107520
    s_xor_b32 s47, s47, 128
    buffer_load_dwordx4 v144, s[16:19], s47 offen lds
    ds_read_b64_tr_b16 a[46:47], v157 offset:19968
    ds_read_b64_tr_b16 a[48:49], v156 offset:14336
    ds_read_b64_tr_b16 a[50:51], v156 offset:14848
    ds_read_b64_tr_b16 a[52:53], v156 offset:20480
    s_add_u32 m0, s54, 114688
    s_add_u32 s47, s70, 0
    buffer_load_dwordx4 v144, s[16:19], s47 offen lds
    ds_read_b64_tr_b16 a[54:55], v156 offset:20992
    ds_read_b64_tr_b16 a[56:57], v157 offset:14336
    ds_read_b64_tr_b16 a[58:59], v157 offset:14848
    s_add_u32 m0, s54, 115712
    s_xor_b32 s47, s47, 128
    buffer_load_dwordx4 v144, s[16:19], s47 offen lds
    ds_read_b64_tr_b16 a[60:61], v157 offset:20480
    ds_read_b64_tr_b16 a[62:63], v157 offset:20992
    ds_read_b64_tr_b16 a[64:65], v156 offset:12288
    s_add_u32 m0, s54, 122880
    s_add_u32 s47, s71, 0
    buffer_load_dwordx4 v144, s[16:19], s47 offen lds
    ds_read_b64_tr_b16 a[66:67], v156 offset:12800
    ds_read_b64_tr_b16 a[68:69], v156 offset:18432
    ds_read_b64_tr_b16 a[70:71], v156 offset:18944
    s_add_u32 m0, s54, 123904
    s_xor_b32 s47, s47, 128
    buffer_load_dwordx4 v144, s[16:19], s47 offen lds
    ds_read_b64_tr_b16 a[72:73], v157 offset:12288
    ds_read_b64_tr_b16 a[74:75], v157 offset:12800
    ds_read_b64_tr_b16 a[76:77], v157 offset:18432
    ds_read_b64_tr_b16 a[78:79], v157 offset:18944
    s_waitcnt vmcnt(8) lgkmcnt(0)
    s_barrier
    s_setprio 1
    v_mfma_f32_16x16x32_bf16 v[0:3], a[32:35], a[0:3], v[0:3]
    v_mfma_f32_16x16x32_bf16 v[0:3], a[36:39], a[16:19], v[0:3]
    v_mfma_f32_16x16x32_bf16 v[4:7], a[36:39], a[20:23], v[4:7]
    v_mfma_f32_16x16x32_bf16 v[4:7], a[32:35], a[4:7], v[4:7]
    v_mfma_f32_16x16x32_bf16 v[8:11], a[32:35], a[8:11], v[8:11]
    v_mfma_f32_16x16x32_bf16 v[8:11], a[36:39], a[24:27], v[8:11]
    v_mfma_f32_16x16x32_bf16 v[12:15], a[36:39], a[28:31], v[12:15]
    v_mfma_f32_16x16x32_bf16 v[12:15], a[32:35], a[12:15], v[12:15]
    v_mfma_f32_16x16x32_bf16 v[28:31], a[40:43], a[12:15], v[28:31]
    v_mfma_f32_16x16x32_bf16 v[28:31], a[44:47], a[28:31], v[28:31]
    v_mfma_f32_16x16x32_bf16 v[24:27], a[44:47], a[24:27], v[24:27]
    v_mfma_f32_16x16x32_bf16 v[24:27], a[40:43], a[8:11], v[24:27]
    v_mfma_f32_16x16x32_bf16 v[20:23], a[40:43], a[4:7], v[20:23]
    v_mfma_f32_16x16x32_bf16 v[20:23], a[44:47], a[20:23], v[20:23]
    s_nop 1
    v_cvt_pk_bf16_f32 v12, v12, v13
    v_cvt_pk_bf16_f32 v13, v14, v15
    v_mfma_f32_16x16x32_bf16 v[16:19], a[44:47], a[16:19], v[16:19]
    v_cvt_pk_bf16_f32 v14, v28, v29
    v_cvt_pk_bf16_f32 v15, v30, v31
    v_mfma_f32_16x16x32_bf16 v[16:19], a[40:43], a[0:3], v[16:19]
    buffer_store_dwordx4 v[12:15], v158, s[8:11], s61 offen offset:1024 sc1
    v_mfma_f32_16x16x32_bf16 v[32:35], a[0:3], a[48:51], v[32:35]
    ds_write_b128 v133, v[12:15] offset:33792
    v_cvt_pk_bf16_f32 v8, v8, v9
    v_mfma_f32_16x16x32_bf16 v[32:35], a[16:19], a[52:55], v[32:35]
    v_cvt_pk_bf16_f32 v9, v10, v11
    v_cvt_pk_bf16_f32 v10, v24, v25
    v_mfma_f32_16x16x32_bf16 v[36:39], a[20:23], a[52:55], v[36:39]
    v_cvt_pk_bf16_f32 v11, v26, v27
    buffer_store_dwordx4 v[8:11], v158, s[8:11], s61 offen offset:0 sc1
    v_mfma_f32_16x16x32_bf16 v[36:39], a[4:7], a[48:51], v[36:39]
    ds_write_b128 v133, v[8:11] offset:32768
    v_cvt_pk_bf16_f32 v4, v4, v5
    v_mfma_f32_16x16x32_bf16 v[40:43], a[8:11], a[48:51], v[40:43]
    v_cvt_pk_bf16_f32 v5, v6, v7
    v_cvt_pk_bf16_f32 v6, v20, v21
    v_mfma_f32_16x16x32_bf16 v[40:43], a[24:27], a[52:55], v[40:43]
    v_cvt_pk_bf16_f32 v7, v22, v23
    buffer_store_dwordx4 v[4:7], v158, s[8:11], s60 offen offset:1024 sc1
    v_mfma_f32_16x16x32_bf16 v[44:47], a[28:31], a[52:55], v[44:47]
    ds_write_b128 v132, v[4:7] offset:33792
    v_cvt_pk_bf16_f32 v0, v0, v1
    v_mfma_f32_16x16x32_bf16 v[44:47], a[12:15], a[48:51], v[44:47]
    v_cvt_pk_bf16_f32 v1, v2, v3
    v_cvt_pk_bf16_f32 v2, v16, v17
    v_mfma_f32_16x16x32_bf16 v[60:63], a[12:15], a[56:59], v[60:63]
    v_cvt_pk_bf16_f32 v3, v18, v19
    buffer_store_dwordx4 v[0:3], v158, s[8:11], s60 offen offset:0 sc1
    v_mfma_f32_16x16x32_bf16 v[60:63], a[28:31], a[60:63], v[60:63]
    ds_write_b128 v132, v[0:3] offset:32768
    v_cvt_pk_bf16_f32 v32, v32, v33
    v_mfma_f32_16x16x32_bf16 v[56:59], a[24:27], a[60:63], v[56:59]
    v_cvt_pk_bf16_f32 v33, v34, v35
    v_cvt_pk_bf16_f32 v34, v36, v37
    v_mfma_f32_16x16x32_bf16 v[56:59], a[8:11], a[56:59], v[56:59]
    v_cvt_pk_bf16_f32 v35, v38, v39
    buffer_store_dwordx4 v[32:35], v158, s[8:11], s60 offen offset:2048 sc1
    v_mfma_f32_16x16x32_bf16 v[52:55], a[4:7], a[56:59], v[52:55]
    ds_write_b128 v132, v[32:35] offset:34816
    v_cvt_pk_bf16_f32 v40, v40, v41
    v_mfma_f32_16x16x32_bf16 v[52:55], a[20:23], a[60:63], v[52:55]
    v_cvt_pk_bf16_f32 v41, v42, v43
    v_cvt_pk_bf16_f32 v42, v44, v45
    v_mfma_f32_16x16x32_bf16 v[48:51], a[16:19], a[60:63], v[48:51]
    v_cvt_pk_bf16_f32 v43, v46, v47
    buffer_store_dwordx4 v[40:43], v158, s[8:11], s61 offen offset:2048 sc1
    v_mfma_f32_16x16x32_bf16 v[48:51], a[0:3], a[56:59], v[48:51]
    ds_write_b128 v133, v[40:43] offset:34816
    v_cvt_pk_bf16_f32 v56, v56, v57
    v_mfma_f32_16x16x32_bf16 v[64:67], a[64:67], a[0:3], v[64:67]
    v_cvt_pk_bf16_f32 v57, v58, v59
    v_cvt_pk_bf16_f32 v58, v60, v61
    v_mfma_f32_16x16x32_bf16 v[64:67], a[68:71], a[16:19], v[64:67]
    v_cvt_pk_bf16_f32 v59, v62, v63
    buffer_store_dwordx4 v[56:59], v158, s[8:11], s61 offen offset:3072 sc1
    v_mfma_f32_16x16x32_bf16 v[68:71], a[68:71], a[20:23], v[68:71]
    ds_write_b128 v133, v[56:59] offset:35840
    v_mfma_f32_16x16x32_bf16 v[68:71], a[64:67], a[4:7], v[68:71]
    v_cvt_pk_bf16_f32 v48, v48, v49
    v_cvt_pk_bf16_f32 v49, v50, v51
    v_mfma_f32_16x16x32_bf16 v[72:75], a[64:67], a[8:11], v[72:75]
    v_cvt_pk_bf16_f32 v50, v52, v53
    v_cvt_pk_bf16_f32 v51, v54, v55
    v_mfma_f32_16x16x32_bf16 v[72:75], a[68:71], a[24:27], v[72:75]
    buffer_store_dwordx4 v[48:51], v158, s[8:11], s60 offen offset:3072 sc1
    v_mfma_f32_16x16x32_bf16 v[76:79], a[68:71], a[28:31], v[76:79]
    ds_write_b128 v132, v[48:51] offset:35840
    s_waitcnt lgkmcnt(0)
    s_barrier
    v_mfma_f32_16x16x32_bf16 v[76:79], a[64:67], a[12:15], v[76:79]
    v_mfma_f32_16x16x32_bf16 v[92:95], a[72:75], a[12:15], v[92:95]
    v_mfma_f32_16x16x32_bf16 v[92:95], a[76:79], a[28:31], v[92:95]
    v_mfma_f32_16x16x32_bf16 v[88:91], a[76:79], a[24:27], v[88:91]
    v_mfma_f32_16x16x32_bf16 v[88:91], a[72:75], a[8:11], v[88:91]
    v_mfma_f32_16x16x32_bf16 v[84:87], a[72:75], a[4:7], v[84:87]
    v_mfma_f32_16x16x32_bf16 v[84:87], a[76:79], a[20:23], v[84:87]
fused_kernel_pg12:
    s_cbranch_execz fused_kernel_pgrB
    v_mfma_f32_16x16x32_bf16 v[80:83], a[76:79], a[16:19], v[80:83]
    v_mfma_f32_16x16x32_bf16 v[80:83], a[72:75], a[0:3], v[80:83]
    v_cvt_pk_bf16_f32 v64, v64, v65
    v_cvt_pk_bf16_f32 v65, v66, v67
    s_nop 5
    v_cvt_pk_bf16_f32 v66, v80, v81
    v_cvt_pk_bf16_f32 v67, v82, v83
    v_cvt_pk_bf16_f32 v68, v68, v69
    v_cvt_pk_bf16_f32 v69, v70, v71
    v_cvt_pk_bf16_f32 v70, v84, v85
    v_cvt_pk_bf16_f32 v71, v86, v87
    v_cvt_pk_bf16_f32 v72, v72, v73
    v_cvt_pk_bf16_f32 v73, v74, v75
    v_cvt_pk_bf16_f32 v74, v88, v89
    v_cvt_pk_bf16_f32 v75, v90, v91
    v_cvt_pk_bf16_f32 v76, v76, v77
    v_cvt_pk_bf16_f32 v77, v78, v79
    v_cvt_pk_bf16_f32 v78, v92, v93
    v_cvt_pk_bf16_f32 v79, v94, v95
    ds_read_b128 a[0:3], v132 offset:16384
    ds_read_b128 a[4:7], v132 offset:17408
    ds_read_b128 a[8:11], v132 offset:20480
    ds_read_b128 a[12:15], v132 offset:21504
    ds_read_b128 a[16:19], v132 offset:24576
    ds_read_b128 a[20:23], v132 offset:25600
    ds_read_b128 a[24:27], v132 offset:28672
    s_add_u32 m0, s54, 131072
    s_add_u32 s47, s72, 0
    buffer_load_dwordx4 v144, s[16:19], s47 offen lds
    s_waitcnt lgkmcnt(5)
    v_mfma_f32_16x16x32_bf16 v[0:3], a[0:3], v[64:67], 0
    v_mfma_f32_16x16x32_bf16 v[4:7], a[0:3], v[68:71], 0
    ds_read_b128 a[28:31], v132 offset:29696
    v_mfma_f32_16x16x32_bf16 v[8:11], a[4:7], v[64:67], 0
    v_mfma_f32_16x16x32_bf16 v[12:15], a[4:7], v[68:71], 0
    ds_read_b128 a[0:3], v132 offset:32768
    s_waitcnt lgkmcnt(5)
    v_mfma_f32_16x16x32_bf16 v[16:19], a[8:11], v[64:67], 0
    v_mfma_f32_16x16x32_bf16 v[20:23], a[8:11], v[68:71], 0
    ds_read_b128 a[4:7], v132 offset:33792
    v_mfma_f32_16x16x32_bf16 v[24:27], a[12:15], v[64:67], 0
    v_max3_f32 v134, v0, v1, v2
    v_max_f32 v134, v134, v3
    v_mfma_f32_16x16x32_bf16 v[28:31], a[12:15], v[68:71], 0
    v_max3_f32 v135, v4, v5, v6
    v_max_f32 v135, v135, v7
    ds_read_b128 a[8:11], v132 offset:18432
    s_waitcnt lgkmcnt(5)
    v_mfma_f32_16x16x32_bf16 v[32:35], a[16:19], v[64:67], 0
    v_max3_f32 v134, v134, v8, v9
    v_max3_f32 v134, v134, v10, v11
    s_add_u32 m0, s54, 132096
    s_xor_b32 s47, s47, 128
    buffer_load_dwordx4 v144, s[16:19], s47 offen lds
    v_mfma_f32_16x16x32_bf16 v[36:39], a[16:19], v[68:71], 0
    v_max3_f32 v135, v135, v12, v13
    v_max3_f32 v135, v135, v14, v15
    ds_read_b128 a[12:15], v132 offset:19456
    v_mfma_f32_16x16x32_bf16 v[40:43], a[20:23], v[64:67], 0
    v_max3_f32 v134, v134, v16, v17
    v_max3_f32 v134, v134, v18, v19
    v_mfma_f32_16x16x32_bf16 v[44:47], a[20:23], v[68:71], 0
    v_max3_f32 v135, v135, v20, v21
    v_max3_f32 v135, v135, v22, v23
    ds_read_b128 a[16:19], v132 offset:22528
    s_waitcnt lgkmcnt(5)
    v_mfma_f32_16x16x32_bf16 v[48:51], a[24:27], v[64:67], 0
    v_max3_f32 v134, v134, v24, v25
    v_max3_f32 v134, v134, v26, v27
    v_mfma_f32_16x16x32_bf16 v[52:55], a[24:27], v[68:71], 0
    v_max3_f32 v135, v135, v28, v29
    v_max3_f32 v135, v135, v30, v31
    ds_read_b128 a[20:23], v132 offset:23552
    v_mfma_f32_16x16x32_bf16 v[56:59], a[28:31], v[64:67], 0
    v_max3_f32 v134, v134, v32, v33
    v_max3_f32 v134, v134, v34, v35
    s_add_u32 m0, s54, 139264
    s_add_u32 s47, s73, 0
    buffer_load_dwordx4 v144, s[16:19], s47 offen lds
    v_mfma_f32_16x16x32_bf16 v[60:63], a[28:31], v[68:71], 0
    v_max3_f32 v135, v135, v36, v37
    v_max3_f32 v135, v135, v38, v39
    ds_read_b128 a[24:27], v132 offset:26624
    s_waitcnt lgkmcnt(5)
    v_mfma_f32_16x16x32_bf16 v[80:83], a[0:3], v[64:67], v[124:127]
    v_max3_f32 v134, v134, v40, v41
    v_max3_f32 v134, v134, v42, v43
    v_mfma_f32_16x16x32_bf16 v[84:87], a[0:3], v[68:71], 0
    v_max3_f32 v135, v135, v44, v45
    v_max3_f32 v135, v135, v46, v47
    ds_read_b128 a[28:31], v132 offset:27648
    v_mfma_f32_16x16x32_bf16 v[92:95], a[4:7], v[68:71], v[124:127]
    v_max3_f32 v134, v134, v48, v49
    v_max3_f32 v134, v134, v50, v51
    v_max3_f32 v135, v135, v52, v53
    v_max3_f32 v135, v135, v54, v55
    v_max3_f32 v134, v134, v56, v57
    v_max3_f32 v134, v134, v58, v59
    v_max3_f32 v135, v135, v60, v61
    v_max3_f32 v135, v135, v62, v63
    v_max3_f32 v134, v134, v80, v81
    s_add_u32 m0, s54, 140288
    s_xor_b32 s47, s47, 128
    buffer_load_dwordx4 v144, s[16:19], s47 offen lds
    v_max3_f32 v134, v134, v82, v83
    v_max3_f32 v135, v135, v84, v85
    v_max3_f32 v135, v135, v86, v87
    v_max3_f32 v135, v135, v92, v93
    v_max3_f32 v135, v135, v94, v95
    v_mov_b32 v138, v134
    v_mov_b32 v139, v135
    s_nop 0
    v_permlane32_swap_b32 v134, v138
    v_permlane32_swap_b32 v135, v139
    v_max_f32 v134, v134, v138
    v_max_f32 v135, v135, v139
    v_mov_b32 v138, v134
    v_mov_b32 v139, v135
    s_nop 0
    v_permlane16_swap_b32 v134, v138
    v_permlane16_swap_b32 v135, v139
    v_max_f32 v134, v134, v138
    v_max_f32 v135, v135, v139
    v_mul_f32 v136, s90, v134
    v_mul_f32 v137, s90, v135
    s_waitcnt vmcnt(4)
    s_cmp_lg_u32 s59, 1
    s_cbranch_scc1 fused_kernel_sfkv
    buffer_store_dword v151, v148, s[8:11], s57 offen offset:512
fused_kernel_sfrkv:
    v_fma_f32 v0, v0, s90, -v136
    s_add_u32 m0, s54, 147456
    s_add_u32 s47, s65, 65536
    buffer_load_dwordx4 v144, s[16:19], s47 offen lds
    v_fma_f32 v1, v1, s90, -v136
    v_fma_f32 v2, v2, s90, -v136
    v_fma_f32 v3, v3, s90, -v136
    v_fma_f32 v4, v4, s90, -v137
    v_fma_f32 v5, v5, s90, -v137
    v_fma_f32 v6, v6, s90, -v137
    v_fma_f32 v7, v7, s90, -v137
    v_fma_f32 v8, v8, s90, -v136
    v_fma_f32 v9, v9, s90, -v136
    v_fma_f32 v10, v10, s90, -v136
    v_fma_f32 v11, v11, s90, -v136
    v_fma_f32 v12, v12, s90, -v137
    v_fma_f32 v13, v13, s90, -v137
    v_fma_f32 v14, v14, s90, -v137
    v_fma_f32 v15, v15, s90, -v137
    v_exp_f32 v0, v0
    v_exp_f32 v1, v1
    v_exp_f32 v2, v2
    v_exp_f32 v3, v3
    v_exp_f32 v4, v4
    v_exp_f32 v5, v5
    v_exp_f32 v6, v6
    s_add_u32 m0, s54, 148480
    s_xor_b32 s47, s47, 128
    buffer_load_dwordx4 v144, s[16:19], s47 offen lds
    v_exp_f32 v7, v7
    v_exp_f32 v8, v8
    v_exp_f32 v9, v9
    v_exp_f32 v10, v10
    v_exp_f32 v11, v11
    v_exp_f32 v12, v12
    v_exp_f32 v13, v13
    v_exp_f32 v14, v14
    v_exp_f32 v15, v15
    v_cvt_pk_bf16_f32 v0, v0, v1
    v_cvt_pk_bf16_f32 v1, v2, v3
    v_cvt_pk_bf16_f32 v2, v8, v9
    v_cvt_pk_bf16_f32 v3, v10, v11
    v_cvt_pk_bf16_f32 v4, v4, v5
    v_cvt_pk_bf16_f32 v5, v6, v7
    v_cvt_pk_bf16_f32 v6, v12, v13
    v_cvt_pk_bf16_f32 v7, v14, v15
    buffer_load_dword v146, v147, s[12:15], s49 offen sc1
    s_waitcnt lgkmcnt(4)
    v_fma_f32 v16, v16, s90, -v136
    v_fma_f32 v17, v17, s90, -v136
    s_add_u32 m0, s54, 155648
    s_add_u32 s47, s66, 65536
    buffer_load_dwordx4 v144, s[16:19], s47 offen lds
    v_mfma_f32_16x16x32_bf16 v[96:99], a[8:11], v[0:3], 0
    v_fma_f32 v18, v18, s90, -v136
    v_fma_f32 v19, v19, s90, -v136
    v_fma_f32 v20, v20, s90, -v137
    v_fma_f32 v21, v21, s90, -v137
    v_fma_f32 v22, v22, s90, -v137
    v_fma_f32 v23, v23, s90, -v137
    v_mfma_f32_16x16x32_bf16 v[100:103], a[12:15], v[0:3], 0
    v_fma_f32 v24, v24, s90, -v136
    v_fma_f32 v25, v25, s90, -v136
    v_fma_f32 v26, v26, s90, -v136
    v_fma_f32 v27, v27, s90, -v136
    v_fma_f32 v28, v28, s90, -v137
    v_fma_f32 v29, v29, s90, -v137
    v_mfma_f32_16x16x32_bf16 v[104:107], a[92:95], v[0:3], 0
    v_fma_f32 v30, v30, s90, -v137
    v_fma_f32 v31, v31, s90, -v137
    v_exp_f32 v16, v16
    v_exp_f32 v17, v17
    v_exp_f32 v18, v18
    v_exp_f32 v19, v19
    v_mfma_f32_16x16x32_bf16 v[108:111], a[8:11], v[4:7], 0
    s_add_u32 m0, s54, 156672
    s_xor_b32 s47, s47, 128
    buffer_load_dwordx4 v144, s[16:19], s47 offen lds
    v_exp_f32 v20, v20
    v_exp_f32 v21, v21
    v_exp_f32 v22, v22
    v_exp_f32 v23, v23
    v_exp_f32 v24, v24
    v_exp_f32 v25, v25
    v_mfma_f32_16x16x32_bf16 v[112:115], a[12:15], v[4:7], 0
    v_exp_f32 v26, v26
    v_exp_f32 v27, v27
    v_exp_f32 v28, v28
    v_exp_f32 v29, v29
    v_exp_f32 v30, v30
    v_exp_f32 v31, v31
    v_mfma_f32_16x16x32_bf16 v[116:119], a[92:95], v[4:7], 0
    v_cvt_pk_bf16_f32 v16, v16, v17
    v_cvt_pk_bf16_f32 v17, v18, v19
    v_cvt_pk_bf16_f32 v18, v24, v25
    v_cvt_pk_bf16_f32 v19, v26, v27
    v_cvt_pk_bf16_f32 v20, v20, v21
    v_cvt_pk_bf16_f32 v21, v22, v23
    v_cvt_pk_bf16_f32 v22, v28, v29
    v_cvt_pk_bf16_f32 v23, v30, v31
    ds_read_b128 a[0:3], v132 offset:30720
    ds_read_b128 a[4:7], v132 offset:31744
    ds_read_b128 a[8:11], v132 offset:34816
    s_waitcnt lgkmcnt(5)
    v_fma_f32 v32, v32, s90, -v136
    v_fma_f32 v33, v33, s90, -v136
    v_mfma_f32_16x16x32_bf16 v[96:99], a[16:19], v[16:19], v[96:99]
    v_fma_f32 v34, v34, s90, -v136
    v_fma_f32 v35, v35, s90, -v136
    v_fma_f32 v36, v36, s90, -v137
    v_fma_f32 v37, v37, s90, -v137
    v_fma_f32 v38, v38, s90, -v137
    v_fma_f32 v39, v39, s90, -v137
    v_mfma_f32_16x16x32_bf16 v[100:103], a[20:23], v[16:19], v[100:103]
    v_fma_f32 v40, v40, s90, -v136
    v_fma_f32 v41, v41, s90, -v136
    v_fma_f32 v42, v42, s90, -v136
    v_fma_f32 v43, v43, s90, -v136
    v_fma_f32 v44, v44, s90, -v137
    v_fma_f32 v45, v45, s90, -v137
    v_mfma_f32_16x16x32_bf16 v[104:107], a[92:95], v[16:19], v[104:107]
    v_fma_f32 v46, v46, s90, -v137
    v_fma_f32 v47, v47, s90, -v137
    v_exp_f32 v32, v32
    v_exp_f32 v33, v33
    v_exp_f32 v34, v34
    v_exp_f32 v35, v35
    v_mfma_f32_16x16x32_bf16 v[108:111], a[16:19], v[20:23], v[108:111]
    v_exp_f32 v36, v36
    v_exp_f32 v37, v37
    v_exp_f32 v38, v38
    v_exp_f32 v39, v39
    v_exp_f32 v40, v40
    v_exp_f32 v41, v41
    v_mfma_f32_16x16x32_bf16 v[112:115], a[20:23], v[20:23], v[112:115]
    v_exp_f32 v42, v42
    v_exp_f32 v43, v43
    v_exp_f32 v44, v44
    v_exp_f32 v45, v45
    v_exp_f32 v46, v46
    v_exp_f32 v47, v47
    v_mfma_f32_16x16x32_bf16 v[116:119], a[92:95], v[20:23], v[116:119]
    v_cvt_pk_bf16_f32 v32, v32, v33
    v_cvt_pk_bf16_f32 v33, v34, v35
    v_cvt_pk_bf16_f32 v34, v40, v41
    v_cvt_pk_bf16_f32 v35, v42, v43
    v_cvt_pk_bf16_f32 v36, v36, v37
    v_cvt_pk_bf16_f32 v37, v38, v39
    v_cvt_pk_bf16_f32 v38, v44, v45
    v_cvt_pk_bf16_f32 v39, v46, v47
    ds_read_b128 a[12:15], v132 offset:35840
    s_waitcnt vmcnt(2)
    v_cmp_gt_u32 vcc, s50, v146
    s_nop 1
    s_cbranch_vccnz fused_kernel_spin_kv
fused_kernel_ret_kv:
    s_mov_b32 m0, s74
    s_nop 0
    buffer_load_dwordx4 v158, s[4:7], s88 offen offset:0 sc1 lds
    s_mov_b32 m0, s74
    s_nop 0
    buffer_load_dwordx4 v158, s[4:7], s88 offen offset:1024 sc1 lds
    s_mov_b32 m0, s74
    s_nop 0
    buffer_load_dwordx4 v158, s[4:7], s88 offen offset:2048 sc1 lds
    s_mov_b32 m0, s74
    s_nop 0
    buffer_load_dwordx4 v158, s[4:7], s88 offen offset:3072 sc1 lds
    s_mov_b32 m0, s75
    s_nop 0
    buffer_load_dwordx4 v158, s[4:7], s89 offen offset:0 sc1 lds
    s_mov_b32 m0, s75
    s_nop 0
    buffer_load_dwordx4 v158, s[4:7], s89 offen offset:1024 sc1 lds
    s_mov_b32 m0, s75
    s_nop 0
    buffer_load_dwordx4 v158, s[4:7], s89 offen offset:2048 sc1 lds
    s_mov_b32 m0, s75
    s_nop 0
    buffer_load_dwordx4 v158, s[4:7], s89 offen offset:3072 sc1 lds
    s_waitcnt lgkmcnt(4)
    v_fma_f32 v48, v48, s90, -v136
    v_fma_f32 v49, v49, s90, -v136
    v_mfma_f32_16x16x32_bf16 v[96:99], a[24:27], v[32:35], v[96:99]
    v_fma_f32 v50, v50, s90, -v136
    v_fma_f32 v51, v51, s90, -v136
    v_fma_f32 v52, v52, s90, -v137
    v_fma_f32 v53, v53, s90, -v137
    v_fma_f32 v54, v54, s90, -v137
    v_fma_f32 v55, v55, s90, -v137
    v_mfma_f32_16x16x32_bf16 v[100:103], a[28:31], v[32:35], v[100:103]
    v_fma_f32 v56, v56, s90, -v136
    v_fma_f32 v57, v57, s90, -v136
    v_fma_f32 v58, v58, s90, -v136
    v_fma_f32 v59, v59, s90, -v136
    v_fma_f32 v60, v60, s90, -v137
    v_fma_f32 v61, v61, s90, -v137
    v_mfma_f32_16x16x32_bf16 v[104:107], a[92:95], v[32:35], v[104:107]
    v_fma_f32 v62, v62, s90, -v137
    v_fma_f32 v63, v63, s90, -v137
    v_exp_f32 v48, v48
    v_exp_f32 v49, v49
    v_exp_f32 v50, v50
    v_exp_f32 v51, v51
    v_mfma_f32_16x16x32_bf16 v[108:111], a[24:27], v[36:39], v[108:111]
    v_exp_f32 v52, v52
    v_exp_f32 v53, v53
    v_exp_f32 v54, v54
    v_exp_f32 v55, v55
    v_exp_f32 v56, v56
    v_exp_f32 v57, v57
    v_mfma_f32_16x16x32_bf16 v[112:115], a[28:31], v[36:39], v[112:115]
    v_exp_f32 v58, v58
    v_exp_f32 v59, v59
    v_exp_f32 v60, v60
    v_exp_f32 v61, v61
    v_exp_f32 v62, v62
    v_exp_f32 v63, v63
    v_mfma_f32_16x16x32_bf16 v[116:119], a[92:95], v[36:39], v[116:119]
    v_cvt_pk_bf16_f32 v48, v48, v49
    v_cvt_pk_bf16_f32 v49, v50, v51
    v_cvt_pk_bf16_f32 v50, v56, v57
    v_cvt_pk_bf16_f32 v51, v58, v59
    v_cvt_pk_bf16_f32 v52, v52, v53
    v_cvt_pk_bf16_f32 v53, v54, v55
    v_cvt_pk_bf16_f32 v54, v60, v61
    v_cvt_pk_bf16_f32 v55, v62, v63
    s_waitcnt lgkmcnt(2)
    v_fma_f32 v80, v80, s90, -v136
    v_fma_f32 v81, v81, s90, -v136
    v_mfma_f32_16x16x32_bf16 v[96:99], a[0:3], v[48:51], v[96:99]
    v_fma_f32 v82, v82, s90, -v136
    v_fma_f32 v83, v83, s90, -v136
    v_fma_f32 v84, v84, s90, -v137
    v_fma_f32 v85, v85, s90, -v137
    v_fma_f32 v86, v86, s90, -v137
    v_mfma_f32_16x16x32_bf16 v[100:103], a[4:7], v[48:51], v[100:103]
    v_fma_f32 v87, v87, s90, -v137
    v_fma_f32 v92, v92, s90, -v137
    v_fma_f32 v93, v93, s90, -v137
    v_fma_f32 v94, v94, s90, -v137
    v_fma_f32 v95, v95, s90, -v137
    v_mfma_f32_16x16x32_bf16 v[104:107], a[92:95], v[48:51], v[104:107]
    v_exp_f32 v80, v80
    v_exp_f32 v81, v81
    v_exp_f32 v82, v82
    v_exp_f32 v83, v83
    v_exp_f32 v84, v84
    v_mfma_f32_16x16x32_bf16 v[108:111], a[0:3], v[52:55], v[108:111]
    v_exp_f32 v85, v85
    v_exp_f32 v86, v86
    v_exp_f32 v87, v87
    v_exp_f32 v92, v92
    v_exp_f32 v93, v93
    v_mfma_f32_16x16x32_bf16 v[112:115], a[4:7], v[52:55], v[112:115]
    v_exp_f32 v94, v94
    v_exp_f32 v95, v95
    v_cvt_pk_bf16_f32 v80, v80, v81
    v_cvt_pk_bf16_f32 v81, v82, v83
    v_mov_b32 v82, 0
    v_mfma_f32_16x16x32_bf16 v[116:119], a[92:95], v[52:55], v[116:119]
    v_mov_b32 v83, 0
    v_cvt_pk_bf16_f32 v84, v84, v85
    v_cvt_pk_bf16_f32 v85, v86, v87
    v_cvt_pk_bf16_f32 v86, v92, v93
    v_cvt_pk_bf16_f32 v87, v94, v95
    s_waitcnt lgkmcnt(0)
    v_mfma_f32_16x16x32_bf16 v[96:99], a[8:11], v[80:83], v[96:99]
    v_mfma_f32_16x16x32_bf16 v[100:103], a[12:15], v[80:83], v[100:103]
    v_mfma_f32_16x16x32_bf16 v[104:107], a[92:95], v[80:83], v[104:107]
    v_mfma_f32_16x16x32_bf16 v[108:111], a[8:11], v[84:87], v[108:111]
    v_mfma_f32_16x16x32_bf16 v[112:115], a[12:15], v[84:87], v[112:115]
    v_mfma_f32_16x16x32_bf16 v[116:119], a[92:95], v[84:87], v[116:119]
    v_sub_f32 v152, 1.0, v140
    v_cvt_pk_bf16_f32 v152, v152, v152
    v_lshlrev_b32 v152, 16, v152
    v_max_f32 v152, 729808896, v152
    v_rcp_f32 v138, v152
    s_nop 0
    v_mul_f32 v140, v140, v138
    v_sub_f32 v153, 1.0, v141
    v_cvt_pk_bf16_f32 v153, v153, v153
    v_lshlrev_b32 v153, 16, v153
    v_max_f32 v153, 729808896, v153
    v_rcp_f32 v139, v153
    s_nop 0
    v_mul_f32 v141, v141, v139
    v_sub_f32 v154, 1.0, v142
    v_cvt_pk_bf16_f32 v154, v154, v154
    v_lshlrev_b32 v154, 16, v154
    v_max_f32 v154, 729808896, v154
    v_rcp_f32 v138, v154
    s_nop 0
    v_mul_f32 v142, v142, v138
    v_sub_f32 v155, 1.0, v143
    v_cvt_pk_bf16_f32 v155, v155, v155
    v_lshlrev_b32 v155, 16, v155
    v_max_f32 v155, 729808896, v155
    v_rcp_f32 v139, v155
    s_nop 0
    v_mul_f32 v143, v143, v139
    s_waitcnt vmcnt(0)
    s_barrier
    ds_read_b128 a[16:19], v132 offset:0
    ds_read_b128 a[20:23], v132 offset:1024
    ds_read_b128 a[24:27], v132 offset:4096
    ds_read_b128 a[28:31], v132 offset:5120
    ds_read_b128 a[0:3], v132 offset:8192
    s_add_u32 m0, s54, 65536
    s_add_u32 s47, s67, 65536
    buffer_load_dwordx4 v144, s[16:19], s47 offen lds
    ds_read_b128 a[4:7], v132 offset:9216
    v_mov_b32 v128, s91
    v_mov_b32 v129, s91
    v_mov_b32 v130, s91
    v_mov_b32 v131, s91
    ds_read_b128 a[8:11], v132 offset:12288
    s_waitcnt lgkmcnt(5)
    v_mfma_f32_16x16x32_bf16 v[0:3], a[16:19], v[64:67], v[120:123]
    ds_read_b128 a[12:15], v132 offset:13312
    v_mfma_f32_16x16x32_bf16 v[8:11], a[20:23], v[64:67], v[128:131]
    v_mfma_f32_16x16x32_bf16 v[12:15], a[20:23], v[68:71], v[120:123]
    ds_read_b128 a[16:19], v132 offset:2048
    s_waitcnt lgkmcnt(5)
    s_cmp_eq_u32 s92, 2
    s_cbranch_scc1 fused_kernel_zf2
fused_kernel_zfr2:
    v_mfma_f32_16x16x32_bf16 v[16:19], a[24:27], v[64:67], v[128:131]
    v_mfma_f32_16x16x32_bf16 v[20:23], a[24:27], v[68:71], v[128:131]
    ds_read_b128 a[20:23], v132 offset:3072
    v_mfma_f32_16x16x32_bf16 v[24:27], a[28:31], v[64:67], v[128:131]
    v_max3_f32 v134, v134, v0, v1
    s_add_u32 m0, s54, 66560
    s_xor_b32 s47, s47, 128
    buffer_load_dwordx4 v144, s[16:19], s47 offen lds
    v_max3_f32 v134, v134, v2, v3
    v_mfma_f32_16x16x32_bf16 v[28:31], a[28:31], v[68:71], v[128:131]
    ds_read_b128 a[24:27], v132 offset:6144
    s_waitcnt lgkmcnt(5)
    s_cmp_eq_u32 s92, 4
    s_cbranch_scc1 fused_kernel_zf4
fused_kernel_zfr4:
    v_mfma_f32_16x16x32_bf16 v[32:35], a[0:3], v[64:67], v[128:131]
    v_max3_f32 v134, v134, v8, v9
    v_max3_f32 v134, v134, v10, v11
    v_mfma_f32_16x16x32_bf16 v[36:39], a[0:3], v[68:71], v[128:131]
    v_max3_f32 v135, v135, v12, v13
    v_max3_f32 v135, v135, v14, v15
    ds_read_b128 a[28:31], v132 offset:7168
    v_mfma_f32_16x16x32_bf16 v[40:43], a[4:7], v[64:67], v[128:131]
    v_max3_f32 v134, v134, v16, v17
    v_max3_f32 v134, v134, v18, v19
    v_mfma_f32_16x16x32_bf16 v[44:47], a[4:7], v[68:71], v[128:131]
    v_max3_f32 v135, v135, v20, v21
    v_max3_f32 v135, v135, v22, v23
    ds_read_b128 a[0:3], v132 offset:10240
    s_waitcnt lgkmcnt(5)
    s_add_u32 m0, s54, 73728
    s_add_u32 s47, s70, 65536
    buffer_load_dwordx4 v144, s[16:19], s47 offen lds
    s_cmp_eq_u32 s92, 6
    s_cbranch_scc1 fused_kernel_zf6
fused_kernel_zfr6:
    v_mfma_f32_16x16x32_bf16 v[48:51], a[8:11], v[64:67], v[128:131]
    v_max3_f32 v134, v134, v24, v25
    v_max3_f32 v134, v134, v26, v27
    v_mfma_f32_16x16x32_bf16 v[52:55], a[8:11], v[68:71], v[128:131]
    v_max3_f32 v135, v135, v28, v29
    v_max3_f32 v135, v135, v30, v31
    ds_read_b128 a[4:7], v132 offset:11264
    v_mfma_f32_16x16x32_bf16 v[56:59], a[12:15], v[64:67], v[128:131]
    v_max3_f32 v134, v134, v32, v33
    v_max3_f32 v134, v134, v34, v35
    v_mfma_f32_16x16x32_bf16 v[60:63], a[12:15], v[68:71], v[128:131]
    v_max3_f32 v135, v135, v36, v37
    v_max3_f32 v135, v135, v38, v39
    v_max3_f32 v134, v134, v40, v41
    v_max3_f32 v134, v134, v42, v43
    v_max3_f32 v135, v135, v44, v45
    v_max3_f32 v135, v135, v46, v47
    v_max3_f32 v134, v134, v48, v49
    v_max3_f32 v134, v134, v50, v51
    s_add_u32 m0, s54, 74752
    s_xor_b32 s47, s47, 128
    buffer_load_dwordx4 v144, s[16:19], s47 offen lds
    v_max3_f32 v135, v135, v52, v53
    v_max3_f32 v135, v135, v54, v55
    v_max3_f32 v134, v134, v56, v57
    v_max3_f32 v134, v134, v58, v59
    v_max3_f32 v135, v135, v60, v61
    v_max3_f32 v135, v135, v62, v63
    v_mov_b32 v138, v134
    v_mov_b32 v139, v135
    s_nop 0
    v_permlane32_swap_b32 v134, v138
    v_permlane32_swap_b32 v135, v139
    v_max_f32 v134, v134, v138
    v_max_f32 v135, v135, v139
    v_mov_b32 v138, v134
    v_mov_b32 v139, v135
    s_nop 0
    v_permlane16_swap_b32 v134, v138
    v_permlane16_swap_b32 v135, v139
    v_max_f32 v134, v134, v138
    v_max_f32 v135, v135, v139
    v_fma_f32 v138, v134, s90, -v136
    v_fma_f32 v139, v135, s90, -v137
    s_add_u32 m0, s54, 49152
    s_xor_b32 s47, s56, 0
    buffer_load_dwordx4 v144, s[84:87], s47 offen lds
    v_exp_f32 v138, -v138
    v_exp_f32 v139, -v139
    v_mul_f32 v136, s90, v134
    v_mul_f32 v137, s90, v135
    v_mul_f32 v96, v96, v138
    v_mul_f32 v97, v97, v138
    v_mul_f32 v98, v98, v138
    v_mul_f32 v99, v99, v138
    v_mul_f32 v100, v100, v138
    v_mul_f32 v101, v101, v138
    v_mul_f32 v102, v102, v138
    v_mul_f32 v103, v103, v138
    v_mul_f32 v104, v104, v138
    v_mul_f32 v108, v108, v139
    v_mul_f32 v109, v109, v139
    v_mul_f32 v110, v110, v139
    v_mul_f32 v111, v111, v139
    v_mul_f32 v112, v112, v139
    v_mul_f32 v113, v113, v139
    v_mul_f32 v114, v114, v139
    s_add_u32 m0, s54, 50176
    s_xor_b32 s47, s47, 128
    buffer_load_dwordx4 v144, s[84:87], s47 offen lds
    v_mul_f32 v115, v115, v139
    v_mul_f32 v116, v116, v139
    v_fma_f32 v0, v0, s90, -v136
    v_fma_f32 v1, v1, s90, -v136
    v_fma_f32 v2, v2, s90, -v136
    v_fma_f32 v3, v3, s90, -v136
    v_fma_f32 v8, v8, s90, -v136
    v_fma_f32 v9, v9, s90, -v136
    v_fma_f32 v10, v10, s90, -v136
    v_fma_f32 v11, v11, s90, -v136
    v_fma_f32 v12, v12, s90, -v137
    v_fma_f32 v13, v13, s90, -v137
    v_fma_f32 v14, v14, s90, -v137
    v_fma_f32 v15, v15, s90, -v137
    v_exp_f32 v0, v0
    v_exp_f32 v1, v1
    v_exp_f32 v2, v2
    v_exp_f32 v3, v3
    v_exp_f32 v8, v8
    s_add_u32 m0, s54, 57344
    s_xor_b32 s47, s56, 65536
    buffer_load_dwordx4 v144, s[84:87], s47 offen lds
    v_exp_f32 v9, v9
    v_exp_f32 v10, v10
    v_exp_f32 v11, v11
    v_exp_f32 v12, v12
    v_exp_f32 v13, v13
    v_exp_f32 v14, v14
    v_exp_f32 v15, v15
    v_cvt_pk_bf16_f32 v0, v0, v1
    v_cvt_pk_bf16_f32 v1, v2, v3
    v_cvt_pk_bf16_f32 v2, v8, v9
    v_cvt_pk_bf16_f32 v3, v10, v11
    v_mov_b32 v4, 0
    v_mov_b32 v5, 0
    v_cvt_pk_bf16_f32 v6, v12, v13
    v_cvt_pk_bf16_f32 v7, v14, v15
    s_waitcnt lgkmcnt(4)
    v_fma_f32 v16, v16, s90, -v136
    v_fma_f32 v17, v17, s90, -v136
    v_mfma_f32_16x16x32_bf16 v[96:99], a[16:19], v[0:3], v[96:99]
    s_add_u32 m0, s54, 58368
    s_xor_b32 s47, s47, 128
    buffer_load_dwordx4 v144, s[84:87], s47 offen lds
    v_fma_f32 v18, v18, s90, -v136
    v_fma_f32 v19, v19, s90, -v136
    v_fma_f32 v20, v20, s90, -v137
    v_fma_f32 v21, v21, s90, -v137
    v_fma_f32 v22, v22, s90, -v137
    v_fma_f32 v23, v23, s90, -v137
    v_mfma_f32_16x16x32_bf16 v[100:103], a[20:23], v[0:3], v[100:103]
    v_fma_f32 v24, v24, s90, -v136
    v_fma_f32 v25, v25, s90, -v136
    v_fma_f32 v26, v26, s90, -v136
    v_fma_f32 v27, v27, s90, -v136
    v_fma_f32 v28, v28, s90, -v137
    v_fma_f32 v29, v29, s90, -v137
    v_mfma_f32_16x16x32_bf16 v[104:107], a[92:95], v[0:3], v[104:107]
    v_fma_f32 v30, v30, s90, -v137
    v_fma_f32 v31, v31, s90, -v137
    v_exp_f32 v16, v16
    v_exp_f32 v17, v17
    v_exp_f32 v18, v18
    v_exp_f32 v19, v19
fused_kernel_pg13:
    s_cbranch_execz fused_kernel_pgrA
    v_mfma_f32_16x16x32_bf16 v[108:111], a[16:19], v[4:7], v[108:111]
    v_exp_f32 v20, v20
    v_exp_f32 v21, v21
    v_exp_f32 v22, v22
    v_exp_f32 v23, v23
    v_exp_f32 v24, v24
    v_exp_f32 v25, v25
    v_mfma_f32_16x16x32_bf16 v[112:115], a[20:23], v[4:7], v[112:115]
    v_exp_f32 v26, v26
    v_exp_f32 v27, v27
    v_exp_f32 v28, v28
    v_exp_f32 v29, v29
    v_exp_f32 v30, v30
    v_exp_f32 v31, v31
    v_mfma_f32_16x16x32_bf16 v[116:119], a[92:95], v[4:7], v[116:119]
    v_cvt_pk_bf16_f32 v16, v16, v17
    v_cvt_pk_bf16_f32 v17, v18, v19
    v_cvt_pk_bf16_f32 v18, v24, v25
    v_cvt_pk_bf16_f32 v19, v26, v27
    v_cvt_pk_bf16_f32 v20, v20, v21
    v_cvt_pk_bf16_f32 v21, v22, v23
    v_cvt_pk_bf16_f32 v22, v28, v29
    v_cvt_pk_bf16_f32 v23, v30, v31
    ds_read_b128 a[8:11], v132 offset:14336
    ds_read_b128 a[12:15], v132 offset:15360
    s_waitcnt lgkmcnt(4)
    v_fma_f32 v32, v32, s90, -v136
    v_fma_f32 v33, v33, s90, -v136
    v_mfma_f32_16x16x32_bf16 v[96:99], a[24:27], v[16:19], v[96:99]
    v_fma_f32 v34, v34, s90, -v136
    v_fma_f32 v35, v35, s90, -v136
    v_fma_f32 v36, v36, s90, -v137
    v_fma_f32 v37, v37, s90, -v137
    v_fma_f32 v38, v38, s90, -v137
    v_fma_f32 v39, v39, s90, -v137
    v_mfma_f32_16x16x32_bf16 v[100:103], a[28:31], v[16:19], v[100:103]
    v_fma_f32 v40, v40, s90, -v136
    v_fma_f32 v41, v41, s90, -v136
    v_fma_f32 v42, v42, s90, -v136
    v_fma_f32 v43, v43, s90, -v136
    v_fma_f32 v44, v44, s90, -v137
    v_fma_f32 v45, v45, s90, -v137
    v_mfma_f32_16x16x32_bf16 v[104:107], a[92:95], v[16:19], v[104:107]
    v_fma_f32 v46, v46, s90, -v137
    v_fma_f32 v47, v47, s90, -v137
    v_exp_f32 v32, v32
    v_exp_f32 v33, v33
    v_exp_f32 v34, v34
    v_exp_f32 v35, v35
    v_mfma_f32_16x16x32_bf16 v[108:111], a[24:27], v[20:23], v[108:111]
    v_exp_f32 v36, v36
    v_exp_f32 v37, v37
    v_exp_f32 v38, v38
    v_exp_f32 v39, v39
    v_exp_f32 v40, v40
    v_exp_f32 v41, v41
    v_mfma_f32_16x16x32_bf16 v[112:115], a[28:31], v[20:23], v[112:115]
    v_exp_f32 v42, v42
    v_exp_f32 v43, v43
    v_exp_f32 v44, v44
    v_exp_f32 v45, v45
    v_exp_f32 v46, v46
    v_exp_f32 v47, v47
    v_mfma_f32_16x16x32_bf16 v[116:119], a[92:95], v[20:23], v[116:119]
    v_cvt_pk_bf16_f32 v32, v32, v33
    v_cvt_pk_bf16_f32 v33, v34, v35
    v_cvt_pk_bf16_f32 v34, v40, v41
    v_cvt_pk_bf16_f32 v35, v42, v43
    v_cvt_pk_bf16_f32 v36, v36, v37
    v_cvt_pk_bf16_f32 v37, v38, v39
    v_cvt_pk_bf16_f32 v38, v44, v45
    v_cvt_pk_bf16_f32 v39, v46, v47
    s_waitcnt lgkmcnt(2)
    v_fma_f32 v48, v48, s90, -v136
    v_fma_f32 v49, v49, s90, -v136
    v_mfma_f32_16x16x32_bf16 v[96:99], a[0:3], v[32:35], v[96:99]
    v_fma_f32 v50, v50, s90, -v136
    v_fma_f32 v51, v51, s90, -v136
    v_fma_f32 v52, v52, s90, -v137
    v_fma_f32 v53, v53, s90, -v137
    v_fma_f32 v54, v54, s90, -v137
    v_fma_f32 v55, v55, s90, -v137
    v_mfma_f32_16x16x32_bf16 v[100:103], a[4:7], v[32:35], v[100:103]
    v_fma_f32 v56, v56, s90, -v136
    v_fma_f32 v57, v57, s90, -v136
    v_fma_f32 v58, v58, s90, -v136
    v_fma_f32 v59, v59, s90, -v136
    v_fma_f32 v60, v60, s90, -v137
    v_fma_f32 v61, v61, s90, -v137
    v_mfma_f32_16x16x32_bf16 v[104:107], a[92:95], v[32:35], v[104:107]
    v_fma_f32 v62, v62, s90, -v137
    v_fma_f32 v63, v63, s90, -v137
    v_exp_f32 v48, v48
    v_exp_f32 v49, v49
    v_exp_f32 v50, v50
    v_exp_f32 v51, v51
    v_mfma_f32_16x16x32_bf16 v[108:111], a[0:3], v[36:39], v[108:111]
    v_exp_f32 v52, v52
    v_exp_f32 v53, v53
    v_exp_f32 v54, v54
    v_exp_f32 v55, v55
    v_exp_f32 v56, v56
    v_exp_f32 v57, v57
    v_mfma_f32_16x16x32_bf16 v[112:115], a[4:7], v[36:39], v[112:115]
    v_exp_f32 v58, v58
    v_exp_f32 v59, v59
    v_exp_f32 v60, v60
    v_exp_f32 v61, v61
    v_exp_f32 v62, v62
    v_exp_f32 v63, v63
    v_mfma_f32_16x16x32_bf16 v[116:119], a[92:95], v[36:39], v[116:119]
    v_cvt_pk_bf16_f32 v48, v48, v49
    v_cvt_pk_bf16_f32 v49, v50, v51
    v_cvt_pk_bf16_f32 v50, v56, v57
    v_cvt_pk_bf16_f32 v51, v58, v59
    v_cvt_pk_bf16_f32 v52, v52, v53
    v_cvt_pk_bf16_f32 v53, v54, v55
    v_cvt_pk_bf16_f32 v54, v60, v61
    v_cvt_pk_bf16_f32 v55, v62, v63
    s_waitcnt lgkmcnt(0)
    v_mfma_f32_16x16x32_bf16 v[96:99], a[8:11], v[48:51], v[96:99]
    v_mfma_f32_16x16x32_bf16 v[100:103], a[12:15], v[48:51], v[100:103]
    v_mfma_f32_16x16x32_bf16 v[104:107], a[92:95], v[48:51], v[104:107]
    v_mfma_f32_16x16x32_bf16 v[108:111], a[8:11], v[52:55], v[108:111]
    v_mfma_f32_16x16x32_bf16 v[112:115], a[12:15], v[52:55], v[112:115]
    v_mfma_f32_16x16x32_bf16 v[116:119], a[92:95], v[52:55], v[116:119]
    s_add_u32 s48, s44, s51
    s_sub_u32 s92, 18, s92
    s_nop 2
    v_rcp_f32 v138, v104
    s_nop 1
    v_rcp_f32 v139, v116
    v_mul_f32 v138, v138, v140
    v_mul_f32 v139, v139, v141
    v_mul_f32 v96, v96, v138
    v_mul_f32 v97, v97, v138
    v_mul_f32 v98, v98, v138
    v_mul_f32 v99, v99, v138
    v_mul_f32 v100, v100, v138
    v_mul_f32 v101, v101, v138
    v_mul_f32 v102, v102, v138
    v_mul_f32 v103, v103, v138
    v_cvt_pk_bf16_f32 v64, v96, v97
    v_cvt_pk_bf16_f32 v65, v98, v99
    v_cvt_pk_bf16_f32 v66, v100, v101
    v_cvt_pk_bf16_f32 v67, v102, v103
    buffer_store_dwordx4 v[64:67], v158, s[12:15], s48 offen offset:0 sc1
    v_mul_f32 v108, v108, v139
    v_mul_f32 v109, v109, v139
    v_mul_f32 v110, v110, v139
    v_mul_f32 v111, v111, v139
    v_mul_f32 v112, v112, v139
    v_mul_f32 v113, v113, v139
    v_mul_f32 v114, v114, v139
    v_mul_f32 v115, v115, v139
    v_cvt_pk_bf16_f32 v68, v108, v109
    v_cvt_pk_bf16_f32 v69, v110, v111
    v_cvt_pk_bf16_f32 v70, v112, v113
    v_cvt_pk_bf16_f32 v71, v114, v115
    buffer_store_dwordx4 v[68:71], v158, s[12:15], s48 offen offset:1024 sc1
    s_barrier
    ds_read_b128 a[16:19], v133 offset:16384
    ds_read_b128 a[20:23], v133 offset:17408
    ds_read_b128 a[24:27], v133 offset:20480
    ds_read_b128 a[28:31], v133 offset:21504
    ds_read_b128 a[0:3], v133 offset:24576
    ds_read_b128 a[4:7], v133 offset:25600
    v_mov_b32 v128, s91
    v_mov_b32 v129, s91
    s_add_u32 m0, s54, 81920
    s_add_u32 s47, s71, 65536
    buffer_load_dwordx4 v144, s[16:19], s47 offen lds
    v_mov_b32 v130, s91
    v_mov_b32 v131, s91
    ds_read_b128 a[8:11], v133 offset:28672
    s_waitcnt lgkmcnt(5)
    v_mfma_f32_16x16x32_bf16 v[0:3], a[16:19], v[72:75], v[128:131]
    v_mfma_f32_16x16x32_bf16 v[4:7], a[16:19], v[76:79], v[128:131]
    ds_read_b128 a[12:15], v133 offset:29696
    v_mfma_f32_16x16x32_bf16 v[8:11], a[20:23], v[72:75], v[128:131]
    v_mfma_f32_16x16x32_bf16 v[12:15], a[20:23], v[76:79], v[128:131]
    ds_read_b128 a[16:19], v133 offset:32768
    s_waitcnt lgkmcnt(5)
    s_cmp_eq_u32 s92, 10
    s_cbranch_scc1 fused_kernel_zf10
fused_kernel_zfr10:
    v_mfma_f32_16x16x32_bf16 v[16:19], a[24:27], v[72:75], v[128:131]
    v_mfma_f32_16x16x32_bf16 v[20:23], a[24:27], v[76:79], v[128:131]
    ds_read_b128 a[20:23], v133 offset:33792
    v_mfma_f32_16x16x32_bf16 v[24:27], a[28:31], v[72:75], v[128:131]
    v_max3_f32 v134, v0, v1, v2
    v_max_f32 v134, v134, v3
    v_mfma_f32_16x16x32_bf16 v[28:31], a[28:31], v[76:79], v[128:131]
    v_max3_f32 v135, v4, v5, v6
    v_max_f32 v135, v135, v7
    ds_read_b128 a[24:27], v133 offset:18432
    s_waitcnt lgkmcnt(5)
    s_cmp_eq_u32 s92, 12
    s_cbranch_scc1 fused_kernel_zf12
fused_kernel_zfr12:
    v_mfma_f32_16x16x32_bf16 v[32:35], a[0:3], v[72:75], v[128:131]
    v_max3_f32 v134, v134, v8, v9
    v_max3_f32 v134, v134, v10, v11
    s_add_u32 m0, s54, 82944
    s_xor_b32 s47, s47, 128
    buffer_load_dwordx4 v144, s[16:19], s47 offen lds
    v_mfma_f32_16x16x32_bf16 v[36:39], a[0:3], v[76:79], v[128:131]
    v_max3_f32 v135, v135, v12, v13
    v_max3_f32 v135, v135, v14, v15
    ds_read_b128 a[28:31], v133 offset:19456
    v_mfma_f32_16x16x32_bf16 v[40:43], a[4:7], v[72:75], v[128:131]
    v_max3_f32 v134, v134, v16, v17
    v_max3_f32 v134, v134, v18, v19
    v_mfma_f32_16x16x32_bf16 v[44:47], a[4:7], v[76:79], v[128:131]
    v_max3_f32 v135, v135, v20, v21
    v_max3_f32 v135, v135, v22, v23
    ds_read_b128 a[0:3], v133 offset:22528
    s_waitcnt lgkmcnt(5)
    s_cmp_eq_u32 s92, 14
    s_cbranch_scc1 fused_kernel_zf14
fused_kernel_zfr14:
    v_mfma_f32_16x16x32_bf16 v[48:51], a[8:11], v[72:75], v[128:131]
    v_max3_f32 v134, v134, v24, v25
    v_max3_f32 v134, v134, v26, v27
    v_mfma_f32_16x16x32_bf16 v[52:55], a[8:11], v[76:79], v[128:131]
    v_max3_f32 v135, v135, v28, v29
    v_max3_f32 v135, v135, v30, v31
    ds_read_b128 a[4:7], v133 offset:23552
    v_mfma_f32_16x16x32_bf16 v[56:59], a[12:15], v[72:75], v[128:131]
    v_max3_f32 v134, v134, v32, v33
    v_max3_f32 v134, v134, v34, v35
    v_mfma_f32_16x16x32_bf16 v[60:63], a[12:15], v[76:79], v[128:131]
    v_max3_f32 v135, v135, v36, v37
    v_max3_f32 v135, v135, v38, v39
    ds_read_b128 a[8:11], v133 offset:26624
    s_add_u32 m0, s54, 90112
    s_add_u32 s47, s72, 65536
    buffer_load_dwordx4 v144, s[16:19], s47 offen lds
    s_waitcnt lgkmcnt(5)
    v_mfma_f32_16x16x32_bf16 v[80:83], a[16:19], v[72:75], v[124:127]
    v_max3_f32 v134, v134, v40, v41
    v_max3_f32 v134, v134, v42, v43
    v_mfma_f32_16x16x32_bf16 v[84:87], a[16:19], v[76:79], 0
    v_max3_f32 v135, v135, v44, v45
    v_max3_f32 v135, v135, v46, v47
    ds_read_b128 a[12:15], v133 offset:27648
    v_mfma_f32_16x16x32_bf16 v[92:95], a[20:23], v[76:79], v[124:127]
    v_max3_f32 v134, v134, v48, v49
    v_max3_f32 v134, v134, v50, v51
    v_max3_f32 v135, v135, v52, v53
    v_max3_f32 v135, v135, v54, v55
    v_max3_f32 v134, v134, v56, v57
    v_max3_f32 v134, v134, v58, v59
    v_max3_f32 v135, v135, v60, v61
    v_max3_f32 v135, v135, v62, v63
    v_max3_f32 v134, v134, v80, v81
    v_max3_f32 v134, v134, v82, v83
    v_max3_f32 v135, v135, v84, v85
    v_max3_f32 v135, v135, v86, v87
    v_max3_f32 v135, v135, v92, v93
    v_max3_f32 v135, v135, v94, v95
    v_mov_b32 v138, v134
    v_mov_b32 v139, v135
    s_nop 0
    v_permlane32_swap_b32 v134, v138
    v_permlane32_swap_b32 v135, v139
    s_add_u32 m0, s54, 91136
    s_xor_b32 s47, s47, 128
    buffer_load_dwordx4 v144, s[16:19], s47 offen lds
    v_max_f32 v134, v134, v138
    v_max_f32 v135, v135, v139
    v_mov_b32 v138, v134
    v_mov_b32 v139, v135
    s_nop 0
    v_permlane16_swap_b32 v134, v138
    v_permlane16_swap_b32 v135, v139
    v_max_f32 v134, v134, v138
    v_max_f32 v135, v135, v139
    v_mul_f32 v136, s90, v134
    v_mul_f32 v137, s90, v135
    s_waitcnt vmcnt(4)
    s_cmp_lg_u32 s26, 1
    s_cbranch_scc1 fused_kernel_sfo0
    buffer_store_dword v151, v148, s[12:15], s57 offen offset:1024
fused_kernel_sfro0:
    v_fma_f32 v0, v0, s90, -v136
    v_fma_f32 v1, v1, s90, -v136
    v_fma_f32 v2, v2, s90, -v136
    v_fma_f32 v3, v3, s90, -v136
    v_fma_f32 v4, v4, s90, -v137
    v_fma_f32 v5, v5, s90, -v137
    v_fma_f32 v6, v6, s90, -v137
    v_fma_f32 v7, v7, s90, -v137
    v_fma_f32 v8, v8, s90, -v136
    v_fma_f32 v9, v9, s90, -v136
    v_fma_f32 v10, v10, s90, -v136
    v_fma_f32 v11, v11, s90, -v136
    v_fma_f32 v12, v12, s90, -v137
    v_fma_f32 v13, v13, s90, -v137
    s_add_u32 m0, s54, 98304
    s_add_u32 s47, s73, 65536
    buffer_load_dwordx4 v144, s[16:19], s47 offen lds
    v_fma_f32 v14, v14, s90, -v137
    v_fma_f32 v15, v15, s90, -v137
    v_exp_f32 v0, v0
    v_exp_f32 v1, v1
    v_exp_f32 v2, v2
    v_exp_f32 v3, v3
    v_exp_f32 v4, v4
    v_exp_f32 v5, v5
    v_exp_f32 v6, v6
    v_exp_f32 v7, v7
    v_exp_f32 v8, v8
    v_exp_f32 v9, v9
    v_exp_f32 v10, v10
    v_exp_f32 v11, v11
    v_exp_f32 v12, v12
    v_exp_f32 v13, v13
    v_exp_f32 v14, v14
    v_exp_f32 v15, v15
    v_cvt_pk_bf16_f32 v0, v0, v1
    v_cvt_pk_bf16_f32 v1, v2, v3
    v_cvt_pk_bf16_f32 v2, v8, v9
    v_cvt_pk_bf16_f32 v3, v10, v11
    v_cvt_pk_bf16_f32 v4, v4, v5
    v_cvt_pk_bf16_f32 v5, v6, v7
    v_cvt_pk_bf16_f32 v6, v12, v13
    v_cvt_pk_bf16_f32 v7, v14, v15
    s_add_u32 m0, s54, 99328
    s_xor_b32 s47, s47, 128
    buffer_load_dwordx4 v144, s[16:19], s47 offen lds
    s_waitcnt lgkmcnt(4)
    v_fma_f32 v16, v16, s90, -v136
    v_fma_f32 v17, v17, s90, -v136
    v_mfma_f32_16x16x32_bf16 v[96:99], a[24:27], v[0:3], 0
    v_fma_f32 v18, v18, s90, -v136
    v_fma_f32 v19, v19, s90, -v136
    v_fma_f32 v20, v20, s90, -v137
    v_fma_f32 v21, v21, s90, -v137
    v_fma_f32 v22, v22, s90, -v137
    v_fma_f32 v23, v23, s90, -v137
    v_mfma_f32_16x16x32_bf16 v[100:103], a[28:31], v[0:3], 0
    v_fma_f32 v24, v24, s90, -v136
    v_fma_f32 v25, v25, s90, -v136
    v_fma_f32 v26, v26, s90, -v136
    v_fma_f32 v27, v27, s90, -v136
    v_fma_f32 v28, v28, s90, -v137
    v_fma_f32 v29, v29, s90, -v137
    v_mfma_f32_16x16x32_bf16 v[104:107], a[92:95], v[0:3], 0
    v_fma_f32 v30, v30, s90, -v137
    v_fma_f32 v31, v31, s90, -v137
    v_exp_f32 v16, v16
    v_exp_f32 v17, v17
    v_exp_f32 v18, v18
    v_exp_f32 v19, v19
    v_mfma_f32_16x16x32_bf16 v[108:111], a[24:27], v[4:7], 0
    v_exp_f32 v20, v20
    v_exp_f32 v21, v21
    s_add_u32 m0, s54, 106496
    s_add_u32 s47, s64, s27
    buffer_load_dwordx4 v145, s[16:19], s47 offen lds
    v_exp_f32 v22, v22
    v_exp_f32 v23, v23
    v_exp_f32 v24, v24
    v_exp_f32 v25, v25
    v_mfma_f32_16x16x32_bf16 v[112:115], a[28:31], v[4:7], 0
    v_exp_f32 v26, v26
    v_exp_f32 v27, v27
    v_exp_f32 v28, v28
    v_exp_f32 v29, v29
    v_exp_f32 v30, v30
    v_exp_f32 v31, v31
    v_mfma_f32_16x16x32_bf16 v[116:119], a[92:95], v[4:7], 0
    v_cvt_pk_bf16_f32 v16, v16, v17
    v_cvt_pk_bf16_f32 v17, v18, v19
    v_cvt_pk_bf16_f32 v18, v24, v25
    v_cvt_pk_bf16_f32 v19, v26, v27
    v_cvt_pk_bf16_f32 v20, v20, v21
    v_cvt_pk_bf16_f32 v21, v22, v23
    v_cvt_pk_bf16_f32 v22, v28, v29
    v_cvt_pk_bf16_f32 v23, v30, v31
    ds_read_b128 a[16:19], v133 offset:30720
    ds_read_b128 a[20:23], v133 offset:31744
    ds_read_b128 a[24:27], v133 offset:34816
    s_waitcnt lgkmcnt(5)
    v_fma_f32 v32, v32, s90, -v136
    v_fma_f32 v33, v33, s90, -v136
    s_add_u32 m0, s54, 107520
    s_xor_b32 s47, s47, 128
    buffer_load_dwordx4 v145, s[16:19], s47 offen lds
    v_mfma_f32_16x16x32_bf16 v[96:99], a[0:3], v[16:19], v[96:99]
    v_fma_f32 v34, v34, s90, -v136
    v_fma_f32 v35, v35, s90, -v136
    v_fma_f32 v36, v36, s90, -v137
    v_fma_f32 v37, v37, s90, -v137
    v_fma_f32 v38, v38, s90, -v137
    v_fma_f32 v39, v39, s90, -v137
    v_mfma_f32_16x16x32_bf16 v[100:103], a[4:7], v[16:19], v[100:103]
    v_fma_f32 v40, v40, s90, -v136
    v_fma_f32 v41, v41, s90, -v136
    v_fma_f32 v42, v42, s90, -v136
    v_fma_f32 v43, v43, s90, -v136
    v_fma_f32 v44, v44, s90, -v137
    v_fma_f32 v45, v45, s90, -v137
    v_mfma_f32_16x16x32_bf16 v[104:107], a[92:95], v[16:19], v[104:107]
    v_fma_f32 v46, v46, s90, -v137
    v_fma_f32 v47, v47, s90, -v137
    v_exp_f32 v32, v32
    v_exp_f32 v33, v33
    v_exp_f32 v34, v34
    v_exp_f32 v35, v35
    v_mfma_f32_16x16x32_bf16 v[108:111], a[0:3], v[20:23], v[108:111]
    v_exp_f32 v36, v36
    v_exp_f32 v37, v37
    v_exp_f32 v38, v38
    v_exp_f32 v39, v39
    v_exp_f32 v40, v40
    s_add_u32 s45, s62, 12582912
    buffer_store_dwordx4 a[88:91], v158, s[12:15], s45 offen offset:0 sc1
    v_exp_f32 v41, v41
    v_mfma_f32_16x16x32_bf16 v[112:115], a[4:7], v[20:23], v[112:115]
    v_exp_f32 v42, v42
    v_exp_f32 v43, v43
    v_exp_f32 v44, v44
    v_exp_f32 v45, v45
    v_exp_f32 v46, v46
    v_exp_f32 v47, v47
    v_mfma_f32_16x16x32_bf16 v[116:119], a[92:95], v[20:23], v[116:119]
    v_cvt_pk_bf16_f32 v32, v32, v33
    v_cvt_pk_bf16_f32 v33, v34, v35
    v_cvt_pk_bf16_f32 v34, v40, v41
    v_cvt_pk_bf16_f32 v35, v42, v43
    v_cvt_pk_bf16_f32 v36, v36, v37
    v_cvt_pk_bf16_f32 v37, v38, v39
    v_cvt_pk_bf16_f32 v38, v44, v45
    v_cvt_pk_bf16_f32 v39, v46, v47
    ds_read_b128 a[28:31], v133 offset:35840
    buffer_load_dword v150, v149, s[12:15], s58 offen offset:1024 sc1
    s_waitcnt lgkmcnt(4)
    v_fma_f32 v48, v48, s90, -v136
    v_fma_f32 v49, v49, s90, -v136
    v_mfma_f32_16x16x32_bf16 v[96:99], a[8:11], v[32:35], v[96:99]
    v_fma_f32 v50, v50, s90, -v136
    v_fma_f32 v51, v51, s90, -v136
    v_fma_f32 v52, v52, s90, -v137
    v_fma_f32 v53, v53, s90, -v137
    v_fma_f32 v54, v54, s90, -v137
    v_fma_f32 v55, v55, s90, -v137
    v_mfma_f32_16x16x32_bf16 v[100:103], a[12:15], v[32:35], v[100:103]
    v_fma_f32 v56, v56, s90, -v136
    v_fma_f32 v57, v57, s90, -v136
    v_fma_f32 v58, v58, s90, -v136
    v_fma_f32 v59, v59, s90, -v136
    v_fma_f32 v60, v60, s90, -v137
    v_fma_f32 v61, v61, s90, -v137
    v_mfma_f32_16x16x32_bf16 v[104:107], a[92:95], v[32:35], v[104:107]
    v_fma_f32 v62, v62, s90, -v137
    v_fma_f32 v63, v63, s90, -v137
    v_exp_f32 v48, v48
    v_exp_f32 v49, v49
    v_exp_f32 v50, v50
    v_exp_f32 v51, v51
    v_mfma_f32_16x16x32_bf16 v[108:111], a[8:11], v[36:39], v[108:111]
    v_exp_f32 v52, v52
    v_exp_f32 v53, v53
    v_exp_f32 v54, v54
    v_exp_f32 v55, v55
    v_exp_f32 v56, v56
    v_exp_f32 v57, v57
    v_mfma_f32_16x16x32_bf16 v[112:115], a[12:15], v[36:39], v[112:115]
    v_exp_f32 v58, v58
    v_exp_f32 v59, v59
    v_exp_f32 v60, v60
    v_exp_f32 v61, v61
    v_exp_f32 v62, v62
    v_exp_f32 v63, v63
    v_mfma_f32_16x16x32_bf16 v[116:119], a[92:95], v[36:39], v[116:119]
    v_cvt_pk_bf16_f32 v48, v48, v49
    v_cvt_pk_bf16_f32 v49, v50, v51
    v_cvt_pk_bf16_f32 v50, v56, v57
    v_cvt_pk_bf16_f32 v51, v58, v59
    v_cvt_pk_bf16_f32 v52, v52, v53
    v_cvt_pk_bf16_f32 v53, v54, v55
    v_cvt_pk_bf16_f32 v54, v60, v61
    v_cvt_pk_bf16_f32 v55, v62, v63
    s_waitcnt lgkmcnt(2)
    v_fma_f32 v80, v80, s90, -v136
    v_fma_f32 v81, v81, s90, -v136
    v_mfma_f32_16x16x32_bf16 v[96:99], a[16:19], v[48:51], v[96:99]
    v_fma_f32 v82, v82, s90, -v136
    v_fma_f32 v83, v83, s90, -v136
    v_fma_f32 v84, v84, s90, -v137
    v_fma_f32 v85, v85, s90, -v137
    v_fma_f32 v86, v86, s90, -v137
    v_mfma_f32_16x16x32_bf16 v[100:103], a[20:23], v[48:51], v[100:103]
    v_fma_f32 v87, v87, s90, -v137
    v_fma_f32 v92, v92, s90, -v137
    v_fma_f32 v93, v93, s90, -v137
    v_fma_f32 v94, v94, s90, -v137
    v_fma_f32 v95, v95, s90, -v137
    v_mfma_f32_16x16x32_bf16 v[104:107], a[92:95], v[48:51], v[104:107]
    v_exp_f32 v80, v80
    v_exp_f32 v81, v81
    v_exp_f32 v82, v82
    v_exp_f32 v83, v83
    v_exp_f32 v84, v84
    v_mfma_f32_16x16x32_bf16 v[108:111], a[16:19], v[52:55], v[108:111]
    v_exp_f32 v85, v85
    v_exp_f32 v86, v86
    v_exp_f32 v87, v87
    v_exp_f32 v92, v92
    v_exp_f32 v93, v93
    v_mfma_f32_16x16x32_bf16 v[112:115], a[20:23], v[52:55], v[112:115]
    v_exp_f32 v94, v94
    v_exp_f32 v95, v95
    v_cvt_pk_bf16_f32 v80, v80, v81
    v_cvt_pk_bf16_f32 v81, v82, v83
    v_mov_b32 v82, 0
    s_add_u32 s45, s62, 12582912
    buffer_store_dwordx4 a[88:91], v158, s[12:15], s45 offen offset:1024 sc1
    v_mfma_f32_16x16x32_bf16 v[116:119], a[92:95], v[52:55], v[116:119]
    v_mov_b32 v83, 0
    v_cvt_pk_bf16_f32 v84, v84, v85
    v_cvt_pk_bf16_f32 v85, v86, v87
    v_cvt_pk_bf16_f32 v86, v92, v93
    v_cvt_pk_bf16_f32 v87, v94, v95
    s_waitcnt lgkmcnt(0)
    v_mfma_f32_16x16x32_bf16 v[96:99], a[24:27], v[80:83], v[96:99]
    v_mfma_f32_16x16x32_bf16 v[100:103], a[28:31], v[80:83], v[100:103]
    v_mfma_f32_16x16x32_bf16 v[104:107], a[92:95], v[80:83], v[104:107]
    v_mfma_f32_16x16x32_bf16 v[108:111], a[24:27], v[84:87], v[108:111]
    v_mfma_f32_16x16x32_bf16 v[112:115], a[28:31], v[84:87], v[112:115]
    v_mfma_f32_16x16x32_bf16 v[116:119], a[92:95], v[84:87], v[116:119]
    s_waitcnt vmcnt(1)
    v_cmp_gt_u32 vcc, 1, v150
    s_nop 1
    s_cbranch_vccnz fused_kernel_spin_ao0
fused_kernel_ret_ao0:
    s_xor_b32 s46, s51, 4096
    s_add_u32 s46, s46, s44
    buffer_load_dwordx4 a[32:35], v158, s[12:15], s46 offen offset:0 sc1
    buffer_load_dwordx4 a[36:39], v158, s[12:15], s46 offen offset:1024 sc1
    s_xor_b32 s46, s51, 8192
    s_add_u32 s46, s46, s44
    buffer_load_dwordx4 a[40:43], v158, s[12:15], s46 offen offset:0 sc1
    buffer_load_dwordx4 a[44:47], v158, s[12:15], s46 offen offset:1024 sc1
    ds_read_b128 a[0:3], v133 offset:0
    ds_read_b128 a[4:7], v133 offset:1024
    ds_read_b128 a[8:11], v133 offset:4096
    ds_read_b128 a[12:15], v133 offset:5120
    ds_read_b128 a[16:19], v133 offset:8192
    ds_read_b128 a[20:23], v133 offset:9216
    v_mov_b32 v128, s91
    v_mov_b32 v129, s91
    v_mov_b32 v130, s91
    v_mov_b32 v131, s91
    ds_read_b128 a[24:27], v133 offset:12288
    s_waitcnt lgkmcnt(5)
    v_mfma_f32_16x16x32_bf16 v[0:3], a[0:3], v[72:75], v[120:123]
    ds_read_b128 a[28:31], v133 offset:13312
    v_mfma_f32_16x16x32_bf16 v[8:11], a[4:7], v[72:75], v[128:131]
    v_mfma_f32_16x16x32_bf16 v[12:15], a[4:7], v[76:79], v[120:123]
    ds_read_b128 a[0:3], v133 offset:2048
    s_waitcnt lgkmcnt(5)
    v_mfma_f32_16x16x32_bf16 v[16:19], a[8:11], v[72:75], v[128:131]
    v_mfma_f32_16x16x32_bf16 v[20:23], a[8:11], v[76:79], v[128:131]
    ds_read_b128 a[4:7], v133 offset:3072
    v_mfma_f32_16x16x32_bf16 v[24:27], a[12:15], v[72:75], v[128:131]
    v_max3_f32 v134, v134, v0, v1
    v_max3_f32 v134, v134, v2, v3
    v_mfma_f32_16x16x32_bf16 v[28:31], a[12:15], v[76:79], v[128:131]
    ds_read_b128 a[8:11], v133 offset:6144
    s_waitcnt lgkmcnt(5)
    v_mfma_f32_16x16x32_bf16 v[32:35], a[16:19], v[72:75], v[128:131]
    v_max3_f32 v134, v134, v8, v9
    v_max3_f32 v134, v134, v10, v11
    v_mfma_f32_16x16x32_bf16 v[36:39], a[16:19], v[76:79], v[128:131]
    v_max3_f32 v135, v135, v12, v13
    v_max3_f32 v135, v135, v14, v15
    ds_read_b128 a[12:15], v133 offset:7168
    v_mfma_f32_16x16x32_bf16 v[40:43], a[20:23], v[72:75], v[128:131]
    v_max3_f32 v134, v134, v16, v17
    v_max3_f32 v134, v134, v18, v19
    v_mfma_f32_16x16x32_bf16 v[44:47], a[20:23], v[76:79], v[128:131]
    v_max3_f32 v135, v135, v20, v21
    v_max3_f32 v135, v135, v22, v23
    ds_read_b128 a[16:19], v133 offset:10240
    s_waitcnt lgkmcnt(5)
    v_mfma_f32_16x16x32_bf16 v[48:51], a[24:27], v[72:75], v[128:131]
    v_max3_f32 v134, v134, v24, v25
    v_max3_f32 v134, v134, v26, v27
    v_mfma_f32_16x16x32_bf16 v[52:55], a[24:27], v[76:79], v[128:131]
    v_max3_f32 v135, v135, v28, v29
    v_max3_f32 v135, v135, v30, v31
    ds_read_b128 a[20:23], v133 offset:11264
    v_mfma_f32_16x16x32_bf16 v[56:59], a[28:31], v[72:75], v[128:131]
    v_max3_f32 v134, v134, v32, v33
    v_max3_f32 v134, v134, v34, v35
    v_mfma_f32_16x16x32_bf16 v[60:63], a[28:31], v[76:79], v[128:131]
    v_max3_f32 v135, v135, v36, v37
    v_max3_f32 v135, v135, v38, v39
    v_max3_f32 v134, v134, v40, v41
    v_max3_f32 v134, v134, v42, v43
    v_max3_f32 v135, v135, v44, v45
    v_max3_f32 v135, v135, v46, v47
    v_max3_f32 v134, v134, v48, v49
    v_max3_f32 v134, v134, v50, v51
    v_max3_f32 v135, v135, v52, v53
    v_max3_f32 v135, v135, v54, v55
    v_max3_f32 v134, v134, v56, v57
    v_max3_f32 v134, v134, v58, v59
    v_max3_f32 v135, v135, v60, v61
    v_max3_f32 v135, v135, v62, v63
    v_mov_b32 v138, v134
    v_mov_b32 v139, v135
    s_nop 0
    v_permlane32_swap_b32 v134, v138
    v_permlane32_swap_b32 v135, v139
    v_max_f32 v134, v134, v138
    v_max_f32 v135, v135, v139
    v_mov_b32 v138, v134
    v_mov_b32 v139, v135
    s_nop 0
    v_permlane16_swap_b32 v134, v138
    v_permlane16_swap_b32 v135, v139
    v_max_f32 v134, v134, v138
fused_kernel_pg14:
    s_cbranch_execz fused_kernel_pgrA
    v_max_f32 v135, v135, v139
    v_fma_f32 v138, v134, s90, -v136
    v_fma_f32 v139, v135, s90, -v137
    v_exp_f32 v138, -v138
    v_exp_f32 v139, -v139
    v_mul_f32 v136, s90, v134
    v_mul_f32 v137, s90, v135
    v_mul_f32 v96, v96, v138
    v_mul_f32 v97, v97, v138
    v_mul_f32 v98, v98, v138
    v_mul_f32 v99, v99, v138
    v_mul_f32 v100, v100, v138
    v_mul_f32 v101, v101, v138
    v_mul_f32 v102, v102, v138
    v_mul_f32 v103, v103, v138
    v_mul_f32 v104, v104, v138
    v_mul_f32 v108, v108, v139
    v_mul_f32 v109, v109, v139
    v_mul_f32 v110, v110, v139
    v_mul_f32 v111, v111, v139
    v_mul_f32 v112, v112, v139
    v_mul_f32 v113, v113, v139
    v_mul_f32 v114, v114, v139
    v_mul_f32 v115, v115, v139
    v_mul_f32 v116, v116, v139
    s_barrier
    s_xor_b32 s46, s51, 12288
    s_add_u32 s46, s46, s44
    buffer_load_dwordx4 a[48:51], v158, s[12:15], s46 offen offset:0 sc1
    buffer_load_dwordx4 a[52:55], v158, s[12:15], s46 offen offset:1024 sc1
    s_xor_b32 s46, s51, 16384
    s_add_u32 s46, s46, s44
    buffer_load_dwordx4 a[56:59], v158, s[12:15], s46 offen offset:0 sc1
    buffer_load_dwordx4 a[60:63], v158, s[12:15], s46 offen offset:1024 sc1
    v_fma_f32 v0, v0, s90, -v136
    v_fma_f32 v1, v1, s90, -v136
    s_add_u32 m0, s54, 114688
    s_add_u32 s47, s66, s27
    buffer_load_dwordx4 v145, s[16:19], s47 offen lds
    v_fma_f32 v2, v2, s90, -v136
    v_fma_f32 v3, v3, s90, -v136
    v_fma_f32 v8, v8, s90, -v136
    v_fma_f32 v9, v9, s90, -v136
    v_fma_f32 v10, v10, s90, -v136
    v_fma_f32 v11, v11, s90, -v136
    v_fma_f32 v12, v12, s90, -v137
    v_fma_f32 v13, v13, s90, -v137
    v_fma_f32 v14, v14, s90, -v137
    v_fma_f32 v15, v15, s90, -v137
    v_exp_f32 v0, v0
    s_add_u32 m0, s54, 115712
    s_xor_b32 s47, s47, 128
    buffer_load_dwordx4 v145, s[16:19], s47 offen lds
    v_exp_f32 v1, v1
    v_exp_f32 v2, v2
    v_exp_f32 v3, v3
    v_exp_f32 v8, v8
    v_exp_f32 v9, v9
    v_exp_f32 v10, v10
    v_exp_f32 v11, v11
    v_exp_f32 v12, v12
    v_exp_f32 v13, v13
    v_exp_f32 v14, v14
    v_exp_f32 v15, v15
    s_add_u32 m0, s54, 122880
    s_add_u32 s47, s70, s27
    buffer_load_dwordx4 v145, s[16:19], s47 offen lds
    v_cvt_pk_bf16_f32 v0, v0, v1
    v_cvt_pk_bf16_f32 v1, v2, v3
    v_cvt_pk_bf16_f32 v2, v8, v9
    v_cvt_pk_bf16_f32 v3, v10, v11
    v_mov_b32 v4, 0
    v_mov_b32 v5, 0
    v_cvt_pk_bf16_f32 v6, v12, v13
    v_cvt_pk_bf16_f32 v7, v14, v15
    s_xor_b32 s46, s51, 20480
    s_add_u32 s46, s46, s44
    buffer_load_dwordx4 a[64:67], v158, s[12:15], s46 offen offset:0 sc1
    buffer_load_dwordx4 a[68:71], v158, s[12:15], s46 offen offset:1024 sc1
    s_waitcnt lgkmcnt(4)
    s_add_u32 m0, s54, 123904
    s_xor_b32 s47, s47, 128
    buffer_load_dwordx4 v145, s[16:19], s47 offen lds
    v_fma_f32 v16, v16, s90, -v136
    v_fma_f32 v17, v17, s90, -v136
    v_mfma_f32_16x16x32_bf16 v[96:99], a[0:3], v[0:3], v[96:99]
    v_fma_f32 v18, v18, s90, -v136
    v_fma_f32 v19, v19, s90, -v136
    v_fma_f32 v20, v20, s90, -v137
    v_fma_f32 v21, v21, s90, -v137
    v_fma_f32 v22, v22, s90, -v137
    v_fma_f32 v23, v23, s90, -v137
    v_mfma_f32_16x16x32_bf16 v[100:103], a[4:7], v[0:3], v[100:103]
    v_fma_f32 v24, v24, s90, -v136
    s_add_u32 m0, s54, 131072
    s_add_u32 s47, s72, s27
    buffer_load_dwordx4 v145, s[16:19], s47 offen lds
    v_fma_f32 v25, v25, s90, -v136
    v_fma_f32 v26, v26, s90, -v136
    v_fma_f32 v27, v27, s90, -v136
    v_fma_f32 v28, v28, s90, -v137
    v_fma_f32 v29, v29, s90, -v137
    v_mfma_f32_16x16x32_bf16 v[104:107], a[92:95], v[0:3], v[104:107]
    v_fma_f32 v30, v30, s90, -v137
    v_fma_f32 v31, v31, s90, -v137
    v_exp_f32 v16, v16
    v_exp_f32 v17, v17
    v_exp_f32 v18, v18
    s_add_u32 m0, s54, 132096
    s_xor_b32 s47, s47, 128
    buffer_load_dwordx4 v145, s[16:19], s47 offen lds
    v_exp_f32 v19, v19
    v_mfma_f32_16x16x32_bf16 v[108:111], a[0:3], v[4:7], v[108:111]
    v_exp_f32 v20, v20
    v_exp_f32 v21, v21
    v_exp_f32 v22, v22
    v_exp_f32 v23, v23
    v_exp_f32 v24, v24
    v_exp_f32 v25, v25
    v_mfma_f32_16x16x32_bf16 v[112:115], a[4:7], v[4:7], v[112:115]
    v_exp_f32 v26, v26
    v_exp_f32 v27, v27
    s_add_u32 m0, s54, 139264
    s_add_u32 s47, s65, 131072
    buffer_load_dwordx4 v144, s[16:19], s47 offen lds
    v_exp_f32 v28, v28
    v_exp_f32 v29, v29
    v_exp_f32 v30, v30
    v_exp_f32 v31, v31
    v_mfma_f32_16x16x32_bf16 v[116:119], a[92:95], v[4:7], v[116:119]
    v_cvt_pk_bf16_f32 v16, v16, v17
    v_cvt_pk_bf16_f32 v17, v18, v19
    v_cvt_pk_bf16_f32 v18, v24, v25
    v_cvt_pk_bf16_f32 v19, v26, v27
    v_cvt_pk_bf16_f32 v20, v20, v21
    v_cvt_pk_bf16_f32 v21, v22, v23
    s_add_u32 m0, s54, 140288
    s_xor_b32 s47, s47, 128
    buffer_load_dwordx4 v144, s[16:19], s47 offen lds
    v_cvt_pk_bf16_f32 v22, v28, v29
    v_cvt_pk_bf16_f32 v23, v30, v31
    ds_read_b128 a[24:27], v133 offset:14336
    ds_read_b128 a[28:31], v133 offset:15360
    s_xor_b32 s46, s51, 24576
    s_add_u32 s46, s46, s44
    buffer_load_dwordx4 a[72:75], v158, s[12:15], s46 offen offset:0 sc1
    buffer_load_dwordx4 a[76:79], v158, s[12:15], s46 offen offset:1024 sc1
    s_waitcnt lgkmcnt(4)
    v_fma_f32 v32, v32, s90, -v136
    v_fma_f32 v33, v33, s90, -v136
    v_mfma_f32_16x16x32_bf16 v[96:99], a[8:11], v[16:19], v[96:99]
    v_fma_f32 v34, v34, s90, -v136
    s_add_u32 m0, s54, 32768
    s_xor_b32 s47, s56, 131072
    buffer_load_dwordx4 v144, s[84:87], s47 offen lds
    v_fma_f32 v35, v35, s90, -v136
    v_fma_f32 v36, v36, s90, -v137
    v_fma_f32 v37, v37, s90, -v137
    v_fma_f32 v38, v38, s90, -v137
    v_fma_f32 v39, v39, s90, -v137
    v_mfma_f32_16x16x32_bf16 v[100:103], a[12:15], v[16:19], v[100:103]
    v_fma_f32 v40, v40, s90, -v136
    v_fma_f32 v41, v41, s90, -v136
    v_fma_f32 v42, v42, s90, -v136
    v_fma_f32 v43, v43, s90, -v136
    v_fma_f32 v44, v44, s90, -v137
    s_add_u32 m0, s54, 33792
    s_xor_b32 s47, s47, 128
    buffer_load_dwordx4 v144, s[84:87], s47 offen lds
    v_fma_f32 v45, v45, s90, -v137
    v_mfma_f32_16x16x32_bf16 v[104:107], a[92:95], v[16:19], v[104:107]
    v_fma_f32 v46, v46, s90, -v137
    v_fma_f32 v47, v47, s90, -v137
    v_exp_f32 v32, v32
    v_exp_f32 v33, v33
    v_exp_f32 v34, v34
    v_exp_f32 v35, v35
    v_mfma_f32_16x16x32_bf16 v[108:111], a[8:11], v[20:23], v[108:111]
    v_exp_f32 v36, v36
    v_exp_f32 v37, v37
    s_add_u32 m0, s54, 40960
    s_xor_b32 s47, s56, 196608
    buffer_load_dwordx4 v144, s[84:87], s47 offen lds
    v_exp_f32 v38, v38
    v_exp_f32 v39, v39
    v_exp_f32 v40, v40
    v_exp_f32 v41, v41
    v_mfma_f32_16x16x32_bf16 v[112:115], a[12:15], v[20:23], v[112:115]
    v_exp_f32 v42, v42
    v_exp_f32 v43, v43
    v_exp_f32 v44, v44
    v_exp_f32 v45, v45
    v_exp_f32 v46, v46
    v_exp_f32 v47, v47
    s_add_u32 m0, s54, 41984
    s_xor_b32 s47, s47, 128
    buffer_load_dwordx4 v144, s[84:87], s47 offen lds
    v_mfma_f32_16x16x32_bf16 v[116:119], a[92:95], v[20:23], v[116:119]
    v_cvt_pk_bf16_f32 v32, v32, v33
    v_cvt_pk_bf16_f32 v33, v34, v35
    v_cvt_pk_bf16_f32 v34, v40, v41
    v_cvt_pk_bf16_f32 v35, v42, v43
    v_cvt_pk_bf16_f32 v36, v36, v37
    v_cvt_pk_bf16_f32 v37, v38, v39
    v_cvt_pk_bf16_f32 v38, v44, v45
    v_cvt_pk_bf16_f32 v39, v46, v47
    s_xor_b32 s46, s51, 28672
    s_add_u32 s46, s46, s44
    buffer_load_dwordx4 a[80:83], v158, s[12:15], s46 offen offset:0 sc1
    buffer_load_dwordx4 a[84:87], v158, s[12:15], s46 offen offset:1024 sc1
    s_waitcnt lgkmcnt(2)
    s_add_u32 s45, s62, 14680064
    buffer_store_dwordx4 a[88:91], v158, s[12:15], s45 offen offset:0 sc1
    v_fma_f32 v48, v48, s90, -v136
    v_fma_f32 v49, v49, s90, -v136
    v_mfma_f32_16x16x32_bf16 v[96:99], a[16:19], v[32:35], v[96:99]
    v_fma_f32 v50, v50, s90, -v136
    v_fma_f32 v51, v51, s90, -v136
    v_fma_f32 v52, v52, s90, -v137
    v_fma_f32 v53, v53, s90, -v137
    v_fma_f32 v54, v54, s90, -v137
    v_fma_f32 v55, v55, s90, -v137
    v_mfma_f32_16x16x32_bf16 v[100:103], a[20:23], v[32:35], v[100:103]
    v_fma_f32 v56, v56, s90, -v136
    v_fma_f32 v57, v57, s90, -v136
    v_fma_f32 v58, v58, s90, -v136
    v_fma_f32 v59, v59, s90, -v136
    v_fma_f32 v60, v60, s90, -v137
    v_fma_f32 v61, v61, s90, -v137
    v_mfma_f32_16x16x32_bf16 v[104:107], a[92:95], v[32:35], v[104:107]
    v_fma_f32 v62, v62, s90, -v137
    v_fma_f32 v63, v63, s90, -v137
    v_exp_f32 v48, v48
    v_exp_f32 v49, v49
    v_exp_f32 v50, v50
    v_exp_f32 v51, v51
    v_mfma_f32_16x16x32_bf16 v[108:111], a[16:19], v[36:39], v[108:111]
    v_exp_f32 v52, v52
    v_exp_f32 v53, v53
    v_exp_f32 v54, v54
    v_exp_f32 v55, v55
    v_exp_f32 v56, v56
    v_exp_f32 v57, v57
    v_mfma_f32_16x16x32_bf16 v[112:115], a[20:23], v[36:39], v[112:115]
    v_exp_f32 v58, v58
    v_exp_f32 v59, v59
    v_exp_f32 v60, v60
    v_exp_f32 v61, v61
    v_exp_f32 v62, v62
    v_exp_f32 v63, v63
    v_mfma_f32_16x16x32_bf16 v[116:119], a[92:95], v[36:39], v[116:119]
    v_cvt_pk_bf16_f32 v48, v48, v49
    v_cvt_pk_bf16_f32 v49, v50, v51
    v_cvt_pk_bf16_f32 v50, v56, v57
    v_cvt_pk_bf16_f32 v51, v58, v59
    v_cvt_pk_bf16_f32 v52, v52, v53
    v_cvt_pk_bf16_f32 v53, v54, v55
    v_cvt_pk_bf16_f32 v54, v60, v61
    v_cvt_pk_bf16_f32 v55, v62, v63
    s_waitcnt lgkmcnt(0)
    v_mfma_f32_16x16x32_bf16 v[96:99], a[24:27], v[48:51], v[96:99]
    v_mfma_f32_16x16x32_bf16 v[100:103], a[28:31], v[48:51], v[100:103]
    v_mfma_f32_16x16x32_bf16 v[104:107], a[92:95], v[48:51], v[104:107]
    v_mfma_f32_16x16x32_bf16 v[108:111], a[24:27], v[52:55], v[108:111]
    v_mfma_f32_16x16x32_bf16 v[112:115], a[28:31], v[52:55], v[112:115]
    v_mfma_f32_16x16x32_bf16 v[116:119], a[92:95], v[52:55], v[116:119]
    s_add_u32 s48, s44, s51
    s_sub_u32 s92, 18, s92
    s_nop 2
    v_rcp_f32 v138, v104
    s_nop 1
    v_rcp_f32 v139, v116
    v_mul_f32 v138, v138, v142
    v_mul_f32 v139, v139, v143
    v_mul_f32 v96, v96, v138
    s_add_u32 s45, s62, 14680064
    buffer_store_dwordx4 a[88:91], v158, s[12:15], s45 offen offset:1024 sc1
    v_mul_f32 v97, v97, v138
    v_mul_f32 v98, v98, v138
    v_mul_f32 v99, v99, v138
    v_mul_f32 v100, v100, v138
    v_mul_f32 v101, v101, v138
    v_mul_f32 v102, v102, v138
    v_mul_f32 v103, v103, v138
    v_cvt_pk_bf16_f32 v72, v96, v97
    v_cvt_pk_bf16_f32 v73, v98, v99
    v_cvt_pk_bf16_f32 v74, v100, v101
    v_cvt_pk_bf16_f32 v75, v102, v103
    buffer_store_dwordx4 v[72:75], v158, s[12:15], s48 offen offset:2048 sc1
    v_mul_f32 v108, v108, v139
    v_mul_f32 v109, v109, v139
    v_mul_f32 v110, v110, v139
    v_mul_f32 v111, v111, v139
    v_mul_f32 v112, v112, v139
    v_mul_f32 v113, v113, v139
    v_mul_f32 v114, v114, v139
    v_mul_f32 v115, v115, v139
    v_cvt_pk_bf16_f32 v76, v108, v109
    v_cvt_pk_bf16_f32 v77, v110, v111
    v_cvt_pk_bf16_f32 v78, v112, v113
    v_cvt_pk_bf16_f32 v79, v114, v115
    buffer_store_dwordx4 v[76:79], v158, s[12:15], s48 offen offset:3072 sc1
    v_bfe_u32 v80, v158, 6, 3
    v_lshrrev_b32 v81, 1, v80
    v_lshlrev_b32 v81, 5, v81
    v_lshl_add_u32 v81, v80, 7, v81
    v_lshrrev_b32 v80, 9, v158
    v_lshl_add_u32 v81, v80, 11, v81
    v_bfe_u32 v82, v158, 4, 2
    v_lshl_add_u32 v81, v82, 3, v81
    v_mov_b32 v134, v81
    v_xor_b32 v135, 32, v81
    v_xor_b32 v136, 64, v81
    v_xor_b32 v137, 96, v81
    v_bfe_u32 v81, v158, 4, 4
    v_lshlrev_b32 v81, 11, v81
    v_lshl_add_u32 v81, v80, 4, v81
    v_bfe_u32 v80, v158, 8, 1
    v_lshl_add_u32 v138, v80, 5, v81
    v_add_u32 v139, 2097152, v158
    s_add_u32 s40, s75, 98304
    v_add_u32 v156, s40, v158
    v_lshrrev_b32 v128, 8, v158
    v_bfe_u32 v129, v158, 6, 2
    v_mov_b32 v132, 0x3f80
    v_cmp_eq_u32 s[30:31], v128, v129
    v_and_b32 v133, 0x30, v158
    v_mov_b32 v129, 0
    v_cndmask_b32 v128, 0, v132, s[30:31]
    v_mov_b32 v132, 0
    v_lshlrev_b64 v[130:131], v133, v[128:129]
    v_mov_b32 v128, 0
    v_mov_b32 v133, 0
    s_mov_b32 s8, s78
    s_and_b32 s9, s79, 0xffff
    s_mov_b32 s10, 4194304
    s_lshl_b32 s40, s28, 19
    s_lshr_b32 s41, s51, 4
    s_add_u32 s40, s40, s41
    s_lshl_b32 s41, s43, 6
    s_add_u32 s40, s40, s41
    s_lshl_b32 s41, s74, 4
    s_add_u32 s60, s40, s41
    s_add_u32 s61, s60, 32768
    s_lshl_b32 s41, s75, 4
    s_add_u32 s88, s40, s41
    s_add_u32 s89, s88, 32768
    s_add_u32 s40, s62, 4194304
    s_add_u32 s41, s62, 8388608
    s_add_u32 s42, s62, 12582912
    s_waitcnt vmcnt(16)
    s_barrier
    v_mov_b32 v151, 2
    s_waitcnt vmcnt(0)
    s_cmp_lg_u32 s26, 1
    s_cbranch_scc1 fused_kernel_sfo
    buffer_store_dword v151, v148, s[12:15], s57 offen offset:1024
fused_kernel_sfro:
    buffer_store_dword v151, v148, s[12:15], s57 offen offset:1536 sc1
    s_add_u32 m0, s54, 147456
    s_add_u32 s47, s66, 131072
    buffer_load_dwordx4 v144, s[16:19], s47 offen lds
    s_add_u32 m0, s54, 148480
    s_xor_b32 s47, s47, 128
    buffer_load_dwordx4 v144, s[16:19], s47 offen lds
    s_add_u32 m0, s54, 155648
    s_add_u32 s47, s67, 131072
    buffer_load_dwordx4 v144, s[16:19], s47 offen lds
    s_add_u32 m0, s54, 156672
    s_xor_b32 s47, s47, 128
    buffer_load_dwordx4 v144, s[16:19], s47 offen lds
    s_add_u32 m0, s54, 65536
    s_add_u32 s47, s70, 131072
    buffer_load_dwordx4 v144, s[16:19], s47 offen lds
    s_add_u32 m0, s54, 66560
    s_xor_b32 s47, s47, 128
    buffer_load_dwordx4 v144, s[16:19], s47 offen lds
    s_add_u32 m0, s54, 73728
    s_add_u32 s47, s71, 131072
    buffer_load_dwordx4 v144, s[16:19], s47 offen lds
    s_add_u32 m0, s54, 74752
    s_xor_b32 s47, s47, 128
    buffer_load_dwordx4 v144, s[16:19], s47 offen lds
    s_add_u32 m0, s54, 0
    s_xor_b32 s47, s56, 262144
    buffer_load_dwordx4 v144, s[84:87], s47 offen lds
    s_add_u32 m0, s54, 1024
    s_xor_b32 s47, s47, 128
    buffer_load_dwordx4 v144, s[84:87], s47 offen lds
    s_add_u32 m0, s54, 8192
    s_xor_b32 s47, s56, 327680
    buffer_load_dwordx4 v144, s[84:87], s47 offen lds
    s_add_u32 m0, s54, 9216
    s_xor_b32 s47, s47, 128
    buffer_load_dwordx4 v144, s[84:87], s47 offen lds
    s_add_u32 m0, s54, 16384
    s_xor_b32 s47, s56, 393216
    buffer_load_dwordx4 v144, s[84:87], s47 offen lds
    s_add_u32 m0, s54, 17408
    s_xor_b32 s47, s47, 128
    buffer_load_dwordx4 v144, s[84:87], s47 offen lds
    s_add_u32 m0, s54, 24576
    s_xor_b32 s47, s56, 458752
    buffer_load_dwordx4 v144, s[84:87], s47 offen lds
    s_add_u32 m0, s54, 25600
    s_xor_b32 s47, s47, 128
    buffer_load_dwordx4 v144, s[84:87], s47 offen lds
    s_waitcnt vmcnt(0)
    s_barrier
    s_add_u32 m0, s54, 81920
    s_add_u32 s47, s72, 131072
    buffer_load_dwordx4 v144, s[16:19], s47 offen lds
    s_add_u32 m0, s54, 82944
    s_xor_b32 s47, s47, 128
    buffer_load_dwordx4 v144, s[16:19], s47 offen lds
    s_add_u32 m0, s54, 90112
    s_add_u32 s47, s73, 131072
    buffer_load_dwordx4 v144, s[16:19], s47 offen lds
    s_add_u32 m0, s54, 91136
    s_xor_b32 s47, s47, 128
    buffer_load_dwordx4 v144, s[16:19], s47 offen lds
    buffer_load_dword v150, v149, s[12:15], s58 offen offset:1024 sc1
    s_waitcnt vmcnt(0)
    v_cmp_gt_u32 vcc, 2, v150
    s_nop 1
    s_cbranch_vccnz fused_kernel_spin_ao
fused_kernel_ret_ao:
    s_xor_b32 s46, s51, 4096
    s_add_u32 s46, s46, s44
    buffer_load_dwordx4 v[32:35], v158, s[12:15], s46 offen offset:2048 sc1
    buffer_load_dwordx4 v[36:39], v158, s[12:15], s46 offen offset:3072 sc1
    s_xor_b32 s46, s51, 8192
    s_add_u32 s46, s46, s44
    buffer_load_dwordx4 v[40:43], v158, s[12:15], s46 offen offset:2048 sc1
    buffer_load_dwordx4 v[44:47], v158, s[12:15], s46 offen offset:3072 sc1
    s_xor_b32 s46, s51, 12288
    s_add_u32 s46, s46, s44
    buffer_load_dwordx4 a[0:3], v158, s[12:15], s46 offen offset:2048 sc1
    buffer_load_dwordx4 a[4:7], v158, s[12:15], s46 offen offset:3072 sc1
    s_xor_b32 s46, s51, 16384
    s_add_u32 s46, s46, s44
    buffer_load_dwordx4 a[8:11], v158, s[12:15], s46 offen offset:2048 sc1
    buffer_load_dwordx4 a[12:15], v158, s[12:15], s46 offen offset:3072 sc1
    s_xor_b32 s46, s51, 20480
    s_add_u32 s46, s46, s44
    buffer_load_dwordx4 a[16:19], v158, s[12:15], s46 offen offset:2048 sc1
    buffer_load_dwordx4 a[20:23], v158, s[12:15], s46 offen offset:3072 sc1
    s_xor_b32 s46, s51, 24576
    s_add_u32 s46, s46, s44
    buffer_load_dwordx4 a[24:27], v158, s[12:15], s46 offen offset:2048 sc1
    buffer_load_dwordx4 a[28:31], v158, s[12:15], s46 offen offset:3072 sc1
    s_xor_b32 s46, s51, 28672
    s_add_u32 s46, s46, s44
    buffer_load_dwordx4 a[88:91], v158, s[12:15], s46 offen offset:2048 sc1
    buffer_load_dwordx4 a[92:95], v158, s[12:15], s46 offen offset:3072 sc1
    ds_read_b64_tr_b16 v[48:49], v136 offset:49152
    ds_read_b64_tr_b16 v[50:51], v136 offset:53248
    ds_read_b64_tr_b16 v[52:53], v136 offset:57344
    ds_read_b64_tr_b16 v[54:55], v136 offset:61440
    ds_read_b64_tr_b16 v[56:57], v137 offset:49152
    ds_read_b64_tr_b16 v[58:59], v137 offset:53248
    ds_read_b64_tr_b16 v[60:61], v137 offset:57344
    ds_read_b64_tr_b16 v[62:63], v137 offset:61440
    ds_read_b64_tr_b16 v[80:81], v136 offset:32768
    ds_read_b64_tr_b16 v[82:83], v136 offset:36864
    ds_read_b64_tr_b16 v[84:85], v136 offset:40960
    ds_read_b64_tr_b16 v[86:87], v136 offset:45056
    s_waitcnt vmcnt(12) lgkmcnt(8)
    v_mfma_f32_16x16x32_bf16 v[0:3], v[48:51], v[64:67], 0
    ds_read_b64_tr_b16 v[88:89], v137 offset:32768
    v_mfma_f32_16x16x32_bf16 v[0:3], v[52:55], a[32:35], v[0:3]
    v_mfma_f32_16x16x32_bf16 v[4:7], v[52:55], a[36:39], 0
    ds_read_b64_tr_b16 v[90:91], v137 offset:36864
    v_mfma_f32_16x16x32_bf16 v[4:7], v[48:51], v[68:71], v[4:7]
    v_mfma_f32_16x16x32_bf16 v[8:11], v[48:51], v[72:75], 0
    ds_read_b64_tr_b16 v[92:93], v137 offset:40960
    v_mfma_f32_16x16x32_bf16 v[8:11], v[52:55], v[32:35], v[8:11]
    v_mfma_f32_16x16x32_bf16 v[12:15], v[52:55], v[36:39], 0
    ds_read_b64_tr_b16 v[94:95], v137 offset:45056
    v_mfma_f32_16x16x32_bf16 v[12:15], v[48:51], v[76:79], v[12:15]
    s_waitcnt lgkmcnt(8)
    v_mfma_f32_16x16x32_bf16 v[28:31], v[56:59], v[76:79], 0
    ds_read_b64_tr_b16 v[48:49], v136 offset:0
    v_mfma_f32_16x16x32_bf16 v[28:31], v[60:63], v[36:39], v[28:31]
    v_mfma_f32_16x16x32_bf16 v[24:27], v[60:63], v[32:35], 0
    ds_read_b64_tr_b16 v[50:51], v136 offset:4096
    v_mfma_f32_16x16x32_bf16 v[24:27], v[56:59], v[72:75], v[24:27]
    v_mfma_f32_16x16x32_bf16 v[20:23], v[56:59], v[68:71], 0
    ds_read_b64_tr_b16 v[52:53], v136 offset:8192
    v_mfma_f32_16x16x32_bf16 v[20:23], v[60:63], a[36:39], v[20:23]
    v_mfma_f32_16x16x32_bf16 v[16:19], v[60:63], a[32:35], 0
    ds_read_b64_tr_b16 v[54:55], v136 offset:12288
    v_mfma_f32_16x16x32_bf16 v[16:19], v[56:59], v[64:67], v[16:19]
    s_waitcnt vmcnt(8) lgkmcnt(8)
    v_mfma_f32_16x16x32_bf16 v[0:3], v[80:83], a[40:43], v[0:3]
    ds_read_b64_tr_b16 v[56:57], v137 offset:0
    v_mfma_f32_16x16x32_bf16 v[0:3], v[84:87], a[48:51], v[0:3]
    v_mfma_f32_16x16x32_bf16 v[4:7], v[84:87], a[52:55], v[4:7]
    ds_read_b64_tr_b16 v[58:59], v137 offset:4096
    v_mfma_f32_16x16x32_bf16 v[4:7], v[80:83], a[44:47], v[4:7]
    v_mfma_f32_16x16x32_bf16 v[8:11], v[80:83], v[40:43], v[8:11]
    ds_read_b64_tr_b16 v[60:61], v137 offset:8192
    v_mfma_f32_16x16x32_bf16 v[8:11], v[84:87], a[0:3], v[8:11]
    v_mfma_f32_16x16x32_bf16 v[12:15], v[84:87], a[4:7], v[12:15]
    ds_read_b64_tr_b16 v[62:63], v137 offset:12288
    v_mfma_f32_16x16x32_bf16 v[12:15], v[80:83], v[44:47], v[12:15]
    s_waitcnt lgkmcnt(8)
    v_mfma_f32_16x16x32_bf16 v[28:31], v[88:91], v[44:47], v[28:31]
    ds_read_b64_tr_b16 v[80:81], v136 offset:16384
    v_mfma_f32_16x16x32_bf16 v[28:31], v[92:95], a[4:7], v[28:31]
    v_mfma_f32_16x16x32_bf16 v[24:27], v[92:95], a[0:3], v[24:27]
    ds_read_b64_tr_b16 v[82:83], v136 offset:20480
    v_mfma_f32_16x16x32_bf16 v[24:27], v[88:91], v[40:43], v[24:27]
    v_mfma_f32_16x16x32_bf16 v[20:23], v[88:91], a[44:47], v[20:23]
    ds_read_b64_tr_b16 v[84:85], v136 offset:24576
    v_mfma_f32_16x16x32_bf16 v[20:23], v[92:95], a[52:55], v[20:23]
    v_mfma_f32_16x16x32_bf16 v[16:19], v[92:95], a[48:51], v[16:19]
    ds_read_b64_tr_b16 v[86:87], v136 offset:28672
    v_mfma_f32_16x16x32_bf16 v[16:19], v[88:91], a[40:43], v[16:19]
    s_waitcnt vmcnt(4) lgkmcnt(8)
    v_mfma_f32_16x16x32_bf16 v[0:3], v[48:51], a[56:59], v[0:3]
    ds_read_b64_tr_b16 v[88:89], v137 offset:16384
    v_mfma_f32_16x16x32_bf16 v[0:3], v[52:55], a[64:67], v[0:3]
    v_mfma_f32_16x16x32_bf16 v[4:7], v[52:55], a[68:71], v[4:7]
    ds_read_b64_tr_b16 v[90:91], v137 offset:20480
    v_mfma_f32_16x16x32_bf16 v[4:7], v[48:51], a[60:63], v[4:7]
    v_mfma_f32_16x16x32_bf16 v[8:11], v[48:51], a[8:11], v[8:11]
    ds_read_b64_tr_b16 v[92:93], v137 offset:24576
    v_mfma_f32_16x16x32_bf16 v[8:11], v[52:55], a[16:19], v[8:11]
    v_mfma_f32_16x16x32_bf16 v[12:15], v[52:55], a[20:23], v[12:15]
    ds_read_b64_tr_b16 v[94:95], v137 offset:28672
    v_mfma_f32_16x16x32_bf16 v[12:15], v[48:51], a[12:15], v[12:15]
    s_waitcnt lgkmcnt(8)
    v_mfma_f32_16x16x32_bf16 v[28:31], v[56:59], a[12:15], v[28:31]
    ds_read_b64_tr_b16 v[48:49], v134 offset:50176
    v_mfma_f32_16x16x32_bf16 v[28:31], v[60:63], a[20:23], v[28:31]
    v_mfma_f32_16x16x32_bf16 v[24:27], v[60:63], a[16:19], v[24:27]
    ds_read_b64_tr_b16 v[50:51], v134 offset:54272
    v_mfma_f32_16x16x32_bf16 v[24:27], v[56:59], a[8:11], v[24:27]
    v_mfma_f32_16x16x32_bf16 v[20:23], v[56:59], a[60:63], v[20:23]
    ds_read_b64_tr_b16 v[52:53], v134 offset:58368
    v_mfma_f32_16x16x32_bf16 v[20:23], v[60:63], a[68:71], v[20:23]
    v_mfma_f32_16x16x32_bf16 v[16:19], v[60:63], a[64:67], v[16:19]
    ds_read_b64_tr_b16 v[54:55], v134 offset:62464
    v_mfma_f32_16x16x32_bf16 v[16:19], v[56:59], a[56:59], v[16:19]
    s_waitcnt vmcnt(0) lgkmcnt(8)
    v_mfma_f32_16x16x32_bf16 v[0:3], v[80:83], a[72:75], v[0:3]
    ds_read_b64_tr_b16 v[56:57], v135 offset:50176
    v_mfma_f32_16x16x32_bf16 v[0:3], v[84:87], a[80:83], v[0:3]
    v_mfma_f32_16x16x32_bf16 v[4:7], v[84:87], a[84:87], v[4:7]
    ds_read_b64_tr_b16 v[58:59], v135 offset:54272
    v_mfma_f32_16x16x32_bf16 v[4:7], v[80:83], a[76:79], v[4:7]
    v_mfma_f32_16x16x32_bf16 v[8:11], v[80:83], a[24:27], v[8:11]
    ds_read_b64_tr_b16 v[60:61], v135 offset:58368
    v_mfma_f32_16x16x32_bf16 v[8:11], v[84:87], a[88:91], v[8:11]
    v_mfma_f32_16x16x32_bf16 v[12:15], v[84:87], a[92:95], v[12:15]
    ds_read_b64_tr_b16 v[62:63], v135 offset:62464
    v_mfma_f32_16x16x32_bf16 v[12:15], v[80:83], a[28:31], v[12:15]
    s_waitcnt lgkmcnt(8)
    v_mfma_f32_16x16x32_bf16 v[28:31], v[88:91], a[28:31], v[28:31]
    ds_read_b64_tr_b16 v[80:81], v134 offset:33792
    v_mfma_f32_16x16x32_bf16 v[28:31], v[92:95], a[92:95], v[28:31]
    v_mfma_f32_16x16x32_bf16 v[24:27], v[92:95], a[88:91], v[24:27]
    ds_read_b64_tr_b16 v[82:83], v134 offset:37888
    v_mfma_f32_16x16x32_bf16 v[24:27], v[88:91], a[24:27], v[24:27]
    v_mfma_f32_16x16x32_bf16 v[20:23], v[88:91], a[76:79], v[20:23]
    ds_read_b64_tr_b16 v[84:85], v134 offset:41984
    s_barrier
    v_mfma_f32_16x16x32_bf16 v[20:23], v[92:95], a[84:87], v[20:23]
    v_cvt_pk_bf16_f32 v12, v12, v13
    v_cvt_pk_bf16_f32 v13, v14, v15
    v_mfma_f32_16x16x32_bf16 v[16:19], v[92:95], a[80:83], v[16:19]
    ds_read_b64_tr_b16 v[86:87], v134 offset:46080
    v_cvt_pk_bf16_f32 v14, v28, v29
    v_mfma_f32_16x16x32_bf16 v[16:19], v[88:91], a[72:75], v[16:19]
    v_cvt_pk_bf16_f32 v15, v30, v31
    ds_write_b128 v156, v[12:15] offset:3072
    s_waitcnt lgkmcnt(9)
    v_mfma_f32_16x16x32_bf16 v[96:99], v[48:51], v[64:67], 0
    ds_read_b64_tr_b16 v[88:89], v135 offset:33792
    v_cvt_pk_bf16_f32 v8, v8, v9
    v_mfma_f32_16x16x32_bf16 v[96:99], v[52:55], a[32:35], v[96:99]
    v_cvt_pk_bf16_f32 v9, v10, v11
    v_cvt_pk_bf16_f32 v10, v24, v25
    v_mfma_f32_16x16x32_bf16 v[100:103], v[52:55], a[36:39], 0
    ds_read_b64_tr_b16 v[90:91], v135 offset:37888
    v_cvt_pk_bf16_f32 v11, v26, v27
    v_mfma_f32_16x16x32_bf16 v[100:103], v[48:51], v[68:71], v[100:103]
    ds_write_b128 v156, v[8:11] offset:2048
    v_cvt_pk_bf16_f32 v4, v4, v5
    v_mfma_f32_16x16x32_bf16 v[104:107], v[48:51], v[72:75], 0
    ds_read_b64_tr_b16 v[92:93], v135 offset:41984
    v_cvt_pk_bf16_f32 v5, v6, v7
    v_mfma_f32_16x16x32_bf16 v[104:107], v[52:55], v[32:35], v[104:107]
    v_cvt_pk_bf16_f32 v6, v20, v21
    v_cvt_pk_bf16_f32 v7, v22, v23
    v_mfma_f32_16x16x32_bf16 v[108:111], v[52:55], v[36:39], 0
    ds_read_b64_tr_b16 v[94:95], v135 offset:46080
    ds_write_b128 v156, v[4:7] offset:1024
    v_mfma_f32_16x16x32_bf16 v[108:111], v[48:51], v[76:79], v[108:111]
    v_cvt_pk_bf16_f32 v0, v0, v1
fused_kernel_pg15:
    s_cbranch_execz fused_kernel_pgrA
    v_cvt_pk_bf16_f32 v1, v2, v3
    s_waitcnt lgkmcnt(11)
    v_mfma_f32_16x16x32_bf16 v[124:127], v[56:59], v[76:79], 0
    ds_read_b64_tr_b16 v[48:49], v134 offset:1024
    v_cvt_pk_bf16_f32 v2, v16, v17
    v_mfma_f32_16x16x32_bf16 v[124:127], v[60:63], v[36:39], v[124:127]
    v_cvt_pk_bf16_f32 v3, v18, v19
    ds_write_b128 v156, v[0:3] offset:0
    v_mfma_f32_16x16x32_bf16 v[120:123], v[60:63], v[32:35], 0
    ds_read_b64_tr_b16 v[50:51], v134 offset:5120
    v_mfma_f32_16x16x32_bf16 v[120:123], v[56:59], v[72:75], v[120:123]
    v_mfma_f32_16x16x32_bf16 v[116:119], v[56:59], v[68:71], 0
    ds_read_b64_tr_b16 v[52:53], v134 offset:9216
    v_mfma_f32_16x16x32_bf16 v[116:119], v[60:63], a[36:39], v[116:119]
    v_mfma_f32_16x16x32_bf16 v[112:115], v[60:63], a[32:35], 0
    ds_read_b64_tr_b16 v[54:55], v134 offset:13312
    v_mfma_f32_16x16x32_bf16 v[112:115], v[56:59], v[64:67], v[112:115]
    s_waitcnt lgkmcnt(3)
    s_barrier
    v_mfma_f32_16x16x32_bf16 v[96:99], v[80:83], a[40:43], v[96:99]
    ds_read_b64_tr_b16 v[56:57], v135 offset:1024
    v_mfma_f32_16x16x32_bf16 v[96:99], v[84:87], a[48:51], v[96:99]
    v_mfma_f32_16x16x32_bf16 v[100:103], v[84:87], a[52:55], v[100:103]
    ds_read_b64_tr_b16 v[58:59], v135 offset:5120
    v_mfma_f32_16x16x32_bf16 v[100:103], v[80:83], a[44:47], v[100:103]
    v_mfma_f32_16x16x32_bf16 v[104:107], v[80:83], v[40:43], v[104:107]
    ds_read_b64_tr_b16 v[60:61], v135 offset:9216
    v_mfma_f32_16x16x32_bf16 v[104:107], v[84:87], a[0:3], v[104:107]
    v_mfma_f32_16x16x32_bf16 v[108:111], v[84:87], a[4:7], v[108:111]
    ds_read_b64_tr_b16 v[62:63], v135 offset:13312
    v_mfma_f32_16x16x32_bf16 v[108:111], v[80:83], v[44:47], v[108:111]
    v_mfma_f32_16x16x32_bf16 v[124:127], v[88:91], v[44:47], v[124:127]
    ds_read_b64_tr_b16 v[80:81], v134 offset:17408
    v_mfma_f32_16x16x32_bf16 v[124:127], v[92:95], a[4:7], v[124:127]
    v_mfma_f32_16x16x32_bf16 v[120:123], v[92:95], a[0:3], v[120:123]
    ds_read_b64_tr_b16 v[82:83], v134 offset:21504
    v_mfma_f32_16x16x32_bf16 v[120:123], v[88:91], v[40:43], v[120:123]
    v_mfma_f32_16x16x32_bf16 v[116:119], v[88:91], a[44:47], v[116:119]
    ds_read_b64_tr_b16 v[84:85], v134 offset:25600
    v_mfma_f32_16x16x32_bf16 v[116:119], v[92:95], a[52:55], v[116:119]
    v_mfma_f32_16x16x32_bf16 v[112:115], v[92:95], a[48:51], v[112:115]
    ds_read_b64_tr_b16 v[86:87], v134 offset:29696
    v_mfma_f32_16x16x32_bf16 v[112:115], v[88:91], a[40:43], v[112:115]
    s_waitcnt lgkmcnt(8)
    v_mfma_f32_16x16x32_bf16 v[96:99], v[48:51], a[56:59], v[96:99]
    ds_read_b64_tr_b16 v[88:89], v135 offset:17408
    v_mfma_f32_16x16x32_bf16 v[96:99], v[52:55], a[64:67], v[96:99]
    v_mfma_f32_16x16x32_bf16 v[100:103], v[52:55], a[68:71], v[100:103]
    ds_read_b64_tr_b16 v[90:91], v135 offset:21504
    v_mfma_f32_16x16x32_bf16 v[100:103], v[48:51], a[60:63], v[100:103]
    v_mfma_f32_16x16x32_bf16 v[104:107], v[48:51], a[8:11], v[104:107]
    ds_read_b64_tr_b16 v[92:93], v135 offset:25600
    v_mfma_f32_16x16x32_bf16 v[104:107], v[52:55], a[16:19], v[104:107]
    v_mfma_f32_16x16x32_bf16 v[108:111], v[52:55], a[20:23], v[108:111]
    ds_read_b64_tr_b16 v[94:95], v135 offset:29696
    v_mfma_f32_16x16x32_bf16 v[108:111], v[48:51], a[12:15], v[108:111]
    s_waitcnt lgkmcnt(8)
    v_mfma_f32_16x16x32_bf16 v[124:127], v[56:59], a[12:15], v[124:127]
    ds_read_b64_tr_b16 v[48:49], v136 offset:50176
    v_mfma_f32_16x16x32_bf16 v[124:127], v[60:63], a[20:23], v[124:127]
    v_mfma_f32_16x16x32_bf16 v[120:123], v[60:63], a[16:19], v[120:123]
    ds_read_b64_tr_b16 v[50:51], v136 offset:54272
    v_mfma_f32_16x16x32_bf16 v[120:123], v[56:59], a[8:11], v[120:123]
    v_mfma_f32_16x16x32_bf16 v[116:119], v[56:59], a[60:63], v[116:119]
    ds_read_b64_tr_b16 v[52:53], v136 offset:58368
    v_mfma_f32_16x16x32_bf16 v[116:119], v[60:63], a[68:71], v[116:119]
    v_mfma_f32_16x16x32_bf16 v[112:115], v[60:63], a[64:67], v[112:115]
    ds_read_b64_tr_b16 v[54:55], v136 offset:62464
    v_mfma_f32_16x16x32_bf16 v[112:115], v[56:59], a[56:59], v[112:115]
    s_waitcnt lgkmcnt(8)
    v_mfma_f32_16x16x32_bf16 v[96:99], v[80:83], a[72:75], v[96:99]
    ds_read_b64_tr_b16 v[56:57], v137 offset:50176
    v_mfma_f32_16x16x32_bf16 v[96:99], v[84:87], a[80:83], v[96:99]
    v_mfma_f32_16x16x32_bf16 v[100:103], v[84:87], a[84:87], v[100:103]
    ds_read_b64_tr_b16 v[58:59], v137 offset:54272
    v_mfma_f32_16x16x32_bf16 v[100:103], v[80:83], a[76:79], v[100:103]
    v_mfma_f32_16x16x32_bf16 v[104:107], v[80:83], a[24:27], v[104:107]
    ds_read_b64_tr_b16 v[60:61], v137 offset:58368
    v_mfma_f32_16x16x32_bf16 v[104:107], v[84:87], a[88:91], v[104:107]
    v_mfma_f32_16x16x32_bf16 v[108:111], v[84:87], a[92:95], v[108:111]
    ds_read_b64_tr_b16 v[62:63], v137 offset:62464
    v_mfma_f32_16x16x32_bf16 v[108:111], v[80:83], a[28:31], v[108:111]
    s_waitcnt lgkmcnt(8)
    v_mfma_f32_16x16x32_bf16 v[124:127], v[88:91], a[28:31], v[124:127]
    ds_read_b64_tr_b16 v[80:81], v136 offset:33792
    v_mfma_f32_16x16x32_bf16 v[124:127], v[92:95], a[92:95], v[124:127]
    v_mfma_f32_16x16x32_bf16 v[120:123], v[92:95], a[88:91], v[120:123]
    ds_read_b64_tr_b16 v[82:83], v136 offset:37888
    v_mfma_f32_16x16x32_bf16 v[120:123], v[88:91], a[24:27], v[120:123]
    v_mfma_f32_16x16x32_bf16 v[116:119], v[88:91], a[76:79], v[116:119]
    ds_read_b64_tr_b16 v[84:85], v136 offset:41984
    v_mfma_f32_16x16x32_bf16 v[116:119], v[92:95], a[84:87], v[116:119]
    v_cvt_pk_bf16_f32 v108, v108, v109
    v_cvt_pk_bf16_f32 v109, v110, v111
    v_mfma_f32_16x16x32_bf16 v[112:115], v[92:95], a[80:83], v[112:115]
    ds_read_b64_tr_b16 v[86:87], v136 offset:46080
    v_cvt_pk_bf16_f32 v110, v124, v125
    v_mfma_f32_16x16x32_bf16 v[112:115], v[88:91], a[72:75], v[112:115]
    v_cvt_pk_bf16_f32 v111, v126, v127
    ds_write_b128 v156, v[108:111] offset:19456
    s_waitcnt lgkmcnt(9)
    v_mfma_f32_16x16x32_bf16 v[0:3], v[48:51], v[64:67], 0
    ds_read_b64_tr_b16 v[88:89], v137 offset:33792
    v_cvt_pk_bf16_f32 v104, v104, v105
    v_mfma_f32_16x16x32_bf16 v[0:3], v[52:55], a[32:35], v[0:3]
    v_cvt_pk_bf16_f32 v105, v106, v107
    v_cvt_pk_bf16_f32 v106, v120, v121
    v_mfma_f32_16x16x32_bf16 v[4:7], v[52:55], a[36:39], 0
    ds_read_b64_tr_b16 v[90:91], v137 offset:37888
    v_cvt_pk_bf16_f32 v107, v122, v123
    v_mfma_f32_16x16x32_bf16 v[4:7], v[48:51], v[68:71], v[4:7]
    ds_write_b128 v156, v[104:107] offset:18432
    v_cvt_pk_bf16_f32 v100, v100, v101
    v_mfma_f32_16x16x32_bf16 v[8:11], v[48:51], v[72:75], 0
    ds_read_b64_tr_b16 v[92:93], v137 offset:41984
    v_cvt_pk_bf16_f32 v101, v102, v103
    v_mfma_f32_16x16x32_bf16 v[8:11], v[52:55], v[32:35], v[8:11]
    v_cvt_pk_bf16_f32 v102, v116, v117
    v_cvt_pk_bf16_f32 v103, v118, v119
    v_mfma_f32_16x16x32_bf16 v[12:15], v[52:55], v[36:39], 0
    ds_read_b64_tr_b16 v[94:95], v137 offset:46080
    ds_write_b128 v156, v[100:103] offset:17408
    v_mfma_f32_16x16x32_bf16 v[12:15], v[48:51], v[76:79], v[12:15]
    v_cvt_pk_bf16_f32 v96, v96, v97
    v_cvt_pk_bf16_f32 v97, v98, v99
    s_waitcnt lgkmcnt(11)
    v_mfma_f32_16x16x32_bf16 v[28:31], v[56:59], v[76:79], 0
    ds_read_b64_tr_b16 v[48:49], v136 offset:1024
    v_cvt_pk_bf16_f32 v98, v112, v113
    v_mfma_f32_16x16x32_bf16 v[28:31], v[60:63], v[36:39], v[28:31]
    v_cvt_pk_bf16_f32 v99, v114, v115
    ds_write_b128 v156, v[96:99] offset:16384
    v_mfma_f32_16x16x32_bf16 v[24:27], v[60:63], v[32:35], 0
    ds_read_b64_tr_b16 v[50:51], v136 offset:5120
    v_mfma_f32_16x16x32_bf16 v[24:27], v[56:59], v[72:75], v[24:27]
    v_mfma_f32_16x16x32_bf16 v[20:23], v[56:59], v[68:71], 0
    ds_read_b64_tr_b16 v[52:53], v136 offset:9216
    v_mfma_f32_16x16x32_bf16 v[20:23], v[60:63], a[36:39], v[20:23]
    v_mfma_f32_16x16x32_bf16 v[16:19], v[60:63], a[32:35], 0
    ds_read_b64_tr_b16 v[54:55], v136 offset:13312
    v_mfma_f32_16x16x32_bf16 v[16:19], v[56:59], v[64:67], v[16:19]
    s_waitcnt lgkmcnt(3)
    s_barrier
    v_mfma_f32_16x16x32_bf16 v[0:3], v[80:83], a[40:43], v[0:3]
    ds_read_b64_tr_b16 v[56:57], v137 offset:1024
    v_mfma_f32_16x16x32_bf16 v[0:3], v[84:87], a[48:51], v[0:3]
    v_mfma_f32_16x16x32_bf16 v[4:7], v[84:87], a[52:55], v[4:7]
    ds_read_b64_tr_b16 v[58:59], v137 offset:5120
    v_mfma_f32_16x16x32_bf16 v[4:7], v[80:83], a[44:47], v[4:7]
    v_mfma_f32_16x16x32_bf16 v[8:11], v[80:83], v[40:43], v[8:11]
    ds_read_b64_tr_b16 v[60:61], v137 offset:9216
    v_mfma_f32_16x16x32_bf16 v[8:11], v[84:87], a[0:3], v[8:11]
    v_mfma_f32_16x16x32_bf16 v[12:15], v[84:87], a[4:7], v[12:15]
    ds_read_b64_tr_b16 v[62:63], v137 offset:13312
    v_mfma_f32_16x16x32_bf16 v[12:15], v[80:83], v[44:47], v[12:15]
    v_mfma_f32_16x16x32_bf16 v[28:31], v[88:91], v[44:47], v[28:31]
    ds_read_b64_tr_b16 v[80:81], v136 offset:17408
    v_mfma_f32_16x16x32_bf16 v[28:31], v[92:95], a[4:7], v[28:31]
    v_mfma_f32_16x16x32_bf16 v[24:27], v[92:95], a[0:3], v[24:27]
    ds_read_b64_tr_b16 v[82:83], v136 offset:21504
    v_mfma_f32_16x16x32_bf16 v[24:27], v[88:91], v[40:43], v[24:27]
    v_mfma_f32_16x16x32_bf16 v[20:23], v[88:91], a[44:47], v[20:23]
    ds_read_b64_tr_b16 v[84:85], v136 offset:25600
    v_mfma_f32_16x16x32_bf16 v[20:23], v[92:95], a[52:55], v[20:23]
    v_mfma_f32_16x16x32_bf16 v[16:19], v[92:95], a[48:51], v[16:19]
    ds_read_b64_tr_b16 v[86:87], v136 offset:29696
    v_mfma_f32_16x16x32_bf16 v[16:19], v[88:91], a[40:43], v[16:19]
    s_waitcnt lgkmcnt(8)
    v_mfma_f32_16x16x32_bf16 v[0:3], v[48:51], a[56:59], v[0:3]
    ds_read_b64_tr_b16 v[88:89], v137 offset:17408
    v_mfma_f32_16x16x32_bf16 v[0:3], v[52:55], a[64:67], v[0:3]
    v_mfma_f32_16x16x32_bf16 v[4:7], v[52:55], a[68:71], v[4:7]
    ds_read_b64_tr_b16 v[90:91], v137 offset:21504
    v_mfma_f32_16x16x32_bf16 v[4:7], v[48:51], a[60:63], v[4:7]
    v_mfma_f32_16x16x32_bf16 v[8:11], v[48:51], a[8:11], v[8:11]
    ds_read_b64_tr_b16 v[92:93], v137 offset:25600
    v_mfma_f32_16x16x32_bf16 v[8:11], v[52:55], a[16:19], v[8:11]
    v_mfma_f32_16x16x32_bf16 v[12:15], v[52:55], a[20:23], v[12:15]
    ds_read_b64_tr_b16 v[94:95], v137 offset:29696
    v_mfma_f32_16x16x32_bf16 v[12:15], v[48:51], a[12:15], v[12:15]
    s_waitcnt lgkmcnt(8)
    v_mfma_f32_16x16x32_bf16 v[28:31], v[56:59], a[12:15], v[28:31]
    ds_read_b64_tr_b16 v[48:49], v134 offset:49152
    v_mfma_f32_16x16x32_bf16 v[28:31], v[60:63], a[20:23], v[28:31]
    v_mfma_f32_16x16x32_bf16 v[24:27], v[60:63], a[16:19], v[24:27]
    ds_read_b64_tr_b16 v[50:51], v134 offset:53248
    s_xor_b32 s45, s57, 128
    buffer_load_dword v146, v147, s[12:15], s45 offen sc1
    v_mfma_f32_16x16x32_bf16 v[24:27], v[56:59], a[8:11], v[24:27]
    v_mfma_f32_16x16x32_bf16 v[20:23], v[56:59], a[60:63], v[20:23]
    ds_read_b64_tr_b16 v[52:53], v134 offset:57344
    v_mfma_f32_16x16x32_bf16 v[20:23], v[60:63], a[68:71], v[20:23]
    v_mfma_f32_16x16x32_bf16 v[16:19], v[60:63], a[64:67], v[16:19]
    ds_read_b64_tr_b16 v[54:55], v134 offset:61440
    v_mfma_f32_16x16x32_bf16 v[16:19], v[56:59], a[56:59], v[16:19]
    s_waitcnt lgkmcnt(8)
    v_mfma_f32_16x16x32_bf16 v[0:3], v[80:83], a[72:75], v[0:3]
    ds_read_b64_tr_b16 v[56:57], v135 offset:49152
    v_mfma_f32_16x16x32_bf16 v[0:3], v[84:87], a[80:83], v[0:3]
    v_mfma_f32_16x16x32_bf16 v[4:7], v[84:87], a[84:87], v[4:7]
    ds_read_b64_tr_b16 v[58:59], v135 offset:53248
    v_mfma_f32_16x16x32_bf16 v[4:7], v[80:83], a[76:79], v[4:7]
    v_mfma_f32_16x16x32_bf16 v[8:11], v[80:83], a[24:27], v[8:11]
    ds_read_b64_tr_b16 v[60:61], v135 offset:57344
    v_mfma_f32_16x16x32_bf16 v[8:11], v[84:87], a[88:91], v[8:11]
    v_mfma_f32_16x16x32_bf16 v[12:15], v[84:87], a[92:95], v[12:15]
    ds_read_b64_tr_b16 v[62:63], v135 offset:61440
    v_mfma_f32_16x16x32_bf16 v[12:15], v[80:83], a[28:31], v[12:15]
    s_waitcnt lgkmcnt(8)
    v_mfma_f32_16x16x32_bf16 v[28:31], v[88:91], a[28:31], v[28:31]
    ds_read_b64_tr_b16 v[80:81], v134 offset:32768
    v_mfma_f32_16x16x32_bf16 v[28:31], v[92:95], a[92:95], v[28:31]
    v_mfma_f32_16x16x32_bf16 v[24:27], v[92:95], a[88:91], v[24:27]
    ds_read_b64_tr_b16 v[82:83], v134 offset:36864
    v_mfma_f32_16x16x32_bf16 v[24:27], v[88:91], a[24:27], v[24:27]
    v_mfma_f32_16x16x32_bf16 v[20:23], v[88:91], a[76:79], v[20:23]
    ds_read_b64_tr_b16 v[84:85], v134 offset:40960
    v_mfma_f32_16x16x32_bf16 v[20:23], v[92:95], a[84:87], v[20:23]
    v_cvt_pk_bf16_f32 v12, v12, v13
    v_cvt_pk_bf16_f32 v13, v14, v15
    v_mfma_f32_16x16x32_bf16 v[16:19], v[92:95], a[80:83], v[16:19]
    ds_read_b64_tr_b16 v[86:87], v134 offset:45056
    v_cvt_pk_bf16_f32 v14, v28, v29
    v_mfma_f32_16x16x32_bf16 v[16:19], v[88:91], a[72:75], v[16:19]
    v_cvt_pk_bf16_f32 v15, v30, v31
    ds_write_b128 v156, v[12:15] offset:35840
    s_waitcnt lgkmcnt(9)
    v_mfma_f32_16x16x32_bf16 v[96:99], v[48:51], v[64:67], 0
    ds_read_b64_tr_b16 v[88:89], v135 offset:32768
    v_cvt_pk_bf16_f32 v8, v8, v9
    v_mfma_f32_16x16x32_bf16 v[96:99], v[52:55], a[32:35], v[96:99]
    v_cvt_pk_bf16_f32 v9, v10, v11
    v_cvt_pk_bf16_f32 v10, v24, v25
    v_mfma_f32_16x16x32_bf16 v[100:103], v[52:55], a[36:39], 0
    ds_read_b64_tr_b16 v[90:91], v135 offset:36864
    v_cvt_pk_bf16_f32 v11, v26, v27
    v_mfma_f32_16x16x32_bf16 v[100:103], v[48:51], v[68:71], v[100:103]
    ds_write_b128 v156, v[8:11] offset:34816
    v_cvt_pk_bf16_f32 v4, v4, v5
    v_mfma_f32_16x16x32_bf16 v[104:107], v[48:51], v[72:75], 0
    ds_read_b64_tr_b16 v[92:93], v135 offset:40960
    v_cvt_pk_bf16_f32 v5, v6, v7
    v_mfma_f32_16x16x32_bf16 v[104:107], v[52:55], v[32:35], v[104:107]
    v_cvt_pk_bf16_f32 v6, v20, v21
    v_cvt_pk_bf16_f32 v7, v22, v23
    v_mfma_f32_16x16x32_bf16 v[108:111], v[52:55], v[36:39], 0
    ds_read_b64_tr_b16 v[94:95], v135 offset:45056
    ds_write_b128 v156, v[4:7] offset:33792
    v_mfma_f32_16x16x32_bf16 v[108:111], v[48:51], v[76:79], v[108:111]
    v_cvt_pk_bf16_f32 v0, v0, v1
    v_cvt_pk_bf16_f32 v1, v2, v3
    s_waitcnt lgkmcnt(11)
    v_mfma_f32_16x16x32_bf16 v[124:127], v[56:59], v[76:79], 0
    ds_read_b64_tr_b16 v[48:49], v134 offset:0
    v_cvt_pk_bf16_f32 v2, v16, v17
    v_mfma_f32_16x16x32_bf16 v[124:127], v[60:63], v[36:39], v[124:127]
    v_cvt_pk_bf16_f32 v3, v18, v19
    ds_write_b128 v156, v[0:3] offset:32768
    v_mfma_f32_16x16x32_bf16 v[120:123], v[60:63], v[32:35], 0
    ds_read_b64_tr_b16 v[50:51], v134 offset:4096
    v_mfma_f32_16x16x32_bf16 v[120:123], v[56:59], v[72:75], v[120:123]
    v_mfma_f32_16x16x32_bf16 v[116:119], v[56:59], v[68:71], 0
    ds_read_b64_tr_b16 v[52:53], v134 offset:8192
    v_mfma_f32_16x16x32_bf16 v[116:119], v[60:63], a[36:39], v[116:119]
    s_xor_b32 s46, s57, 256
    buffer_load_dword v150, v147, s[12:15], s46 offen sc1
    v_mfma_f32_16x16x32_bf16 v[112:115], v[60:63], a[32:35], 0
    ds_read_b64_tr_b16 v[54:55], v134 offset:12288
    v_mfma_f32_16x16x32_bf16 v[112:115], v[56:59], v[64:67], v[112:115]
    s_waitcnt lgkmcnt(3)
    s_barrier
    v_mfma_f32_16x16x32_bf16 v[96:99], v[80:83], a[40:43], v[96:99]
    ds_read_b64_tr_b16 v[56:57], v135 offset:0
    s_waitcnt vmcnt(1)
    v_cmp_gt_u32 vcc, 4, v146
    s_nop 1
    s_cbranch_vccnz fused_kernel_spin_sf1
fused_kernel_ret_sf1:
    buffer_load_dwordx4 v[64:67], v158, s[12:15], s40 offen offset:0 sc1
    v_mfma_f32_16x16x32_bf16 v[96:99], v[84:87], a[48:51], v[96:99]
    buffer_load_dwordx4 v[68:71], v158, s[12:15], s40 offen offset:1024 sc1
    v_mfma_f32_16x16x32_bf16 v[100:103], v[84:87], a[52:55], v[100:103]
    ds_read_b64_tr_b16 v[58:59], v135 offset:4096
    buffer_load_dwordx4 v[72:75], v139, s[12:15], s40 offen offset:0 sc1
    v_mfma_f32_16x16x32_bf16 v[100:103], v[80:83], a[44:47], v[100:103]
    buffer_load_dwordx4 v[76:79], v139, s[12:15], s40 offen offset:1024 sc1
    v_mfma_f32_16x16x32_bf16 v[104:107], v[80:83], v[40:43], v[104:107]
    ds_read_b64_tr_b16 v[60:61], v135 offset:8192
    v_mfma_f32_16x16x32_bf16 v[104:107], v[84:87], a[0:3], v[104:107]
    v_mfma_f32_16x16x32_bf16 v[108:111], v[84:87], a[4:7], v[108:111]
    ds_read_b64_tr_b16 v[62:63], v135 offset:12288
    v_mfma_f32_16x16x32_bf16 v[108:111], v[80:83], v[44:47], v[108:111]
    v_mfma_f32_16x16x32_bf16 v[124:127], v[88:91], v[44:47], v[124:127]
    ds_read_b64_tr_b16 v[80:81], v134 offset:16384
    v_mfma_f32_16x16x32_bf16 v[124:127], v[92:95], a[4:7], v[124:127]
    v_mfma_f32_16x16x32_bf16 v[120:123], v[92:95], a[0:3], v[120:123]
    ds_read_b64_tr_b16 v[82:83], v134 offset:20480
    v_mfma_f32_16x16x32_bf16 v[120:123], v[88:91], v[40:43], v[120:123]
    v_mfma_f32_16x16x32_bf16 v[116:119], v[88:91], a[44:47], v[116:119]
    ds_read_b64_tr_b16 v[84:85], v134 offset:24576
    v_mfma_f32_16x16x32_bf16 v[116:119], v[92:95], a[52:55], v[116:119]
    v_mfma_f32_16x16x32_bf16 v[112:115], v[92:95], a[48:51], v[112:115]
    ds_read_b64_tr_b16 v[86:87], v134 offset:28672
    v_mfma_f32_16x16x32_bf16 v[112:115], v[88:91], a[40:43], v[112:115]
    s_waitcnt lgkmcnt(8)
    v_mfma_f32_16x16x32_bf16 v[96:99], v[48:51], a[56:59], v[96:99]
    ds_read_b64_tr_b16 v[88:89], v135 offset:16384
    v_mfma_f32_16x16x32_bf16 v[96:99], v[52:55], a[64:67], v[96:99]
    v_mfma_f32_16x16x32_bf16 v[100:103], v[52:55], a[68:71], v[100:103]
    ds_read_b64_tr_b16 v[90:91], v135 offset:20480
    v_mfma_f32_16x16x32_bf16 v[100:103], v[48:51], a[60:63], v[100:103]
    v_mfma_f32_16x16x32_bf16 v[104:107], v[48:51], a[8:11], v[104:107]
    ds_read_b64_tr_b16 v[92:93], v135 offset:24576
    v_mfma_f32_16x16x32_bf16 v[104:107], v[52:55], a[16:19], v[104:107]
    v_mfma_f32_16x16x32_bf16 v[108:111], v[52:55], a[20:23], v[108:111]
    ds_read_b64_tr_b16 v[94:95], v135 offset:28672
    v_mfma_f32_16x16x32_bf16 v[108:111], v[48:51], a[12:15], v[108:111]
    s_waitcnt lgkmcnt(8)
    v_mfma_f32_16x16x32_bf16 v[124:127], v[56:59], a[12:15], v[124:127]
    s_waitcnt vmcnt(4)
    v_cmp_gt_u32 vcc, 5, v150
    s_nop 1
    s_cbranch_vccnz fused_kernel_spin_sf2
fused_kernel_ret_sf2:
    buffer_load_dwordx4 v[0:3], v158, s[12:15], s41 offen offset:0 sc1
    v_mfma_f32_16x16x32_bf16 v[124:127], v[60:63], a[20:23], v[124:127]
    buffer_load_dwordx4 v[4:7], v158, s[12:15], s41 offen offset:1024 sc1
    v_mfma_f32_16x16x32_bf16 v[120:123], v[60:63], a[16:19], v[120:123]
    buffer_load_dwordx4 v[8:11], v139, s[12:15], s41 offen offset:0 sc1
    v_mfma_f32_16x16x32_bf16 v[120:123], v[56:59], a[8:11], v[120:123]
    buffer_load_dwordx4 v[12:15], v139, s[12:15], s41 offen offset:1024 sc1
    v_mfma_f32_16x16x32_bf16 v[116:119], v[56:59], a[60:63], v[116:119]
    v_mfma_f32_16x16x32_bf16 v[116:119], v[60:63], a[68:71], v[116:119]
    v_mfma_f32_16x16x32_bf16 v[112:115], v[60:63], a[64:67], v[112:115]
    v_mfma_f32_16x16x32_bf16 v[112:115], v[56:59], a[56:59], v[112:115]
    s_waitcnt lgkmcnt(4)
    v_mfma_f32_16x16x32_bf16 v[96:99], v[80:83], a[72:75], v[96:99]
    v_mfma_f32_16x16x32_bf16 v[96:99], v[84:87], a[80:83], v[96:99]
    v_mfma_f32_16x16x32_bf16 v[100:103], v[84:87], a[84:87], v[100:103]
    v_mfma_f32_16x16x32_bf16 v[100:103], v[80:83], a[76:79], v[100:103]
    v_mfma_f32_16x16x32_bf16 v[104:107], v[80:83], a[24:27], v[104:107]
    v_mfma_f32_16x16x32_bf16 v[104:107], v[84:87], a[88:91], v[104:107]
    v_mfma_f32_16x16x32_bf16 v[108:111], v[84:87], a[92:95], v[108:111]
    v_mfma_f32_16x16x32_bf16 v[108:111], v[80:83], a[28:31], v[108:111]
    s_waitcnt lgkmcnt(0)
    v_mfma_f32_16x16x32_bf16 v[124:127], v[88:91], a[28:31], v[124:127]
    v_mfma_f32_16x16x32_bf16 v[124:127], v[92:95], a[92:95], v[124:127]
    v_mfma_f32_16x16x32_bf16 v[120:123], v[92:95], a[88:91], v[120:123]
    v_mfma_f32_16x16x32_bf16 v[120:123], v[88:91], a[24:27], v[120:123]
    v_mfma_f32_16x16x32_bf16 v[116:119], v[88:91], a[76:79], v[116:119]
    buffer_load_dwordx4 v[16:19], v158, s[12:15], s42 offen offset:0 sc1
    v_mfma_f32_16x16x32_bf16 v[116:119], v[92:95], a[84:87], v[116:119]
    buffer_load_dwordx4 v[20:23], v158, s[12:15], s42 offen offset:1024 sc1
    v_mfma_f32_16x16x32_bf16 v[112:115], v[92:95], a[80:83], v[112:115]
    buffer_load_dwordx4 v[24:27], v139, s[12:15], s42 offen offset:0 sc1
    v_mfma_f32_16x16x32_bf16 v[112:115], v[88:91], a[72:75], v[112:115]
    buffer_load_dwordx4 v[28:31], v139, s[12:15], s42 offen offset:1024 sc1
    s_barrier
    ds_read_b128 v[48:51], v156 offset:49152
    ds_read_b128 v[52:55], v156 offset:50176
    ds_read_b128 v[56:59], v156 offset:51200
    ds_read_b128 v[60:63], v156 offset:52224
    s_waitcnt lgkmcnt(0)
    v_mfma_f32_16x16x32_bf16 v[96:99], v[130:133], v[48:51], v[96:99]
    v_mfma_f32_16x16x32_bf16 v[112:115], v[128:131], v[48:51], v[112:115]
    v_mfma_f32_16x16x32_bf16 v[100:103], v[130:133], v[52:55], v[100:103]
    v_mfma_f32_16x16x32_bf16 v[116:119], v[128:131], v[52:55], v[116:119]
    v_mfma_f32_16x16x32_bf16 v[104:107], v[130:133], v[56:59], v[104:107]
    v_mfma_f32_16x16x32_bf16 v[120:123], v[128:131], v[56:59], v[120:123]
    v_mfma_f32_16x16x32_bf16 v[108:111], v[130:133], v[60:63], v[108:111]
    v_mfma_f32_16x16x32_bf16 v[124:127], v[128:131], v[60:63], v[124:127]
    s_waitcnt vmcnt(8)
    v_mfma_f32_16x16x32_bf16 v[96:99], v[130:133], v[64:67], v[96:99]
    v_mfma_f32_16x16x32_bf16 v[112:115], v[128:131], v[64:67], v[112:115]
    v_mfma_f32_16x16x32_bf16 v[100:103], v[130:133], v[68:71], v[100:103]
    v_mfma_f32_16x16x32_bf16 v[116:119], v[128:131], v[68:71], v[116:119]
    v_mfma_f32_16x16x32_bf16 v[104:107], v[130:133], v[72:75], v[104:107]
    v_mfma_f32_16x16x32_bf16 v[120:123], v[128:131], v[72:75], v[120:123]
    v_mfma_f32_16x16x32_bf16 v[108:111], v[130:133], v[76:79], v[108:111]
    v_mfma_f32_16x16x32_bf16 v[124:127], v[128:131], v[76:79], v[124:127]
    s_waitcnt vmcnt(4)
    v_mfma_f32_16x16x32_bf16 v[96:99], v[130:133], v[0:3], v[96:99]
    v_mfma_f32_16x16x32_bf16 v[112:115], v[128:131], v[0:3], v[112:115]
    v_mfma_f32_16x16x32_bf16 v[100:103], v[130:133], v[4:7], v[100:103]
    v_mfma_f32_16x16x32_bf16 v[116:119], v[128:131], v[4:7], v[116:119]
    v_mfma_f32_16x16x32_bf16 v[104:107], v[130:133], v[8:11], v[104:107]
    v_mfma_f32_16x16x32_bf16 v[120:123], v[128:131], v[8:11], v[120:123]
    v_mfma_f32_16x16x32_bf16 v[108:111], v[130:133], v[12:15], v[108:111]
    v_mfma_f32_16x16x32_bf16 v[124:127], v[128:131], v[12:15], v[124:127]
    s_waitcnt vmcnt(0)
    v_max3_u32 v150, v16, v17, v18
    v_max3_u32 v151, v19, v20, v21
    v_max3_u32 v151, v151, v22, v23
    v_max3_u32 v150, v150, v24, v25
    v_max3_u32 v151, v151, v26, v27
    v_max3_u32 v150, v150, v28, v29
    v_max3_u32 v151, v151, v30, v31
    v_max_u32 v150, v150, v151
    v_cmp_eq_u32 vcc, -1, v150
    s_nop 1
    s_cbranch_vccnz fused_kernel_rx3
fused_kernel_rxr3:
    v_mfma_f32_16x16x32_bf16 v[96:99], v[130:133], v[16:19], v[96:99]
    v_mfma_f32_16x16x32_bf16 v[112:115], v[128:131], v[16:19], v[112:115]
    v_mfma_f32_16x16x32_bf16 v[100:103], v[130:133], v[20:23], v[100:103]
    v_mfma_f32_16x16x32_bf16 v[116:119], v[128:131], v[20:23], v[116:119]
    v_mfma_f32_16x16x32_bf16 v[104:107], v[130:133], v[24:27], v[104:107]
    v_mfma_f32_16x16x32_bf16 v[120:123], v[128:131], v[24:27], v[120:123]
    v_mfma_f32_16x16x32_bf16 v[108:111], v[130:133], v[28:31], v[108:111]
    v_mfma_f32_16x16x32_bf16 v[124:127], v[128:131], v[28:31], v[124:127]
    s_nop 0
    v_mul_f32 v96, v96, v152
    v_mul_f32 v112, v112, v152
    v_mul_f32 v97, v97, v152
    v_mul_f32 v113, v113, v152
    v_mul_f32 v98, v98, v152
    v_mul_f32 v114, v114, v152
    v_mul_f32 v99, v99, v152
    v_mul_f32 v115, v115, v152
    v_cvt_pk_bf16_f32 v96, v96, v97
    v_cvt_pk_bf16_f32 v97, v98, v99
    v_cvt_pk_bf16_f32 v98, v112, v113
    v_cvt_pk_bf16_f32 v99, v114, v115
    s_nop 0
    v_permlane16_swap_b32 v96, v98
    v_permlane16_swap_b32 v97, v99
    buffer_store_dwordx4 v[96:99], v138, s[8:11], s60 offen
    v_mul_f32 v100, v100, v153
    v_mul_f32 v116, v116, v153
    v_mul_f32 v101, v101, v153
    v_mul_f32 v117, v117, v153
    v_mul_f32 v102, v102, v153
    v_mul_f32 v118, v118, v153
    v_mul_f32 v103, v103, v153
    v_mul_f32 v119, v119, v153
    v_cvt_pk_bf16_f32 v100, v100, v101
    v_cvt_pk_bf16_f32 v101, v102, v103
    v_cvt_pk_bf16_f32 v102, v116, v117
    v_cvt_pk_bf16_f32 v103, v118, v119
    s_nop 0
    v_permlane16_swap_b32 v100, v102
    v_permlane16_swap_b32 v101, v103
    buffer_store_dwordx4 v[100:103], v138, s[8:11], s61 offen
    v_mul_f32 v104, v104, v154
    v_mul_f32 v120, v120, v154
    v_mul_f32 v105, v105, v154
    v_mul_f32 v121, v121, v154
    v_mul_f32 v106, v106, v154
    v_mul_f32 v122, v122, v154
    v_mul_f32 v107, v107, v154
    v_mul_f32 v123, v123, v154
    v_cvt_pk_bf16_f32 v104, v104, v105
    v_cvt_pk_bf16_f32 v105, v106, v107
    v_cvt_pk_bf16_f32 v106, v120, v121
    v_cvt_pk_bf16_f32 v107, v122, v123
    s_nop 0
    v_permlane16_swap_b32 v104, v106
    v_permlane16_swap_b32 v105, v107
    buffer_store_dwordx4 v[104:107], v138, s[8:11], s88 offen
    v_mul_f32 v108, v108, v155
    v_mul_f32 v124, v124, v155
    v_mul_f32 v109, v109, v155
    v_mul_f32 v125, v125, v155
    v_mul_f32 v110, v110, v155
    v_mul_f32 v126, v126, v155
    v_mul_f32 v111, v111, v155
    v_mul_f32 v127, v127, v155
    v_cvt_pk_bf16_f32 v108, v108, v109
    v_cvt_pk_bf16_f32 v109, v110, v111
    v_cvt_pk_bf16_f32 v110, v124, v125
    v_cvt_pk_bf16_f32 v111, v126, v127
    s_nop 0
    v_permlane16_swap_b32 v108, v110
    v_permlane16_swap_b32 v109, v111
    buffer_store_dwordx4 v[108:111], v138, s[8:11], s89 offen
fused_kernel_end:
    s_endpgm
fused_kernel_sfh1:
    buffer_store_dword v151, v148, s[12:15], s57 offen offset:0 sc1
    s_branch fused_kernel_sfrh1
fused_kernel_sfh2:
    buffer_store_dword v151, v148, s[12:15], s57 offen offset:0 sc1
    s_branch fused_kernel_sfrh2
fused_kernel_sfh3:
    buffer_store_dword v151, v148, s[12:15], s57 offen offset:0 sc1
    s_branch fused_kernel_sfrh3
fused_kernel_spin_h3:
    s_mov_b32 s93, 0
fused_kernel_spinl_h3:
    s_sleep 1
    buffer_load_dword v150, v149, s[12:15], s58 offen offset:0 sc1
    s_add_u32 s93, s93, 1
    s_waitcnt vmcnt(0)
    v_cmp_gt_u32 vcc, 1, v150
    s_cmp_gt_u32 s93, 0x40000
    s_cbranch_scc1 fused_kernel_ret_h3
    s_nop 1
    s_cbranch_vccnz fused_kernel_spinl_h3
    s_branch fused_kernel_ret_h3
fused_kernel_spin_h10:
    s_mov_b32 s93, 0
fused_kernel_spinl_h10:
    s_sleep 1
    buffer_load_dword v150, v149, s[12:15], s58 offen offset:0 sc1
    s_add_u32 s93, s93, 1
    s_waitcnt vmcnt(0)
    v_cmp_gt_u32 vcc, 2, v150
    s_cmp_gt_u32 s93, 0x40000
    s_cbranch_scc1 fused_kernel_ret_h10
    s_nop 1
    s_cbranch_vccnz fused_kernel_spinl_h10
    s_branch fused_kernel_ret_h10
fused_kernel_spin_h17:
    s_mov_b32 s93, 0
fused_kernel_spinl_h17:
    s_sleep 1
    buffer_load_dword v150, v149, s[12:15], s58 offen offset:0 sc1
    s_add_u32 s93, s93, 1
    s_waitcnt vmcnt(0)
    v_cmp_gt_u32 vcc, 3, v150
    s_cmp_gt_u32 s93, 0x40000
    s_cbranch_scc1 fused_kernel_ret_h17
    s_nop 1
    s_cbranch_vccnz fused_kernel_spinl_h17
    s_branch fused_kernel_ret_h17
fused_kernel_spin_rdy:
    s_mov_b32 s93, 0
fused_kernel_spinl_rdy:
    s_sleep 1
    buffer_load_dword v149, v157, s[12:15], s45 offen offset:1536 sc1
    s_add_u32 s93, s93, 1
    s_waitcnt vmcnt(0)
    v_cmp_gt_u32 vcc, 1, v149
    s_cmp_gt_u32 s93, 0x40000
    s_cbranch_scc1 fused_kernel_ret_rdy
    s_nop 1
    s_cbranch_vccnz fused_kernel_spinl_rdy
    s_branch fused_kernel_ret_rdy
fused_kernel_spin_g:
    s_mov_b32 s93, 0
fused_kernel_spinl_g:
    s_sleep 1
    buffer_load_dword v150, v146, s[36:39], 0 offen offset:0 sc1
    s_add_u32 s93, s93, 1
    s_waitcnt vmcnt(0)
    v_cmp_ne_u32 vcc, s33, v150
    s_cmp_gt_u32 s93, 0x40000
    s_cbranch_scc1 fused_kernel_ret_g
    s_nop 1
    s_cbranch_vccnz fused_kernel_spinl_g
    s_branch fused_kernel_ret_g
fused_kernel_zf2:
    s_nop 3
    v_mov_b32 v128, 0
    v_mov_b32 v129, 0
    v_mov_b32 v130, 0
    v_mov_b32 v131, 0
    s_nop 1
    s_branch fused_kernel_zfr2
fused_kernel_zf4:
    s_nop 3
    v_mov_b32 v128, 0
    v_mov_b32 v129, 0
    v_mov_b32 v130, 0
    v_mov_b32 v131, 0
    s_nop 1
    s_branch fused_kernel_zfr4
fused_kernel_zf6:
    s_nop 3
    v_mov_b32 v128, 0
    v_mov_b32 v129, 0
    v_mov_b32 v130, 0
    v_mov_b32 v131, 0
    s_nop 1
    s_branch fused_kernel_zfr6
fused_kernel_zf10:
    s_nop 3
    v_mov_b32 v128, 0
    v_mov_b32 v129, 0
    v_mov_b32 v130, 0
    v_mov_b32 v131, 0
    s_nop 1
    s_branch fused_kernel_zfr10
fused_kernel_zf12:
    s_nop 3
    v_mov_b32 v128, 0
    v_mov_b32 v129, 0
    v_mov_b32 v130, 0
    v_mov_b32 v131, 0
    s_nop 1
    s_branch fused_kernel_zfr12
fused_kernel_zf14:
    s_nop 3
    v_mov_b32 v128, 0
    v_mov_b32 v129, 0
    v_mov_b32 v130, 0
    v_mov_b32 v131, 0
    s_nop 1
    s_branch fused_kernel_zfr14
fused_kernel_sfkv:
    buffer_store_dword v151, v148, s[8:11], s57 offen offset:512 sc1
    s_branch fused_kernel_sfrkv
fused_kernel_spin_kv:
    s_mov_b32 s93, 0
fused_kernel_spinl_kv:
    s_sleep 1
    buffer_load_dword v146, v147, s[12:15], s49 offen offset:0 sc1
    s_add_u32 s93, s93, 1
    s_waitcnt vmcnt(0)
    v_cmp_gt_u32 vcc, s50, v146
    s_cmp_gt_u32 s93, 0x40000
    s_cbranch_scc1 fused_kernel_ret_kv
    s_nop 1
    s_cbranch_vccnz fused_kernel_spinl_kv
    s_branch fused_kernel_ret_kv
fused_kernel_sfo0:
    buffer_store_dword v151, v148, s[12:15], s57 offen offset:1024 sc1
    s_branch fused_kernel_sfro0
fused_kernel_spin_ao0:
    s_mov_b32 s93, 0
fused_kernel_spinl_ao0:
    s_sleep 1
    buffer_load_dword v150, v149, s[12:15], s58 offen offset:1024 sc1
    s_add_u32 s93, s93, 1
    s_waitcnt vmcnt(0)
    v_cmp_gt_u32 vcc, 1, v150
    s_cmp_gt_u32 s93, 0x40000
    s_cbranch_scc1 fused_kernel_ret_ao0
    s_nop 1
    s_cbranch_vccnz fused_kernel_spinl_ao0
    s_branch fused_kernel_ret_ao0
fused_kernel_sfo:
    buffer_store_dword v151, v148, s[12:15], s57 offen offset:1024 sc1
    s_branch fused_kernel_sfro
fused_kernel_spin_ao:
    s_mov_b32 s93, 0
fused_kernel_spinl_ao:
    s_sleep 1
    buffer_load_dword v150, v149, s[12:15], s58 offen offset:1024 sc1
    s_add_u32 s93, s93, 1
    s_waitcnt vmcnt(0)
    v_cmp_gt_u32 vcc, 2, v150
    s_cmp_gt_u32 s93, 0x40000
    s_cbranch_scc1 fused_kernel_ret_ao
    s_nop 1
    s_cbranch_vccnz fused_kernel_spinl_ao
    s_branch fused_kernel_ret_ao
fused_kernel_spin_sf1:
    s_mov_b32 s93, 0
fused_kernel_spinl_sf1:
    s_sleep 1
    buffer_load_dword v146, v147, s[12:15], s45 offen offset:0 sc1
    s_add_u32 s93, s93, 1
    s_waitcnt vmcnt(0)
    v_cmp_gt_u32 vcc, 4, v146
    s_cmp_gt_u32 s93, 0x40000
    s_cbranch_scc1 fused_kernel_ret_sf1
    s_nop 1
    s_cbranch_vccnz fused_kernel_spinl_sf1
    s_branch fused_kernel_ret_sf1
fused_kernel_spin_sf2:
    s_mov_b32 s93, 0
fused_kernel_spinl_sf2:
    s_sleep 1
    buffer_load_dword v150, v147, s[12:15], s46 offen offset:0 sc1
    s_add_u32 s93, s93, 1
    s_waitcnt vmcnt(0)
    v_cmp_gt_u32 vcc, 5, v150
    s_cmp_gt_u32 s93, 0x40000
    s_cbranch_scc1 fused_kernel_ret_sf2
    s_nop 1
    s_cbranch_vccnz fused_kernel_spinl_sf2
    s_branch fused_kernel_ret_sf2
fused_kernel_rx3:
    s_mov_b32 s93, 0
fused_kernel_rxl3:
    s_sleep 1
    buffer_load_dwordx4 v[16:19], v158, s[12:15], s42 offen offset:0 sc1
    buffer_load_dwordx4 v[20:23], v158, s[12:15], s42 offen offset:1024 sc1
    buffer_load_dwordx4 v[24:27], v139, s[12:15], s42 offen offset:0 sc1
    buffer_load_dwordx4 v[28:31], v139, s[12:15], s42 offen offset:1024 sc1
    s_add_u32 s93, s93, 1
    s_waitcnt vmcnt(0)
    v_max3_u32 v150, v16, v17, v18
    v_max3_u32 v151, v19, v20, v21
    v_max3_u32 v151, v151, v22, v23
    v_max3_u32 v150, v150, v24, v25
    v_max3_u32 v151, v151, v26, v27
    v_max3_u32 v150, v150, v28, v29
    v_max3_u32 v151, v151, v30, v31
    v_max_u32 v150, v150, v151
    v_cmp_eq_u32 vcc, -1, v150
    s_cmp_gt_u32 s93, 0x40000
    s_cbranch_scc1 fused_kernel_rxr3
    s_nop 1
    s_cbranch_vccnz fused_kernel_rxl3
    s_branch fused_kernel_rxr3
fused_kernel_last:
.section .rodata,"a"
.p2align 6
.amdhsa_kernel fused_kernel
  .amdhsa_next_free_vgpr 256
  .amdhsa_next_free_sgpr 102
  .amdhsa_accum_offset 160
  .amdhsa_group_segment_fixed_size 0
  .amdhsa_kernarg_size 80
  .amdhsa_user_sgpr_count 2
  .amdhsa_user_sgpr_kernarg_segment_ptr 1
  .amdhsa_system_sgpr_workgroup_id_x 1
.end_amdhsa_kernel
```
